```python
import torch

def _softmax(x, axis=-1):
    return torch.softmax(x, dim=axis)

def _gelu(x):
    return torch.nn.functional.gelu(x, approximate='tanh')

def _silu(x):
    return torch.nn.functional.silu(x)

def _sigmoid(x):
    return torch.sigmoid(x)

def _layernorm(x, axis=-1, eps=1e-05):
    m = x.mean(dim=axis, keepdim=True)
    v = x.var(dim=axis, keepdim=True, unbiased=False)
    return (x - m) / torch.sqrt(v + eps)

def _scatter_add(tgt, idx, src, axis=0):
    return tgt.clone().index_add_(axis, idx, src)

def _segment_sum(src, seg, n):
    out = torch.zeros((n,) + src.shape[1:], dtype=src.dtype)
    return out.index_add_(0, seg, src)

def _pad(x, pw):
    flat = tuple((v for pair in reversed(pw) for v in pair))
    return torch.nn.functional.pad(x, flat)
kernel_name = 'standalone__varlen_attn_packed__ragged'

def setup_inputs():

    _w = lambda a: (lambda t: t.to(torch.bfloat16) if t.is_floating_point() else t)(torch.as_tensor(a))
    cu = torch.tensor([0, 321, 555, 878, 1299, 1551, 1670, 1878, 2181, 2351, 2646, 2810, 3248, 3471, 3811, 4169, 4391], dtype=torch.int64)
    T, H, D = (int(cu[-1]), 16, 128)
    return {'q': _w((lambda *s: torch.randn(*s, dtype=torch.bfloat16) * 0.8)(T, H, D)), 'k': _w((lambda *s: torch.randn(*s, dtype=torch.bfloat16) * 0.8)(T, H, D)), 'v': _w((lambda *s: torch.randn(*s, dtype=torch.bfloat16) * 0.05)(T, H, D)), 'cu': _w(cu)}

def reference(q, k, v, cu):
    T, H, D = q.shape
    out = torch.zeros_like(q)
    scale = D ** (-0.5)
    outs = []
    for i in range(len(cu) - 1):
        s, e = (int(cu[i]), int(cu[i + 1]))
        qi, ki, vi = (q[s:e].clone(), k[s:e].clone(), v[s:e].clone())
        p = _softmax(torch.einsum('qhd,khd->hqk', qi, ki) * scale, axis=-1)
        outs.append(torch.einsum('hqk,khd->qhd', p, vi))
    return torch.concatenate(outs, axis=0)
```

```asm
; @launch grid=(256,1,1) block=(768,1,1) lds=155600
.amdgcn_target "amdgcn-amd-amdhsa--gfx950"
.text
.globl standalone__varlen_attn_packed__ragged_kernel
.p2align 8
.type standalone__varlen_attn_packed__ragged_kernel,@function
standalone__varlen_attn_packed__ragged_kernel:
    s_cmp_ge_u32 s2, 256
    s_cbranch_scc1 END
    v_lshrrev_b32 v1, 6, v0
    s_getpc_b64 s[12:13]
PCREF:
    s_load_dwordx4 s[4:7], s[0:1], 0
    v_readfirstlane_b32 s14, v1
    s_load_dwordx2 s[8:9], s[0:1], 16
    s_and_b32 s3, s2, 7
    s_bitcmp1_b32 0x48, s3
    s_cselect_b32 s3, 5, 0
    s_xor_b32 s2, s2, s3
    s_lshr_b32 s3, s2, 4
    s_and_b32 s15, s2, 1
    s_lshl2_add_u32 s3, s3, s15
    s_bfe_u32 s15, s2, 0x10002
    s_lshl1_add_u32 s3, s15, s3
    s_mul_i32 s3, s3, 3072
    s_lshl_b32 s15, s14, 8
    s_add_u32 s3, s3, s15
    s_add_u32 s3, s3, TABLE-PCREF
    s_add_u32 s12, s12, s3
    s_addc_u32 s13, s13, 0
    s_load_dwordx16 s[36:51], s[12:13], 0
    s_load_dwordx16 s[52:67], s[12:13], 64
    s_load_dwordx16 s[68:83], s[12:13], 128
    s_load_dwordx16 s[84:99], s[12:13], 192
    s_load_dwordx2 s[10:11], s[0:1], 32
    s_lshr_b32 s16, s2, 1
    s_and_b32 s16, s16, 4
    s_xor_b32 s15, s2, s16
    s_and_b32 s15, s15, 7
    s_lshl_b32 s15, s15, 9
    v_and_b32 v0, 63, v0
    s_cmp_ge_u32 s14, 2
    s_cbranch_scc1 CONSUMER
LOADER:
    s_setprio 0
    s_and_b32 s20, s14, 1
    s_lshl_b32 s23, s20, 24
    v_mov_b32 v2, s23
    v_lshlrev_b32 v3, 4, v0
    v_lshl_add_u32 v3, s20, 2, v3
    v_add_u32 v3, 155136, v3
    v_bfe_u32 v5, v0, 4, 1
    s_mov_b64 exec, 0xfff
    ds_write_b32 v3, v2
    s_mov_b64 exec, -1
    v_and_b32 v4, 15, v0
    v_add_u32 v6, 4, v4
    v_subrev_u32 v7, 7, v4
    v_cmp_gt_u32 vcc, 8, v4
    v_mov_b32 v24, 0
    v_cndmask_b32 v4, v7, v6, vcc
    v_lshlrev_b32 v4, 4, v4
    v_add_u32 v4, 155144, v4
    v_mov_b32 v18, 0x2000000
    v_and_b32 v6, 15, v0
    v_lshrrev_b32 v7, 5, v0
    v_lshlrev_b32 v7, 16, v7
    v_lshl_add_u32 v7, v5, 12, v7
    v_lshl_add_u32 v8, v6, 4, v7
    v_add_u32 v9, 7136, v8
    v_add_u32 v10, 14272, v8
    v_add_u32 v11, 21408, v8
    v_add_u32 v12, 0x8000, v8
    v_add_u32 v13, 0x8000, v9
    v_add_u32 v14, 0x8000, v10
    v_add_u32 v15, 0x8000, v11
    s_mov_b32 s22, 0
    s_mov_b32 s27, 0x40000
    s_mov_b32 s33, 0
    s_mov_b32 s13, 0
    s_waitcnt lgkmcnt(0)
    s_mov_b32 m0, 0
    s_mov_b32 s19, 0x00020000
S_NEXT:
    s_movrels_b64 s[24:25], s[36:37]
    s_bfe_u32 s12, s25, 0x30002
    s_cmp_ge_u32 s22, s12
    s_cbranch_scc1 L_FIRST
    s_lshr_b32 s28, s25, 25
    s_and_b32 s24, s24, 0x01fff900
    s_mul_i32 s28, s28, 8416
    s_and_b32 s18, s25, 0x01fff000
    s_xor_b32 s24, s24, s15
    s_and_b32 s29, s25, 0x200
    s_add_u32 m0, s28, 20480
    s_xor_b32 s24, s24, s29
    s_bitcmp1_b32 s25, 1
    s_cselect_b64 s[16:17], s[6:7], s[4:5]
    s_bitcmp1_b32 s25, 0
    s_cselect_b64 s[16:17], s[8:9], s[16:17]
    s_bitcmp1_b32 s25, 6
    s_cbranch_scc1 S_X
    buffer_load_dwordx4 v8, s[16:19], s24 offen offset:0 lds
    buffer_load_dwordx4 v9, s[16:19], s24 offen offset:1056 lds
    buffer_load_dwordx4 v10, s[16:19], s24 offen offset:2112 lds
    buffer_load_dwordx4 v11, s[16:19], s24 offen offset:3168 lds
    s_add_u32 m0, s28, 24704
    s_nop 0
    buffer_load_dwordx4 v12, s[16:19], s24 offen offset:0 lds
    buffer_load_dwordx4 v13, s[16:19], s24 offen offset:1056 lds
    buffer_load_dwordx4 v14, s[16:19], s24 offen offset:2112 lds
    buffer_load_dwordx4 v15, s[16:19], s24 offen offset:3168 lds
S_DONE:
    s_add_u32 s20, s20, 2
    s_add_u32 s22, s22, 1
    s_and_b32 m0, s20, -2
    s_branch S_NEXT
S_X:
    buffer_load_dwordx4 v8, s[16:19], s24 offen offset:0 nt lds
    buffer_load_dwordx4 v9, s[16:19], s24 offen offset:1056 nt lds
    buffer_load_dwordx4 v10, s[16:19], s24 offen offset:2112 nt lds
    buffer_load_dwordx4 v11, s[16:19], s24 offen offset:3168 nt lds
    s_add_u32 m0, s28, 24704
    s_nop 0
    buffer_load_dwordx4 v12, s[16:19], s24 offen offset:0 nt lds
    buffer_load_dwordx4 v13, s[16:19], s24 offen offset:1056 nt lds
    buffer_load_dwordx4 v14, s[16:19], s24 offen offset:2112 nt lds
    buffer_load_dwordx4 v15, s[16:19], s24 offen offset:3168 nt lds
    s_branch S_DONE
L_FIRST:
    s_barrier
    s_branch L_WAIT
L_NEXT:
    s_movrels_b64 s[24:25], s[36:37]
    s_bfe_u32 s12, s25, 0x30002
    s_cmp_lt_u32 s22, s12
    s_cbranch_scc1 L_CHK
L_WAIT:
    s_cmp_eq_u32 s22, 3
    s_cbranch_scc0 L_W2
    s_waitcnt vmcnt(16)
L_PUB:
    s_mov_b64 exec, 0xffc
    ds_add_u32 v3, v18
    s_mov_b64 exec, -1
    s_sub_u32 s22, s22, 1
    s_cmp_ge_u32 s22, s12
    s_cbranch_scc1 L_WAIT
L_CHK:
    s_and_b32 s26, s24, 0x6ff
    s_cbranch_scc0 L_ISSUE
    s_setprio 3
    s_lshr_b32 s21, s24, 25
    v_cmp_gt_u32 vcc, s21, v24
    s_setprio 0
    s_and_b32 s3, vcc_lo, s26
    s_cbranch_scc0 L_ISSUE
L_POLL:
    ds_read_b32 v24, v4
    s_setprio 3
    s_waitcnt lgkmcnt(0)
    v_cmp_gt_u32 vcc, s21, v24
    s_setprio 0
    s_and_b32 s3, vcc_lo, s26
    s_cbranch_scc1 L_FAIL
L_ISSUE:
    s_lshr_b32 s28, s25, 25
    s_and_b32 s24, s24, 0x01fff900
    s_mul_i32 s28, s28, 8416
    s_and_b32 s18, s25, 0x01fff000
    s_xor_b32 s24, s24, s15
    s_and_b32 s29, s25, 0x200
    s_add_u32 m0, s28, 20480
    s_xor_b32 s24, s24, s29
    s_bitcmp1_b32 s25, 1
    s_cselect_b64 s[16:17], s[6:7], s[4:5]
    s_bitcmp1_b32 s25, 0
    s_cselect_b64 s[16:17], s[8:9], s[16:17]
    s_bitcmp1_b32 s25, 6
    s_cbranch_scc1 L_X
    buffer_load_dwordx4 v8, s[16:19], s24 offen offset:0 lds
    buffer_load_dwordx4 v9, s[16:19], s24 offen offset:1056 lds
    buffer_load_dwordx4 v10, s[16:19], s24 offen offset:2112 lds
    buffer_load_dwordx4 v11, s[16:19], s24 offen offset:3168 lds
    s_add_u32 m0, s28, 24704
    s_nop 0
    buffer_load_dwordx4 v12, s[16:19], s24 offen offset:0 lds
    buffer_load_dwordx4 v13, s[16:19], s24 offen offset:1056 lds
    buffer_load_dwordx4 v14, s[16:19], s24 offen offset:2112 lds
    buffer_load_dwordx4 v15, s[16:19], s24 offen offset:3168 lds
L_DONE:
    s_add_u32 s20, s20, 2
    s_add_u32 s22, s22, 1
    s_and_b32 m0, s20, -2
    s_branch L_NEXT
L_X:
    buffer_load_dwordx4 v8, s[16:19], s24 offen offset:0 nt lds
    buffer_load_dwordx4 v9, s[16:19], s24 offen offset:1056 nt lds
    buffer_load_dwordx4 v10, s[16:19], s24 offen offset:2112 nt lds
    buffer_load_dwordx4 v11, s[16:19], s24 offen offset:3168 nt lds
    s_add_u32 m0, s28, 24704
    s_nop 0
    buffer_load_dwordx4 v12, s[16:19], s24 offen offset:0 nt lds
    buffer_load_dwordx4 v13, s[16:19], s24 offen offset:1056 nt lds
    buffer_load_dwordx4 v14, s[16:19], s24 offen offset:2112 nt lds
    buffer_load_dwordx4 v15, s[16:19], s24 offen offset:3168 nt lds
    s_branch L_DONE
L_FAIL:
    s_lshl_b32 s13, s22, 3
    s_mov_b32 s29, 2
L_F1:
    s_getreg_b32 s3, hwreg(HW_REG_IB_STS)
    s_bfe_u32 s30, s3, 0x20016
    s_and_b32 s3, s3, 15
    s_lshl4_add_u32 s3, s30, s3
    s_add_u32 s3, s3, 8
    s_cmp_le_u32 s3, s13
    s_cbranch_scc1 L_WAIT
    s_sleep 1
    s_sub_u32 s29, s29, 1
    s_cbranch_scc0 L_F1
    s_sub_u32 s27, s27, 1
    s_cbranch_scc0 L_POLL
    s_branch END
L_W2:
    s_cmp_eq_u32 s22, 2
    s_cbranch_scc0 L_W1
    s_waitcnt vmcnt(8)
    s_branch L_PUB
L_W4:
    s_cmp_eq_u32 s22, 4
    s_cbranch_scc0 L_W5
    s_waitcnt vmcnt(24)
    s_branch L_PUB
L_W5:
    s_cmp_eq_u32 s22, 5
    s_cbranch_scc0 L_W6
    s_waitcnt vmcnt(32)
    s_branch L_PUB
L_W6:
    s_waitcnt vmcnt(40)
    s_branch L_PUB
L_W1:
    s_cmp_gt_u32 s22, 3
    s_cbranch_scc1 L_W4
    s_cmp_eq_u32 s22, 0
    s_cbranch_scc1 L_END
    s_waitcnt vmcnt(0)
    s_branch L_PUB
L_END:
    s_endpgm
CONSUMER:
    s_cmp_ge_u32 s2, 16
    s_cbranch_scc1 L2W_X
    s_cmp_lg_u32 s14, 2
    s_cbranch_scc1 L2W_X
    s_getpc_b64 s[16:17]
    v_lshlrev_b32 v1, 7, v0
    v_add_u32 v2, 0x2000, v1
    global_load_dword v112, v1, s[16:17] offset:-1024
    global_load_dword v113, v2, s[16:17] offset:-1024
L2W_X:
    s_lshl_b32 s3, s14, 4
    s_add_u32 s3, s3, 155136
    v_lshlrev_b32 v166, 2, v0
    v_and_b32 v166, -8, v166
    v_add_u32 v166, 155328, v166
    v_and_b32 v1, 7, v0
    v_bfe_u32 v2, v0, 3, 1
    v_writelane_b32 v166, s3, 0
    v_lshrrev_b32 v3, 4, v0
    v_mul_u32_u24 v160, 1056, v1
    v_lshl_add_u32 v160, v2, 8, v160
    v_lshl_add_u32 v160, v3, 4, v160
    v_bfe_u32 v4, v0, 2, 3
    v_lshrrev_b32 v5, 5, v0
    v_and_b32 v6, 3, v0
    v_mul_u32_u24 v161, 1056, v4
    v_lshl_add_u32 v161, v5, 8, v161
    v_lshl_add_u32 v161, v6, 3, v161
    s_mul_i32 s3, s14, 2048
    s_add_u32 s3, s3, -4096
    s_mov_b32 s13, s3
    s_mov_b32 s26, 0xff800000
    s_mov_b32 s16, 0x3e0293ee
    s_mov_b32 s17, 0xffff0000
    s_mov_b32 s18, 0x4b800000
    s_mov_b32 s19, 0
    s_mov_b32 s20, 0x40000
    s_mov_b32 m0, 0
    s_waitcnt lgkmcnt(0)
    s_lshr_b32 s3, s41, 24
    v_mov_b32 v164, s3
    s_mov_b32 s7, 0x00020000
    ds_write_b32 v166, v164 offset:8
    s_waitcnt lgkmcnt(0)
    s_barrier
    s_waitcnt vmcnt(0)
TASK:
    s_movrels_b64 s[28:29], s[36:37]
    s_movrels_b64 s[30:31], s[38:39]
    s_movrels_b64 s[32:33], s[40:41]
    s_movrels_b64 s[24:25], s[42:43]
    s_add_u32 m0, m0, 8
    s_cmp_eq_u32 s29, 0
    s_cbranch_scc1 C_END
    s_bitcmp1_b32 s33, 8
    s_cbranch_scc1 BODY_B
    v_mov_b32 v112, 0
    v_mov_b32 v113, 0
    v_mov_b32 v114, 0
    v_mov_b32 v115, 0
    v_mov_b32 v162, 0
    v_mov_b32 v152, 0x7f800000
    v_mov_b32 v163, 0
    v_mov_b32 v156, 0x7f800000
    s_lshr_b32 s21, s32, 24
    s_and_b32 s22, s33, 0xff
    v_mad_i32_i24 v116, s31, 1, v160
    v_mad_i32_i24 v160, s32, 1, v160
    v_add_u32 v161, s25, v161
    s_mov_b32 s23, 1
    v_mfma_f32_32x32x16_bf16 v[0:15], v[112:115], v[112:115], 0
    v_mfma_f32_32x32x16_bf16 v[16:31], v[112:115], v[112:115], 0
    v_mfma_f32_32x32x16_bf16 v[32:47], v[112:115], v[112:115], 0
    v_mfma_f32_32x32x16_bf16 v[48:63], v[112:115], v[112:115], 0
    s_cmp_gt_u32 s19, s31
    s_cbranch_scc1 POLLOK_T
POLL_T:
    ds_read_b64 v[96:97], v166
    s_waitcnt lgkmcnt(0)
    v_min_u32 v96, v96, v97
    s_sub_u32 s20, s20, 1
    s_cbranch_scc1 END
    v_readfirstlane_b32 s19, v96
    s_cmp_gt_u32 s19, s31
    s_cbranch_scc1 POLLOK_T
    s_sleep 1
    s_branch POLL_T
POLLOK_T:
    s_setprio 3
    ds_read_b128 v[64:67], v116 offset:0
    ds_read_b128 v[80:83], v116 offset:512
    ds_read_b128 v[68:71], v116 offset:64
    ds_read_b128 v[84:87], v116 offset:576
    ds_read_b128 v[72:75], v116 offset:128
    ds_read_b128 v[88:91], v116 offset:640
    ds_read_b128 v[76:79], v116 offset:192
    ds_read_b128 v[92:95], v116 offset:704
    ds_read_b128 v[120:123], v160 offset:0
    ds_read_b128 v[124:127], v160 offset:512
    ds_read_b128 v[128:131], v160 offset:64
    ds_read_b128 v[132:135], v160 offset:576
    ds_read_b128 v[136:139], v160 offset:128
    ds_read_b128 v[140:143], v160 offset:640
    s_waitcnt lgkmcnt(13)
    v_lshlrev_b32 v112, 16, v64
    v_and_b32 v113, s17, v64
    v_lshlrev_b32 v114, 16, v65
    v_and_b32 v115, s17, v65
    v_mul_f32 v112, s16, v112
    v_mul_f32 v113, s16, v113
    v_lshlrev_b32 v116, 16, v66
    v_and_b32 v117, s17, v66
    v_mul_f32 v114, s16, v114
    v_mul_f32 v115, s16, v115
    v_cvt_pk_bf16_f32 v64, v112, v113
    v_lshlrev_b32 v118, 16, v67
    v_and_b32 v119, s17, v67
    v_mul_f32 v116, s16, v116
    v_mul_f32 v117, s16, v117
    v_cvt_pk_bf16_f32 v65, v114, v115
    s_waitcnt lgkmcnt(12)
    ds_read_b128 v[144:147], v160 offset:192
    ds_read_b128 v[148:151], v160 offset:704
    v_lshlrev_b32 v112, 16, v80
    v_and_b32 v113, s17, v80
    v_mul_f32 v118, s16, v118
    v_mul_f32 v119, s16, v119
    v_cvt_pk_bf16_f32 v66, v116, v117
    v_lshlrev_b32 v114, 16, v81
    v_and_b32 v115, s17, v81
    v_mul_f32 v112, s16, v112
    v_mul_f32 v113, s16, v113
    v_cvt_pk_bf16_f32 v67, v118, v119
    v_lshlrev_b32 v116, 16, v82
    v_and_b32 v117, s17, v82
    s_waitcnt lgkmcnt(7)
    v_mfma_f32_16x16x32_bf16 v[96:99], v[120:123], v[64:67], 0
    v_mul_f32 v114, s16, v114
    v_mul_f32 v115, s16, v115
    v_cvt_pk_bf16_f32 v80, v112, v113
    v_lshlrev_b32 v118, 16, v83
    s_waitcnt lgkmcnt(6)
    v_mfma_f32_16x16x32_bf16 v[100:103], v[124:127], v[64:67], 0
    v_and_b32 v119, s17, v83
    v_mul_f32 v116, s16, v116
    v_mul_f32 v117, s16, v117
    v_cvt_pk_bf16_f32 v81, v114, v115
    v_lshlrev_b32 v112, 16, v68
    v_and_b32 v113, s17, v68
    v_mul_f32 v118, s16, v118
    v_mul_f32 v119, s16, v119
    v_cvt_pk_bf16_f32 v82, v116, v117
    v_lshlrev_b32 v114, 16, v69
    v_and_b32 v115, s17, v69
    v_mul_f32 v112, s16, v112
    v_mul_f32 v113, s16, v113
    v_cvt_pk_bf16_f32 v83, v118, v119
    v_lshlrev_b32 v116, 16, v70
    v_and_b32 v117, s17, v70
    v_mfma_f32_16x16x32_bf16 v[104:107], v[120:123], v[80:83], 0
    v_mul_f32 v114, s16, v114
    v_mul_f32 v115, s16, v115
    v_cvt_pk_bf16_f32 v68, v112, v113
    v_lshlrev_b32 v118, 16, v71
    v_mfma_f32_16x16x32_bf16 v[108:111], v[124:127], v[80:83], 0
    v_and_b32 v119, s17, v71
    v_mul_f32 v116, s16, v116
    v_mul_f32 v117, s16, v117
    v_cvt_pk_bf16_f32 v69, v114, v115
    v_lshlrev_b32 v112, 16, v84
    v_and_b32 v113, s17, v84
    v_mul_f32 v118, s16, v118
    v_mul_f32 v119, s16, v119
    v_cvt_pk_bf16_f32 v70, v116, v117
    v_lshlrev_b32 v114, 16, v85
    v_and_b32 v115, s17, v85
    v_mul_f32 v112, s16, v112
    v_mul_f32 v113, s16, v113
    v_cvt_pk_bf16_f32 v71, v118, v119
    v_lshlrev_b32 v116, 16, v86
    v_and_b32 v117, s17, v86
    s_waitcnt lgkmcnt(5)
    v_mfma_f32_16x16x32_bf16 v[96:99], v[128:131], v[68:71], v[96:99]
    v_mul_f32 v114, s16, v114
    v_mul_f32 v115, s16, v115
    v_cvt_pk_bf16_f32 v84, v112, v113
    v_lshlrev_b32 v118, 16, v87
    s_waitcnt lgkmcnt(4)
    v_mfma_f32_16x16x32_bf16 v[100:103], v[132:135], v[68:71], v[100:103]
    v_and_b32 v119, s17, v87
    v_mul_f32 v116, s16, v116
    v_mul_f32 v117, s16, v117
    v_cvt_pk_bf16_f32 v85, v114, v115
    v_lshlrev_b32 v112, 16, v72
    v_and_b32 v113, s17, v72
    v_mul_f32 v118, s16, v118
    v_mul_f32 v119, s16, v119
    v_cvt_pk_bf16_f32 v86, v116, v117
    v_lshlrev_b32 v114, 16, v73
    v_and_b32 v115, s17, v73
    v_mul_f32 v112, s16, v112
    v_mul_f32 v113, s16, v113
    v_cvt_pk_bf16_f32 v87, v118, v119
    v_lshlrev_b32 v116, 16, v74
    v_and_b32 v117, s17, v74
    v_mfma_f32_16x16x32_bf16 v[104:107], v[128:131], v[84:87], v[104:107]
    v_mul_f32 v114, s16, v114
    v_mul_f32 v115, s16, v115
    v_cvt_pk_bf16_f32 v72, v112, v113
    v_lshlrev_b32 v118, 16, v75
    v_mfma_f32_16x16x32_bf16 v[108:111], v[132:135], v[84:87], v[108:111]
    v_and_b32 v119, s17, v75
    v_mul_f32 v116, s16, v116
    v_mul_f32 v117, s16, v117
    v_cvt_pk_bf16_f32 v73, v114, v115
    v_lshlrev_b32 v112, 16, v88
    v_and_b32 v113, s17, v88
    v_mul_f32 v118, s16, v118
    v_mul_f32 v119, s16, v119
    v_cvt_pk_bf16_f32 v74, v116, v117
    v_lshlrev_b32 v114, 16, v89
    v_and_b32 v115, s17, v89
    v_mul_f32 v112, s16, v112
    v_mul_f32 v113, s16, v113
    v_cvt_pk_bf16_f32 v75, v118, v119
    v_lshlrev_b32 v116, 16, v90
    v_and_b32 v117, s17, v90
    s_waitcnt lgkmcnt(3)
    v_mfma_f32_16x16x32_bf16 v[96:99], v[136:139], v[72:75], v[96:99]
    v_mul_f32 v114, s16, v114
    v_mul_f32 v115, s16, v115
    v_cvt_pk_bf16_f32 v88, v112, v113
    v_lshlrev_b32 v118, 16, v91
    s_waitcnt lgkmcnt(2)
    v_mfma_f32_16x16x32_bf16 v[100:103], v[140:143], v[72:75], v[100:103]
    v_and_b32 v119, s17, v91
    v_mul_f32 v116, s16, v116
    v_mul_f32 v117, s16, v117
    v_cvt_pk_bf16_f32 v89, v114, v115
    v_lshlrev_b32 v112, 16, v76
    v_and_b32 v113, s17, v76
    v_mul_f32 v118, s16, v118
    v_mul_f32 v119, s16, v119
    v_cvt_pk_bf16_f32 v90, v116, v117
    v_lshlrev_b32 v114, 16, v77
    v_and_b32 v115, s17, v77
    v_mul_f32 v112, s16, v112
    v_mul_f32 v113, s16, v113
    v_cvt_pk_bf16_f32 v91, v118, v119
    v_lshlrev_b32 v116, 16, v78
    v_and_b32 v117, s17, v78
    v_mfma_f32_16x16x32_bf16 v[104:107], v[136:139], v[88:91], v[104:107]
    v_mul_f32 v114, s16, v114
    v_mul_f32 v115, s16, v115
    v_cvt_pk_bf16_f32 v76, v112, v113
    v_lshlrev_b32 v118, 16, v79
    v_mfma_f32_16x16x32_bf16 v[108:111], v[140:143], v[88:91], v[108:111]
    v_and_b32 v119, s17, v79
    v_mul_f32 v116, s16, v116
    v_mul_f32 v117, s16, v117
    v_cvt_pk_bf16_f32 v77, v114, v115
    ds_read_b64 v[164:165], v166
    v_lshlrev_b32 v112, 16, v92
    v_and_b32 v113, s17, v92
    v_mul_f32 v118, s16, v118
    v_mul_f32 v119, s16, v119
    v_cvt_pk_bf16_f32 v78, v116, v117
    v_lshlrev_b32 v114, 16, v93
    v_and_b32 v115, s17, v93
    v_mul_f32 v112, s16, v112
    v_mul_f32 v113, s16, v113
    v_cvt_pk_bf16_f32 v79, v118, v119
    v_lshlrev_b32 v116, 16, v94
    v_and_b32 v117, s17, v94
    s_waitcnt lgkmcnt(2)
    v_mfma_f32_16x16x32_bf16 v[96:99], v[144:147], v[76:79], v[96:99]
    v_mul_f32 v114, s16, v114
    v_mul_f32 v115, s16, v115
    v_cvt_pk_bf16_f32 v92, v112, v113
    v_lshlrev_b32 v118, 16, v95
    s_waitcnt lgkmcnt(1)
    v_mfma_f32_16x16x32_bf16 v[100:103], v[148:151], v[76:79], v[100:103]
    v_and_b32 v119, s17, v95
    v_mul_f32 v116, s16, v116
    v_mul_f32 v117, s16, v117
    v_cvt_pk_bf16_f32 v93, v114, v115
    v_mul_f32 v118, s16, v118
    v_mul_f32 v119, s16, v119
    v_cvt_pk_bf16_f32 v94, v116, v117
    v_cvt_pk_bf16_f32 v95, v118, v119
    s_nop 1
    v_mfma_f32_16x16x32_bf16 v[104:107], v[144:147], v[92:95], v[104:107]
    v_mfma_f32_16x16x32_bf16 v[108:111], v[148:151], v[92:95], v[108:111]
F_NZ:
    s_waitcnt lgkmcnt(0)
    v_min_u32 v164, v164, v165
    ds_inc_u32 v166, v166 offset:8
    v_mad_i32_i24 v160, s24, 1, v160
    s_nop 0
    v_readfirstlane_b32 s19, v164
    s_cmp_gt_u32 s19, s24
    s_cbranch_scc0 F_NOK
    ds_read_b128 v[120:123], v160 offset:0
    ds_read_b128 v[124:127], v160 offset:512
    ds_read_b128 v[128:131], v160 offset:64
    ds_read_b128 v[132:135], v160 offset:576
    ds_read_b128 v[136:139], v160 offset:128
    ds_read_b128 v[140:143], v160 offset:640
    ds_read_b128 v[144:147], v160 offset:192
    ds_read_b128 v[148:151], v160 offset:704
F_NOK:
    v_max3_f32 v164, v96, v97, v98
    v_max3_f32 v165, v104, v105, v106
    v_max3_f32 v164, v164, v99, v100
    v_max3_f32 v165, v165, v107, v108
    v_max3_f32 v164, v164, v101, v102
    v_max3_f32 v165, v165, v109, v110
    v_max_f32 v164, v164, v103
    v_max_f32 v165, v165, v111
    s_nop 1
    v_permlane16_swap_b32 v164, v165
    v_max_f32 v164, v164, v165
    v_mov_b32 v165, v164
    s_nop 1
    v_permlane32_swap_b32 v164, v165
    v_max_f32 v164, v164, v165
    v_mul_f32 v164, -1.0, v164
    v_mov_b32 v165, v164
    s_nop 1
    v_permlane16_swap_b32 v164, v165
    v_min_f32 v164, v164, v152
    v_min_f32 v165, v165, v156
    s_cmp_eq_u32 s23, 0
    s_cbranch_scc1 RESCALE
R_BACK:
    v_mov_b32 v152, v164
    v_mov_b32 v156, v165
    v_mov_b32 v153, v164
    v_mov_b32 v157, v165
    v_mov_b32 v154, v164
    v_mov_b32 v158, v165
    v_mov_b32 v155, v164
    v_mov_b32 v159, v165
    v_add_f32 v96, v96, v152
    v_add_f32 v104, v104, v156
    v_exp_f32 v96, v96
    v_add_f32 v97, v97, v152
    v_exp_f32 v104, v104
    v_add_f32 v105, v105, v156
    v_exp_f32 v97, v97
    v_add_f32 v98, v98, v152
    v_exp_f32 v105, v105
    v_add_f32 v106, v106, v156
    v_exp_f32 v98, v98
    v_add_f32 v99, v99, v152
    v_exp_f32 v106, v106
    v_add_f32 v107, v107, v156
    v_exp_f32 v99, v99
    v_add_f32 v100, v100, v152
    v_exp_f32 v107, v107
    v_add_f32 v108, v108, v156
    v_exp_f32 v100, v100
    v_add_f32 v101, v101, v152
    v_exp_f32 v108, v108
    v_add_f32 v109, v109, v156
    v_exp_f32 v101, v101
    v_add_f32 v102, v102, v152
    v_exp_f32 v109, v109
    v_add_f32 v110, v110, v156
    v_exp_f32 v102, v102
    v_add_f32 v103, v103, v152
    v_exp_f32 v110, v110
    v_add_f32 v111, v111, v156
    v_exp_f32 v103, v103
    v_exp_f32 v111, v111
    v_add_f32 v164, v96, v97
    v_add_f32 v165, v104, v105
    v_cvt_pk_bf16_f32 v112, v96, v97
    v_add_f32 v164, v164, v98
    v_add_f32 v165, v165, v106
    v_cvt_pk_bf16_f32 v116, v104, v105
    v_add_f32 v164, v164, v99
    v_add_f32 v165, v165, v107
    v_cvt_pk_bf16_f32 v113, v98, v99
    v_add_f32 v164, v164, v100
    v_add_f32 v165, v165, v108
    v_cvt_pk_bf16_f32 v117, v106, v107
    v_add_f32 v164, v164, v101
    v_add_f32 v165, v165, v109
    v_cvt_pk_bf16_f32 v114, v100, v101
    v_add_f32 v164, v164, v102
    v_add_f32 v165, v165, v110
    v_add_f32 v164, v164, v103
    v_add_f32 v165, v165, v111
    v_cvt_pk_bf16_f32 v118, v108, v109
    v_cvt_pk_bf16_f32 v115, v102, v103
    v_cvt_pk_bf16_f32 v119, v110, v111
    s_mov_b32 s23, 0
    s_waitcnt lgkmcnt(0)
    s_cmp_gt_u32 s19, s24
    s_cbranch_scc1 CONT
LATE:
    s_cmp_gt_u32 s19, s24
    s_cbranch_scc1 POLLOK_L
POLL_L:
    ds_read_b64 v[96:97], v166
    s_waitcnt lgkmcnt(0)
    v_min_u32 v96, v96, v97
    s_sub_u32 s20, s20, 1
    s_cbranch_scc1 END
    v_readfirstlane_b32 s19, v96
    s_cmp_gt_u32 s19, s24
    s_cbranch_scc1 POLLOK_L
    s_sleep 1
    s_branch POLL_L
POLLOK_L:
    ds_read_b128 v[120:123], v160 offset:0
    ds_read_b128 v[124:127], v160 offset:512
    ds_read_b128 v[128:131], v160 offset:64
    ds_read_b128 v[132:135], v160 offset:576
    ds_read_b128 v[136:139], v160 offset:128
    ds_read_b128 v[140:143], v160 offset:640
    ds_read_b128 v[144:147], v160 offset:192
    ds_read_b128 v[148:151], v160 offset:704
    s_waitcnt lgkmcnt(0)
    s_branch CONT
LOOP:
    s_waitcnt lgkmcnt(1)
    s_setprio 2
    v_mfma_f32_16x16x32_bf16 v[96:99], v[120:123], v[64:67], v[152:155]
    v_mfma_f32_16x16x32_bf16 v[104:107], v[120:123], v[80:83], v[156:159]
    v_mfma_f32_16x16x32_bf16 v[100:103], v[124:127], v[64:67], v[152:155]
    v_mfma_f32_16x16x32_bf16 v[108:111], v[124:127], v[80:83], v[156:159]
L_BACK:
    ds_read_b64_tr_b16 v[120:121], v161 offset:0
    ds_read_b64_tr_b16 v[122:123], v161 offset:512
    ds_read_b64_tr_b16 v[124:125], v161 offset:32
    ds_read_b64_tr_b16 v[126:127], v161 offset:544
    v_add_f32 v162, v162, v164
    v_add_f32 v163, v163, v165
    v_mfma_f32_16x16x32_bf16 v[96:99], v[128:131], v[68:71], v[96:99]
    v_mfma_f32_16x16x32_bf16 v[104:107], v[128:131], v[84:87], v[104:107]
    ds_read_b64_tr_b16 v[128:129], v161 offset:64
    ds_read_b64_tr_b16 v[130:131], v161 offset:576
    s_movrels_b64 s[24:25], s[36:37]
    v_mfma_f32_16x16x32_bf16 v[100:103], v[132:135], v[68:71], v[100:103]
    v_mfma_f32_16x16x32_bf16 v[108:111], v[132:135], v[84:87], v[108:111]
    ds_read_b64_tr_b16 v[132:133], v161 offset:96
    ds_read_b64_tr_b16 v[134:135], v161 offset:608
    s_add_u32 m0, m0, 2
    v_mfma_f32_16x16x32_bf16 v[96:99], v[136:139], v[72:75], v[96:99]
    v_mfma_f32_16x16x32_bf16 v[104:107], v[136:139], v[88:91], v[104:107]
    ds_read_b64_tr_b16 v[136:137], v161 offset:128
    ds_read_b64_tr_b16 v[138:139], v161 offset:640
    v_mfma_f32_16x16x32_bf16 v[100:103], v[140:143], v[72:75], v[100:103]
    v_mfma_f32_16x16x32_bf16 v[108:111], v[140:143], v[88:91], v[108:111]
    ds_read_b64_tr_b16 v[140:141], v161 offset:160
    ds_read_b64_tr_b16 v[142:143], v161 offset:672
    v_mad_i32_i24 v160, s24, 1, v160
    v_mfma_f32_16x16x32_bf16 v[96:99], v[144:147], v[76:79], v[96:99]
    v_mfma_f32_16x16x32_bf16 v[104:107], v[144:147], v[92:95], v[104:107]
    ds_read_b64_tr_b16 v[144:145], v161 offset:192
    ds_read_b64_tr_b16 v[146:147], v161 offset:704
    ds_read_b64 v[164:165], v166
    v_mfma_f32_16x16x32_bf16 v[100:103], v[148:151], v[76:79], v[100:103]
    v_mfma_f32_16x16x32_bf16 v[108:111], v[148:151], v[92:95], v[108:111]
    s_setprio 3
    ds_read_b64_tr_b16 v[148:149], v161 offset:224
    ds_read_b64_tr_b16 v[150:151], v161 offset:736
    s_waitcnt lgkmcnt(9)
    v_mfma_f32_16x16x32_bf16 v[0:3], v[120:123], v[112:115], v[0:3]
    v_mfma_f32_16x16x32_bf16 v[4:7], v[120:123], v[116:119], v[4:7]
    v_add_u32 v161, s25, v161
    v_mfma_f32_16x16x32_bf16 v[8:11], v[124:127], v[112:115], v[8:11]
    v_mfma_f32_16x16x32_bf16 v[12:15], v[124:127], v[116:119], v[12:15]
    ds_read_b128 v[120:123], v160 offset:0
    ds_read_b128 v[124:127], v160 offset:512
    v_mfma_f32_16x16x32_bf16 v[16:19], v[128:131], v[112:115], v[16:19]
    v_mfma_f32_16x16x32_bf16 v[20:23], v[128:131], v[116:119], v[20:23]
    ds_read_b128 v[128:131], v160 offset:64
    v_mfma_f32_16x16x32_bf16 v[24:27], v[132:135], v[112:115], v[24:27]
    v_mfma_f32_16x16x32_bf16 v[28:31], v[132:135], v[116:119], v[28:31]
    ds_read_b128 v[132:135], v160 offset:576
    s_waitcnt lgkmcnt(4)
    v_mfma_f32_16x16x32_bf16 v[32:35], v[136:139], v[112:115], v[32:35]
    v_mfma_f32_16x16x32_bf16 v[36:39], v[136:139], v[116:119], v[36:39]
    ds_read_b128 v[136:139], v160 offset:128
    v_mfma_f32_16x16x32_bf16 v[40:43], v[140:143], v[112:115], v[40:43]
    v_mfma_f32_16x16x32_bf16 v[44:47], v[140:143], v[116:119], v[44:47]
    ds_read_b128 v[140:143], v160 offset:640
    v_mfma_f32_16x16x32_bf16 v[48:51], v[144:147], v[112:115], v[48:51]
    v_mfma_f32_16x16x32_bf16 v[52:55], v[144:147], v[116:119], v[52:55]
    ds_read_b128 v[144:147], v160 offset:192
    v_min_u32 v164, v164, v165
    v_mfma_f32_16x16x32_bf16 v[56:59], v[148:151], v[112:115], v[56:59]
    v_mfma_f32_16x16x32_bf16 v[60:63], v[148:151], v[116:119], v[60:63]
    ds_read_b128 v[148:151], v160 offset:704
    s_setprio 1
    v_readfirstlane_b32 s19, v164
    v_exp_f32 v96, v96
    v_exp_f32 v104, v104
    v_exp_f32 v97, v97
    v_exp_f32 v105, v105
    v_exp_f32 v98, v98
    v_exp_f32 v106, v106
    v_exp_f32 v99, v99
    v_exp_f32 v107, v107
    v_exp_f32 v100, v100
    v_exp_f32 v108, v108
    v_exp_f32 v101, v101
    v_exp_f32 v109, v109
    v_exp_f32 v102, v102
    v_exp_f32 v110, v110
    v_exp_f32 v103, v103
    v_exp_f32 v111, v111
    v_add_f32 v164, v96, v97
    v_add_f32 v165, v104, v105
    v_cvt_pk_bf16_f32 v112, v96, v97
    v_add_f32 v164, v164, v98
    v_add_f32 v165, v165, v106
    v_cvt_pk_bf16_f32 v116, v104, v105
    v_add_f32 v164, v164, v99
    v_add_f32 v165, v165, v107
    v_cvt_pk_bf16_f32 v113, v98, v99
    v_add_f32 v164, v164, v100
    v_add_f32 v165, v165, v108
    v_cvt_pk_bf16_f32 v117, v106, v107
    v_add_f32 v164, v164, v101
    v_add_f32 v165, v165, v109
    v_cvt_pk_bf16_f32 v114, v100, v101
    v_add_f32 v164, v164, v102
    v_add_f32 v165, v165, v110
    v_add_f32 v164, v164, v103
    v_add_f32 v165, v165, v111
    v_cvt_pk_bf16_f32 v118, v108, v109
    v_cmp_nge_f32 vcc, s18, v164
    v_cmp_nge_f32 s[34:35], s18, v165
    v_cvt_pk_bf16_f32 v115, v102, v103
    v_cvt_pk_bf16_f32 v119, v110, v111
    s_or_b64 vcc, vcc, s[34:35]
    s_cbranch_scc1 FRESH
    ds_inc_u32 v166, v166 offset:8
    s_cmp_gt_u32 s19, s24
    s_cbranch_scc0 LATE
CONT:
    s_sub_u32 s21, s21, 1
    s_cbranch_scc1 FINAL
    s_cmp_eq_u32 s21, s22
    s_cbranch_scc0 LOOP
DRY_IN:
    s_mov_b32 s27, 0
MASK:
    v_mov_b32 v111, s30
    s_mov_b32 exec_lo, 0xffff0000
    s_mov_b32 exec_hi, 0xffff0000
    v_lshrrev_b32 v111, 8, v111
    s_mov_b32 exec_lo, 0
    s_mov_b32 exec_hi, -1
    v_lshrrev_b32 v111, 1, v111
    s_mov_b32 exec_lo, -1
    v_bfe_i32 v96, v111, 0, 1
    v_bfe_i32 v97, v111, 2, 1
    v_bfe_i32 v98, v111, 4, 1
    v_bfe_i32 v99, v111, 6, 1
    v_bfe_i32 v100, v111, 16, 1
    v_bfe_i32 v101, v111, 18, 1
    v_bfe_i32 v102, v111, 20, 1
    v_bfe_i32 v103, v111, 22, 1
    s_cmp_eq_u32 s27, 0
    s_cbranch_scc0 MASK_F
    s_bitcmp1_b32 s33, 12
    s_cbranch_scc1 MASKH
    v_bfi_b32 v104, v96, s26, v156
    v_bfi_b32 v96, v96, s26, v152
    v_bfi_b32 v105, v97, s26, v156
    v_bfi_b32 v97, v97, s26, v152
    v_bfi_b32 v106, v98, s26, v156
    v_bfi_b32 v98, v98, s26, v152
    v_bfi_b32 v107, v99, s26, v156
    v_bfi_b32 v99, v99, s26, v152
    v_bfi_b32 v108, v100, s26, v156
    v_bfi_b32 v100, v100, s26, v152
    v_bfi_b32 v109, v101, s26, v156
    v_bfi_b32 v101, v101, s26, v152
    v_bfi_b32 v110, v102, s26, v156
    v_bfi_b32 v102, v102, s26, v152
    v_bfi_b32 v111, v103, s26, v156
    v_bfi_b32 v103, v103, s26, v152
    s_waitcnt lgkmcnt(0)
    s_nop 0
    v_mfma_f32_16x16x32_bf16 v[96:99], v[120:123], v[64:67], v[96:99]
    v_mfma_f32_16x16x32_bf16 v[104:107], v[120:123], v[80:83], v[104:107]
    v_mfma_f32_16x16x32_bf16 v[100:103], v[124:127], v[64:67], v[100:103]
    v_mfma_f32_16x16x32_bf16 v[108:111], v[124:127], v[80:83], v[108:111]
    s_branch L_BACK
MASK_F:
    v_lshlrev_b32 v104, 23, v96
    v_lshlrev_b32 v96, 23, v96
    v_lshlrev_b32 v105, 23, v97
    v_lshlrev_b32 v97, 23, v97
    v_lshlrev_b32 v106, 23, v98
    v_lshlrev_b32 v98, 23, v98
    v_lshlrev_b32 v107, 23, v99
    v_lshlrev_b32 v99, 23, v99
    v_lshlrev_b32 v108, 23, v100
    v_lshlrev_b32 v100, 23, v100
    v_lshlrev_b32 v109, 23, v101
    v_lshlrev_b32 v101, 23, v101
    v_lshlrev_b32 v110, 23, v102
    v_lshlrev_b32 v102, 23, v102
    v_lshlrev_b32 v111, 23, v103
    v_lshlrev_b32 v103, 23, v103
    s_waitcnt lgkmcnt(0)
    s_nop 0
    v_mfma_f32_16x16x32_bf16 v[96:99], v[120:123], v[64:67], v[96:99]
    v_mfma_f32_16x16x32_bf16 v[104:107], v[120:123], v[80:83], v[104:107]
    v_mfma_f32_16x16x32_bf16 v[100:103], v[124:127], v[64:67], v[100:103]
    v_mfma_f32_16x16x32_bf16 v[108:111], v[124:127], v[80:83], v[108:111]
    s_branch F_BACK
MASKH:
    v_bfi_b32 v104, v96, s26, v156
    v_bfi_b32 v96, v96, s26, v152
    v_bfi_b32 v105, v97, s26, v156
    v_bfi_b32 v97, v97, s26, v152
    v_bfi_b32 v106, v98, s26, v156
    v_bfi_b32 v98, v98, s26, v152
    v_bfi_b32 v107, v99, s26, v156
    v_bfi_b32 v99, v99, s26, v152
    s_waitcnt lgkmcnt(0)
    s_nop 0
    v_mfma_f32_16x16x32_bf16 v[96:99], v[120:123], v[64:67], v[96:99]
    v_mfma_f32_16x16x32_bf16 v[104:107], v[120:123], v[80:83], v[104:107]
    ds_read_b64_tr_b16 v[120:121], v161 offset:0
    ds_read_b64_tr_b16 v[122:123], v161 offset:512
    ds_read_b64_tr_b16 v[124:125], v161 offset:32
    ds_read_b64_tr_b16 v[126:127], v161 offset:544
    v_add_f32 v162, v162, v164
    v_add_f32 v163, v163, v165
    v_mfma_f32_16x16x32_bf16 v[96:99], v[128:131], v[68:71], v[96:99]
    v_mfma_f32_16x16x32_bf16 v[104:107], v[128:131], v[84:87], v[104:107]
    ds_read_b64_tr_b16 v[128:129], v161 offset:64
    ds_read_b64_tr_b16 v[130:131], v161 offset:576
    s_movrels_b64 s[24:25], s[36:37]
    ds_read_b64_tr_b16 v[132:133], v161 offset:96
    ds_read_b64_tr_b16 v[134:135], v161 offset:608
    s_add_u32 m0, m0, 2
    v_mfma_f32_16x16x32_bf16 v[96:99], v[136:139], v[72:75], v[96:99]
    v_mfma_f32_16x16x32_bf16 v[104:107], v[136:139], v[88:91], v[104:107]
    ds_read_b64_tr_b16 v[136:137], v161 offset:128
    ds_read_b64_tr_b16 v[138:139], v161 offset:640
    ds_read_b64_tr_b16 v[140:141], v161 offset:160
    ds_read_b64_tr_b16 v[142:143], v161 offset:672
    v_mad_i32_i24 v160, s24, 1, v160
    v_mfma_f32_16x16x32_bf16 v[96:99], v[144:147], v[76:79], v[96:99]
    v_mfma_f32_16x16x32_bf16 v[104:107], v[144:147], v[92:95], v[104:107]
    ds_read_b64_tr_b16 v[144:145], v161 offset:192
    ds_read_b64_tr_b16 v[146:147], v161 offset:704
    ds_read_b64 v[164:165], v166
    s_setprio 3
    ds_read_b64_tr_b16 v[148:149], v161 offset:224
    ds_read_b64_tr_b16 v[150:151], v161 offset:736
    s_waitcnt lgkmcnt(9)
    v_mfma_f32_16x16x32_bf16 v[0:3], v[120:123], v[112:115], v[0:3]
    v_mfma_f32_16x16x32_bf16 v[4:7], v[120:123], v[116:119], v[4:7]
    v_add_u32 v161, s25, v161
    v_mfma_f32_16x16x32_bf16 v[8:11], v[124:127], v[112:115], v[8:11]
    v_mfma_f32_16x16x32_bf16 v[12:15], v[124:127], v[116:119], v[12:15]
    ds_read_b128 v[120:123], v160 offset:0
    ds_read_b128 v[124:127], v160 offset:512
    v_mfma_f32_16x16x32_bf16 v[16:19], v[128:131], v[112:115], v[16:19]
    v_mfma_f32_16x16x32_bf16 v[20:23], v[128:131], v[116:119], v[20:23]
    ds_read_b128 v[128:131], v160 offset:64
    v_mfma_f32_16x16x32_bf16 v[24:27], v[132:135], v[112:115], v[24:27]
    v_mfma_f32_16x16x32_bf16 v[28:31], v[132:135], v[116:119], v[28:31]
    ds_read_b128 v[132:135], v160 offset:576
    s_waitcnt lgkmcnt(4)
    v_mfma_f32_16x16x32_bf16 v[32:35], v[136:139], v[112:115], v[32:35]
    v_mfma_f32_16x16x32_bf16 v[36:39], v[136:139], v[116:119], v[36:39]
    ds_read_b128 v[136:139], v160 offset:128
    v_mfma_f32_16x16x32_bf16 v[40:43], v[140:143], v[112:115], v[40:43]
    v_mfma_f32_16x16x32_bf16 v[44:47], v[140:143], v[116:119], v[44:47]
    ds_read_b128 v[140:143], v160 offset:640
    v_mfma_f32_16x16x32_bf16 v[48:51], v[144:147], v[112:115], v[48:51]
    v_mfma_f32_16x16x32_bf16 v[52:55], v[144:147], v[116:119], v[52:55]
    ds_read_b128 v[144:147], v160 offset:192
    v_min_u32 v164, v164, v165
    v_mfma_f32_16x16x32_bf16 v[56:59], v[148:151], v[112:115], v[56:59]
    v_mfma_f32_16x16x32_bf16 v[60:63], v[148:151], v[116:119], v[60:63]
    ds_read_b128 v[148:151], v160 offset:704
    s_setprio 1
    v_readfirstlane_b32 s19, v164
    v_exp_f32 v96, v96
    v_exp_f32 v104, v104
    v_exp_f32 v97, v97
    v_exp_f32 v105, v105
    v_exp_f32 v98, v98
    v_exp_f32 v106, v106
    v_exp_f32 v99, v99
    v_exp_f32 v107, v107
    v_add_f32 v164, v96, v97
    v_add_f32 v165, v104, v105
    v_cvt_pk_bf16_f32 v112, v96, v97
    v_add_f32 v164, v164, v98
    v_add_f32 v165, v165, v106
    v_cvt_pk_bf16_f32 v116, v104, v105
    v_add_f32 v164, v164, v99
    v_add_f32 v165, v165, v107
    v_cvt_pk_bf16_f32 v113, v98, v99
    v_cvt_pk_bf16_f32 v117, v106, v107
    v_mov_b32 v114, 0
    v_mov_b32 v118, 0
    v_cmp_nge_f32 vcc, s18, v164
    v_cmp_nge_f32 s[34:35], s18, v165
    v_mov_b32 v115, 0
    v_mov_b32 v119, 0
    s_or_b64 vcc, vcc, s[34:35]
    s_cbranch_scc1 FRESH
    ds_inc_u32 v166, v166 offset:8
    s_cmp_gt_u32 s19, s24
    s_cbranch_scc0 LATE
    s_branch CONT
FINAL:
    s_waitcnt lgkmcnt(4)
    ds_read_b64_tr_b16 v[120:121], v161 offset:0
    ds_read_b64_tr_b16 v[122:123], v161 offset:512
    ds_read_b64_tr_b16 v[124:125], v161 offset:32
    ds_read_b64_tr_b16 v[126:127], v161 offset:544
    ds_read_b64_tr_b16 v[128:129], v161 offset:64
    ds_read_b64_tr_b16 v[130:131], v161 offset:576
    ds_read_b64_tr_b16 v[132:133], v161 offset:96
    ds_read_b64_tr_b16 v[134:135], v161 offset:608
    ds_read_b64_tr_b16 v[136:137], v161 offset:128
    ds_read_b64_tr_b16 v[138:139], v161 offset:640
    v_add_f32 v162, v162, v164
    v_add_f32 v163, v163, v165
    s_movrels_b32 s3, s41
    s_xor_b32 s4, s28, s15
    v_permlane16_swap_b32 v162, v163
    v_add_f32 v162, v162, v163
    v_mov_b32 v163, v162
    s_add_u32 s4, s10, s4
    s_addc_u32 s5, s11, 0
    s_lshr_b32 s3, s3, 24
    v_permlane32_swap_b32 v162, v163
    v_add_f32 v162, v162, v163
    v_rcp_f32 v162, v162
    v_mbcnt_lo_u32_b32 v108, -1, 0
    v_mov_b32 v163, v162
    v_mbcnt_hi_u32_b32 v108, -1, v108
    v_mov_b32 v164, s3
    v_permlane16_swap_b32 v162, v163
    s_mov_b32 s6, s29
    v_and_b32 v102, 7, v108
    v_lshrrev_b32 v103, 5, v108
    v_xor_b32 v103, v102, v103
    v_lshl_add_u32 v99, v102, 8, s13
    v_lshl_add_u32 v99, v103, 4, v99
    v_bfe_u32 v102, v108, 3, 1
    v_bfe_u32 v103, v108, 4, 1
    v_lshl_add_u32 v99, v102, 7, v99
    v_lshl_add_u32 v99, v103, 3, v99
    s_setprio 3
    s_waitcnt lgkmcnt(8)
    v_mfma_f32_16x16x32_bf16 v[0:3], v[120:123], v[112:115], v[0:3]
    v_mfma_f32_16x16x32_bf16 v[4:7], v[120:123], v[116:119], v[4:7]
    ds_read_b64_tr_b16 v[140:141], v161 offset:160
    ds_read_b64_tr_b16 v[142:143], v161 offset:672
    v_lshrrev_b32 v109, 3, v108
    v_and_b32 v110, 7, v108
    v_lshrrev_b32 v108, 4, v108
    s_waitcnt lgkmcnt(8)
    v_mfma_f32_16x16x32_bf16 v[8:11], v[124:127], v[112:115], v[8:11]
    v_mfma_f32_16x16x32_bf16 v[12:15], v[124:127], v[116:119], v[12:15]
    ds_read_b64_tr_b16 v[144:145], v161 offset:192
    ds_read_b64_tr_b16 v[146:147], v161 offset:704
    v_xor_b32 v108, v108, v110
    v_lshl_add_u32 v100, v109, 7, s13
    v_xor_b32 v96, 32, v99
    s_waitcnt lgkmcnt(8)
    v_mfma_f32_16x16x32_bf16 v[16:19], v[128:131], v[112:115], v[16:19]
    v_mfma_f32_16x16x32_bf16 v[20:23], v[128:131], v[116:119], v[20:23]
    ds_read_b64_tr_b16 v[148:149], v161 offset:224
    ds_read_b64_tr_b16 v[150:151], v161 offset:736
    v_lshl_add_u32 v100, v108, 4, v100
    v_xor_b32 v97, 64, v99
    v_xor_b32 v98, 0x60, v99
    s_waitcnt lgkmcnt(8)
    v_mfma_f32_16x16x32_bf16 v[24:27], v[132:135], v[112:115], v[24:27]
    v_mfma_f32_16x16x32_bf16 v[28:31], v[132:135], v[116:119], v[28:31]
    v_mul_f32 v0, v0, v162
    v_mul_f32 v1, v1, v162
    v_mul_f32 v2, v2, v162
    v_mul_f32 v3, v3, v162
    v_cvt_pk_bf16_f32 v64, v0, v1
    v_cvt_pk_bf16_f32 v65, v2, v3
    ds_write_b64 v99, v[64:65]
    s_waitcnt lgkmcnt(7)
    v_mfma_f32_16x16x32_bf16 v[32:35], v[136:139], v[112:115], v[32:35]
    v_mfma_f32_16x16x32_bf16 v[36:39], v[136:139], v[116:119], v[36:39]
    v_mul_f32 v8, v8, v162
    v_mul_f32 v9, v9, v162
    v_mul_f32 v10, v10, v162
    v_mul_f32 v11, v11, v162
    v_cvt_pk_bf16_f32 v68, v8, v9
    v_cvt_pk_bf16_f32 v69, v10, v11
    ds_write_b64 v96, v[68:69]
    s_waitcnt lgkmcnt(6)
    v_mfma_f32_16x16x32_bf16 v[40:43], v[140:143], v[112:115], v[40:43]
    v_mfma_f32_16x16x32_bf16 v[44:47], v[140:143], v[116:119], v[44:47]
    v_mul_f32 v16, v16, v162
    v_mul_f32 v17, v17, v162
    v_mul_f32 v18, v18, v162
    v_mul_f32 v19, v19, v162
    v_cvt_pk_bf16_f32 v72, v16, v17
    v_cvt_pk_bf16_f32 v73, v18, v19
    ds_write_b64 v97, v[72:73]
    s_waitcnt lgkmcnt(5)
    v_mfma_f32_16x16x32_bf16 v[48:51], v[144:147], v[112:115], v[48:51]
    v_mfma_f32_16x16x32_bf16 v[52:55], v[144:147], v[116:119], v[52:55]
    v_xor_b32 v101, 64, v100
    v_lshlrev_b32 v104, 12, v109
    v_lshl_add_u32 v104, v110, 4, v104
    s_waitcnt lgkmcnt(3)
    v_mfma_f32_16x16x32_bf16 v[56:59], v[148:151], v[112:115], v[56:59]
    v_mfma_f32_16x16x32_bf16 v[60:63], v[148:151], v[116:119], v[60:63]
    ds_write_b32 v166, v164 offset:8
    s_setprio 0
    s_cmp_eq_u32 s3, 0xff
    s_cbranch_scc1 E_LAST
    s_setprio 3
E_LAST:
    v_mul_f32 v24, v24, v162
    v_mul_f32 v25, v25, v162
    v_mul_f32 v26, v26, v162
    v_mul_f32 v27, v27, v162
    v_cvt_pk_bf16_f32 v76, v24, v25
    v_cvt_pk_bf16_f32 v77, v26, v27
    ds_write_b64 v98, v[76:77]
    ds_read_b128 v[0:3], v100 offset:0
    ds_read_b128 v[8:11], v101 offset:1024
    v_add_u32 v105, 0x8000, v104
    v_add_u32 v106, 0x10000, v104
    v_add_u32 v107, 0x18000, v104
    v_mul_f32 v4, v4, v163
    v_mul_f32 v5, v5, v163
    v_mul_f32 v6, v6, v163
    v_mul_f32 v7, v7, v163
    v_cvt_pk_bf16_f32 v66, v4, v5
    v_cvt_pk_bf16_f32 v67, v6, v7
    ds_write_b64 v99, v[66:67]
    v_mul_f32 v12, v12, v163
    v_mul_f32 v13, v13, v163
    v_mul_f32 v14, v14, v163
    v_mul_f32 v15, v15, v163
    v_cvt_pk_bf16_f32 v70, v12, v13
    v_cvt_pk_bf16_f32 v71, v14, v15
    ds_write_b64 v96, v[70:71]
    v_mul_f32 v20, v20, v163
    v_mul_f32 v21, v21, v163
    v_mul_f32 v22, v22, v163
    v_mul_f32 v23, v23, v163
    v_cvt_pk_bf16_f32 v74, v20, v21
    v_cvt_pk_bf16_f32 v75, v22, v23
    ds_write_b64 v97, v[74:75]
    v_mul_f32 v28, v28, v163
    v_mul_f32 v29, v29, v163
    v_mul_f32 v30, v30, v163
    v_mul_f32 v31, v31, v163
    v_cvt_pk_bf16_f32 v78, v28, v29
    v_cvt_pk_bf16_f32 v79, v30, v31
    ds_write_b64 v98, v[78:79]
    ds_read_b128 v[4:7], v100 offset:0
    ds_read_b128 v[12:15], v101 offset:1024
    s_waitcnt lgkmcnt(7)
    buffer_store_dwordx4 v[0:3], v104, s[4:7], 0 offen offset:0 sc0 sc1
    s_waitcnt lgkmcnt(6)
    buffer_store_dwordx4 v[8:11], v105, s[4:7], 0 offen offset:0 sc0 sc1
    v_mul_f32 v32, v32, v162
    v_mul_f32 v33, v33, v162
    v_mul_f32 v34, v34, v162
    v_mul_f32 v35, v35, v162
    v_cvt_pk_bf16_f32 v80, v32, v33
    v_cvt_pk_bf16_f32 v81, v34, v35
    ds_write_b64 v99, v[80:81]
    v_mul_f32 v40, v40, v162
    v_mul_f32 v41, v41, v162
    v_mul_f32 v42, v42, v162
    v_mul_f32 v43, v43, v162
    v_cvt_pk_bf16_f32 v84, v40, v41
    v_cvt_pk_bf16_f32 v85, v42, v43
    ds_write_b64 v96, v[84:85]
    v_mul_f32 v48, v48, v162
    v_mul_f32 v49, v49, v162
    v_mul_f32 v50, v50, v162
    v_mul_f32 v51, v51, v162
    v_cvt_pk_bf16_f32 v88, v48, v49
    v_cvt_pk_bf16_f32 v89, v50, v51
    ds_write_b64 v97, v[88:89]
    v_mul_f32 v56, v56, v162
    v_mul_f32 v57, v57, v162
    v_mul_f32 v58, v58, v162
    v_mul_f32 v59, v59, v162
    v_cvt_pk_bf16_f32 v92, v56, v57
    v_cvt_pk_bf16_f32 v93, v58, v59
    ds_write_b64 v98, v[92:93]
    ds_read_b128 v[32:35], v100 offset:0
    ds_read_b128 v[40:43], v101 offset:1024
    s_waitcnt lgkmcnt(7)
    buffer_store_dwordx4 v[4:7], v106, s[4:7], 0 offen offset:0 sc0 sc1
    s_waitcnt lgkmcnt(6)
    buffer_store_dwordx4 v[12:15], v107, s[4:7], 0 offen offset:0 sc0 sc1
    v_mul_f32 v36, v36, v163
    v_mul_f32 v37, v37, v163
    v_mul_f32 v38, v38, v163
    v_mul_f32 v39, v39, v163
    v_cvt_pk_bf16_f32 v82, v36, v37
    v_cvt_pk_bf16_f32 v83, v38, v39
    ds_write_b64 v99, v[82:83]
    v_mul_f32 v44, v44, v163
    v_mul_f32 v45, v45, v163
    v_mul_f32 v46, v46, v163
    v_mul_f32 v47, v47, v163
    v_cvt_pk_bf16_f32 v86, v44, v45
    v_cvt_pk_bf16_f32 v87, v46, v47
    ds_write_b64 v96, v[86:87]
    v_mul_f32 v52, v52, v163
    v_mul_f32 v53, v53, v163
    v_mul_f32 v54, v54, v163
    v_mul_f32 v55, v55, v163
    v_cvt_pk_bf16_f32 v90, v52, v53
    v_cvt_pk_bf16_f32 v91, v54, v55
    ds_write_b64 v97, v[90:91]
    v_mul_f32 v60, v60, v163
    v_mul_f32 v61, v61, v163
    v_mul_f32 v62, v62, v163
    v_mul_f32 v63, v63, v163
    v_cvt_pk_bf16_f32 v94, v60, v61
    v_cvt_pk_bf16_f32 v95, v62, v63
    ds_write_b64 v98, v[94:95]
    ds_read_b128 v[36:39], v100 offset:0
    ds_read_b128 v[44:47], v101 offset:1024
    s_waitcnt lgkmcnt(7)
    buffer_store_dwordx4 v[32:35], v104, s[4:7], 0 offen offset:128 sc0 sc1
    s_waitcnt lgkmcnt(6)
    buffer_store_dwordx4 v[40:43], v105, s[4:7], 0 offen offset:128 sc0 sc1
    s_waitcnt lgkmcnt(1)
    buffer_store_dwordx4 v[36:39], v106, s[4:7], 0 offen offset:128 sc0 sc1
    s_waitcnt lgkmcnt(0)
    buffer_store_dwordx4 v[44:47], v107, s[4:7], 0 offen offset:128 sc0 sc1
    s_setprio 1
    s_branch TASK
C_END:
END:
    s_endpgm
FRESH:
    v_mad_i32_i24 v160, s24, -1, v160
    s_waitcnt lgkmcnt(7)
    ds_read_b128 v[120:123], v160 offset:0
    ds_read_b128 v[124:127], v160 offset:512
    ds_read_b128 v[128:131], v160 offset:64
    ds_read_b128 v[132:135], v160 offset:576
    ds_read_b128 v[136:139], v160 offset:128
    ds_read_b128 v[140:143], v160 offset:640
    ds_read_b128 v[144:147], v160 offset:192
    ds_read_b128 v[148:151], v160 offset:704
    s_cmp_eq_u32 s21, s22
    s_cbranch_scc1 FMASK
    s_waitcnt lgkmcnt(7)
    v_mfma_f32_16x16x32_bf16 v[96:99], v[120:123], v[64:67], 0
    v_mfma_f32_16x16x32_bf16 v[104:107], v[120:123], v[80:83], 0
    s_waitcnt lgkmcnt(6)
    v_mfma_f32_16x16x32_bf16 v[100:103], v[124:127], v[64:67], 0
    v_mfma_f32_16x16x32_bf16 v[108:111], v[124:127], v[80:83], 0
F_BACK:
    ds_read_b64 v[164:165], v166
    s_waitcnt lgkmcnt(6)
    v_mfma_f32_16x16x32_bf16 v[96:99], v[128:131], v[68:71], v[96:99]
    v_mfma_f32_16x16x32_bf16 v[104:107], v[128:131], v[84:87], v[104:107]
    s_waitcnt lgkmcnt(5)
    v_mfma_f32_16x16x32_bf16 v[100:103], v[132:135], v[68:71], v[100:103]
    v_mfma_f32_16x16x32_bf16 v[108:111], v[132:135], v[84:87], v[108:111]
    s_waitcnt lgkmcnt(4)
    v_mfma_f32_16x16x32_bf16 v[96:99], v[136:139], v[72:75], v[96:99]
    v_mfma_f32_16x16x32_bf16 v[104:107], v[136:139], v[88:91], v[104:107]
    s_waitcnt lgkmcnt(3)
    v_mfma_f32_16x16x32_bf16 v[100:103], v[140:143], v[72:75], v[100:103]
    v_mfma_f32_16x16x32_bf16 v[108:111], v[140:143], v[88:91], v[108:111]
    s_waitcnt lgkmcnt(2)
    v_mfma_f32_16x16x32_bf16 v[96:99], v[144:147], v[76:79], v[96:99]
    v_mfma_f32_16x16x32_bf16 v[104:107], v[144:147], v[92:95], v[104:107]
    s_waitcnt lgkmcnt(1)
    v_mfma_f32_16x16x32_bf16 v[100:103], v[148:151], v[76:79], v[100:103]
    v_mfma_f32_16x16x32_bf16 v[108:111], v[148:151], v[92:95], v[108:111]
    s_branch F_NZ
FMASK:
    s_mov_b32 s27, 1
    s_branch MASK
RESCALE:
    v_sub_f32 v112, v164, v152
    v_sub_f32 v113, v165, v156
    v_exp_f32 v112, v112
    v_exp_f32 v113, v113
    s_nop 0
    v_mul_f32 v162, v162, v112
    v_mul_f32 v163, v163, v113
    v_mul_f32 v0, v0, v112
    v_mul_f32 v1, v1, v112
    v_mul_f32 v2, v2, v112
    v_mul_f32 v3, v3, v112
    v_mul_f32 v4, v4, v113
    v_mul_f32 v5, v5, v113
    v_mul_f32 v6, v6, v113
    v_mul_f32 v7, v7, v113
    v_mul_f32 v8, v8, v112
    v_mul_f32 v9, v9, v112
    v_mul_f32 v10, v10, v112
    v_mul_f32 v11, v11, v112
    v_mul_f32 v12, v12, v113
    v_mul_f32 v13, v13, v113
    v_mul_f32 v14, v14, v113
    v_mul_f32 v15, v15, v113
    v_mul_f32 v16, v16, v112
    v_mul_f32 v17, v17, v112
    v_mul_f32 v18, v18, v112
    v_mul_f32 v19, v19, v112
    v_mul_f32 v20, v20, v113
    v_mul_f32 v21, v21, v113
    v_mul_f32 v22, v22, v113
    v_mul_f32 v23, v23, v113
    v_mul_f32 v24, v24, v112
    v_mul_f32 v25, v25, v112
    v_mul_f32 v26, v26, v112
    v_mul_f32 v27, v27, v112
    v_mul_f32 v28, v28, v113
    v_mul_f32 v29, v29, v113
    v_mul_f32 v30, v30, v113
    v_mul_f32 v31, v31, v113
    v_mul_f32 v32, v32, v112
    v_mul_f32 v33, v33, v112
    v_mul_f32 v34, v34, v112
    v_mul_f32 v35, v35, v112
    v_mul_f32 v36, v36, v113
    v_mul_f32 v37, v37, v113
    v_mul_f32 v38, v38, v113
    v_mul_f32 v39, v39, v113
    v_mul_f32 v40, v40, v112
    v_mul_f32 v41, v41, v112
    v_mul_f32 v42, v42, v112
    v_mul_f32 v43, v43, v112
    v_mul_f32 v44, v44, v113
    v_mul_f32 v45, v45, v113
    v_mul_f32 v46, v46, v113
    v_mul_f32 v47, v47, v113
    v_mul_f32 v48, v48, v112
    v_mul_f32 v49, v49, v112
    v_mul_f32 v50, v50, v112
    v_mul_f32 v51, v51, v112
    v_mul_f32 v52, v52, v113
    v_mul_f32 v53, v53, v113
    v_mul_f32 v54, v54, v113
    v_mul_f32 v55, v55, v113
    v_mul_f32 v56, v56, v112
    v_mul_f32 v57, v57, v112
    v_mul_f32 v58, v58, v112
    v_mul_f32 v59, v59, v112
    v_mul_f32 v60, v60, v113
    v_mul_f32 v61, v61, v113
    v_mul_f32 v62, v62, v113
    v_mul_f32 v63, v63, v113
    s_branch R_BACK
BODY_B:
    v_mov_b32 v112, 0
    v_mov_b32 v113, 0
    v_mov_b32 v114, 0
    v_mov_b32 v115, 0
    v_mov_b32 v162, 0
    v_mov_b32 v152, 0x7f800000
    s_lshr_b32 s21, s32, 24
    s_and_b32 s22, s33, 0xff
    v_mad_i32_i24 v116, s31, 1, v160
    v_mad_i32_i24 v160, s32, 1, v160
    v_add_u32 v161, s25, v161
    s_mov_b32 s23, 1
    v_mfma_f32_32x32x16_bf16 v[0:15], v[112:115], v[112:115], 0
    v_mfma_f32_32x32x16_bf16 v[16:31], v[112:115], v[112:115], 0
    v_mfma_f32_32x32x16_bf16 v[32:47], v[112:115], v[112:115], 0
    v_mfma_f32_32x32x16_bf16 v[48:63], v[112:115], v[112:115], 0
    s_cmp_gt_u32 s19, s31
    s_cbranch_scc1 POLLOK_T_B
POLL_T_B:
    ds_read_b64 v[96:97], v166
    s_waitcnt lgkmcnt(0)
    v_min_u32 v96, v96, v97
    s_sub_u32 s20, s20, 1
    s_cbranch_scc1 END
    v_readfirstlane_b32 s19, v96
    s_cmp_gt_u32 s19, s31
    s_cbranch_scc1 POLLOK_T_B
    s_sleep 1
    s_branch POLL_T_B
POLLOK_T_B:
    s_setprio 3
    ds_read_b128 v[64:67], v116 offset:0
    ds_read_b128 v[68:71], v116 offset:64
    ds_read_b128 v[72:75], v116 offset:128
    ds_read_b128 v[76:79], v116 offset:192
    ds_read_b128 v[120:123], v160 offset:0
    ds_read_b128 v[124:127], v160 offset:512
    ds_read_b128 v[128:131], v160 offset:64
    ds_read_b128 v[132:135], v160 offset:576
    ds_read_b128 v[136:139], v160 offset:128
    ds_read_b128 v[140:143], v160 offset:640
    ds_read_b128 v[144:147], v160 offset:192
    ds_read_b128 v[148:151], v160 offset:704
    s_waitcnt lgkmcnt(11)
    v_lshlrev_b32 v112, 16, v64
    v_and_b32 v113, s17, v64
    v_lshlrev_b32 v114, 16, v65
    v_and_b32 v115, s17, v65
    v_mul_f32 v112, s16, v112
    v_mul_f32 v113, s16, v113
    v_lshlrev_b32 v116, 16, v66
    v_and_b32 v117, s17, v66
    v_mul_f32 v114, s16, v114
    v_mul_f32 v115, s16, v115
    v_cvt_pk_bf16_f32 v64, v112, v113
    v_lshlrev_b32 v118, 16, v67
    v_and_b32 v119, s17, v67
    v_mul_f32 v116, s16, v116
    v_mul_f32 v117, s16, v117
    v_cvt_pk_bf16_f32 v65, v114, v115
    s_waitcnt lgkmcnt(10)
    v_lshlrev_b32 v112, 16, v68
    v_and_b32 v113, s17, v68
    v_mul_f32 v118, s16, v118
    v_mul_f32 v119, s16, v119
    v_cvt_pk_bf16_f32 v66, v116, v117
    v_lshlrev_b32 v114, 16, v69
    v_and_b32 v115, s17, v69
    v_mul_f32 v112, s16, v112
    v_mul_f32 v113, s16, v113
    v_cvt_pk_bf16_f32 v67, v118, v119
    v_lshlrev_b32 v116, 16, v70
    v_and_b32 v117, s17, v70
    s_waitcnt lgkmcnt(7)
    v_mfma_f32_16x16x32_bf16 v[96:99], v[120:123], v[64:67], 0
    v_mul_f32 v114, s16, v114
    v_mul_f32 v115, s16, v115
    v_cvt_pk_bf16_f32 v68, v112, v113
    v_lshlrev_b32 v118, 16, v71
    s_waitcnt lgkmcnt(6)
    v_mfma_f32_16x16x32_bf16 v[100:103], v[124:127], v[64:67], 0
    v_and_b32 v119, s17, v71
    v_mul_f32 v116, s16, v116
    v_mul_f32 v117, s16, v117
    v_cvt_pk_bf16_f32 v69, v114, v115
    v_lshlrev_b32 v112, 16, v72
    v_and_b32 v113, s17, v72
    v_mul_f32 v118, s16, v118
    v_mul_f32 v119, s16, v119
    v_cvt_pk_bf16_f32 v70, v116, v117
    v_lshlrev_b32 v114, 16, v73
    v_and_b32 v115, s17, v73
    v_mul_f32 v112, s16, v112
    v_mul_f32 v113, s16, v113
    v_cvt_pk_bf16_f32 v71, v118, v119
    v_lshlrev_b32 v116, 16, v74
    v_and_b32 v117, s17, v74
    s_waitcnt lgkmcnt(5)
    v_mfma_f32_16x16x32_bf16 v[96:99], v[128:131], v[68:71], v[96:99]
    v_mul_f32 v114, s16, v114
    v_mul_f32 v115, s16, v115
    v_cvt_pk_bf16_f32 v72, v112, v113
    v_lshlrev_b32 v118, 16, v75
    s_waitcnt lgkmcnt(4)
    v_mfma_f32_16x16x32_bf16 v[100:103], v[132:135], v[68:71], v[100:103]
    v_and_b32 v119, s17, v75
    v_mul_f32 v116, s16, v116
    v_mul_f32 v117, s16, v117
    v_cvt_pk_bf16_f32 v73, v114, v115
    ds_read_b64 v[164:165], v166
    v_lshlrev_b32 v112, 16, v76
    v_and_b32 v113, s17, v76
    v_mul_f32 v118, s16, v118
    v_mul_f32 v119, s16, v119
    v_cvt_pk_bf16_f32 v74, v116, v117
    v_lshlrev_b32 v114, 16, v77
    v_and_b32 v115, s17, v77
    v_mul_f32 v112, s16, v112
    v_mul_f32 v113, s16, v113
    v_cvt_pk_bf16_f32 v75, v118, v119
    v_lshlrev_b32 v116, 16, v78
    v_and_b32 v117, s17, v78
    s_waitcnt lgkmcnt(4)
    v_mfma_f32_16x16x32_bf16 v[96:99], v[136:139], v[72:75], v[96:99]
    v_mul_f32 v114, s16, v114
    v_mul_f32 v115, s16, v115
    v_cvt_pk_bf16_f32 v76, v112, v113
    v_lshlrev_b32 v118, 16, v79
    s_waitcnt lgkmcnt(3)
    v_mfma_f32_16x16x32_bf16 v[100:103], v[140:143], v[72:75], v[100:103]
    v_and_b32 v119, s17, v79
    v_mul_f32 v116, s16, v116
    v_mul_f32 v117, s16, v117
    v_cvt_pk_bf16_f32 v77, v114, v115
    v_mul_f32 v118, s16, v118
    v_mul_f32 v119, s16, v119
    v_cvt_pk_bf16_f32 v78, v116, v117
    v_cvt_pk_bf16_f32 v79, v118, v119
    s_nop 1
    s_waitcnt lgkmcnt(2)
    v_mfma_f32_16x16x32_bf16 v[96:99], v[144:147], v[76:79], v[96:99]
    s_waitcnt lgkmcnt(1)
    v_mfma_f32_16x16x32_bf16 v[100:103], v[148:151], v[76:79], v[100:103]
F_NZ_B:
    s_waitcnt lgkmcnt(0)
    v_min_u32 v164, v164, v165
    ds_inc_u32 v166, v166 offset:8
    v_mad_i32_i24 v160, s24, 1, v160
    s_nop 0
    v_readfirstlane_b32 s19, v164
    s_cmp_gt_u32 s19, s24
    s_cbranch_scc0 F_NOK_B
    ds_read_b128 v[120:123], v160 offset:0
    ds_read_b128 v[124:127], v160 offset:512
    ds_read_b128 v[128:131], v160 offset:64
    ds_read_b128 v[132:135], v160 offset:576
    ds_read_b128 v[136:139], v160 offset:128
    ds_read_b128 v[140:143], v160 offset:640
    ds_read_b128 v[144:147], v160 offset:192
    ds_read_b128 v[148:151], v160 offset:704
F_NOK_B:
    v_max3_f32 v164, v96, v97, v98
    v_max3_f32 v164, v164, v99, v100
    v_max3_f32 v164, v164, v101, v102
    v_max_f32 v164, v164, v103
    v_mov_b32 v165, v164
    s_nop 1
    v_permlane16_swap_b32 v164, v165
    v_max_f32 v164, v164, v165
    v_mov_b32 v165, v164
    s_nop 1
    v_permlane32_swap_b32 v164, v165
    v_max_f32 v164, v164, v165
    v_mul_f32 v164, -1.0, v164
    v_min_f32 v164, v164, v152
    s_cmp_eq_u32 s23, 0
    s_cbranch_scc1 RESCALE_B
R_BACK_B:
    v_mov_b32 v152, v164
    v_mov_b32 v153, v164
    v_mov_b32 v154, v164
    v_mov_b32 v155, v164
    v_add_f32 v96, v96, v152
    v_add_f32 v97, v97, v152
    v_exp_f32 v96, v96
    v_add_f32 v98, v98, v152
    v_exp_f32 v97, v97
    v_add_f32 v99, v99, v152
    v_exp_f32 v98, v98
    v_add_f32 v100, v100, v152
    v_exp_f32 v99, v99
    v_add_f32 v101, v101, v152
    v_exp_f32 v100, v100
    v_add_f32 v102, v102, v152
    v_exp_f32 v101, v101
    v_add_f32 v103, v103, v152
    v_exp_f32 v102, v102
    v_exp_f32 v103, v103
    v_add_f32 v164, v96, v97
    v_cvt_pk_bf16_f32 v112, v96, v97
    v_add_f32 v164, v164, v98
    v_cvt_pk_bf16_f32 v113, v98, v99
    v_add_f32 v164, v164, v99
    v_cvt_pk_bf16_f32 v114, v100, v101
    v_add_f32 v164, v164, v100
    v_add_f32 v164, v164, v101
    v_add_f32 v164, v164, v102
    v_add_f32 v164, v164, v103
    v_cvt_pk_bf16_f32 v115, v102, v103
    s_mov_b32 s23, 0
    s_waitcnt lgkmcnt(0)
    s_cmp_gt_u32 s19, s24
    s_cbranch_scc1 CONT_B
LATE_B:
    s_cmp_gt_u32 s19, s24
    s_cbranch_scc1 POLLOK_L_B
POLL_L_B:
    ds_read_b64 v[96:97], v166
    s_waitcnt lgkmcnt(0)
    v_min_u32 v96, v96, v97
    s_sub_u32 s20, s20, 1
    s_cbranch_scc1 END
    v_readfirstlane_b32 s19, v96
    s_cmp_gt_u32 s19, s24
    s_cbranch_scc1 POLLOK_L_B
    s_sleep 1
    s_branch POLL_L_B
POLLOK_L_B:
    ds_read_b128 v[120:123], v160 offset:0
    ds_read_b128 v[124:127], v160 offset:512
    ds_read_b128 v[128:131], v160 offset:64
    ds_read_b128 v[132:135], v160 offset:576
    ds_read_b128 v[136:139], v160 offset:128
    ds_read_b128 v[140:143], v160 offset:640
    ds_read_b128 v[144:147], v160 offset:192
    ds_read_b128 v[148:151], v160 offset:704
    s_waitcnt lgkmcnt(0)
    s_branch CONT_B
LOOP_B:
    s_waitcnt lgkmcnt(1)
    s_setprio 2
    v_mfma_f32_16x16x32_bf16 v[96:99], v[120:123], v[64:67], v[152:155]
    v_mfma_f32_16x16x32_bf16 v[100:103], v[124:127], v[64:67], v[152:155]
L_BACK_B:
    ds_read_b64_tr_b16 v[120:121], v161 offset:0
    ds_read_b64_tr_b16 v[122:123], v161 offset:512
    ds_read_b64_tr_b16 v[124:125], v161 offset:32
    ds_read_b64_tr_b16 v[126:127], v161 offset:544
    v_add_f32 v162, v162, v164
    v_mfma_f32_16x16x32_bf16 v[96:99], v[128:131], v[68:71], v[96:99]
    ds_read_b64_tr_b16 v[128:129], v161 offset:64
    ds_read_b64_tr_b16 v[130:131], v161 offset:576
    s_movrels_b64 s[24:25], s[36:37]
    v_mfma_f32_16x16x32_bf16 v[100:103], v[132:135], v[68:71], v[100:103]
    ds_read_b64_tr_b16 v[132:133], v161 offset:96
    ds_read_b64_tr_b16 v[134:135], v161 offset:608
    s_add_u32 m0, m0, 2
    v_mfma_f32_16x16x32_bf16 v[96:99], v[136:139], v[72:75], v[96:99]
    ds_read_b64_tr_b16 v[136:137], v161 offset:128
    ds_read_b64_tr_b16 v[138:139], v161 offset:640
    v_mfma_f32_16x16x32_bf16 v[100:103], v[140:143], v[72:75], v[100:103]
    ds_read_b64_tr_b16 v[140:141], v161 offset:160
    ds_read_b64_tr_b16 v[142:143], v161 offset:672
    v_mad_i32_i24 v160, s24, 1, v160
    v_mfma_f32_16x16x32_bf16 v[96:99], v[144:147], v[76:79], v[96:99]
    ds_read_b64_tr_b16 v[144:145], v161 offset:192
    ds_read_b64_tr_b16 v[146:147], v161 offset:704
    ds_read_b64 v[164:165], v166
    v_mfma_f32_16x16x32_bf16 v[100:103], v[148:151], v[76:79], v[100:103]
    s_setprio 3
    ds_read_b64_tr_b16 v[148:149], v161 offset:224
    ds_read_b64_tr_b16 v[150:151], v161 offset:736
    s_waitcnt lgkmcnt(9)
    v_mfma_f32_16x16x32_bf16 v[0:3], v[120:123], v[112:115], v[0:3]
    v_add_u32 v161, s25, v161
    v_mfma_f32_16x16x32_bf16 v[8:11], v[124:127], v[112:115], v[8:11]
    ds_read_b128 v[120:123], v160 offset:0
    ds_read_b128 v[124:127], v160 offset:512
    v_mfma_f32_16x16x32_bf16 v[16:19], v[128:131], v[112:115], v[16:19]
    ds_read_b128 v[128:131], v160 offset:64
    v_mfma_f32_16x16x32_bf16 v[24:27], v[132:135], v[112:115], v[24:27]
    ds_read_b128 v[132:135], v160 offset:576
    s_waitcnt lgkmcnt(4)
    v_mfma_f32_16x16x32_bf16 v[32:35], v[136:139], v[112:115], v[32:35]
    ds_read_b128 v[136:139], v160 offset:128
    v_mfma_f32_16x16x32_bf16 v[40:43], v[140:143], v[112:115], v[40:43]
    ds_read_b128 v[140:143], v160 offset:640
    v_mfma_f32_16x16x32_bf16 v[48:51], v[144:147], v[112:115], v[48:51]
    ds_read_b128 v[144:147], v160 offset:192
    v_min_u32 v164, v164, v165
    v_mfma_f32_16x16x32_bf16 v[56:59], v[148:151], v[112:115], v[56:59]
    ds_read_b128 v[148:151], v160 offset:704
    s_setprio 1
    v_readfirstlane_b32 s19, v164
    v_exp_f32 v96, v96
    v_exp_f32 v97, v97
    v_exp_f32 v98, v98
    v_exp_f32 v99, v99
    v_exp_f32 v100, v100
    v_exp_f32 v101, v101
    v_exp_f32 v102, v102
    v_exp_f32 v103, v103
    v_add_f32 v164, v96, v97
    v_cvt_pk_bf16_f32 v112, v96, v97
    v_add_f32 v164, v164, v98
    v_cvt_pk_bf16_f32 v113, v98, v99
    v_add_f32 v164, v164, v99
    v_cvt_pk_bf16_f32 v114, v100, v101
    v_add_f32 v164, v164, v100
    v_add_f32 v164, v164, v101
    v_add_f32 v164, v164, v102
    v_add_f32 v164, v164, v103
    v_cvt_pk_bf16_f32 v115, v102, v103
    v_cmp_nge_f32 vcc, s18, v164
    s_cbranch_vccnz FRESH_B
    ds_inc_u32 v166, v166 offset:8
    s_cmp_gt_u32 s19, s24
    s_cbranch_scc0 LATE_B
CONT_B:
    s_sub_u32 s21, s21, 1
    s_cbranch_scc1 FINAL_B
    s_cmp_eq_u32 s21, s22
    s_cbranch_scc0 LOOP_B
DRY_IN_B:
    s_mov_b32 s27, 0
MASK_B:
    v_mov_b32 v111, s30
    s_mov_b32 exec_lo, 0xffff0000
    s_mov_b32 exec_hi, 0xffff0000
    v_lshrrev_b32 v111, 8, v111
    s_mov_b32 exec_lo, 0
    s_mov_b32 exec_hi, -1
    v_lshrrev_b32 v111, 1, v111
    s_mov_b32 exec_lo, -1
    v_bfe_i32 v96, v111, 0, 1
    v_bfe_i32 v97, v111, 2, 1
    v_bfe_i32 v98, v111, 4, 1
    v_bfe_i32 v99, v111, 6, 1
    v_bfe_i32 v100, v111, 16, 1
    v_bfe_i32 v101, v111, 18, 1
    v_bfe_i32 v102, v111, 20, 1
    v_bfe_i32 v103, v111, 22, 1
    s_cmp_eq_u32 s27, 0
    s_cbranch_scc0 MASK_F_B
    s_bitcmp1_b32 s33, 12
    s_cbranch_scc1 MASKH_B
    v_bfi_b32 v96, v96, s26, v152
    v_bfi_b32 v97, v97, s26, v152
    v_bfi_b32 v98, v98, s26, v152
    v_bfi_b32 v99, v99, s26, v152
    v_bfi_b32 v100, v100, s26, v152
    v_bfi_b32 v101, v101, s26, v152
    v_bfi_b32 v102, v102, s26, v152
    v_bfi_b32 v103, v103, s26, v152
    s_waitcnt lgkmcnt(0)
    s_nop 0
    v_mfma_f32_16x16x32_bf16 v[96:99], v[120:123], v[64:67], v[96:99]
    v_mfma_f32_16x16x32_bf16 v[100:103], v[124:127], v[64:67], v[100:103]
    s_branch L_BACK_B
MASK_F_B:
    v_lshlrev_b32 v96, 23, v96
    v_lshlrev_b32 v97, 23, v97
    v_lshlrev_b32 v98, 23, v98
    v_lshlrev_b32 v99, 23, v99
    v_lshlrev_b32 v100, 23, v100
    v_lshlrev_b32 v101, 23, v101
    v_lshlrev_b32 v102, 23, v102
    v_lshlrev_b32 v103, 23, v103
    s_waitcnt lgkmcnt(0)
    s_nop 0
    v_mfma_f32_16x16x32_bf16 v[96:99], v[120:123], v[64:67], v[96:99]
    v_mfma_f32_16x16x32_bf16 v[100:103], v[124:127], v[64:67], v[100:103]
    s_branch F_BACK_B
MASKH_B:
    v_bfi_b32 v96, v96, s26, v152
    v_bfi_b32 v97, v97, s26, v152
    v_bfi_b32 v98, v98, s26, v152
    v_bfi_b32 v99, v99, s26, v152
    s_waitcnt lgkmcnt(0)
    s_nop 0
    v_mfma_f32_16x16x32_bf16 v[96:99], v[120:123], v[64:67], v[96:99]
    ds_read_b64_tr_b16 v[120:121], v161 offset:0
    ds_read_b64_tr_b16 v[122:123], v161 offset:512
    ds_read_b64_tr_b16 v[124:125], v161 offset:32
    ds_read_b64_tr_b16 v[126:127], v161 offset:544
    v_add_f32 v162, v162, v164
    v_mfma_f32_16x16x32_bf16 v[96:99], v[128:131], v[68:71], v[96:99]
    ds_read_b64_tr_b16 v[128:129], v161 offset:64
    ds_read_b64_tr_b16 v[130:131], v161 offset:576
    s_movrels_b64 s[24:25], s[36:37]
    ds_read_b64_tr_b16 v[132:133], v161 offset:96
    ds_read_b64_tr_b16 v[134:135], v161 offset:608
    s_add_u32 m0, m0, 2
    v_mfma_f32_16x16x32_bf16 v[96:99], v[136:139], v[72:75], v[96:99]
    ds_read_b64_tr_b16 v[136:137], v161 offset:128
    ds_read_b64_tr_b16 v[138:139], v161 offset:640
    ds_read_b64_tr_b16 v[140:141], v161 offset:160
    ds_read_b64_tr_b16 v[142:143], v161 offset:672
    v_mad_i32_i24 v160, s24, 1, v160
    v_mfma_f32_16x16x32_bf16 v[96:99], v[144:147], v[76:79], v[96:99]
    ds_read_b64_tr_b16 v[144:145], v161 offset:192
    ds_read_b64_tr_b16 v[146:147], v161 offset:704
    ds_read_b64 v[164:165], v166
    s_setprio 3
    ds_read_b64_tr_b16 v[148:149], v161 offset:224
    ds_read_b64_tr_b16 v[150:151], v161 offset:736
    s_waitcnt lgkmcnt(9)
    v_mfma_f32_16x16x32_bf16 v[0:3], v[120:123], v[112:115], v[0:3]
    v_add_u32 v161, s25, v161
    v_mfma_f32_16x16x32_bf16 v[8:11], v[124:127], v[112:115], v[8:11]
    ds_read_b128 v[120:123], v160 offset:0
    ds_read_b128 v[124:127], v160 offset:512
    v_mfma_f32_16x16x32_bf16 v[16:19], v[128:131], v[112:115], v[16:19]
    ds_read_b128 v[128:131], v160 offset:64
    v_mfma_f32_16x16x32_bf16 v[24:27], v[132:135], v[112:115], v[24:27]
    ds_read_b128 v[132:135], v160 offset:576
    s_waitcnt lgkmcnt(4)
    v_mfma_f32_16x16x32_bf16 v[32:35], v[136:139], v[112:115], v[32:35]
    ds_read_b128 v[136:139], v160 offset:128
    v_mfma_f32_16x16x32_bf16 v[40:43], v[140:143], v[112:115], v[40:43]
    ds_read_b128 v[140:143], v160 offset:640
    v_mfma_f32_16x16x32_bf16 v[48:51], v[144:147], v[112:115], v[48:51]
    ds_read_b128 v[144:147], v160 offset:192
    v_min_u32 v164, v164, v165
    v_mfma_f32_16x16x32_bf16 v[56:59], v[148:151], v[112:115], v[56:59]
    ds_read_b128 v[148:151], v160 offset:704
    s_setprio 1
    v_readfirstlane_b32 s19, v164
    v_exp_f32 v96, v96
    v_exp_f32 v97, v97
    v_exp_f32 v98, v98
    v_exp_f32 v99, v99
    v_add_f32 v164, v96, v97
    v_cvt_pk_bf16_f32 v112, v96, v97
    v_add_f32 v164, v164, v98
    v_cvt_pk_bf16_f32 v113, v98, v99
    v_add_f32 v164, v164, v99
    v_mov_b32 v114, 0
    v_mov_b32 v115, 0
    v_cmp_nge_f32 vcc, s18, v164
    s_cbranch_vccnz FRESH_B
    ds_inc_u32 v166, v166 offset:8
    s_cmp_gt_u32 s19, s24
    s_cbranch_scc0 LATE_B
    s_branch CONT_B
FINAL_B:
    s_waitcnt lgkmcnt(4)
    ds_read_b64_tr_b16 v[120:121], v161 offset:0
    ds_read_b64_tr_b16 v[122:123], v161 offset:512
    ds_read_b64_tr_b16 v[124:125], v161 offset:32
    ds_read_b64_tr_b16 v[126:127], v161 offset:544
    ds_read_b64_tr_b16 v[128:129], v161 offset:64
    ds_read_b64_tr_b16 v[130:131], v161 offset:576
    ds_read_b64_tr_b16 v[132:133], v161 offset:96
    ds_read_b64_tr_b16 v[134:135], v161 offset:608
    ds_read_b64_tr_b16 v[136:137], v161 offset:128
    ds_read_b64_tr_b16 v[138:139], v161 offset:640
    v_add_f32 v162, v162, v164
    v_mov_b32 v163, v162
    s_movrels_b32 s3, s41
    s_xor_b32 s4, s28, s15
    v_permlane16_swap_b32 v162, v163
    v_add_f32 v162, v162, v163
    v_mov_b32 v163, v162
    s_add_u32 s4, s10, s4
    s_addc_u32 s5, s11, 0
    s_lshr_b32 s3, s3, 24
    v_permlane32_swap_b32 v162, v163
    v_add_f32 v162, v162, v163
    v_rcp_f32 v162, v162
    v_mbcnt_lo_u32_b32 v108, -1, 0
    v_mbcnt_hi_u32_b32 v108, -1, v108
    v_mov_b32 v164, s3
    s_mov_b32 s6, s29
    v_and_b32 v102, 7, v108
    v_lshrrev_b32 v103, 5, v108
    v_xor_b32 v103, v102, v103
    v_lshl_add_u32 v99, v102, 8, s13
    v_lshl_add_u32 v99, v103, 4, v99
    v_bfe_u32 v102, v108, 3, 1
    v_bfe_u32 v103, v108, 4, 1
    v_lshl_add_u32 v99, v102, 7, v99
    v_lshl_add_u32 v99, v103, 3, v99
    s_setprio 3
    s_waitcnt lgkmcnt(8)
    v_mfma_f32_16x16x32_bf16 v[0:3], v[120:123], v[112:115], v[0:3]
    ds_read_b64_tr_b16 v[140:141], v161 offset:160
    ds_read_b64_tr_b16 v[142:143], v161 offset:672
    v_lshrrev_b32 v109, 3, v108
    v_and_b32 v110, 7, v108
    v_lshrrev_b32 v108, 4, v108
    s_waitcnt lgkmcnt(8)
    v_mfma_f32_16x16x32_bf16 v[8:11], v[124:127], v[112:115], v[8:11]
    ds_read_b64_tr_b16 v[144:145], v161 offset:192
    ds_read_b64_tr_b16 v[146:147], v161 offset:704
    v_xor_b32 v108, v108, v110
    v_lshl_add_u32 v100, v109, 7, s13
    v_xor_b32 v96, 32, v99
    s_waitcnt lgkmcnt(8)
    v_mfma_f32_16x16x32_bf16 v[16:19], v[128:131], v[112:115], v[16:19]
    ds_read_b64_tr_b16 v[148:149], v161 offset:224
    ds_read_b64_tr_b16 v[150:151], v161 offset:736
    v_lshl_add_u32 v100, v108, 4, v100
    v_xor_b32 v97, 64, v99
    v_xor_b32 v98, 0x60, v99
    s_waitcnt lgkmcnt(8)
    v_mfma_f32_16x16x32_bf16 v[24:27], v[132:135], v[112:115], v[24:27]
    v_mul_f32 v0, v0, v162
    v_mul_f32 v1, v1, v162
    v_mul_f32 v2, v2, v162
    v_mul_f32 v3, v3, v162
    v_cvt_pk_bf16_f32 v64, v0, v1
    v_cvt_pk_bf16_f32 v65, v2, v3
    ds_write_b64 v99, v[64:65]
    s_waitcnt lgkmcnt(7)
    v_mfma_f32_16x16x32_bf16 v[32:35], v[136:139], v[112:115], v[32:35]
    v_mul_f32 v8, v8, v162
    v_mul_f32 v9, v9, v162
    v_mul_f32 v10, v10, v162
    v_mul_f32 v11, v11, v162
    v_cvt_pk_bf16_f32 v68, v8, v9
    v_cvt_pk_bf16_f32 v69, v10, v11
    ds_write_b64 v96, v[68:69]
    s_waitcnt lgkmcnt(6)
    v_mfma_f32_16x16x32_bf16 v[40:43], v[140:143], v[112:115], v[40:43]
    v_mul_f32 v16, v16, v162
    v_mul_f32 v17, v17, v162
    v_mul_f32 v18, v18, v162
    v_mul_f32 v19, v19, v162
    v_cvt_pk_bf16_f32 v72, v16, v17
    v_cvt_pk_bf16_f32 v73, v18, v19
    ds_write_b64 v97, v[72:73]
    s_waitcnt lgkmcnt(5)
    v_mfma_f32_16x16x32_bf16 v[48:51], v[144:147], v[112:115], v[48:51]
    v_xor_b32 v101, 64, v100
    v_lshlrev_b32 v104, 12, v109
    v_lshl_add_u32 v104, v110, 4, v104
    s_waitcnt lgkmcnt(3)
    v_mfma_f32_16x16x32_bf16 v[56:59], v[148:151], v[112:115], v[56:59]
    ds_write_b32 v166, v164 offset:8
    s_setprio 0
    s_cmp_eq_u32 s3, 0xff
    s_cbranch_scc1 E_LAST_B
    s_setprio 3
E_LAST_B:
    v_mul_f32 v24, v24, v162
    v_mul_f32 v25, v25, v162
    v_mul_f32 v26, v26, v162
    v_mul_f32 v27, v27, v162
    v_cvt_pk_bf16_f32 v76, v24, v25
    v_cvt_pk_bf16_f32 v77, v26, v27
    ds_write_b64 v98, v[76:77]
    ds_read_b128 v[0:3], v100 offset:0
    ds_read_b128 v[8:11], v101 offset:1024
    v_add_u32 v105, 0x8000, v104
    v_mul_f32 v32, v32, v162
    v_mul_f32 v33, v33, v162
    v_mul_f32 v34, v34, v162
    v_mul_f32 v35, v35, v162
    v_cvt_pk_bf16_f32 v80, v32, v33
    v_cvt_pk_bf16_f32 v81, v34, v35
    ds_write_b64 v99, v[80:81]
    v_mul_f32 v40, v40, v162
    v_mul_f32 v41, v41, v162
    v_mul_f32 v42, v42, v162
    v_mul_f32 v43, v43, v162
    v_cvt_pk_bf16_f32 v84, v40, v41
    v_cvt_pk_bf16_f32 v85, v42, v43
    ds_write_b64 v96, v[84:85]
    v_mul_f32 v48, v48, v162
    v_mul_f32 v49, v49, v162
    v_mul_f32 v50, v50, v162
    v_mul_f32 v51, v51, v162
    v_cvt_pk_bf16_f32 v88, v48, v49
    v_cvt_pk_bf16_f32 v89, v50, v51
    ds_write_b64 v97, v[88:89]
    v_mul_f32 v56, v56, v162
    v_mul_f32 v57, v57, v162
    v_mul_f32 v58, v58, v162
    v_mul_f32 v59, v59, v162
    v_cvt_pk_bf16_f32 v92, v56, v57
    v_cvt_pk_bf16_f32 v93, v58, v59
    ds_write_b64 v98, v[92:93]
    ds_read_b128 v[32:35], v100 offset:0
    ds_read_b128 v[40:43], v101 offset:1024
    s_waitcnt lgkmcnt(7)
    buffer_store_dwordx4 v[0:3], v104, s[4:7], 0 offen offset:0 sc0 sc1
    s_waitcnt lgkmcnt(6)
    buffer_store_dwordx4 v[8:11], v105, s[4:7], 0 offen offset:0 sc0 sc1
    s_waitcnt lgkmcnt(1)
    buffer_store_dwordx4 v[32:35], v104, s[4:7], 0 offen offset:128 sc0 sc1
    s_waitcnt lgkmcnt(0)
    buffer_store_dwordx4 v[40:43], v105, s[4:7], 0 offen offset:128 sc0 sc1
    s_setprio 1
    s_branch TASK
FRESH_B:
    v_mad_i32_i24 v160, s24, -1, v160
    s_waitcnt lgkmcnt(7)
    ds_read_b128 v[120:123], v160 offset:0
    ds_read_b128 v[124:127], v160 offset:512
    ds_read_b128 v[128:131], v160 offset:64
    ds_read_b128 v[132:135], v160 offset:576
    ds_read_b128 v[136:139], v160 offset:128
    ds_read_b128 v[140:143], v160 offset:640
    ds_read_b128 v[144:147], v160 offset:192
    ds_read_b128 v[148:151], v160 offset:704
    s_cmp_eq_u32 s21, s22
    s_cbranch_scc1 FMASK_B
    s_waitcnt lgkmcnt(7)
    v_mfma_f32_16x16x32_bf16 v[96:99], v[120:123], v[64:67], 0
    s_waitcnt lgkmcnt(6)
    v_mfma_f32_16x16x32_bf16 v[100:103], v[124:127], v[64:67], 0
F_BACK_B:
    ds_read_b64 v[164:165], v166
    s_waitcnt lgkmcnt(6)
    v_mfma_f32_16x16x32_bf16 v[96:99], v[128:131], v[68:71], v[96:99]
    s_waitcnt lgkmcnt(5)
    v_mfma_f32_16x16x32_bf16 v[100:103], v[132:135], v[68:71], v[100:103]
    s_waitcnt lgkmcnt(4)
    v_mfma_f32_16x16x32_bf16 v[96:99], v[136:139], v[72:75], v[96:99]
    s_waitcnt lgkmcnt(3)
    v_mfma_f32_16x16x32_bf16 v[100:103], v[140:143], v[72:75], v[100:103]
    s_waitcnt lgkmcnt(2)
    v_mfma_f32_16x16x32_bf16 v[96:99], v[144:147], v[76:79], v[96:99]
    s_waitcnt lgkmcnt(1)
    v_mfma_f32_16x16x32_bf16 v[100:103], v[148:151], v[76:79], v[100:103]
    s_branch F_NZ_B
FMASK_B:
    s_mov_b32 s27, 1
    s_branch MASK_B
RESCALE_B:
    v_sub_f32 v112, v164, v152
    v_exp_f32 v112, v112
    s_nop 0
    v_mul_f32 v162, v162, v112
    v_mul_f32 v0, v0, v112
    v_mul_f32 v1, v1, v112
    v_mul_f32 v2, v2, v112
    v_mul_f32 v3, v3, v112
    v_mul_f32 v8, v8, v112
    v_mul_f32 v9, v9, v112
    v_mul_f32 v10, v10, v112
    v_mul_f32 v11, v11, v112
    v_mul_f32 v16, v16, v112
    v_mul_f32 v17, v17, v112
    v_mul_f32 v18, v18, v112
    v_mul_f32 v19, v19, v112
    v_mul_f32 v24, v24, v112
    v_mul_f32 v25, v25, v112
    v_mul_f32 v26, v26, v112
    v_mul_f32 v27, v27, v112
    v_mul_f32 v32, v32, v112
    v_mul_f32 v33, v33, v112
    v_mul_f32 v34, v34, v112
    v_mul_f32 v35, v35, v112
    v_mul_f32 v40, v40, v112
    v_mul_f32 v41, v41, v112
    v_mul_f32 v42, v42, v112
    v_mul_f32 v43, v43, v112
    v_mul_f32 v48, v48, v112
    v_mul_f32 v49, v49, v112
    v_mul_f32 v50, v50, v112
    v_mul_f32 v51, v51, v112
    v_mul_f32 v56, v56, v112
    v_mul_f32 v57, v57, v112
    v_mul_f32 v58, v58, v112
    v_mul_f32 v59, v59, v112
    s_branch R_BACK_B
.p2align 6
TABLE:
    .long 0x36e000, 0x51300e, 0x38e000, 0x451300c, 0x3ce000, 0x851300c, 0x40e000, 0xc51300c
    .long 0x36e000, 0x1051300d, 0x38e000, 0x1451300d, 0x3ae000, 0x1851300d, 0x3ce000, 0x1c51300e
    .long 0x260f001, 0x268600e, 0x23ee004, 0x651300d, 0x240e010, 0xa51300e, 0x260f07f, 0x68600d
    .long 0x442e07f, 0x1051300d, 0x644e07f, 0x1451300e, 0x4262f080, 0x1a68600d, 0x846e07f, 0x1c51300d
    .long 0x4248e400, 0x851300e, 0xa64f07f, 0x1e68600d, 0xc4ae07f, 0xa51300d, 0xe4ce07f, 0xe51300e
    .long 0x4466f480, 0x1268600d, 0x104ee07f, 0x1451300d, 0x4650e480, 0x1a51300d, 0x0, 0x0
    .long 0x0, 0x0, 0x0, 0x0, 0x0, 0x0, 0x0, 0x0
    .long 0x0, 0x0, 0x0, 0x0, 0x0, 0x0, 0x0, 0x0
    .long 0x36e000, 0x251300c, 0x3ae000, 0x651300c, 0x3ee000, 0xa51300c, 0x42e000, 0xe51300c
    .long 0x38e000, 0x1251300e, 0x3ae000, 0x1651300e, 0x60f000, 0x1a68600c, 0x3ce000, 0x1e51300d
    .long 0x23ee002, 0x451300e, 0x262f008, 0x868600c, 0x240e020, 0xc51300d, 0x242e040, 0xe51300e
    .long 0x462f07f, 0x1268600e, 0x644e07f, 0x1651300d, 0x846e07f, 0x1851300e, 0x4264f480, 0x268600e
    .long 0xa48e07f, 0x451300d, 0xc4ae07f, 0x651300e, 0xe66f07f, 0xc68600e, 0x444ce480, 0x51300d
    .long 0x104ee07f, 0x1051300e, 0x4650e480, 0x251300e, 0x0, 0x0, 0x0, 0x0
    .long 0x0, 0x0, 0x0, 0x0, 0x0, 0x0, 0x0, 0x0
    .long 0x0, 0x0, 0x0, 0x0, 0x0, 0x0, 0x0, 0x0
    .long 0x0, 0x0, 0x0, 0x0, 0x0, 0xff000000, 0x0, 0x0
    .long 0x0, 0x0, 0x0, 0x0, 0x0, 0x0, 0x0, 0x0
    .long 0x0, 0x0, 0x0, 0x0, 0x0, 0x0, 0x0, 0x0
    .long 0x0, 0x0, 0x0, 0x0, 0x0, 0x0, 0x0, 0x0
    .long 0x0, 0x0, 0x0, 0x0, 0x0, 0x0, 0x0, 0x0
    .long 0x0, 0x0, 0x0, 0x0, 0x0, 0x0, 0x0, 0x0
    .long 0x0, 0x0, 0x0, 0x0, 0x0, 0x0, 0x0, 0x0
    .long 0x0, 0x0, 0x0, 0x0, 0x0, 0x0, 0x0, 0x0
    .long 0x62f000, 0x1f100, 0xff800000, 0x1300d380, 0x30070e0, 0x20000000, 0x19010700, 0x5000
    .long 0x1ffef900, 0x1ab60, 0x2500a460, 0x41c0, 0x28000000, 0xffff3ac0, 0x0, 0x0
    .long 0x0, 0x0, 0x0, 0xff000000, 0x0, 0x0, 0x0, 0x0
    .long 0x0, 0x0, 0x0, 0x0, 0x0, 0x0, 0x0, 0x0
    .long 0x0, 0x0, 0x0, 0x0, 0x0, 0x0, 0x0, 0x0
    .long 0x0, 0x0, 0x0, 0x0, 0x0, 0x0, 0x0, 0x0
    .long 0x0, 0x0, 0x0, 0x0, 0x0, 0x0, 0x0, 0x0
    .long 0x0, 0x0, 0x0, 0x0, 0x0, 0x0, 0x0, 0x0
    .long 0x36e000, 0x1f100, 0xffffffe0, 0x10070e0, 0xd005000, 0x1c00, 0x90127e0, 0x15700
    .long 0xb0041c0, 0x41c0, 0xe0062a0, 0x41c0, 0x11fe7580, 0x62a0, 0x140062a0, 0xfffe7580
    .long 0x170041c0, 0x62a0, 0x1a0062a0, 0x41c0, 0x1d0041c0, 0x62a0, 0x20fef900, 0x62a0
    .long 0x23ffdf20, 0xfffe7580, 0x26008380, 0x62a0, 0x290020e0, 0xffff5ba0, 0x2bff19e0, 0x148c0
    .long 0x2c000000, 0x62a0, 0x0, 0x0, 0x0, 0x0, 0x0, 0xff000000
    .long 0x0, 0x0, 0x0, 0x0, 0x0, 0x0, 0x0, 0x0
    .long 0x0, 0x0, 0x0, 0x0, 0x0, 0x0, 0x0, 0x0
    .long 0x0, 0x0, 0x0, 0x0, 0x0, 0x0, 0x0, 0x0
    .long 0x38e000, 0x1f100, 0xffffffe0, 0x20091c0, 0xd005000, 0x1c00, 0x90127e0, 0x15700
    .long 0xb0041c0, 0x41c0, 0xe0062a0, 0x41c0, 0x11fe7580, 0x62a0, 0x140062a0, 0xfffe7580
    .long 0x170041c0, 0x62a0, 0x1a0062a0, 0x41c0, 0x1d0041c0, 0x62a0, 0x20fef900, 0x62a0
    .long 0x23ffdf20, 0xfffe7580, 0x26008380, 0x62a0, 0x290020e0, 0xffff5ba0, 0x2bff19e0, 0x148c0
    .long 0x2c000000, 0x62a0, 0x0, 0x0, 0x0, 0x0, 0x0, 0xff000000
    .long 0x0, 0x0, 0x0, 0x0, 0x0, 0x0, 0x0, 0x0
    .long 0x0, 0x0, 0x0, 0x0, 0x0, 0x0, 0x0, 0x0
    .long 0x0, 0x0, 0x0, 0x0, 0x0, 0x0, 0x0, 0x0
    .long 0x3ae000, 0x1f100, 0xffffffe0, 0x300b2a0, 0xd005000, 0x1c00, 0x90127e0, 0x15700
    .long 0xb0041c0, 0x41c0, 0xe0062a0, 0x41c0, 0x11fe7580, 0x62a0, 0x140062a0, 0xfffe7580
    .long 0x170041c0, 0x62a0, 0x1a0062a0, 0x41c0, 0x1d0041c0, 0x62a0, 0x20fef900, 0x62a0
    .long 0x23ffdf20, 0xfffe7580, 0x26008380, 0x62a0, 0x290020e0, 0xffff5ba0, 0x2bff19e0, 0x148c0
    .long 0x2c000000, 0x62a0, 0x0, 0x0, 0x0, 0x0, 0x0, 0xff000000
    .long 0x0, 0x0, 0x0, 0x0, 0x0, 0x0, 0x0, 0x0
    .long 0x0, 0x0, 0x0, 0x0, 0x0, 0x0, 0x0, 0x0
    .long 0x0, 0x0, 0x0, 0x0, 0x0, 0x0, 0x0, 0x0
    .long 0x3ce000, 0x1f100, 0xffffffe0, 0x400d380, 0xd005000, 0x1c00, 0x90127e0, 0x15700
    .long 0xb0041c0, 0x41c0, 0xe0062a0, 0x41c0, 0x11fe7580, 0x62a0, 0x140062a0, 0xfffe7580
    .long 0x170041c0, 0x62a0, 0x1a0062a0, 0x41c0, 0x1d0041c0, 0x62a0, 0x20fef900, 0x62a0
    .long 0x23ffdf20, 0xfffe7580, 0x26008380, 0x62a0, 0x290020e0, 0xffff5ba0, 0x2bff19e0, 0x148c0
    .long 0x2c000000, 0x62a0, 0x0, 0x0, 0x0, 0x0, 0x0, 0xff000000
    .long 0x0, 0x0, 0x0, 0x0, 0x0, 0x0, 0x0, 0x0
    .long 0x0, 0x0, 0x0, 0x0, 0x0, 0x0, 0x0, 0x0
    .long 0x0, 0x0, 0x0, 0x0, 0x0, 0x0, 0x0, 0x0
    .long 0x3ee000, 0x1f100, 0xffffffe0, 0x500f460, 0xd005000, 0x1000, 0x90127e0, 0x15700
    .long 0xb0041c0, 0x41c0, 0xe0062a0, 0x41c0, 0x11fe7580, 0x62a0, 0x140062a0, 0xfffe7580
    .long 0x170041c0, 0x62a0, 0x1a0062a0, 0x41c0, 0x1d0041c0, 0x62a0, 0x20fef900, 0x62a0
    .long 0x23ffdf20, 0xfffe7580, 0x26008380, 0x62a0, 0x290020e0, 0xffff5ba0, 0x2bff19e0, 0x148c0
    .long 0x2c000000, 0x62a0, 0x0, 0x0, 0x0, 0x0, 0x0, 0xff000000
    .long 0x0, 0x0, 0x0, 0x0, 0x0, 0x0, 0x0, 0x0
    .long 0x0, 0x0, 0x0, 0x0, 0x0, 0x0, 0x0, 0x0
    .long 0x0, 0x0, 0x0, 0x0, 0x0, 0x0, 0x0, 0x0
    .long 0x40e000, 0x1f100, 0xffffffe0, 0x6011540, 0xd005000, 0x1000, 0x90127e0, 0x15700
    .long 0xb0041c0, 0x41c0, 0xe0062a0, 0x41c0, 0x11fe7580, 0x62a0, 0x140062a0, 0xfffe7580
    .long 0x170041c0, 0x62a0, 0x1a0062a0, 0x41c0, 0x1d0041c0, 0x62a0, 0x20fef900, 0x62a0
    .long 0x23ffdf20, 0xfffe7580, 0x26008380, 0x62a0, 0x290020e0, 0xffff5ba0, 0x2bff19e0, 0x148c0
    .long 0x2c000000, 0x62a0, 0x0, 0x0, 0x0, 0x0, 0x0, 0xff000000
    .long 0x0, 0x0, 0x0, 0x0, 0x0, 0x0, 0x0, 0x0
    .long 0x0, 0x0, 0x0, 0x0, 0x0, 0x0, 0x0, 0x0
    .long 0x0, 0x0, 0x0, 0x0, 0x0, 0x0, 0x0, 0x0
    .long 0x42e000, 0x1f100, 0xffffffe0, 0x7013620, 0xd005000, 0x1000, 0x90127e0, 0x15700
    .long 0xb0041c0, 0x41c0, 0xe0062a0, 0x41c0, 0x11fe7580, 0x62a0, 0x140062a0, 0xfffe7580
    .long 0x170041c0, 0x62a0, 0x1a0062a0, 0x41c0, 0x1d0041c0, 0x62a0, 0x20fef900, 0x62a0
    .long 0x23ffdf20, 0xfffe7580, 0x26008380, 0x62a0, 0x290020e0, 0xffff5ba0, 0x2bff19e0, 0x148c0
    .long 0x2c000000, 0x62a0, 0x0, 0x0, 0x0, 0x0, 0x0, 0xff000000
    .long 0x0, 0x0, 0x0, 0x0, 0x0, 0x0, 0x0, 0x0
    .long 0x0, 0x0, 0x0, 0x0, 0x0, 0x0, 0x0, 0x0
    .long 0x0, 0x0, 0x0, 0x0, 0x0, 0x0, 0x0, 0x0
    .long 0x60f000, 0x1f100, 0xff800000, 0x1001fb60, 0x30070e0, 0x20000000, 0x19010700, 0x5000
    .long 0x1ffef900, 0x1ab60, 0x2500a460, 0x41c0, 0x28000000, 0xffff3ac0, 0x0, 0x0
    .long 0x0, 0x0, 0x0, 0xff000000, 0x0, 0x0, 0x0, 0x0
    .long 0x0, 0x0, 0x0, 0x0, 0x0, 0x0, 0x0, 0x0
    .long 0x0, 0x0, 0x0, 0x0, 0x0, 0x0, 0x0, 0x0
    .long 0x0, 0x0, 0x0, 0x0, 0x0, 0x0, 0x0, 0x0
    .long 0x0, 0x0, 0x0, 0x0, 0x0, 0x0, 0x0, 0x0
    .long 0x0, 0x0, 0x0, 0x0, 0x0, 0x0, 0x0, 0x0
    .long 0xafa100, 0xcb000e, 0xb1a100, 0x4cb000c, 0xb7a100, 0x8cb000c, 0xbba100, 0xccb000c
    .long 0xb1a100, 0x10cb000e, 0xb3a100, 0x14cb000e, 0xb5a100, 0x18cb000e, 0x2b5a102, 0x4cb000d
    .long 0x2b7a110, 0x8cb000d, 0x2b9a140, 0xccb000d, 0x2bba17f, 0xcb000d, 0x4bda17f, 0x10cb000d
    .long 0x6bfa17f, 0x14cb000d, 0x8c1a17f, 0x18cb000d, 0xac3a17f, 0x4cb000d, 0xcc5a17f, 0x8cb000d
    .long 0xec7a17f, 0x2cb000d, 0x10c9a17f, 0xcb000d, 0x0, 0x0, 0x0, 0x0
    .long 0x0, 0x0, 0x0, 0x0, 0x0, 0x0, 0x0, 0x0
    .long 0x0, 0x0, 0x0, 0x0, 0x0, 0x0, 0x0, 0x0
    .long 0x0, 0x0, 0x0, 0x0, 0x0, 0x0, 0x0, 0x0
    .long 0xafa100, 0x2cb000c, 0xb3a100, 0x6cb000c, 0xb9a100, 0xacb000c, 0xafa100, 0xecb000d
    .long 0xb1a100, 0x12cb000d, 0xb3a100, 0x16cb000d, 0x2b5a101, 0x2cb000c, 0x2b7a104, 0x6cb000e
    .long 0x2b9a120, 0xacb000e, 0x2bba108, 0x2cb000e, 0x4bda17f, 0xecb000e, 0x6bfa17f, 0x12cb000e
    .long 0x8c1a17f, 0x16cb000e, 0xac3a17f, 0x6cb000e, 0xcc5a17f, 0xacb000e, 0xec7a17f, 0xccb000e
    .long 0x10c9a17f, 0xecb000e, 0x0, 0x0, 0x0, 0x0, 0x0, 0x0
    .long 0x0, 0x0, 0x0, 0x0, 0x0, 0x0, 0x0, 0x0
    .long 0x0, 0x0, 0x0, 0x0, 0x0, 0x0, 0x0, 0x0
    .long 0x0, 0x0, 0x0, 0x0, 0x0, 0x0, 0x0, 0x0
    .long 0x0, 0x0, 0x0, 0x0, 0x0, 0xff000000, 0x0, 0x0
    .long 0x0, 0x0, 0x0, 0x0, 0x0, 0x0, 0x0, 0x0
    .long 0x0, 0x0, 0x0, 0x0, 0x0, 0x0, 0x0, 0x0
    .long 0x0, 0x0, 0x0, 0x0, 0x0, 0x0, 0x0, 0x0
    .long 0x0, 0x0, 0x0, 0x0, 0x0, 0x0, 0x0, 0x0
    .long 0x0, 0x0, 0x0, 0x0, 0x0, 0x0, 0x0, 0x0
    .long 0x0, 0x0, 0x0, 0x0, 0x0, 0x0, 0x0, 0x0
    .long 0x0, 0x0, 0x0, 0x0, 0x0, 0x0, 0x0, 0x0
    .long 0x0, 0x0, 0x0, 0x0, 0x0, 0xff000000, 0x0, 0x0
    .long 0x0, 0x0, 0x0, 0x0, 0x0, 0x0, 0x0, 0x0
    .long 0x0, 0x0, 0x0, 0x0, 0x0, 0x0, 0x0, 0x0
    .long 0x0, 0x0, 0x0, 0x0, 0x0, 0x0, 0x0, 0x0
    .long 0x0, 0x0, 0x0, 0x0, 0x0, 0x0, 0x0, 0x0
    .long 0x0, 0x0, 0x0, 0x0, 0x0, 0x0, 0x0, 0x0
    .long 0x0, 0x0, 0x0, 0x0, 0x0, 0x0, 0x0, 0x0
    .long 0x0, 0x0, 0x0, 0x0, 0x0, 0x0, 0x0, 0x0
    .long 0xafa100, 0x1f100, 0xffc00000, 0x10070e0, 0xd005000, 0xc00, 0x8010700, 0x13620
    .long 0xa0041c0, 0x41c0, 0xc0041c0, 0x41c0, 0xffed820, 0xfffed820, 0x110041c0, 0x41c0
    .long 0x13ff7c80, 0x41c0, 0x1500c540, 0xffff3ac0, 0x170041c0, 0x10700, 0x190041c0, 0x41c0
    .long 0x1bfef900, 0x41c0, 0x1d0041c0, 0xfffeb740, 0x1f0020e0, 0x41c0, 0x210020e0, 0xffff9d60
    .long 0x22000000, 0xffffdf20, 0x0, 0x0, 0x0, 0x0, 0x0, 0xff000000
    .long 0x0, 0x0, 0x0, 0x0, 0x0, 0x0, 0x0, 0x0
    .long 0x0, 0x0, 0x0, 0x0, 0x0, 0x0, 0x0, 0x0
    .long 0x0, 0x0, 0x0, 0x0, 0x0, 0x0, 0x0, 0x0
    .long 0xb1a100, 0x1f100, 0xffc00000, 0x20091c0, 0xd005000, 0xc00, 0x8010700, 0x13620
    .long 0xa0041c0, 0x41c0, 0xc0041c0, 0x41c0, 0xffed820, 0xfffed820, 0x110041c0, 0x41c0
    .long 0x13ff7c80, 0x41c0, 0x1500c540, 0xffff3ac0, 0x170041c0, 0x10700, 0x190041c0, 0x41c0
    .long 0x1bfef900, 0x41c0, 0x1d0041c0, 0xfffeb740, 0x1f0020e0, 0x41c0, 0x210020e0, 0xffff9d60
    .long 0x22000000, 0xffffdf20, 0x0, 0x0, 0x0, 0x0, 0x0, 0xff000000
    .long 0x0, 0x0, 0x0, 0x0, 0x0, 0x0, 0x0, 0x0
    .long 0x0, 0x0, 0x0, 0x0, 0x0, 0x0, 0x0, 0x0
    .long 0x0, 0x0, 0x0, 0x0, 0x0, 0x0, 0x0, 0x0
    .long 0xb3a100, 0x1f100, 0xffc00000, 0x300b2a0, 0xd005000, 0xc00, 0x8010700, 0x13620
    .long 0xa0041c0, 0x41c0, 0xc0041c0, 0x41c0, 0xffed820, 0xfffed820, 0x110041c0, 0x41c0
    .long 0x13ff7c80, 0x41c0, 0x1500c540, 0xffff3ac0, 0x170041c0, 0x10700, 0x190041c0, 0x41c0
    .long 0x1bfef900, 0x41c0, 0x1d0041c0, 0xfffeb740, 0x1f0020e0, 0x41c0, 0x210020e0, 0xffff9d60
    .long 0x22000000, 0xffffdf20, 0x0, 0x0, 0x0, 0x0, 0x0, 0xff000000
    .long 0x0, 0x0, 0x0, 0x0, 0x0, 0x0, 0x0, 0x0
    .long 0x0, 0x0, 0x0, 0x0, 0x0, 0x0, 0x0, 0x0
    .long 0x0, 0x0, 0x0, 0x0, 0x0, 0x0, 0x0, 0x0
    .long 0xb5a100, 0x1f100, 0xffc00000, 0xd0070e0, 0xd005000, 0xc00, 0x8010700, 0x13620
    .long 0xa0041c0, 0x41c0, 0xc0041c0, 0x41c0, 0xffed820, 0xfffed820, 0x110041c0, 0x41c0
    .long 0x13ff7c80, 0x41c0, 0x1500c540, 0xffff3ac0, 0x170041c0, 0x10700, 0x190041c0, 0x41c0
    .long 0x1bfef900, 0x41c0, 0x1d0041c0, 0xfffeb740, 0x1f0020e0, 0x41c0, 0x210020e0, 0xffff9d60
    .long 0x22000000, 0xffffdf20, 0x0, 0x0, 0x0, 0x0, 0x0, 0xff000000
    .long 0x0, 0x0, 0x0, 0x0, 0x0, 0x0, 0x0, 0x0
    .long 0x0, 0x0, 0x0, 0x0, 0x0, 0x0, 0x0, 0x0
    .long 0x0, 0x0, 0x0, 0x0, 0x0, 0x0, 0x0, 0x0
    .long 0xb7a100, 0x1f100, 0xffc00000, 0x400d380, 0xd005000, 0x0, 0x8010700, 0x13620
    .long 0xa0041c0, 0x41c0, 0xc0041c0, 0x41c0, 0xffed820, 0xfffed820, 0x110041c0, 0x41c0
    .long 0x13ff7c80, 0x41c0, 0x1500c540, 0xffff3ac0, 0x170041c0, 0x10700, 0x190041c0, 0x41c0
    .long 0x1bfef900, 0x41c0, 0x1d0041c0, 0xfffeb740, 0x1f0020e0, 0x41c0, 0x210020e0, 0xffff9d60
    .long 0x22000000, 0xffffdf20, 0x0, 0x0, 0x0, 0x0, 0x0, 0xff000000
    .long 0x0, 0x0, 0x0, 0x0, 0x0, 0x0, 0x0, 0x0
    .long 0x0, 0x0, 0x0, 0x0, 0x0, 0x0, 0x0, 0x0
    .long 0x0, 0x0, 0x0, 0x0, 0x0, 0x0, 0x0, 0x0
    .long 0xb9a100, 0x1f100, 0xffc00000, 0x500f460, 0xd005000, 0x0, 0x8010700, 0x13620
    .long 0xa0041c0, 0x41c0, 0xc0041c0, 0x41c0, 0xffed820, 0xfffed820, 0x110041c0, 0x41c0
    .long 0x13ff7c80, 0x41c0, 0x1500c540, 0xffff3ac0, 0x170041c0, 0x10700, 0x190041c0, 0x41c0
    .long 0x1bfef900, 0x41c0, 0x1d0041c0, 0xfffeb740, 0x1f0020e0, 0x41c0, 0x210020e0, 0xffff9d60
    .long 0x22000000, 0xffffdf20, 0x0, 0x0, 0x0, 0x0, 0x0, 0xff000000
    .long 0x0, 0x0, 0x0, 0x0, 0x0, 0x0, 0x0, 0x0
    .long 0x0, 0x0, 0x0, 0x0, 0x0, 0x0, 0x0, 0x0
    .long 0x0, 0x0, 0x0, 0x0, 0x0, 0x0, 0x0, 0x0
    .long 0xbba100, 0x1f100, 0xffc00000, 0x6011540, 0xd005000, 0x0, 0x8010700, 0x13620
    .long 0xa0041c0, 0x41c0, 0xc0041c0, 0x41c0, 0xffed820, 0xfffed820, 0x110041c0, 0x41c0
    .long 0x13ff7c80, 0x41c0, 0x1500c540, 0xffff3ac0, 0x170041c0, 0x10700, 0x190041c0, 0x41c0
    .long 0x1bfef900, 0x41c0, 0x1d0041c0, 0xfffeb740, 0x1f0020e0, 0x41c0, 0x210020e0, 0xffff9d60
    .long 0x22000000, 0xffffdf20, 0x0, 0x0, 0x0, 0x0, 0x0, 0xff000000
    .long 0x0, 0x0, 0x0, 0x0, 0x0, 0x0, 0x0, 0x0
    .long 0x0, 0x0, 0x0, 0x0, 0x0, 0x0, 0x0, 0x0
    .long 0x0, 0x0, 0x0, 0x0, 0x0, 0x0, 0x0, 0x0
    .long 0x0, 0x0, 0x0, 0x0, 0x0, 0xff000000, 0x0, 0x0
    .long 0x0, 0x0, 0x0, 0x0, 0x0, 0x0, 0x0, 0x0
    .long 0x0, 0x0, 0x0, 0x0, 0x0, 0x0, 0x0, 0x0
    .long 0x0, 0x0, 0x0, 0x0, 0x0, 0x0, 0x0, 0x0
    .long 0x0, 0x0, 0x0, 0x0, 0x0, 0x0, 0x0, 0x0
    .long 0x0, 0x0, 0x0, 0x0, 0x0, 0x0, 0x0, 0x0
    .long 0x0, 0x0, 0x0, 0x0, 0x0, 0x0, 0x0, 0x0
    .long 0x0, 0x0, 0x0, 0x0, 0x0, 0x0, 0x0, 0x0
    .long 0xcb0100, 0xd8f00e, 0xcd0100, 0x4d8f00c, 0xd10100, 0x8d8f00c, 0xd50100, 0xcd8f00c
    .long 0xcb0100, 0x10d8f00d, 0x100, 0x1414100e, 0x120100, 0x1814100c, 0x100, 0x1c14100d
    .long 0x42cd0104, 0x2d8f00d, 0x42020140, 0x614100d, 0x42cf0110, 0xad8f00d, 0x420403fc, 0x14100d
    .long 0x2d10101, 0x16d8f00d, 0x440603fc, 0x1014100d, 0x2d30503, 0x14d8f00d, 0x4080503, 0x1c14100d
    .long 0x46d503fc, 0x2d8f00d, 0x60a0503, 0x614100d, 0x48d703fc, 0xad8f00d, 0x80e0503, 0x14100e
    .long 0x4a1003fc, 0x1814100e, 0xa120503, 0x1214100e, 0x4c1403fc, 0x1a14100e, 0x0, 0x0
    .long 0x0, 0x0, 0x0, 0x0, 0x0, 0x0, 0x0, 0x0
    .long 0x0, 0x0, 0x0, 0x0, 0x0, 0x0, 0x0, 0x0
    .long 0xcb0100, 0x2d8f00c, 0xcf0100, 0x6d8f00c, 0xd30100, 0xad8f00c, 0xd70100, 0xed8f00c
    .long 0xcd0100, 0x12d8f00e, 0x100100, 0x1614100c, 0x140100, 0x1a14100c, 0x20100, 0x1e14100e
    .long 0x42cf0108, 0x4d8f00e, 0x42040300, 0x814100e, 0x42d10120, 0xcd8f00e, 0x42060180, 0xe14100e
    .long 0x2d30102, 0x18d8f00e, 0x440803fc, 0x1214100e, 0x2d50500, 0x1ad8f00e, 0x40a0503, 0x1e14100e
    .long 0x46d703fc, 0x4d8f00e, 0x60c0503, 0x814100e, 0x480c03fc, 0xc14100d, 0x80e0503, 0xe14100d
    .long 0x4a1003fc, 0x1614100d, 0xa120503, 0x1014100d, 0x4c1403fc, 0x1414100d, 0x0, 0x0
    .long 0x0, 0x0, 0x0, 0x0, 0x0, 0x0, 0x0, 0x0
    .long 0x0, 0x0, 0x0, 0x0, 0x0, 0x0, 0x0, 0x0
    .long 0xd10100, 0x1f100, 0x80000000, 0x400d380, 0x6005000, 0x20000000, 0x90127e0, 0x15700
    .long 0x11ff19e0, 0xffff19e0, 0x15008380, 0x8380, 0x1900c540, 0xc540, 0x1d0020e0, 0xffffdf20
    .long 0x21fe9660, 0xfffed820, 0x24000000, 0x8380, 0x0, 0x0, 0x0, 0x0
    .long 0x0, 0xff000000, 0x0, 0x0, 0x0, 0x0, 0x0, 0x0
    .long 0x0, 0x0, 0x0, 0x0, 0x0, 0x0, 0x0, 0x0
    .long 0x0, 0x0, 0x0, 0x0, 0x0, 0x0, 0x0, 0x0
    .long 0x0, 0x0, 0x0, 0x0, 0x0, 0x0, 0x0, 0x0
    .long 0x0, 0x0, 0x0, 0x0, 0x0, 0x0, 0x0, 0x0
    .long 0x140100, 0x100, 0xfffffffe, 0xd01fb60, 0xa0198c0, 0x1100, 0xf00a460, 0x21c40
    .long 0x13fe9660, 0xfffe9660, 0x170062a0, 0xffff9d60, 0x1b0041c0, 0x10700, 0x1f00c540, 0xc540
    .long 0x23fe9660, 0xfffe9660, 0x26ff7c80, 0x62a0, 0x28018a80, 0x20e0, 0x2aff9d60, 0x8380
    .long 0x2c008380, 0xffff9d60, 0x2d000000, 0x41c0, 0x0, 0x0, 0x0, 0x0
    .long 0x0, 0xff000000, 0x0, 0x0, 0x0, 0x0, 0x0, 0x0
    .long 0x0, 0x0, 0x0, 0x0, 0x0, 0x0, 0x0, 0x0
    .long 0x0, 0x0, 0x0, 0x0, 0x0, 0x0, 0x0, 0x0
    .long 0x0, 0x0, 0x0, 0x0, 0x0, 0x0, 0x0, 0x0
    .long 0x100100, 0x1f100, 0xfffffffe, 0xb01b9a0, 0xa0198c0, 0x1c00, 0xf00a460, 0x21c40
    .long 0x13fe9660, 0xfffe9660, 0x170062a0, 0xffff9d60, 0x1b0041c0, 0x10700, 0x1f00c540, 0xc540
    .long 0x23fe9660, 0xfffe9660, 0x26ff7c80, 0x62a0, 0x28018a80, 0x20e0, 0x2aff9d60, 0x8380
    .long 0x2c008380, 0xffff9d60, 0x2d000000, 0x41c0, 0x0, 0x0, 0x0, 0x0
    .long 0x0, 0xff000000, 0x0, 0x0, 0x0, 0x0, 0x0, 0x0
    .long 0x0, 0x0, 0x0, 0x0, 0x0, 0x0, 0x0, 0x0
    .long 0x0, 0x0, 0x0, 0x0, 0x0, 0x0, 0x0, 0x0
    .long 0x0, 0x0, 0x0, 0x0, 0x0, 0x0, 0x0, 0x0
    .long 0x120100, 0x1f100, 0xfffffffe, 0xc01da80, 0xa0198c0, 0x1c00, 0xf00a460, 0x21c40
    .long 0x13fe9660, 0xfffe9660, 0x170062a0, 0xffff9d60, 0x1b0041c0, 0x10700, 0x1f00c540, 0xc540
    .long 0x23fe9660, 0xfffe9660, 0x26ff7c80, 0x62a0, 0x28018a80, 0x20e0, 0x2aff9d60, 0x8380
    .long 0x2c008380, 0xffff9d60, 0x2d000000, 0x41c0, 0x0, 0x0, 0x0, 0x0
    .long 0x0, 0xff000000, 0x0, 0x0, 0x0, 0x0, 0x0, 0x0
    .long 0x0, 0x0, 0x0, 0x0, 0x0, 0x0, 0x0, 0x0
    .long 0x0, 0x0, 0x0, 0x0, 0x0, 0x0, 0x0, 0x0
    .long 0x0, 0x0, 0x0, 0x0, 0x0, 0x0, 0x0, 0x0
    .long 0xcb0100, 0x1f100, 0x80000000, 0x10070e0, 0x6005000, 0x20000c00, 0x90127e0, 0x15700
    .long 0x11ff19e0, 0xffff19e0, 0x15008380, 0x8380, 0x1900c540, 0xc540, 0x1d0020e0, 0xffffdf20
    .long 0x21fe9660, 0xfffed820, 0x24000000, 0x8380, 0x0, 0x0, 0x0, 0x0
    .long 0x0, 0xff000000, 0x0, 0x0, 0x0, 0x0, 0x0, 0x0
    .long 0x0, 0x0, 0x0, 0x0, 0x0, 0x0, 0x0, 0x0
    .long 0x0, 0x0, 0x0, 0x0, 0x0, 0x0, 0x0, 0x0
    .long 0x0, 0x0, 0x0, 0x0, 0x0, 0x0, 0x0, 0x0
    .long 0x0, 0x0, 0x0, 0x0, 0x0, 0x0, 0x0, 0x0
    .long 0xcd0100, 0x1f100, 0x80000000, 0x20091c0, 0x6005000, 0x20000c00, 0x90127e0, 0x15700
    .long 0x11ff19e0, 0xffff19e0, 0x15008380, 0x8380, 0x1900c540, 0xc540, 0x1d0020e0, 0xffffdf20
    .long 0x21fe9660, 0xfffed820, 0x24000000, 0x8380, 0x0, 0x0, 0x0, 0x0
    .long 0x0, 0xff000000, 0x0, 0x0, 0x0, 0x0, 0x0, 0x0
    .long 0x0, 0x0, 0x0, 0x0, 0x0, 0x0, 0x0, 0x0
    .long 0x0, 0x0, 0x0, 0x0, 0x0, 0x0, 0x0, 0x0
    .long 0x0, 0x0, 0x0, 0x0, 0x0, 0x0, 0x0, 0x0
    .long 0x0, 0x0, 0x0, 0x0, 0x0, 0x0, 0x0, 0x0
    .long 0xd30100, 0x1f100, 0x80000000, 0x500f460, 0x6005000, 0x20000000, 0x90127e0, 0x15700
    .long 0x11ff19e0, 0xffff19e0, 0x15008380, 0x8380, 0x1900c540, 0xc540, 0x1d0020e0, 0xffffdf20
    .long 0x21fe9660, 0xfffed820, 0x24000000, 0x8380, 0x0, 0x0, 0x0, 0x0
    .long 0x0, 0xff000000, 0x0, 0x0, 0x0, 0x0, 0x0, 0x0
    .long 0x0, 0x0, 0x0, 0x0, 0x0, 0x0, 0x0, 0x0
    .long 0x0, 0x0, 0x0, 0x0, 0x0, 0x0, 0x0, 0x0
    .long 0x0, 0x0, 0x0, 0x0, 0x0, 0x0, 0x0, 0x0
    .long 0x0, 0x0, 0x0, 0x0, 0x0, 0x0, 0x0, 0x0
    .long 0xd50100, 0x1f100, 0x80000000, 0x6011540, 0x6005000, 0x20000000, 0x90127e0, 0x15700
    .long 0x11ff19e0, 0xffff19e0, 0x15008380, 0x8380, 0x1900c540, 0xc540, 0x1d0020e0, 0xffffdf20
    .long 0x21fe9660, 0xfffed820, 0x24000000, 0x8380, 0x0, 0x0, 0x0, 0x0
    .long 0x0, 0xff000000, 0x0, 0x0, 0x0, 0x0, 0x0, 0x0
    .long 0x0, 0x0, 0x0, 0x0, 0x0, 0x0, 0x0, 0x0
    .long 0x0, 0x0, 0x0, 0x0, 0x0, 0x0, 0x0, 0x0
    .long 0x0, 0x0, 0x0, 0x0, 0x0, 0x0, 0x0, 0x0
    .long 0x0, 0x0, 0x0, 0x0, 0x0, 0x0, 0x0, 0x0
    .long 0xcf0100, 0x1f100, 0x80000000, 0x300b2a0, 0x6005000, 0x20000000, 0x90127e0, 0x15700
    .long 0x11ff19e0, 0xffff19e0, 0x15008380, 0x8380, 0x1900c540, 0xc540, 0x1d0020e0, 0xffffdf20
    .long 0x21fe9660, 0xfffed820, 0x24000000, 0x8380, 0x0, 0x0, 0x0, 0x0
    .long 0x0, 0xff000000, 0x0, 0x0, 0x0, 0x0, 0x0, 0x0
    .long 0x0, 0x0, 0x0, 0x0, 0x0, 0x0, 0x0, 0x0
    .long 0x0, 0x0, 0x0, 0x0, 0x0, 0x0, 0x0, 0x0
    .long 0x0, 0x0, 0x0, 0x0, 0x0, 0x0, 0x0, 0x0
    .long 0x0, 0x0, 0x0, 0x0, 0x0, 0x0, 0x0, 0x0
    .long 0xd70100, 0x1e100, 0x80000000, 0x7013620, 0x6005000, 0x20000000, 0x90127e0, 0x15700
    .long 0x11ff19e0, 0xffff19e0, 0x15008380, 0x8380, 0x1900c540, 0xc540, 0x1d0020e0, 0xffffdf20
    .long 0x21fe9660, 0xfffed820, 0x24000000, 0x8380, 0x0, 0x0, 0x0, 0x0
    .long 0x0, 0xff000000, 0x0, 0x0, 0x0, 0x0, 0x0, 0x0
    .long 0x0, 0x0, 0x0, 0x0, 0x0, 0x0, 0x0, 0x0
    .long 0x0, 0x0, 0x0, 0x0, 0x0, 0x0, 0x0, 0x0
    .long 0x0, 0x0, 0x0, 0x0, 0x0, 0x0, 0x0, 0x0
    .long 0x0, 0x0, 0x0, 0x0, 0x0, 0x0, 0x0, 0x0
    .long 0xcb0100, 0xd8f00e, 0xcd0100, 0x4d8f00c, 0xd10100, 0x8d8f00c, 0xd50100, 0xcd8f00c
    .long 0xcb0100, 0x10d8f00d, 0x100, 0x1414100e, 0x120100, 0x1814100c, 0x100, 0x1c14100d
    .long 0x42cd0104, 0x2d8f00d, 0x42020140, 0x614100d, 0x42cf0110, 0xad8f00d, 0x420403fc, 0x14100d
    .long 0x2d10101, 0x16d8f00d, 0x440603fc, 0x1014100d, 0x2d30503, 0x14d8f00d, 0x4080503, 0x1c14100d
    .long 0x46d503fc, 0x2d8f00d, 0x60a0503, 0x614100d, 0x48d703fc, 0xad8f00d, 0x80e0503, 0x14100e
    .long 0x4a1003fc, 0x1614100e, 0xa120503, 0x1014100e, 0x4c1403fc, 0x1a14100e, 0x0, 0x0
    .long 0x0, 0x0, 0x0, 0x0, 0x0, 0x0, 0x0, 0x0
    .long 0x0, 0x0, 0x0, 0x0, 0x0, 0x0, 0x0, 0x0
    .long 0xcb0100, 0x2d8f00c, 0xcf0100, 0x6d8f00c, 0xd30100, 0xad8f00c, 0xd70100, 0xed8f00c
    .long 0xcd0100, 0x12d8f00e, 0x100100, 0x1614100c, 0x140100, 0x1a14100c, 0x20100, 0x1e14100e
    .long 0x42cf0108, 0x4d8f00e, 0x42040300, 0x814100e, 0x42d10120, 0xcd8f00e, 0x42060180, 0xe14100e
    .long 0x2d30102, 0x18d8f00e, 0x440803fc, 0x1214100e, 0x2d50500, 0x1ad8f00e, 0x40a0503, 0x1e14100e
    .long 0x46d703fc, 0x4d8f00e, 0x60c0503, 0x814100e, 0x480c03fc, 0xc14100d, 0x80e0503, 0xe14100d
    .long 0x4a1003fc, 0x1814100d, 0xa120503, 0x1214100d, 0x4c1403fc, 0x1414100d, 0x0, 0x0
    .long 0x0, 0x0, 0x0, 0x0, 0x0, 0x0, 0x0, 0x0
    .long 0x0, 0x0, 0x0, 0x0, 0x0, 0x0, 0x0, 0x0
    .long 0xd10100, 0x1f100, 0x80000000, 0x400d380, 0x6005000, 0x20000000, 0x90127e0, 0x15700
    .long 0x11ff19e0, 0xffff19e0, 0x15008380, 0x8380, 0x1900c540, 0xc540, 0x1d0020e0, 0xffffdf20
    .long 0x21fe9660, 0xfffed820, 0x24000000, 0x8380, 0x0, 0x0, 0x0, 0x0
    .long 0x0, 0xff000000, 0x0, 0x0, 0x0, 0x0, 0x0, 0x0
    .long 0x0, 0x0, 0x0, 0x0, 0x0, 0x0, 0x0, 0x0
    .long 0x0, 0x0, 0x0, 0x0, 0x0, 0x0, 0x0, 0x0
    .long 0x0, 0x0, 0x0, 0x0, 0x0, 0x0, 0x0, 0x0
    .long 0x0, 0x0, 0x0, 0x0, 0x0, 0x0, 0x0, 0x0
    .long 0x140100, 0x100, 0xfffffffe, 0xd01fb60, 0xa0198c0, 0x1100, 0xf00a460, 0x21c40
    .long 0x13fe9660, 0xfffe9660, 0x170062a0, 0xffff9d60, 0x1b0041c0, 0x10700, 0x1f00c540, 0xc540
    .long 0x23fe9660, 0xfffe9660, 0x26ff7c80, 0x62a0, 0x280169a0, 0x20e0, 0x2aff9d60, 0xa460
    .long 0x2c00a460, 0xffff9d60, 0x2d000000, 0x20e0, 0x0, 0x0, 0x0, 0x0
    .long 0x0, 0xff000000, 0x0, 0x0, 0x0, 0x0, 0x0, 0x0
    .long 0x0, 0x0, 0x0, 0x0, 0x0, 0x0, 0x0, 0x0
    .long 0x0, 0x0, 0x0, 0x0, 0x0, 0x0, 0x0, 0x0
    .long 0x0, 0x0, 0x0, 0x0, 0x0, 0x0, 0x0, 0x0
    .long 0x100100, 0x1f100, 0xfffffffe, 0xb01b9a0, 0xa0198c0, 0x1c00, 0xf00a460, 0x21c40
    .long 0x13fe9660, 0xfffe9660, 0x170062a0, 0xffff9d60, 0x1b0041c0, 0x10700, 0x1f00c540, 0xc540
    .long 0x23fe9660, 0xfffe9660, 0x26ff7c80, 0x62a0, 0x280169a0, 0x20e0, 0x2aff9d60, 0xa460
    .long 0x2c00a460, 0xffff9d60, 0x2d000000, 0x20e0, 0x0, 0x0, 0x0, 0x0
    .long 0x0, 0xff000000, 0x0, 0x0, 0x0, 0x0, 0x0, 0x0
    .long 0x0, 0x0, 0x0, 0x0, 0x0, 0x0, 0x0, 0x0
    .long 0x0, 0x0, 0x0, 0x0, 0x0, 0x0, 0x0, 0x0
    .long 0x0, 0x0, 0x0, 0x0, 0x0, 0x0, 0x0, 0x0
    .long 0x120100, 0x1f100, 0xfffffffe, 0xc01da80, 0xa0198c0, 0x1c00, 0xf00a460, 0x21c40
    .long 0x13fe9660, 0xfffe9660, 0x170062a0, 0xffff9d60, 0x1b0041c0, 0x10700, 0x1f00c540, 0xc540
    .long 0x23fe9660, 0xfffe9660, 0x26ff7c80, 0x62a0, 0x280169a0, 0x20e0, 0x2aff9d60, 0xa460
    .long 0x2c00a460, 0xffff9d60, 0x2d000000, 0x20e0, 0x0, 0x0, 0x0, 0x0
    .long 0x0, 0xff000000, 0x0, 0x0, 0x0, 0x0, 0x0, 0x0
    .long 0x0, 0x0, 0x0, 0x0, 0x0, 0x0, 0x0, 0x0
    .long 0x0, 0x0, 0x0, 0x0, 0x0, 0x0, 0x0, 0x0
    .long 0x0, 0x0, 0x0, 0x0, 0x0, 0x0, 0x0, 0x0
    .long 0xcb0100, 0x1f100, 0x80000000, 0x10070e0, 0x6005000, 0x20000c00, 0x90127e0, 0x15700
    .long 0x11ff19e0, 0xffff19e0, 0x15008380, 0x8380, 0x1900c540, 0xc540, 0x1d0020e0, 0xffffdf20
    .long 0x21fe9660, 0xfffed820, 0x24000000, 0x8380, 0x0, 0x0, 0x0, 0x0
    .long 0x0, 0xff000000, 0x0, 0x0, 0x0, 0x0, 0x0, 0x0
    .long 0x0, 0x0, 0x0, 0x0, 0x0, 0x0, 0x0, 0x0
    .long 0x0, 0x0, 0x0, 0x0, 0x0, 0x0, 0x0, 0x0
    .long 0x0, 0x0, 0x0, 0x0, 0x0, 0x0, 0x0, 0x0
    .long 0x0, 0x0, 0x0, 0x0, 0x0, 0x0, 0x0, 0x0
    .long 0xcd0100, 0x1f100, 0x80000000, 0x20091c0, 0x6005000, 0x20000c00, 0x90127e0, 0x15700
    .long 0x11ff19e0, 0xffff19e0, 0x15008380, 0x8380, 0x1900c540, 0xc540, 0x1d0020e0, 0xffffdf20
    .long 0x21fe9660, 0xfffed820, 0x24000000, 0x8380, 0x0, 0x0, 0x0, 0x0
    .long 0x0, 0xff000000, 0x0, 0x0, 0x0, 0x0, 0x0, 0x0
    .long 0x0, 0x0, 0x0, 0x0, 0x0, 0x0, 0x0, 0x0
    .long 0x0, 0x0, 0x0, 0x0, 0x0, 0x0, 0x0, 0x0
    .long 0x0, 0x0, 0x0, 0x0, 0x0, 0x0, 0x0, 0x0
    .long 0x0, 0x0, 0x0, 0x0, 0x0, 0x0, 0x0, 0x0
    .long 0xd30100, 0x1f100, 0x80000000, 0x500f460, 0x6005000, 0x20000000, 0x90127e0, 0x15700
    .long 0x11ff19e0, 0xffff19e0, 0x15008380, 0x8380, 0x1900c540, 0xc540, 0x1d0020e0, 0xffffdf20
    .long 0x21fe9660, 0xfffed820, 0x24000000, 0x8380, 0x0, 0x0, 0x0, 0x0
    .long 0x0, 0xff000000, 0x0, 0x0, 0x0, 0x0, 0x0, 0x0
    .long 0x0, 0x0, 0x0, 0x0, 0x0, 0x0, 0x0, 0x0
    .long 0x0, 0x0, 0x0, 0x0, 0x0, 0x0, 0x0, 0x0
    .long 0x0, 0x0, 0x0, 0x0, 0x0, 0x0, 0x0, 0x0
    .long 0x0, 0x0, 0x0, 0x0, 0x0, 0x0, 0x0, 0x0
    .long 0xd50100, 0x1f100, 0x80000000, 0x6011540, 0x6005000, 0x20000000, 0x90127e0, 0x15700
    .long 0x11ff19e0, 0xffff19e0, 0x15008380, 0x8380, 0x1900c540, 0xc540, 0x1d0020e0, 0xffffdf20
    .long 0x21fe9660, 0xfffed820, 0x24000000, 0x8380, 0x0, 0x0, 0x0, 0x0
    .long 0x0, 0xff000000, 0x0, 0x0, 0x0, 0x0, 0x0, 0x0
    .long 0x0, 0x0, 0x0, 0x0, 0x0, 0x0, 0x0, 0x0
    .long 0x0, 0x0, 0x0, 0x0, 0x0, 0x0, 0x0, 0x0
    .long 0x0, 0x0, 0x0, 0x0, 0x0, 0x0, 0x0, 0x0
    .long 0x0, 0x0, 0x0, 0x0, 0x0, 0x0, 0x0, 0x0
    .long 0xcf0100, 0x1f100, 0x80000000, 0x300b2a0, 0x6005000, 0x20000000, 0x90127e0, 0x15700
    .long 0x11ff19e0, 0xffff19e0, 0x15008380, 0x8380, 0x1900c540, 0xc540, 0x1d0020e0, 0xffffdf20
    .long 0x21fe9660, 0xfffed820, 0x24000000, 0x8380, 0x0, 0x0, 0x0, 0x0
    .long 0x0, 0xff000000, 0x0, 0x0, 0x0, 0x0, 0x0, 0x0
    .long 0x0, 0x0, 0x0, 0x0, 0x0, 0x0, 0x0, 0x0
    .long 0x0, 0x0, 0x0, 0x0, 0x0, 0x0, 0x0, 0x0
    .long 0x0, 0x0, 0x0, 0x0, 0x0, 0x0, 0x0, 0x0
    .long 0x0, 0x0, 0x0, 0x0, 0x0, 0x0, 0x0, 0x0
    .long 0xd70100, 0x1e100, 0x80000000, 0x7013620, 0x6005000, 0x20000000, 0x90127e0, 0x15700
    .long 0x11ff19e0, 0xffff19e0, 0x15008380, 0x8380, 0x1900c540, 0xc540, 0x1d0020e0, 0xffffdf20
    .long 0x21fe9660, 0xfffed820, 0x24000000, 0x8380, 0x0, 0x0, 0x0, 0x0
    .long 0x0, 0xff000000, 0x0, 0x0, 0x0, 0x0, 0x0, 0x0
    .long 0x0, 0x0, 0x0, 0x0, 0x0, 0x0, 0x0, 0x0
    .long 0x0, 0x0, 0x0, 0x0, 0x0, 0x0, 0x0, 0x0
    .long 0x0, 0x0, 0x0, 0x0, 0x0, 0x0, 0x0, 0x0
    .long 0x0, 0x0, 0x0, 0x0, 0x0, 0x0, 0x0, 0x0
    .long 0x36e100, 0x51300e, 0x38e100, 0x451300c, 0x3ee100, 0x851300c, 0x42e100, 0xc51300c
    .long 0x38e100, 0x1051300e, 0x3ae100, 0x1451300e, 0x3ce100, 0x1851300e, 0x23ce102, 0x451300d
    .long 0x23ee110, 0x851300d, 0x240e140, 0xc51300d, 0x242e17f, 0x51300d, 0x444e17f, 0x1051300d
    .long 0x646e17f, 0x1451300d, 0x848e17f, 0x1851300d, 0xa4ae17f, 0x651300d, 0xc4ce17f, 0xa51300d
    .long 0xe4ee17f, 0xc51300d, 0x1050e17f, 0xe51300d, 0x0, 0x0, 0x0, 0x0
    .long 0x0, 0x0, 0x0, 0x0, 0x0, 0x0, 0x0, 0x0
    .long 0x0, 0x0, 0x0, 0x0, 0x0, 0x0, 0x0, 0x0
    .long 0x0, 0x0, 0x0, 0x0, 0x0, 0x0, 0x0, 0x0
    .long 0x36e100, 0x251300c, 0x3ae100, 0x651300c, 0x40e100, 0xa51300c, 0x36e100, 0xe51300d
    .long 0x38e100, 0x1251300d, 0x3ae100, 0x1651300d, 0x23ce101, 0x251300c, 0x23ee104, 0x651300e
    .long 0x240e120, 0xa51300e, 0x242e108, 0x251300e, 0x444e17f, 0xe51300e, 0x646e17f, 0x1251300e
    .long 0x848e17f, 0x1651300e, 0xa4ae17f, 0x451300e, 0xc4ce17f, 0x851300e, 0xe4ee17f, 0x251300e
    .long 0x1050e17f, 0x51300e, 0x0, 0x0, 0x0, 0x0, 0x0, 0x0
    .long 0x0, 0x0, 0x0, 0x0, 0x0, 0x0, 0x0, 0x0
    .long 0x0, 0x0, 0x0, 0x0, 0x0, 0x0, 0x0, 0x0
    .long 0x0, 0x0, 0x0, 0x0, 0x0, 0x0, 0x0, 0x0
    .long 0x0, 0x0, 0x0, 0x0, 0x0, 0xff000000, 0x0, 0x0
    .long 0x0, 0x0, 0x0, 0x0, 0x0, 0x0, 0x0, 0x0
    .long 0x0, 0x0, 0x0, 0x0, 0x0, 0x0, 0x0, 0x0
    .long 0x0, 0x0, 0x0, 0x0, 0x0, 0x0, 0x0, 0x0
    .long 0x0, 0x0, 0x0, 0x0, 0x0, 0x0, 0x0, 0x0
    .long 0x0, 0x0, 0x0, 0x0, 0x0, 0x0, 0x0, 0x0
    .long 0x0, 0x0, 0x0, 0x0, 0x0, 0x0, 0x0, 0x0
    .long 0x0, 0x0, 0x0, 0x0, 0x0, 0x0, 0x0, 0x0
    .long 0x0, 0x0, 0x0, 0x0, 0x0, 0xff000000, 0x0, 0x0
    .long 0x0, 0x0, 0x0, 0x0, 0x0, 0x0, 0x0, 0x0
    .long 0x0, 0x0, 0x0, 0x0, 0x0, 0x0, 0x0, 0x0
    .long 0x0, 0x0, 0x0, 0x0, 0x0, 0x0, 0x0, 0x0
    .long 0x0, 0x0, 0x0, 0x0, 0x0, 0x0, 0x0, 0x0
    .long 0x0, 0x0, 0x0, 0x0, 0x0, 0x0, 0x0, 0x0
    .long 0x0, 0x0, 0x0, 0x0, 0x0, 0x0, 0x0, 0x0
    .long 0x0, 0x0, 0x0, 0x0, 0x0, 0x0, 0x0, 0x0
    .long 0x36e100, 0x1f100, 0xffffffe0, 0x10070e0, 0xd005000, 0x1c00, 0x8010700, 0x13620
    .long 0xa0041c0, 0x41c0, 0xc0041c0, 0x41c0, 0xffed820, 0xfffed820, 0x110041c0, 0x41c0
    .long 0x13ff7c80, 0x41c0, 0x1500c540, 0xffff3ac0, 0x170041c0, 0x10700, 0x190041c0, 0x41c0
    .long 0x1bfed820, 0x41c0, 0x1d0041c0, 0xfffed820, 0x1fff9d60, 0x41c0, 0x21ffdf20, 0x20e0
    .long 0x22000000, 0x20e0, 0x0, 0x0, 0x0, 0x0, 0x0, 0xff000000
    .long 0x0, 0x0, 0x0, 0x0, 0x0, 0x0, 0x0, 0x0
    .long 0x0, 0x0, 0x0, 0x0, 0x0, 0x0, 0x0, 0x0
    .long 0x0, 0x0, 0x0, 0x0, 0x0, 0x0, 0x0, 0x0
    .long 0x38e100, 0x1f100, 0xffffffe0, 0x20091c0, 0xd005000, 0x1c00, 0x8010700, 0x13620
    .long 0xa0041c0, 0x41c0, 0xc0041c0, 0x41c0, 0xffed820, 0xfffed820, 0x110041c0, 0x41c0
    .long 0x13ff7c80, 0x41c0, 0x1500c540, 0xffff3ac0, 0x170041c0, 0x10700, 0x190041c0, 0x41c0
    .long 0x1bfed820, 0x41c0, 0x1d0041c0, 0xfffed820, 0x1fff9d60, 0x41c0, 0x21ffdf20, 0x20e0
    .long 0x22000000, 0x20e0, 0x0, 0x0, 0x0, 0x0, 0x0, 0xff000000
    .long 0x0, 0x0, 0x0, 0x0, 0x0, 0x0, 0x0, 0x0
    .long 0x0, 0x0, 0x0, 0x0, 0x0, 0x0, 0x0, 0x0
    .long 0x0, 0x0, 0x0, 0x0, 0x0, 0x0, 0x0, 0x0
    .long 0x3ae100, 0x1f100, 0xffffffe0, 0x300b2a0, 0xd005000, 0x1c00, 0x8010700, 0x13620
    .long 0xa0041c0, 0x41c0, 0xc0041c0, 0x41c0, 0xffed820, 0xfffed820, 0x110041c0, 0x41c0
    .long 0x13ff7c80, 0x41c0, 0x1500c540, 0xffff3ac0, 0x170041c0, 0x10700, 0x190041c0, 0x41c0
    .long 0x1bfed820, 0x41c0, 0x1d0041c0, 0xfffed820, 0x1fff9d60, 0x41c0, 0x21ffdf20, 0x20e0
    .long 0x22000000, 0x20e0, 0x0, 0x0, 0x0, 0x0, 0x0, 0xff000000
    .long 0x0, 0x0, 0x0, 0x0, 0x0, 0x0, 0x0, 0x0
    .long 0x0, 0x0, 0x0, 0x0, 0x0, 0x0, 0x0, 0x0
    .long 0x0, 0x0, 0x0, 0x0, 0x0, 0x0, 0x0, 0x0
    .long 0x3ce100, 0x1f100, 0xffffffe0, 0xd0070e0, 0xd005000, 0x1c00, 0x8010700, 0x13620
    .long 0xa0041c0, 0x41c0, 0xc0041c0, 0x41c0, 0xffed820, 0xfffed820, 0x110041c0, 0x41c0
    .long 0x13ff7c80, 0x41c0, 0x1500c540, 0xffff3ac0, 0x170041c0, 0x10700, 0x190041c0, 0x41c0
    .long 0x1bfed820, 0x41c0, 0x1d0041c0, 0xfffed820, 0x1fff9d60, 0x41c0, 0x21ffdf20, 0x20e0
    .long 0x22000000, 0x20e0, 0x0, 0x0, 0x0, 0x0, 0x0, 0xff000000
    .long 0x0, 0x0, 0x0, 0x0, 0x0, 0x0, 0x0, 0x0
    .long 0x0, 0x0, 0x0, 0x0, 0x0, 0x0, 0x0, 0x0
    .long 0x0, 0x0, 0x0, 0x0, 0x0, 0x0, 0x0, 0x0
    .long 0x3ee100, 0x1f100, 0xffffffe0, 0x400d380, 0xd005000, 0x1000, 0x8010700, 0x13620
    .long 0xa0041c0, 0x41c0, 0xc0041c0, 0x41c0, 0xffed820, 0xfffed820, 0x110041c0, 0x41c0
    .long 0x13ff7c80, 0x41c0, 0x1500c540, 0xffff3ac0, 0x170041c0, 0x10700, 0x190041c0, 0x41c0
    .long 0x1bfed820, 0x41c0, 0x1d0041c0, 0xfffed820, 0x1fff9d60, 0x41c0, 0x21ffdf20, 0x20e0
    .long 0x22000000, 0x20e0, 0x0, 0x0, 0x0, 0x0, 0x0, 0xff000000
    .long 0x0, 0x0, 0x0, 0x0, 0x0, 0x0, 0x0, 0x0
    .long 0x0, 0x0, 0x0, 0x0, 0x0, 0x0, 0x0, 0x0
    .long 0x0, 0x0, 0x0, 0x0, 0x0, 0x0, 0x0, 0x0
    .long 0x40e100, 0x1f100, 0xffffffe0, 0x500f460, 0xd005000, 0x1000, 0x8010700, 0x13620
    .long 0xa0041c0, 0x41c0, 0xc0041c0, 0x41c0, 0xffed820, 0xfffed820, 0x110041c0, 0x41c0
    .long 0x13ff7c80, 0x41c0, 0x1500c540, 0xffff3ac0, 0x170041c0, 0x10700, 0x190041c0, 0x41c0
    .long 0x1bfed820, 0x41c0, 0x1d0041c0, 0xfffed820, 0x1fff9d60, 0x41c0, 0x21ffdf20, 0x20e0
    .long 0x22000000, 0x20e0, 0x0, 0x0, 0x0, 0x0, 0x0, 0xff000000
    .long 0x0, 0x0, 0x0, 0x0, 0x0, 0x0, 0x0, 0x0
    .long 0x0, 0x0, 0x0, 0x0, 0x0, 0x0, 0x0, 0x0
    .long 0x0, 0x0, 0x0, 0x0, 0x0, 0x0, 0x0, 0x0
    .long 0x42e100, 0x1f100, 0xffffffe0, 0x6011540, 0xd005000, 0x1000, 0x8010700, 0x13620
    .long 0xa0041c0, 0x41c0, 0xc0041c0, 0x41c0, 0xffed820, 0xfffed820, 0x110041c0, 0x41c0
    .long 0x13ff7c80, 0x41c0, 0x1500c540, 0xffff3ac0, 0x170041c0, 0x10700, 0x190041c0, 0x41c0
    .long 0x1bfed820, 0x41c0, 0x1d0041c0, 0xfffed820, 0x1fff9d60, 0x41c0, 0x21ffdf20, 0x20e0
    .long 0x22000000, 0x20e0, 0x0, 0x0, 0x0, 0x0, 0x0, 0xff000000
    .long 0x0, 0x0, 0x0, 0x0, 0x0, 0x0, 0x0, 0x0
    .long 0x0, 0x0, 0x0, 0x0, 0x0, 0x0, 0x0, 0x0
    .long 0x0, 0x0, 0x0, 0x0, 0x0, 0x0, 0x0, 0x0
    .long 0x0, 0x0, 0x0, 0x0, 0x0, 0xff000000, 0x0, 0x0
    .long 0x0, 0x0, 0x0, 0x0, 0x0, 0x0, 0x0, 0x0
    .long 0x0, 0x0, 0x0, 0x0, 0x0, 0x0, 0x0, 0x0
    .long 0x0, 0x0, 0x0, 0x0, 0x0, 0x0, 0x0, 0x0
    .long 0x0, 0x0, 0x0, 0x0, 0x0, 0x0, 0x0, 0x0
    .long 0x0, 0x0, 0x0, 0x0, 0x0, 0x0, 0x0, 0x0
    .long 0x0, 0x0, 0x0, 0x0, 0x0, 0x0, 0x0, 0x0
    .long 0x0, 0x0, 0x0, 0x0, 0x0, 0x0, 0x0, 0x0
    .long 0xafa000, 0xcb000e, 0xb1a000, 0x4cb000c, 0xb5a000, 0x8cb000c, 0xb9a000, 0xccb000c
    .long 0xafa000, 0x10cb000d, 0xb1a000, 0x14cb000d, 0xb3a000, 0x18cb000d, 0xb5a000, 0x1ccb000e
    .long 0x260f101, 0x268600e, 0x2b7a004, 0x6cb000d, 0x2b9a010, 0xacb000e, 0x260f17f, 0x68600d
    .long 0x4bba07f, 0x10cb000d, 0x6bda07f, 0x14cb000e, 0x4262f180, 0x1a68600d, 0x8bfa07f, 0x1ccb000d
    .long 0x42c1a400, 0x8cb000e, 0xa64f17f, 0x1e68600d, 0xcc3a07f, 0xacb000d, 0xec5a07f, 0xecb000e
    .long 0x4466f580, 0x1268600d, 0x10c7a07f, 0x14cb000d, 0x46c9a480, 0x1acb000d, 0x0, 0x0
    .long 0x0, 0x0, 0x0, 0x0, 0x0, 0x0, 0x0, 0x0
    .long 0x0, 0x0, 0x0, 0x0, 0x0, 0x0, 0x0, 0x0
    .long 0xafa000, 0x2cb000c, 0xb3a000, 0x6cb000c, 0xb7a000, 0xacb000c, 0xbba000, 0xecb000c
    .long 0xb1a000, 0x12cb000e, 0xb3a000, 0x16cb000e, 0x60f100, 0x1a68600c, 0xb5a000, 0x1ecb000d
    .long 0x2b7a002, 0x4cb000e, 0x262f108, 0x868600c, 0x2b9a020, 0xccb000d, 0x2bba040, 0xecb000e
    .long 0x462f17f, 0x1268600e, 0x6bda07f, 0x16cb000d, 0x8bfa07f, 0x18cb000e, 0x4264f580, 0x268600e
    .long 0xac1a07f, 0x4cb000d, 0xcc3a07f, 0x6cb000e, 0xe66f17f, 0xc68600e, 0x44c5a480, 0xcb000d
    .long 0x10c7a07f, 0x10cb000e, 0x46c9a480, 0x2cb000e, 0x0, 0x0, 0x0, 0x0
    .long 0x0, 0x0, 0x0, 0x0, 0x0, 0x0, 0x0, 0x0
    .long 0x0, 0x0, 0x0, 0x0, 0x0, 0x0, 0x0, 0x0
    .long 0x0, 0x0, 0x0, 0x0, 0x0, 0xff000000, 0x0, 0x0
    .long 0x0, 0x0, 0x0, 0x0, 0x0, 0x0, 0x0, 0x0
    .long 0x0, 0x0, 0x0, 0x0, 0x0, 0x0, 0x0, 0x0
    .long 0x0, 0x0, 0x0, 0x0, 0x0, 0x0, 0x0, 0x0
    .long 0x0, 0x0, 0x0, 0x0, 0x0, 0x0, 0x0, 0x0
    .long 0x0, 0x0, 0x0, 0x0, 0x0, 0x0, 0x0, 0x0
    .long 0x0, 0x0, 0x0, 0x0, 0x0, 0x0, 0x0, 0x0
    .long 0x0, 0x0, 0x0, 0x0, 0x0, 0x0, 0x0, 0x0
    .long 0x62f100, 0x1f100, 0xff800000, 0x1300d380, 0x30070e0, 0x20000000, 0x19010700, 0x5000
    .long 0x1ffef900, 0x1ab60, 0x2500a460, 0x41c0, 0x28000000, 0xffff3ac0, 0x0, 0x0
    .long 0x0, 0x0, 0x0, 0xff000000, 0x0, 0x0, 0x0, 0x0
    .long 0x0, 0x0, 0x0, 0x0, 0x0, 0x0, 0x0, 0x0
    .long 0x0, 0x0, 0x0, 0x0, 0x0, 0x0, 0x0, 0x0
    .long 0x0, 0x0, 0x0, 0x0, 0x0, 0x0, 0x0, 0x0
    .long 0x0, 0x0, 0x0, 0x0, 0x0, 0x0, 0x0, 0x0
    .long 0x0, 0x0, 0x0, 0x0, 0x0, 0x0, 0x0, 0x0
    .long 0xafa000, 0x1f100, 0xffc00000, 0x10070e0, 0xd005000, 0xc00, 0x90127e0, 0x15700
    .long 0xb0041c0, 0x41c0, 0xe0062a0, 0x41c0, 0x11fe7580, 0x62a0, 0x140062a0, 0xfffe7580
    .long 0x170041c0, 0x62a0, 0x1a0062a0, 0x41c0, 0x1d0041c0, 0x62a0, 0x20fef900, 0x62a0
    .long 0x23ffdf20, 0xfffe7580, 0x26008380, 0x62a0, 0x290020e0, 0xffff5ba0, 0x2bff19e0, 0x148c0
    .long 0x2c000000, 0x62a0, 0x0, 0x0, 0x0, 0x0, 0x0, 0xff000000
    .long 0x0, 0x0, 0x0, 0x0, 0x0, 0x0, 0x0, 0x0
    .long 0x0, 0x0, 0x0, 0x0, 0x0, 0x0, 0x0, 0x0
    .long 0x0, 0x0, 0x0, 0x0, 0x0, 0x0, 0x0, 0x0
    .long 0xb1a000, 0x1f100, 0xffc00000, 0x20091c0, 0xd005000, 0xc00, 0x90127e0, 0x15700
    .long 0xb0041c0, 0x41c0, 0xe0062a0, 0x41c0, 0x11fe7580, 0x62a0, 0x140062a0, 0xfffe7580
    .long 0x170041c0, 0x62a0, 0x1a0062a0, 0x41c0, 0x1d0041c0, 0x62a0, 0x20fef900, 0x62a0
    .long 0x23ffdf20, 0xfffe7580, 0x26008380, 0x62a0, 0x290020e0, 0xffff5ba0, 0x2bff19e0, 0x148c0
    .long 0x2c000000, 0x62a0, 0x0, 0x0, 0x0, 0x0, 0x0, 0xff000000
    .long 0x0, 0x0, 0x0, 0x0, 0x0, 0x0, 0x0, 0x0
    .long 0x0, 0x0, 0x0, 0x0, 0x0, 0x0, 0x0, 0x0
    .long 0x0, 0x0, 0x0, 0x0, 0x0, 0x0, 0x0, 0x0
    .long 0xb3a000, 0x1f100, 0xffc00000, 0x300b2a0, 0xd005000, 0xc00, 0x90127e0, 0x15700
    .long 0xb0041c0, 0x41c0, 0xe0062a0, 0x41c0, 0x11fe7580, 0x62a0, 0x140062a0, 0xfffe7580
    .long 0x170041c0, 0x62a0, 0x1a0062a0, 0x41c0, 0x1d0041c0, 0x62a0, 0x20fef900, 0x62a0
    .long 0x23ffdf20, 0xfffe7580, 0x26008380, 0x62a0, 0x290020e0, 0xffff5ba0, 0x2bff19e0, 0x148c0
    .long 0x2c000000, 0x62a0, 0x0, 0x0, 0x0, 0x0, 0x0, 0xff000000
    .long 0x0, 0x0, 0x0, 0x0, 0x0, 0x0, 0x0, 0x0
    .long 0x0, 0x0, 0x0, 0x0, 0x0, 0x0, 0x0, 0x0
    .long 0x0, 0x0, 0x0, 0x0, 0x0, 0x0, 0x0, 0x0
    .long 0xb5a000, 0x1f100, 0xffc00000, 0x400d380, 0xd005000, 0xc00, 0x90127e0, 0x15700
    .long 0xb0041c0, 0x41c0, 0xe0062a0, 0x41c0, 0x11fe7580, 0x62a0, 0x140062a0, 0xfffe7580
    .long 0x170041c0, 0x62a0, 0x1a0062a0, 0x41c0, 0x1d0041c0, 0x62a0, 0x20fef900, 0x62a0
    .long 0x23ffdf20, 0xfffe7580, 0x26008380, 0x62a0, 0x290020e0, 0xffff5ba0, 0x2bff19e0, 0x148c0
    .long 0x2c000000, 0x62a0, 0x0, 0x0, 0x0, 0x0, 0x0, 0xff000000
    .long 0x0, 0x0, 0x0, 0x0, 0x0, 0x0, 0x0, 0x0
    .long 0x0, 0x0, 0x0, 0x0, 0x0, 0x0, 0x0, 0x0
    .long 0x0, 0x0, 0x0, 0x0, 0x0, 0x0, 0x0, 0x0
    .long 0xb7a000, 0x1f100, 0xffc00000, 0x500f460, 0xd005000, 0x0, 0x90127e0, 0x15700
    .long 0xb0041c0, 0x41c0, 0xe0062a0, 0x41c0, 0x11fe7580, 0x62a0, 0x140062a0, 0xfffe7580
    .long 0x170041c0, 0x62a0, 0x1a0062a0, 0x41c0, 0x1d0041c0, 0x62a0, 0x20fef900, 0x62a0
    .long 0x23ffdf20, 0xfffe7580, 0x26008380, 0x62a0, 0x290020e0, 0xffff5ba0, 0x2bff19e0, 0x148c0
    .long 0x2c000000, 0x62a0, 0x0, 0x0, 0x0, 0x0, 0x0, 0xff000000
    .long 0x0, 0x0, 0x0, 0x0, 0x0, 0x0, 0x0, 0x0
    .long 0x0, 0x0, 0x0, 0x0, 0x0, 0x0, 0x0, 0x0
    .long 0x0, 0x0, 0x0, 0x0, 0x0, 0x0, 0x0, 0x0
    .long 0xb9a000, 0x1f100, 0xffc00000, 0x6011540, 0xd005000, 0x0, 0x90127e0, 0x15700
    .long 0xb0041c0, 0x41c0, 0xe0062a0, 0x41c0, 0x11fe7580, 0x62a0, 0x140062a0, 0xfffe7580
    .long 0x170041c0, 0x62a0, 0x1a0062a0, 0x41c0, 0x1d0041c0, 0x62a0, 0x20fef900, 0x62a0
    .long 0x23ffdf20, 0xfffe7580, 0x26008380, 0x62a0, 0x290020e0, 0xffff5ba0, 0x2bff19e0, 0x148c0
    .long 0x2c000000, 0x62a0, 0x0, 0x0, 0x0, 0x0, 0x0, 0xff000000
    .long 0x0, 0x0, 0x0, 0x0, 0x0, 0x0, 0x0, 0x0
    .long 0x0, 0x0, 0x0, 0x0, 0x0, 0x0, 0x0, 0x0
    .long 0x0, 0x0, 0x0, 0x0, 0x0, 0x0, 0x0, 0x0
    .long 0xbba000, 0x1f100, 0xffc00000, 0x7013620, 0xd005000, 0x0, 0x90127e0, 0x15700
    .long 0xb0041c0, 0x41c0, 0xe0062a0, 0x41c0, 0x11fe7580, 0x62a0, 0x140062a0, 0xfffe7580
    .long 0x170041c0, 0x62a0, 0x1a0062a0, 0x41c0, 0x1d0041c0, 0x62a0, 0x20fef900, 0x62a0
    .long 0x23ffdf20, 0xfffe7580, 0x26008380, 0x62a0, 0x290020e0, 0xffff5ba0, 0x2bff19e0, 0x148c0
    .long 0x2c000000, 0x62a0, 0x0, 0x0, 0x0, 0x0, 0x0, 0xff000000
    .long 0x0, 0x0, 0x0, 0x0, 0x0, 0x0, 0x0, 0x0
    .long 0x0, 0x0, 0x0, 0x0, 0x0, 0x0, 0x0, 0x0
    .long 0x0, 0x0, 0x0, 0x0, 0x0, 0x0, 0x0, 0x0
    .long 0x60f100, 0x1f100, 0xff800000, 0x1001fb60, 0x30070e0, 0x20000000, 0x19010700, 0x5000
    .long 0x1ffef900, 0x1ab60, 0x2500a460, 0x41c0, 0x28000000, 0xffff3ac0, 0x0, 0x0
    .long 0x0, 0x0, 0x0, 0xff000000, 0x0, 0x0, 0x0, 0x0
    .long 0x0, 0x0, 0x0, 0x0, 0x0, 0x0, 0x0, 0x0
    .long 0x0, 0x0, 0x0, 0x0, 0x0, 0x0, 0x0, 0x0
    .long 0x0, 0x0, 0x0, 0x0, 0x0, 0x0, 0x0, 0x0
    .long 0x0, 0x0, 0x0, 0x0, 0x0, 0x0, 0x0, 0x0
    .long 0x0, 0x0, 0x0, 0x0, 0x0, 0x0, 0x0, 0x0
    .long 0xcb0000, 0xd8f00a, 0xcd0000, 0x4d8f008, 0xd10000, 0x8d8f008, 0xd50000, 0xcd8f008
    .long 0xcb0000, 0x10d8f009, 0x0, 0x1414100a, 0x120000, 0x18141008, 0x0, 0x1a14100d
    .long 0x42cd0004, 0x2d8f00d, 0x42020040, 0x614100d, 0x42cf0200, 0x8d8f00d, 0x420402fc, 0x14100d
    .long 0x2d10001, 0x16d8f00d, 0x2060002, 0x1814100d, 0x2d30403, 0x14d8f00d, 0x4080403, 0x1a14100d
    .long 0x46d502fc, 0x2d8f00d, 0x60a0403, 0x614100d, 0x48d702fc, 0x8d8f00d, 0x80e0403, 0xe14100e
    .long 0x4a1002fc, 0x1614100e, 0xa120403, 0x1814100e, 0x4c1402fc, 0x1c14100e, 0x0, 0x0
    .long 0x0, 0x0, 0x0, 0x0, 0x0, 0x0, 0x0, 0x0
    .long 0x0, 0x0, 0x0, 0x0, 0x0, 0x0, 0x0, 0x0
    .long 0xcb0000, 0x2d8f008, 0xcf0000, 0x6d8f008, 0xd30000, 0xad8f008, 0xd70000, 0xed8f008
    .long 0xcd0000, 0x12d8f00a, 0x100000, 0x16141008, 0x140000, 0x1c141008, 0x20000, 0x1e14100e
    .long 0x42cf0008, 0x4d8f00e, 0x42040010, 0xa14100e, 0x42d10020, 0xcd8f00e, 0x42060080, 0xe14100e
    .long 0x44d302fc, 0x10d8f00e, 0x440802fc, 0x1214100e, 0x2d50400, 0x1cd8f00e, 0x40a0403, 0x1e14100e
    .long 0x46d702fc, 0x4d8f00e, 0x60c0403, 0xa14100e, 0x480c02fc, 0xc14100d, 0x80e0403, 0x14100d
    .long 0x4a1002fc, 0x1014100d, 0xa120403, 0x1214100d, 0x4c1402fc, 0x1414100d, 0x0, 0x0
    .long 0x0, 0x0, 0x0, 0x0, 0x0, 0x0, 0x0, 0x0
    .long 0x0, 0x0, 0x0, 0x0, 0x0, 0x0, 0x0, 0x0
    .long 0xd10000, 0x1f100, 0x80000000, 0x400d380, 0x6005000, 0x20000000, 0x90127e0, 0x15700
    .long 0x11ff19e0, 0xffff19e0, 0x15008380, 0x62a0, 0x190041c0, 0xe620, 0x1d00c540, 0xffffdf20
    .long 0x21fe7580, 0xfffed820, 0x24000000, 0x62a0, 0x0, 0x0, 0x0, 0x0
    .long 0x0, 0xff000000, 0x0, 0x0, 0x0, 0x0, 0x0, 0x0
    .long 0x0, 0x0, 0x0, 0x0, 0x0, 0x0, 0x0, 0x0
    .long 0x0, 0x0, 0x0, 0x0, 0x0, 0x0, 0x0, 0x0
    .long 0x0, 0x0, 0x0, 0x0, 0x0, 0x0, 0x0, 0x0
    .long 0x0, 0x0, 0x0, 0x0, 0x0, 0x0, 0x0, 0x0
    .long 0x140000, 0x100, 0xfffffffe, 0xd021c40, 0xa0198c0, 0x1100, 0xf00a460, 0x1fb60
    .long 0x13feb740, 0xfffeb740, 0x170041c0, 0xffff9d60, 0x1b0041c0, 0x18a80, 0x1f00c540, 0x20e0
    .long 0x23feb740, 0xfffeb740, 0x260041c0, 0x62a0, 0x28008380, 0xffff3ac0, 0x2a0020e0, 0x10700
    .long 0x2c0041c0, 0x20e0, 0x2d000000, 0x20e0, 0x0, 0x0, 0x0, 0x0
    .long 0x0, 0xff000000, 0x0, 0x0, 0x0, 0x0, 0x0, 0x0
    .long 0x0, 0x0, 0x0, 0x0, 0x0, 0x0, 0x0, 0x0
    .long 0x0, 0x0, 0x0, 0x0, 0x0, 0x0, 0x0, 0x0
    .long 0x0, 0x0, 0x0, 0x0, 0x0, 0x0, 0x0, 0x0
    .long 0x100000, 0x1f100, 0xfffffffe, 0xb01b9a0, 0xa0198c0, 0x1c00, 0xf00a460, 0x1fb60
    .long 0x13feb740, 0xfffeb740, 0x170041c0, 0xffff9d60, 0x1b0041c0, 0x18a80, 0x1f00c540, 0x20e0
    .long 0x23feb740, 0xfffeb740, 0x260041c0, 0x62a0, 0x28008380, 0xffff3ac0, 0x2a0020e0, 0x10700
    .long 0x2c0041c0, 0x20e0, 0x2d000000, 0x20e0, 0x0, 0x0, 0x0, 0x0
    .long 0x0, 0xff000000, 0x0, 0x0, 0x0, 0x0, 0x0, 0x0
    .long 0x0, 0x0, 0x0, 0x0, 0x0, 0x0, 0x0, 0x0
    .long 0x0, 0x0, 0x0, 0x0, 0x0, 0x0, 0x0, 0x0
    .long 0x0, 0x0, 0x0, 0x0, 0x0, 0x0, 0x0, 0x0
    .long 0x120000, 0x1f100, 0xfffffffe, 0xc01da80, 0xa0198c0, 0x1c00, 0xf00a460, 0x1fb60
    .long 0x13feb740, 0xfffeb740, 0x170041c0, 0xffff9d60, 0x1b0041c0, 0x18a80, 0x1f00c540, 0x20e0
    .long 0x23feb740, 0xfffeb740, 0x260041c0, 0x62a0, 0x28008380, 0xffff3ac0, 0x2a0020e0, 0x10700
    .long 0x2c0041c0, 0x20e0, 0x2d000000, 0x20e0, 0x0, 0x0, 0x0, 0x0
    .long 0x0, 0xff000000, 0x0, 0x0, 0x0, 0x0, 0x0, 0x0
    .long 0x0, 0x0, 0x0, 0x0, 0x0, 0x0, 0x0, 0x0
    .long 0x0, 0x0, 0x0, 0x0, 0x0, 0x0, 0x0, 0x0
    .long 0x0, 0x0, 0x0, 0x0, 0x0, 0x0, 0x0, 0x0
    .long 0xcb0000, 0x1f100, 0x80000000, 0x10070e0, 0x6005000, 0x20000c00, 0x90127e0, 0x15700
    .long 0x11ff19e0, 0xffff19e0, 0x15008380, 0x62a0, 0x190041c0, 0xe620, 0x1d00c540, 0xffffdf20
    .long 0x21fe7580, 0xfffed820, 0x24000000, 0x62a0, 0x0, 0x0, 0x0, 0x0
    .long 0x0, 0xff000000, 0x0, 0x0, 0x0, 0x0, 0x0, 0x0
    .long 0x0, 0x0, 0x0, 0x0, 0x0, 0x0, 0x0, 0x0
    .long 0x0, 0x0, 0x0, 0x0, 0x0, 0x0, 0x0, 0x0
    .long 0x0, 0x0, 0x0, 0x0, 0x0, 0x0, 0x0, 0x0
    .long 0x0, 0x0, 0x0, 0x0, 0x0, 0x0, 0x0, 0x0
    .long 0xcd0000, 0x1f100, 0x80000000, 0x20091c0, 0x6005000, 0x20000c00, 0x90127e0, 0x15700
    .long 0x11ff19e0, 0xffff19e0, 0x15008380, 0x62a0, 0x190041c0, 0xe620, 0x1d00c540, 0xffffdf20
    .long 0x21fe7580, 0xfffed820, 0x24000000, 0x62a0, 0x0, 0x0, 0x0, 0x0
    .long 0x0, 0xff000000, 0x0, 0x0, 0x0, 0x0, 0x0, 0x0
    .long 0x0, 0x0, 0x0, 0x0, 0x0, 0x0, 0x0, 0x0
    .long 0x0, 0x0, 0x0, 0x0, 0x0, 0x0, 0x0, 0x0
    .long 0x0, 0x0, 0x0, 0x0, 0x0, 0x0, 0x0, 0x0
    .long 0x0, 0x0, 0x0, 0x0, 0x0, 0x0, 0x0, 0x0
    .long 0xd30000, 0x1f100, 0x80000000, 0x500f460, 0x6005000, 0x20000000, 0x90127e0, 0x15700
    .long 0x11ff19e0, 0xffff19e0, 0x15008380, 0x62a0, 0x190041c0, 0xe620, 0x1d00c540, 0xffffdf20
    .long 0x21fe7580, 0xfffed820, 0x24000000, 0x62a0, 0x0, 0x0, 0x0, 0x0
    .long 0x0, 0xff000000, 0x0, 0x0, 0x0, 0x0, 0x0, 0x0
    .long 0x0, 0x0, 0x0, 0x0, 0x0, 0x0, 0x0, 0x0
    .long 0x0, 0x0, 0x0, 0x0, 0x0, 0x0, 0x0, 0x0
    .long 0x0, 0x0, 0x0, 0x0, 0x0, 0x0, 0x0, 0x0
    .long 0x0, 0x0, 0x0, 0x0, 0x0, 0x0, 0x0, 0x0
    .long 0xd50000, 0x1f100, 0x80000000, 0x6011540, 0x6005000, 0x20000000, 0x90127e0, 0x15700
    .long 0x11ff19e0, 0xffff19e0, 0x15008380, 0x62a0, 0x190041c0, 0xe620, 0x1d00c540, 0xffffdf20
    .long 0x21fe7580, 0xfffed820, 0x24000000, 0x62a0, 0x0, 0x0, 0x0, 0x0
    .long 0x0, 0xff000000, 0x0, 0x0, 0x0, 0x0, 0x0, 0x0
    .long 0x0, 0x0, 0x0, 0x0, 0x0, 0x0, 0x0, 0x0
    .long 0x0, 0x0, 0x0, 0x0, 0x0, 0x0, 0x0, 0x0
    .long 0x0, 0x0, 0x0, 0x0, 0x0, 0x0, 0x0, 0x0
    .long 0x0, 0x0, 0x0, 0x0, 0x0, 0x0, 0x0, 0x0
    .long 0xcf0000, 0x1f100, 0x80000000, 0x300b2a0, 0x6005000, 0x20000000, 0x90127e0, 0x15700
    .long 0x11ff19e0, 0xffff19e0, 0x15008380, 0x62a0, 0x190041c0, 0xe620, 0x1d00c540, 0xffffdf20
    .long 0x21fe7580, 0xfffed820, 0x24000000, 0x62a0, 0x0, 0x0, 0x0, 0x0
    .long 0x0, 0xff000000, 0x0, 0x0, 0x0, 0x0, 0x0, 0x0
    .long 0x0, 0x0, 0x0, 0x0, 0x0, 0x0, 0x0, 0x0
    .long 0x0, 0x0, 0x0, 0x0, 0x0, 0x0, 0x0, 0x0
    .long 0x0, 0x0, 0x0, 0x0, 0x0, 0x0, 0x0, 0x0
    .long 0x0, 0x0, 0x0, 0x0, 0x0, 0x0, 0x0, 0x0
    .long 0xd70000, 0x1e100, 0x80000000, 0x7013620, 0x6005000, 0x20000000, 0x90127e0, 0x15700
    .long 0x11ff19e0, 0xffff19e0, 0x15008380, 0x62a0, 0x190041c0, 0xe620, 0x1d00c540, 0xffffdf20
    .long 0x21fe7580, 0xfffed820, 0x24000000, 0x62a0, 0x0, 0x0, 0x0, 0x0
    .long 0x0, 0xff000000, 0x0, 0x0, 0x0, 0x0, 0x0, 0x0
    .long 0x0, 0x0, 0x0, 0x0, 0x0, 0x0, 0x0, 0x0
    .long 0x0, 0x0, 0x0, 0x0, 0x0, 0x0, 0x0, 0x0
    .long 0x0, 0x0, 0x0, 0x0, 0x0, 0x0, 0x0, 0x0
    .long 0x0, 0x0, 0x0, 0x0, 0x0, 0x0, 0x0, 0x0
    .long 0xcb0000, 0xd8f00a, 0xcd0000, 0x4d8f008, 0xd10000, 0x8d8f008, 0xd50000, 0xcd8f008
    .long 0xcb0000, 0x10d8f009, 0x0, 0x1414100a, 0x120000, 0x18141008, 0x0, 0x1a14100d
    .long 0x42cd0004, 0x2d8f00d, 0x42020040, 0x614100d, 0x42cf0200, 0x8d8f00d, 0x420402fc, 0x14100d
    .long 0x2d10001, 0x16d8f00d, 0x2060002, 0x1814100d, 0x2d30403, 0x14d8f00d, 0x4080403, 0x1a14100d
    .long 0x46d502fc, 0x2d8f00d, 0x60a0403, 0x614100d, 0x48d702fc, 0x8d8f00d, 0x80e0403, 0x14100e
    .long 0x4a1002fc, 0x1014100e, 0xa120403, 0x1214100e, 0x4c1402fc, 0x1414100e, 0x0, 0x0
    .long 0x0, 0x0, 0x0, 0x0, 0x0, 0x0, 0x0, 0x0
    .long 0x0, 0x0, 0x0, 0x0, 0x0, 0x0, 0x0, 0x0
    .long 0xcb0000, 0x2d8f008, 0xcf0000, 0x6d8f008, 0xd30000, 0xad8f008, 0xd70000, 0xed8f008
    .long 0xcd0000, 0x12d8f00a, 0x100000, 0x16141008, 0x140000, 0x1c141008, 0x20000, 0x1e14100e
    .long 0x42cf0008, 0x4d8f00e, 0x42040010, 0xa14100e, 0x42d10020, 0xcd8f00e, 0x42060080, 0xe14100e
    .long 0x44d302fc, 0x10d8f00e, 0x440802fc, 0x1214100e, 0x2d50400, 0x1cd8f00e, 0x40a0403, 0x1e14100e
    .long 0x46d702fc, 0x4d8f00e, 0x60c0403, 0xa14100e, 0x480c02fc, 0xc14100d, 0x80e0403, 0xe14100d
    .long 0x4a1002fc, 0x1614100d, 0xa120403, 0x1814100d, 0x4c1402fc, 0x1c14100d, 0x0, 0x0
    .long 0x0, 0x0, 0x0, 0x0, 0x0, 0x0, 0x0, 0x0
    .long 0x0, 0x0, 0x0, 0x0, 0x0, 0x0, 0x0, 0x0
    .long 0xd10000, 0x1f100, 0x80000000, 0x400d380, 0x6005000, 0x20000000, 0x90127e0, 0x15700
    .long 0x11ff19e0, 0xffff19e0, 0x15008380, 0x62a0, 0x190041c0, 0xe620, 0x1d00c540, 0xffffdf20
    .long 0x21fe7580, 0xfffed820, 0x24000000, 0x62a0, 0x0, 0x0, 0x0, 0x0
    .long 0x0, 0xff000000, 0x0, 0x0, 0x0, 0x0, 0x0, 0x0
    .long 0x0, 0x0, 0x0, 0x0, 0x0, 0x0, 0x0, 0x0
    .long 0x0, 0x0, 0x0, 0x0, 0x0, 0x0, 0x0, 0x0
    .long 0x0, 0x0, 0x0, 0x0, 0x0, 0x0, 0x0, 0x0
    .long 0x0, 0x0, 0x0, 0x0, 0x0, 0x0, 0x0, 0x0
    .long 0x140000, 0x100, 0xfffffffe, 0xd021c40, 0xa0198c0, 0x1100, 0xf00a460, 0x1fb60
    .long 0x13feb740, 0xfffeb740, 0x170041c0, 0xffff9d60, 0x1b0041c0, 0x18a80, 0x1f00c540, 0x20e0
    .long 0x23feb740, 0xfffeb740, 0x26ff5ba0, 0x62a0, 0x28010700, 0x20e0, 0x2a0020e0, 0x8380
    .long 0x2c0020e0, 0x20e0, 0x2d000000, 0x41c0, 0x0, 0x0, 0x0, 0x0
    .long 0x0, 0xff000000, 0x0, 0x0, 0x0, 0x0, 0x0, 0x0
    .long 0x0, 0x0, 0x0, 0x0, 0x0, 0x0, 0x0, 0x0
    .long 0x0, 0x0, 0x0, 0x0, 0x0, 0x0, 0x0, 0x0
    .long 0x0, 0x0, 0x0, 0x0, 0x0, 0x0, 0x0, 0x0
    .long 0x100000, 0x1f100, 0xfffffffe, 0xb01b9a0, 0xa0198c0, 0x1c00, 0xf00a460, 0x1fb60
    .long 0x13feb740, 0xfffeb740, 0x170041c0, 0xffff9d60, 0x1b0041c0, 0x18a80, 0x1f00c540, 0x20e0
    .long 0x23feb740, 0xfffeb740, 0x26ff5ba0, 0x62a0, 0x28010700, 0x20e0, 0x2a0020e0, 0x8380
    .long 0x2c0020e0, 0x20e0, 0x2d000000, 0x41c0, 0x0, 0x0, 0x0, 0x0
    .long 0x0, 0xff000000, 0x0, 0x0, 0x0, 0x0, 0x0, 0x0
    .long 0x0, 0x0, 0x0, 0x0, 0x0, 0x0, 0x0, 0x0
    .long 0x0, 0x0, 0x0, 0x0, 0x0, 0x0, 0x0, 0x0
    .long 0x0, 0x0, 0x0, 0x0, 0x0, 0x0, 0x0, 0x0
    .long 0x120000, 0x1f100, 0xfffffffe, 0xc01da80, 0xa0198c0, 0x1c00, 0xf00a460, 0x1fb60
    .long 0x13feb740, 0xfffeb740, 0x170041c0, 0xffff9d60, 0x1b0041c0, 0x18a80, 0x1f00c540, 0x20e0
    .long 0x23feb740, 0xfffeb740, 0x26ff5ba0, 0x62a0, 0x28010700, 0x20e0, 0x2a0020e0, 0x8380
    .long 0x2c0020e0, 0x20e0, 0x2d000000, 0x41c0, 0x0, 0x0, 0x0, 0x0
    .long 0x0, 0xff000000, 0x0, 0x0, 0x0, 0x0, 0x0, 0x0
    .long 0x0, 0x0, 0x0, 0x0, 0x0, 0x0, 0x0, 0x0
    .long 0x0, 0x0, 0x0, 0x0, 0x0, 0x0, 0x0, 0x0
    .long 0x0, 0x0, 0x0, 0x0, 0x0, 0x0, 0x0, 0x0
    .long 0xcb0000, 0x1f100, 0x80000000, 0x10070e0, 0x6005000, 0x20000c00, 0x90127e0, 0x15700
    .long 0x11ff19e0, 0xffff19e0, 0x15008380, 0x62a0, 0x190041c0, 0xe620, 0x1d00c540, 0xffffdf20
    .long 0x21fe7580, 0xfffed820, 0x24000000, 0x62a0, 0x0, 0x0, 0x0, 0x0
    .long 0x0, 0xff000000, 0x0, 0x0, 0x0, 0x0, 0x0, 0x0
    .long 0x0, 0x0, 0x0, 0x0, 0x0, 0x0, 0x0, 0x0
    .long 0x0, 0x0, 0x0, 0x0, 0x0, 0x0, 0x0, 0x0
    .long 0x0, 0x0, 0x0, 0x0, 0x0, 0x0, 0x0, 0x0
    .long 0x0, 0x0, 0x0, 0x0, 0x0, 0x0, 0x0, 0x0
    .long 0xcd0000, 0x1f100, 0x80000000, 0x20091c0, 0x6005000, 0x20000c00, 0x90127e0, 0x15700
    .long 0x11ff19e0, 0xffff19e0, 0x15008380, 0x62a0, 0x190041c0, 0xe620, 0x1d00c540, 0xffffdf20
    .long 0x21fe7580, 0xfffed820, 0x24000000, 0x62a0, 0x0, 0x0, 0x0, 0x0
    .long 0x0, 0xff000000, 0x0, 0x0, 0x0, 0x0, 0x0, 0x0
    .long 0x0, 0x0, 0x0, 0x0, 0x0, 0x0, 0x0, 0x0
    .long 0x0, 0x0, 0x0, 0x0, 0x0, 0x0, 0x0, 0x0
    .long 0x0, 0x0, 0x0, 0x0, 0x0, 0x0, 0x0, 0x0
    .long 0x0, 0x0, 0x0, 0x0, 0x0, 0x0, 0x0, 0x0
    .long 0xd30000, 0x1f100, 0x80000000, 0x500f460, 0x6005000, 0x20000000, 0x90127e0, 0x15700
    .long 0x11ff19e0, 0xffff19e0, 0x15008380, 0x62a0, 0x190041c0, 0xe620, 0x1d00c540, 0xffffdf20
    .long 0x21fe7580, 0xfffed820, 0x24000000, 0x62a0, 0x0, 0x0, 0x0, 0x0
    .long 0x0, 0xff000000, 0x0, 0x0, 0x0, 0x0, 0x0, 0x0
    .long 0x0, 0x0, 0x0, 0x0, 0x0, 0x0, 0x0, 0x0
    .long 0x0, 0x0, 0x0, 0x0, 0x0, 0x0, 0x0, 0x0
    .long 0x0, 0x0, 0x0, 0x0, 0x0, 0x0, 0x0, 0x0
    .long 0x0, 0x0, 0x0, 0x0, 0x0, 0x0, 0x0, 0x0
    .long 0xd50000, 0x1f100, 0x80000000, 0x6011540, 0x6005000, 0x20000000, 0x90127e0, 0x15700
    .long 0x11ff19e0, 0xffff19e0, 0x15008380, 0x62a0, 0x190041c0, 0xe620, 0x1d00c540, 0xffffdf20
    .long 0x21fe7580, 0xfffed820, 0x24000000, 0x62a0, 0x0, 0x0, 0x0, 0x0
    .long 0x0, 0xff000000, 0x0, 0x0, 0x0, 0x0, 0x0, 0x0
    .long 0x0, 0x0, 0x0, 0x0, 0x0, 0x0, 0x0, 0x0
    .long 0x0, 0x0, 0x0, 0x0, 0x0, 0x0, 0x0, 0x0
    .long 0x0, 0x0, 0x0, 0x0, 0x0, 0x0, 0x0, 0x0
    .long 0x0, 0x0, 0x0, 0x0, 0x0, 0x0, 0x0, 0x0
    .long 0xcf0000, 0x1f100, 0x80000000, 0x300b2a0, 0x6005000, 0x20000000, 0x90127e0, 0x15700
    .long 0x11ff19e0, 0xffff19e0, 0x15008380, 0x62a0, 0x190041c0, 0xe620, 0x1d00c540, 0xffffdf20
    .long 0x21fe7580, 0xfffed820, 0x24000000, 0x62a0, 0x0, 0x0, 0x0, 0x0
    .long 0x0, 0xff000000, 0x0, 0x0, 0x0, 0x0, 0x0, 0x0
    .long 0x0, 0x0, 0x0, 0x0, 0x0, 0x0, 0x0, 0x0
    .long 0x0, 0x0, 0x0, 0x0, 0x0, 0x0, 0x0, 0x0
    .long 0x0, 0x0, 0x0, 0x0, 0x0, 0x0, 0x0, 0x0
    .long 0x0, 0x0, 0x0, 0x0, 0x0, 0x0, 0x0, 0x0
    .long 0xd70000, 0x1e100, 0x80000000, 0x7013620, 0x6005000, 0x20000000, 0x90127e0, 0x15700
    .long 0x11ff19e0, 0xffff19e0, 0x15008380, 0x62a0, 0x190041c0, 0xe620, 0x1d00c540, 0xffffdf20
    .long 0x21fe7580, 0xfffed820, 0x24000000, 0x62a0, 0x0, 0x0, 0x0, 0x0
    .long 0x0, 0xff000000, 0x0, 0x0, 0x0, 0x0, 0x0, 0x0
    .long 0x0, 0x0, 0x0, 0x0, 0x0, 0x0, 0x0, 0x0
    .long 0x0, 0x0, 0x0, 0x0, 0x0, 0x0, 0x0, 0x0
    .long 0x0, 0x0, 0x0, 0x0, 0x0, 0x0, 0x0, 0x0
    .long 0x0, 0x0, 0x0, 0x0, 0x0, 0x0, 0x0, 0x0
    .long 0x36e000, 0x51300e, 0x46e000, 0x451300c, 0x4ae000, 0x851300c, 0x4ee000, 0xc51300c
    .long 0x36e000, 0x1051300d, 0x38e000, 0x1451300d, 0x3ae000, 0x1851300d, 0x3ce000, 0x1c51300e
    .long 0x260f001, 0x268600e, 0x23ee004, 0x651300d, 0x240e010, 0xa51300e, 0x260f07f, 0x68600d
    .long 0x442e07f, 0x1051300d, 0x644e07f, 0x1451300e, 0x4262f080, 0x1a68600d, 0x846e07f, 0x1c51300d
    .long 0x4248e400, 0x851300e, 0xa64f07f, 0x1e68600d, 0xc4ae07f, 0xa51300d, 0xe4ce07f, 0xe51300e
    .long 0x4466f480, 0x1268600d, 0x104ee07f, 0x1451300d, 0x4650e480, 0x1a51300d, 0x0, 0x0
    .long 0x0, 0x0, 0x0, 0x0, 0x0, 0x0, 0x0, 0x0
    .long 0x0, 0x0, 0x0, 0x0, 0x0, 0x0, 0x0, 0x0
    .long 0x44e000, 0x251300c, 0x48e000, 0x651300c, 0x4ce000, 0xa51300c, 0x50e000, 0xe51300c
    .long 0x38e000, 0x1251300e, 0x3ae000, 0x1651300e, 0x64f000, 0x1a68600c, 0x3ce000, 0x1e51300d
    .long 0x23ee002, 0x451300e, 0x266f008, 0x868600c, 0x240e020, 0xc51300d, 0x242e040, 0xe51300e
    .long 0x462f07f, 0x1268600e, 0x644e07f, 0x1651300d, 0x846e07f, 0x1851300e, 0x4264f480, 0x268600e
    .long 0xa48e07f, 0x451300d, 0xc4ae07f, 0x651300e, 0xe66f07f, 0xc68600e, 0x444ce480, 0x51300d
    .long 0x104ee07f, 0x1051300e, 0x4650e480, 0x251300e, 0x0, 0x0, 0x0, 0x0
    .long 0x0, 0x0, 0x0, 0x0, 0x0, 0x0, 0x0, 0x0
    .long 0x0, 0x0, 0x0, 0x0, 0x0, 0x0, 0x0, 0x0
    .long 0x0, 0x0, 0x0, 0x0, 0x0, 0xff000000, 0x0, 0x0
    .long 0x0, 0x0, 0x0, 0x0, 0x0, 0x0, 0x0, 0x0
    .long 0x0, 0x0, 0x0, 0x0, 0x0, 0x0, 0x0, 0x0
    .long 0x0, 0x0, 0x0, 0x0, 0x0, 0x0, 0x0, 0x0
    .long 0x0, 0x0, 0x0, 0x0, 0x0, 0x0, 0x0, 0x0
    .long 0x0, 0x0, 0x0, 0x0, 0x0, 0x0, 0x0, 0x0
    .long 0x0, 0x0, 0x0, 0x0, 0x0, 0x0, 0x0, 0x0
    .long 0x0, 0x0, 0x0, 0x0, 0x0, 0x0, 0x0, 0x0
    .long 0x66f000, 0x16100, 0xff800000, 0x1300d380, 0x30070e0, 0x20000000, 0x19010700, 0x5000
    .long 0x1ffef900, 0x1ab60, 0x2500a460, 0x41c0, 0x28000000, 0xffff3ac0, 0x0, 0x0
    .long 0x0, 0x0, 0x0, 0xff000000, 0x0, 0x0, 0x0, 0x0
    .long 0x0, 0x0, 0x0, 0x0, 0x0, 0x0, 0x0, 0x0
    .long 0x0, 0x0, 0x0, 0x0, 0x0, 0x0, 0x0, 0x0
    .long 0x0, 0x0, 0x0, 0x0, 0x0, 0x0, 0x0, 0x0
    .long 0x0, 0x0, 0x0, 0x0, 0x0, 0x0, 0x0, 0x0
    .long 0x0, 0x0, 0x0, 0x0, 0x0, 0x0, 0x0, 0x0
    .long 0x44e000, 0x1f100, 0xffffffe0, 0x10070e0, 0xd005000, 0x1c00, 0x90127e0, 0x15700
    .long 0xb0041c0, 0x41c0, 0xe0062a0, 0x41c0, 0x11fe7580, 0x62a0, 0x140062a0, 0xfffe7580
    .long 0x170041c0, 0x62a0, 0x1a0062a0, 0x41c0, 0x1d0041c0, 0x62a0, 0x20fef900, 0x62a0
    .long 0x23ffdf20, 0xfffe7580, 0x26008380, 0x62a0, 0x290020e0, 0xffff5ba0, 0x2bff19e0, 0x148c0
    .long 0x2c000000, 0x62a0, 0x0, 0x0, 0x0, 0x0, 0x0, 0xff000000
    .long 0x0, 0x0, 0x0, 0x0, 0x0, 0x0, 0x0, 0x0
    .long 0x0, 0x0, 0x0, 0x0, 0x0, 0x0, 0x0, 0x0
    .long 0x0, 0x0, 0x0, 0x0, 0x0, 0x0, 0x0, 0x0
    .long 0x46e000, 0x1f100, 0xffffffe0, 0x20091c0, 0xd005000, 0x1c00, 0x90127e0, 0x15700
    .long 0xb0041c0, 0x41c0, 0xe0062a0, 0x41c0, 0x11fe7580, 0x62a0, 0x140062a0, 0xfffe7580
    .long 0x170041c0, 0x62a0, 0x1a0062a0, 0x41c0, 0x1d0041c0, 0x62a0, 0x20fef900, 0x62a0
    .long 0x23ffdf20, 0xfffe7580, 0x26008380, 0x62a0, 0x290020e0, 0xffff5ba0, 0x2bff19e0, 0x148c0
    .long 0x2c000000, 0x62a0, 0x0, 0x0, 0x0, 0x0, 0x0, 0xff000000
    .long 0x0, 0x0, 0x0, 0x0, 0x0, 0x0, 0x0, 0x0
    .long 0x0, 0x0, 0x0, 0x0, 0x0, 0x0, 0x0, 0x0
    .long 0x0, 0x0, 0x0, 0x0, 0x0, 0x0, 0x0, 0x0
    .long 0x48e000, 0x1f100, 0xffffffe0, 0x300b2a0, 0xd005000, 0x1c00, 0x90127e0, 0x15700
    .long 0xb0041c0, 0x41c0, 0xe0062a0, 0x41c0, 0x11fe7580, 0x62a0, 0x140062a0, 0xfffe7580
    .long 0x170041c0, 0x62a0, 0x1a0062a0, 0x41c0, 0x1d0041c0, 0x62a0, 0x20fef900, 0x62a0
    .long 0x23ffdf20, 0xfffe7580, 0x26008380, 0x62a0, 0x290020e0, 0xffff5ba0, 0x2bff19e0, 0x148c0
    .long 0x2c000000, 0x62a0, 0x0, 0x0, 0x0, 0x0, 0x0, 0xff000000
    .long 0x0, 0x0, 0x0, 0x0, 0x0, 0x0, 0x0, 0x0
    .long 0x0, 0x0, 0x0, 0x0, 0x0, 0x0, 0x0, 0x0
    .long 0x0, 0x0, 0x0, 0x0, 0x0, 0x0, 0x0, 0x0
    .long 0x4ae000, 0x1f100, 0xffffffe0, 0x400d380, 0xd005000, 0x1c00, 0x90127e0, 0x15700
    .long 0xb0041c0, 0x41c0, 0xe0062a0, 0x41c0, 0x11fe7580, 0x62a0, 0x140062a0, 0xfffe7580
    .long 0x170041c0, 0x62a0, 0x1a0062a0, 0x41c0, 0x1d0041c0, 0x62a0, 0x20fef900, 0x62a0
    .long 0x23ffdf20, 0xfffe7580, 0x26008380, 0x62a0, 0x290020e0, 0xffff5ba0, 0x2bff19e0, 0x148c0
    .long 0x2c000000, 0x62a0, 0x0, 0x0, 0x0, 0x0, 0x0, 0xff000000
    .long 0x0, 0x0, 0x0, 0x0, 0x0, 0x0, 0x0, 0x0
    .long 0x0, 0x0, 0x0, 0x0, 0x0, 0x0, 0x0, 0x0
    .long 0x0, 0x0, 0x0, 0x0, 0x0, 0x0, 0x0, 0x0
    .long 0x4ce000, 0x1f100, 0xffffffe0, 0x500f460, 0xd005000, 0x1000, 0x90127e0, 0x15700
    .long 0xb0041c0, 0x41c0, 0xe0062a0, 0x41c0, 0x11fe7580, 0x62a0, 0x140062a0, 0xfffe7580
    .long 0x170041c0, 0x62a0, 0x1a0062a0, 0x41c0, 0x1d0041c0, 0x62a0, 0x20fef900, 0x62a0
    .long 0x23ffdf20, 0xfffe7580, 0x26008380, 0x62a0, 0x290020e0, 0xffff5ba0, 0x2bff19e0, 0x148c0
    .long 0x2c000000, 0x62a0, 0x0, 0x0, 0x0, 0x0, 0x0, 0xff000000
    .long 0x0, 0x0, 0x0, 0x0, 0x0, 0x0, 0x0, 0x0
    .long 0x0, 0x0, 0x0, 0x0, 0x0, 0x0, 0x0, 0x0
    .long 0x0, 0x0, 0x0, 0x0, 0x0, 0x0, 0x0, 0x0
    .long 0x4ee000, 0x1f100, 0xffffffe0, 0x6011540, 0xd005000, 0x1000, 0x90127e0, 0x15700
    .long 0xb0041c0, 0x41c0, 0xe0062a0, 0x41c0, 0x11fe7580, 0x62a0, 0x140062a0, 0xfffe7580
    .long 0x170041c0, 0x62a0, 0x1a0062a0, 0x41c0, 0x1d0041c0, 0x62a0, 0x20fef900, 0x62a0
    .long 0x23ffdf20, 0xfffe7580, 0x26008380, 0x62a0, 0x290020e0, 0xffff5ba0, 0x2bff19e0, 0x148c0
    .long 0x2c000000, 0x62a0, 0x0, 0x0, 0x0, 0x0, 0x0, 0xff000000
    .long 0x0, 0x0, 0x0, 0x0, 0x0, 0x0, 0x0, 0x0
    .long 0x0, 0x0, 0x0, 0x0, 0x0, 0x0, 0x0, 0x0
    .long 0x0, 0x0, 0x0, 0x0, 0x0, 0x0, 0x0, 0x0
    .long 0x50e000, 0x4100, 0xffffffe0, 0x7013620, 0xd005000, 0x1100, 0x90127e0, 0x15700
    .long 0xb0041c0, 0x41c0, 0xe0062a0, 0x41c0, 0x11fe7580, 0x62a0, 0x140062a0, 0xfffe7580
    .long 0x170041c0, 0x62a0, 0x1a0062a0, 0x41c0, 0x1d0041c0, 0x62a0, 0x20fef900, 0x62a0
    .long 0x23ffdf20, 0xfffe7580, 0x26008380, 0x62a0, 0x290020e0, 0xffff5ba0, 0x2bff19e0, 0x148c0
    .long 0x2c000000, 0x62a0, 0x0, 0x0, 0x0, 0x0, 0x0, 0xff000000
    .long 0x0, 0x0, 0x0, 0x0, 0x0, 0x0, 0x0, 0x0
    .long 0x0, 0x0, 0x0, 0x0, 0x0, 0x0, 0x0, 0x0
    .long 0x0, 0x0, 0x0, 0x0, 0x0, 0x0, 0x0, 0x0
    .long 0x64f000, 0x1f100, 0xff800000, 0x1001fb60, 0x30070e0, 0x20000000, 0x19010700, 0x5000
    .long 0x1ffef900, 0x1ab60, 0x2500a460, 0x41c0, 0x28000000, 0xffff3ac0, 0x0, 0x0
    .long 0x0, 0x0, 0x0, 0xff000000, 0x0, 0x0, 0x0, 0x0
    .long 0x0, 0x0, 0x0, 0x0, 0x0, 0x0, 0x0, 0x0
    .long 0x0, 0x0, 0x0, 0x0, 0x0, 0x0, 0x0, 0x0
    .long 0x0, 0x0, 0x0, 0x0, 0x0, 0x0, 0x0, 0x0
    .long 0x0, 0x0, 0x0, 0x0, 0x0, 0x0, 0x0, 0x0
    .long 0x0, 0x0, 0x0, 0x0, 0x0, 0x0, 0x0, 0x0
    .long 0xafa100, 0xcb000e, 0xbfa100, 0x4cb000c, 0xc5a100, 0x8cb000c, 0xc9a100, 0xccb000c
    .long 0xb1a100, 0x10cb000e, 0xb3a100, 0x14cb000e, 0xb5a100, 0x18cb000e, 0x2b5a102, 0x4cb000d
    .long 0x2b7a110, 0x8cb000d, 0x2b9a140, 0xccb000d, 0x2bba17f, 0xcb000d, 0x4bda17f, 0x10cb000d
    .long 0x6bfa17f, 0x14cb000d, 0x8c1a17f, 0x18cb000d, 0xac3a17f, 0x6cb000d, 0xcc5a17f, 0xacb000d
    .long 0xec7a17f, 0xccb000d, 0x10c9a17f, 0xcb000d, 0x0, 0x0, 0x0, 0x0
    .long 0x0, 0x0, 0x0, 0x0, 0x0, 0x0, 0x0, 0x0
    .long 0x0, 0x0, 0x0, 0x0, 0x0, 0x0, 0x0, 0x0
    .long 0x0, 0x0, 0x0, 0x0, 0x0, 0x0, 0x0, 0x0
    .long 0xbda100, 0x2cb000c, 0xc1a100, 0x6cb000c, 0xc7a100, 0xacb000c, 0xafa100, 0xecb000d
    .long 0xb1a100, 0x12cb000d, 0xb3a100, 0x16cb000d, 0x2c3a101, 0x2cb000c, 0x2b7a104, 0x6cb000e
    .long 0x2b9a120, 0xacb000e, 0x2bba108, 0x2cb000e, 0x4bda17f, 0xecb000e, 0x6bfa17f, 0x12cb000e
    .long 0x8c1a17f, 0x16cb000e, 0xac3a17f, 0x4cb000e, 0xcc5a17f, 0x8cb000e, 0xec7a17f, 0x2cb000e
    .long 0x10c9a17f, 0xecb000e, 0x0, 0x0, 0x0, 0x0, 0x0, 0x0
    .long 0x0, 0x0, 0x0, 0x0, 0x0, 0x0, 0x0, 0x0
    .long 0x0, 0x0, 0x0, 0x0, 0x0, 0x0, 0x0, 0x0
    .long 0x0, 0x0, 0x0, 0x0, 0x0, 0x0, 0x0, 0x0
    .long 0x0, 0x0, 0x0, 0x0, 0x0, 0xff000000, 0x0, 0x0
    .long 0x0, 0x0, 0x0, 0x0, 0x0, 0x0, 0x0, 0x0
    .long 0x0, 0x0, 0x0, 0x0, 0x0, 0x0, 0x0, 0x0
    .long 0x0, 0x0, 0x0, 0x0, 0x0, 0x0, 0x0, 0x0
    .long 0x0, 0x0, 0x0, 0x0, 0x0, 0x0, 0x0, 0x0
    .long 0x0, 0x0, 0x0, 0x0, 0x0, 0x0, 0x0, 0x0
    .long 0x0, 0x0, 0x0, 0x0, 0x0, 0x0, 0x0, 0x0
    .long 0x0, 0x0, 0x0, 0x0, 0x0, 0x0, 0x0, 0x0
    .long 0x0, 0x0, 0x0, 0x0, 0x0, 0xff000000, 0x0, 0x0
    .long 0x0, 0x0, 0x0, 0x0, 0x0, 0x0, 0x0, 0x0
    .long 0x0, 0x0, 0x0, 0x0, 0x0, 0x0, 0x0, 0x0
    .long 0x0, 0x0, 0x0, 0x0, 0x0, 0x0, 0x0, 0x0
    .long 0x0, 0x0, 0x0, 0x0, 0x0, 0x0, 0x0, 0x0
    .long 0x0, 0x0, 0x0, 0x0, 0x0, 0x0, 0x0, 0x0
    .long 0x0, 0x0, 0x0, 0x0, 0x0, 0x0, 0x0, 0x0
    .long 0x0, 0x0, 0x0, 0x0, 0x0, 0x0, 0x0, 0x0
    .long 0xbda100, 0x1f100, 0xffc00000, 0x10070e0, 0xd005000, 0xc00, 0x8010700, 0x13620
    .long 0xa0041c0, 0x41c0, 0xc0041c0, 0x41c0, 0xffed820, 0xfffed820, 0x110041c0, 0x41c0
    .long 0x13ff7c80, 0x41c0, 0x1500c540, 0xffff3ac0, 0x170041c0, 0x10700, 0x190041c0, 0x41c0
    .long 0x1bfed820, 0x41c0, 0x1d0041c0, 0xfffed820, 0x1fff9d60, 0x41c0, 0x2100c540, 0x20e0
    .long 0x22000000, 0xffff3ac0, 0x0, 0x0, 0x0, 0x0, 0x0, 0xff000000
    .long 0x0, 0x0, 0x0, 0x0, 0x0, 0x0, 0x0, 0x0
    .long 0x0, 0x0, 0x0, 0x0, 0x0, 0x0, 0x0, 0x0
    .long 0x0, 0x0, 0x0, 0x0, 0x0, 0x0, 0x0, 0x0
    .long 0xbfa100, 0x1f100, 0xffc00000, 0x20091c0, 0xd005000, 0xc00, 0x8010700, 0x13620
    .long 0xa0041c0, 0x41c0, 0xc0041c0, 0x41c0, 0xffed820, 0xfffed820, 0x110041c0, 0x41c0
    .long 0x13ff7c80, 0x41c0, 0x1500c540, 0xffff3ac0, 0x170041c0, 0x10700, 0x190041c0, 0x41c0
    .long 0x1bfed820, 0x41c0, 0x1d0041c0, 0xfffed820, 0x1fff9d60, 0x41c0, 0x2100c540, 0x20e0
    .long 0x22000000, 0xffff3ac0, 0x0, 0x0, 0x0, 0x0, 0x0, 0xff000000
    .long 0x0, 0x0, 0x0, 0x0, 0x0, 0x0, 0x0, 0x0
    .long 0x0, 0x0, 0x0, 0x0, 0x0, 0x0, 0x0, 0x0
    .long 0x0, 0x0, 0x0, 0x0, 0x0, 0x0, 0x0, 0x0
    .long 0xc1a100, 0x1f100, 0xffc00000, 0x300b2a0, 0xd005000, 0xc00, 0x8010700, 0x13620
    .long 0xa0041c0, 0x41c0, 0xc0041c0, 0x41c0, 0xffed820, 0xfffed820, 0x110041c0, 0x41c0
    .long 0x13ff7c80, 0x41c0, 0x1500c540, 0xffff3ac0, 0x170041c0, 0x10700, 0x190041c0, 0x41c0
    .long 0x1bfed820, 0x41c0, 0x1d0041c0, 0xfffed820, 0x1fff9d60, 0x41c0, 0x2100c540, 0x20e0
    .long 0x22000000, 0xffff3ac0, 0x0, 0x0, 0x0, 0x0, 0x0, 0xff000000
    .long 0x0, 0x0, 0x0, 0x0, 0x0, 0x0, 0x0, 0x0
    .long 0x0, 0x0, 0x0, 0x0, 0x0, 0x0, 0x0, 0x0
    .long 0x0, 0x0, 0x0, 0x0, 0x0, 0x0, 0x0, 0x0
    .long 0xc3a100, 0x1f100, 0xffc00000, 0xd0070e0, 0xd005000, 0xc00, 0x8010700, 0x13620
    .long 0xa0041c0, 0x41c0, 0xc0041c0, 0x41c0, 0xffed820, 0xfffed820, 0x110041c0, 0x41c0
    .long 0x13ff7c80, 0x41c0, 0x1500c540, 0xffff3ac0, 0x170041c0, 0x10700, 0x190041c0, 0x41c0
    .long 0x1bfed820, 0x41c0, 0x1d0041c0, 0xfffed820, 0x1fff9d60, 0x41c0, 0x2100c540, 0x20e0
    .long 0x22000000, 0xffff3ac0, 0x0, 0x0, 0x0, 0x0, 0x0, 0xff000000
    .long 0x0, 0x0, 0x0, 0x0, 0x0, 0x0, 0x0, 0x0
    .long 0x0, 0x0, 0x0, 0x0, 0x0, 0x0, 0x0, 0x0
    .long 0x0, 0x0, 0x0, 0x0, 0x0, 0x0, 0x0, 0x0
    .long 0xc5a100, 0x1f100, 0xffc00000, 0x400d380, 0xd005000, 0x0, 0x8010700, 0x13620
    .long 0xa0041c0, 0x41c0, 0xc0041c0, 0x41c0, 0xffed820, 0xfffed820, 0x110041c0, 0x41c0
    .long 0x13ff7c80, 0x41c0, 0x1500c540, 0xffff3ac0, 0x170041c0, 0x10700, 0x190041c0, 0x41c0
    .long 0x1bfed820, 0x41c0, 0x1d0041c0, 0xfffed820, 0x1fff9d60, 0x41c0, 0x2100c540, 0x20e0
    .long 0x22000000, 0xffff3ac0, 0x0, 0x0, 0x0, 0x0, 0x0, 0xff000000
    .long 0x0, 0x0, 0x0, 0x0, 0x0, 0x0, 0x0, 0x0
    .long 0x0, 0x0, 0x0, 0x0, 0x0, 0x0, 0x0, 0x0
    .long 0x0, 0x0, 0x0, 0x0, 0x0, 0x0, 0x0, 0x0
    .long 0xc7a100, 0x1f100, 0xffc00000, 0x500f460, 0xd005000, 0x0, 0x8010700, 0x13620
    .long 0xa0041c0, 0x41c0, 0xc0041c0, 0x41c0, 0xffed820, 0xfffed820, 0x110041c0, 0x41c0
    .long 0x13ff7c80, 0x41c0, 0x1500c540, 0xffff3ac0, 0x170041c0, 0x10700, 0x190041c0, 0x41c0
    .long 0x1bfed820, 0x41c0, 0x1d0041c0, 0xfffed820, 0x1fff9d60, 0x41c0, 0x2100c540, 0x20e0
    .long 0x22000000, 0xffff3ac0, 0x0, 0x0, 0x0, 0x0, 0x0, 0xff000000
    .long 0x0, 0x0, 0x0, 0x0, 0x0, 0x0, 0x0, 0x0
    .long 0x0, 0x0, 0x0, 0x0, 0x0, 0x0, 0x0, 0x0
    .long 0x0, 0x0, 0x0, 0x0, 0x0, 0x0, 0x0, 0x0
    .long 0xc9a100, 0x15100, 0xffc00000, 0x6011540, 0xd005000, 0x0, 0x8010700, 0x13620
    .long 0xa0041c0, 0x41c0, 0xc0041c0, 0x41c0, 0xffed820, 0xfffed820, 0x110041c0, 0x41c0
    .long 0x13ff7c80, 0x41c0, 0x1500c540, 0xffff3ac0, 0x170041c0, 0x10700, 0x190041c0, 0x41c0
    .long 0x1bfed820, 0x41c0, 0x1d0041c0, 0xfffed820, 0x1fff9d60, 0x41c0, 0x2100c540, 0x20e0
    .long 0x22000000, 0xffff3ac0, 0x0, 0x0, 0x0, 0x0, 0x0, 0xff000000
    .long 0x0, 0x0, 0x0, 0x0, 0x0, 0x0, 0x0, 0x0
    .long 0x0, 0x0, 0x0, 0x0, 0x0, 0x0, 0x0, 0x0
    .long 0x0, 0x0, 0x0, 0x0, 0x0, 0x0, 0x0, 0x0
    .long 0x0, 0x0, 0x0, 0x0, 0x0, 0xff000000, 0x0, 0x0
    .long 0x0, 0x0, 0x0, 0x0, 0x0, 0x0, 0x0, 0x0
    .long 0x0, 0x0, 0x0, 0x0, 0x0, 0x0, 0x0, 0x0
    .long 0x0, 0x0, 0x0, 0x0, 0x0, 0x0, 0x0, 0x0
    .long 0x0, 0x0, 0x0, 0x0, 0x0, 0x0, 0x0, 0x0
    .long 0x0, 0x0, 0x0, 0x0, 0x0, 0x0, 0x0, 0x0
    .long 0x0, 0x0, 0x0, 0x0, 0x0, 0x0, 0x0, 0x0
    .long 0x0, 0x0, 0x0, 0x0, 0x0, 0x0, 0x0, 0x0
    .long 0x1049100, 0x112700e, 0x1069100, 0x512700c, 0x10a9100, 0x912700c, 0x10e9100, 0xd12700c
    .long 0x1049100, 0x1112700d, 0x22b100, 0x1436e00e, 0x34b100, 0x1836e00c, 0x22b100, 0x1c36e00d
    .long 0x43069104, 0x312700d, 0x4224b140, 0x636e00d, 0x43089110, 0xb12700d, 0x4226b3fc, 0x36e00d
    .long 0x30a9101, 0x1712700d, 0x4428b3fc, 0x1036e00d, 0x30c9503, 0x1512700d, 0x42ab503, 0x1c36e00d
    .long 0x470e93fc, 0x312700d, 0x62cb503, 0x636e00d, 0x491093fc, 0xb12700d, 0x830b503, 0x36e00e
    .long 0x4a32b3fc, 0x1836e00e, 0xa34b503, 0x1236e00e, 0x4c36b3fc, 0x1a36e00e, 0x0, 0x0
    .long 0x0, 0x0, 0x0, 0x0, 0x0, 0x0, 0x0, 0x0
    .long 0x0, 0x0, 0x0, 0x0, 0x0, 0x0, 0x0, 0x0
    .long 0x1049100, 0x312700c, 0x1089100, 0x712700c, 0x10c9100, 0xb12700c, 0x1109100, 0xf12700c
    .long 0x1069100, 0x1312700e, 0x32b100, 0x1636e00c, 0x36b100, 0x1a36e00c, 0x24b100, 0x1e36e00e
    .long 0x43089108, 0x512700e, 0x4226b300, 0x836e00e, 0x430a9120, 0xd12700e, 0x4228b180, 0xe36e00e
    .long 0x30c9102, 0x1912700e, 0x442ab3fc, 0x1236e00e, 0x30e9500, 0x1b12700e, 0x42cb503, 0x1e36e00e
    .long 0x471093fc, 0x512700e, 0x62eb503, 0x836e00e, 0x482eb3fc, 0xc36e00d, 0x830b503, 0xe36e00d
    .long 0x4a32b3fc, 0x1636e00d, 0xa34b503, 0x1036e00d, 0x4c36b3fc, 0x1436e00d, 0x0, 0x0
    .long 0x0, 0x0, 0x0, 0x0, 0x0, 0x0, 0x0, 0x0
    .long 0x0, 0x0, 0x0, 0x0, 0x0, 0x0, 0x0, 0x0
    .long 0x10a9100, 0x1f100, 0xc0000000, 0x400d380, 0x6005000, 0x20000000, 0x90127e0, 0x15700
    .long 0x11ff19e0, 0xffff19e0, 0x15008380, 0x8380, 0x1900c540, 0xc540, 0x1d0020e0, 0xffffdf20
    .long 0x21fe9660, 0xfffed820, 0x24000000, 0x8380, 0x0, 0x0, 0x0, 0x0
    .long 0x0, 0xff000000, 0x0, 0x0, 0x0, 0x0, 0x0, 0x0
    .long 0x0, 0x0, 0x0, 0x0, 0x0, 0x0, 0x0, 0x0
    .long 0x0, 0x0, 0x0, 0x0, 0x0, 0x0, 0x0, 0x0
    .long 0x0, 0x0, 0x0, 0x0, 0x0, 0x0, 0x0, 0x0
    .long 0x0, 0x0, 0x0, 0x0, 0x0, 0x0, 0x0, 0x0
    .long 0x36b100, 0x2100, 0xfffffff8, 0xd01fb60, 0xa0198c0, 0x1100, 0xf00a460, 0x21c40
    .long 0x13fe9660, 0xfffe9660, 0x170062a0, 0xffff9d60, 0x1b0041c0, 0x10700, 0x1f00c540, 0xc540
    .long 0x23fe9660, 0xfffe9660, 0x26ff7c80, 0x62a0, 0x28018a80, 0x20e0, 0x2aff9d60, 0x8380
    .long 0x2c008380, 0xffff9d60, 0x2d000000, 0x41c0, 0x0, 0x0, 0x0, 0x0
    .long 0x0, 0xff000000, 0x0, 0x0, 0x0, 0x0, 0x0, 0x0
    .long 0x0, 0x0, 0x0, 0x0, 0x0, 0x0, 0x0, 0x0
    .long 0x0, 0x0, 0x0, 0x0, 0x0, 0x0, 0x0, 0x0
    .long 0x0, 0x0, 0x0, 0x0, 0x0, 0x0, 0x0, 0x0
    .long 0x32b100, 0x1f100, 0xfffffff8, 0xb01b9a0, 0xa0198c0, 0x1c00, 0xf00a460, 0x21c40
    .long 0x13fe9660, 0xfffe9660, 0x170062a0, 0xffff9d60, 0x1b0041c0, 0x10700, 0x1f00c540, 0xc540
    .long 0x23fe9660, 0xfffe9660, 0x26ff7c80, 0x62a0, 0x28018a80, 0x20e0, 0x2aff9d60, 0x8380
    .long 0x2c008380, 0xffff9d60, 0x2d000000, 0x41c0, 0x0, 0x0, 0x0, 0x0
    .long 0x0, 0xff000000, 0x0, 0x0, 0x0, 0x0, 0x0, 0x0
    .long 0x0, 0x0, 0x0, 0x0, 0x0, 0x0, 0x0, 0x0
    .long 0x0, 0x0, 0x0, 0x0, 0x0, 0x0, 0x0, 0x0
    .long 0x0, 0x0, 0x0, 0x0, 0x0, 0x0, 0x0, 0x0
    .long 0x34b100, 0x1f100, 0xfffffff8, 0xc01da80, 0xa0198c0, 0x1c00, 0xf00a460, 0x21c40
    .long 0x13fe9660, 0xfffe9660, 0x170062a0, 0xffff9d60, 0x1b0041c0, 0x10700, 0x1f00c540, 0xc540
    .long 0x23fe9660, 0xfffe9660, 0x26ff7c80, 0x62a0, 0x28018a80, 0x20e0, 0x2aff9d60, 0x8380
    .long 0x2c008380, 0xffff9d60, 0x2d000000, 0x41c0, 0x0, 0x0, 0x0, 0x0
    .long 0x0, 0xff000000, 0x0, 0x0, 0x0, 0x0, 0x0, 0x0
    .long 0x0, 0x0, 0x0, 0x0, 0x0, 0x0, 0x0, 0x0
    .long 0x0, 0x0, 0x0, 0x0, 0x0, 0x0, 0x0, 0x0
    .long 0x0, 0x0, 0x0, 0x0, 0x0, 0x0, 0x0, 0x0
    .long 0x1049100, 0x1f100, 0xc0000000, 0x10070e0, 0x6005000, 0x20000c00, 0x90127e0, 0x15700
    .long 0x11ff19e0, 0xffff19e0, 0x15008380, 0x8380, 0x1900c540, 0xc540, 0x1d0020e0, 0xffffdf20
    .long 0x21fe9660, 0xfffed820, 0x24000000, 0x8380, 0x0, 0x0, 0x0, 0x0
    .long 0x0, 0xff000000, 0x0, 0x0, 0x0, 0x0, 0x0, 0x0
    .long 0x0, 0x0, 0x0, 0x0, 0x0, 0x0, 0x0, 0x0
    .long 0x0, 0x0, 0x0, 0x0, 0x0, 0x0, 0x0, 0x0
    .long 0x0, 0x0, 0x0, 0x0, 0x0, 0x0, 0x0, 0x0
    .long 0x0, 0x0, 0x0, 0x0, 0x0, 0x0, 0x0, 0x0
    .long 0x1069100, 0x1f100, 0xc0000000, 0x20091c0, 0x6005000, 0x20000c00, 0x90127e0, 0x15700
    .long 0x11ff19e0, 0xffff19e0, 0x15008380, 0x8380, 0x1900c540, 0xc540, 0x1d0020e0, 0xffffdf20
    .long 0x21fe9660, 0xfffed820, 0x24000000, 0x8380, 0x0, 0x0, 0x0, 0x0
    .long 0x0, 0xff000000, 0x0, 0x0, 0x0, 0x0, 0x0, 0x0
    .long 0x0, 0x0, 0x0, 0x0, 0x0, 0x0, 0x0, 0x0
    .long 0x0, 0x0, 0x0, 0x0, 0x0, 0x0, 0x0, 0x0
    .long 0x0, 0x0, 0x0, 0x0, 0x0, 0x0, 0x0, 0x0
    .long 0x0, 0x0, 0x0, 0x0, 0x0, 0x0, 0x0, 0x0
    .long 0x10c9100, 0x1f100, 0xc0000000, 0x500f460, 0x6005000, 0x20000000, 0x90127e0, 0x15700
    .long 0x11ff19e0, 0xffff19e0, 0x15008380, 0x8380, 0x1900c540, 0xc540, 0x1d0020e0, 0xffffdf20
    .long 0x21fe9660, 0xfffed820, 0x24000000, 0x8380, 0x0, 0x0, 0x0, 0x0
    .long 0x0, 0xff000000, 0x0, 0x0, 0x0, 0x0, 0x0, 0x0
    .long 0x0, 0x0, 0x0, 0x0, 0x0, 0x0, 0x0, 0x0
    .long 0x0, 0x0, 0x0, 0x0, 0x0, 0x0, 0x0, 0x0
    .long 0x0, 0x0, 0x0, 0x0, 0x0, 0x0, 0x0, 0x0
    .long 0x0, 0x0, 0x0, 0x0, 0x0, 0x0, 0x0, 0x0
    .long 0x10e9100, 0x1f100, 0xc0000000, 0x6011540, 0x6005000, 0x20000000, 0x90127e0, 0x15700
    .long 0x11ff19e0, 0xffff19e0, 0x15008380, 0x8380, 0x1900c540, 0xc540, 0x1d0020e0, 0xffffdf20
    .long 0x21fe9660, 0xfffed820, 0x24000000, 0x8380, 0x0, 0x0, 0x0, 0x0
    .long 0x0, 0xff000000, 0x0, 0x0, 0x0, 0x0, 0x0, 0x0
    .long 0x0, 0x0, 0x0, 0x0, 0x0, 0x0, 0x0, 0x0
    .long 0x0, 0x0, 0x0, 0x0, 0x0, 0x0, 0x0, 0x0
    .long 0x0, 0x0, 0x0, 0x0, 0x0, 0x0, 0x0, 0x0
    .long 0x0, 0x0, 0x0, 0x0, 0x0, 0x0, 0x0, 0x0
    .long 0x1089100, 0x1f100, 0xc0000000, 0x300b2a0, 0x6005000, 0x20000000, 0x90127e0, 0x15700
    .long 0x11ff19e0, 0xffff19e0, 0x15008380, 0x8380, 0x1900c540, 0xc540, 0x1d0020e0, 0xffffdf20
    .long 0x21fe9660, 0xfffed820, 0x24000000, 0x8380, 0x0, 0x0, 0x0, 0x0
    .long 0x0, 0xff000000, 0x0, 0x0, 0x0, 0x0, 0x0, 0x0
    .long 0x0, 0x0, 0x0, 0x0, 0x0, 0x0, 0x0, 0x0
    .long 0x0, 0x0, 0x0, 0x0, 0x0, 0x0, 0x0, 0x0
    .long 0x0, 0x0, 0x0, 0x0, 0x0, 0x0, 0x0, 0x0
    .long 0x0, 0x0, 0x0, 0x0, 0x0, 0x0, 0x0, 0x0
    .long 0x1109100, 0x1d100, 0xc0000000, 0x7013620, 0x6005000, 0x20000000, 0x90127e0, 0x15700
    .long 0x11ff19e0, 0xffff19e0, 0x15008380, 0x8380, 0x1900c540, 0xc540, 0x1d0020e0, 0xffffdf20
    .long 0x21fe9660, 0xfffed820, 0x24000000, 0x8380, 0x0, 0x0, 0x0, 0x0
    .long 0x0, 0xff000000, 0x0, 0x0, 0x0, 0x0, 0x0, 0x0
    .long 0x0, 0x0, 0x0, 0x0, 0x0, 0x0, 0x0, 0x0
    .long 0x0, 0x0, 0x0, 0x0, 0x0, 0x0, 0x0, 0x0
    .long 0x0, 0x0, 0x0, 0x0, 0x0, 0x0, 0x0, 0x0
    .long 0x0, 0x0, 0x0, 0x0, 0x0, 0x0, 0x0, 0x0
    .long 0x1049100, 0x112700e, 0x1069100, 0x512700c, 0x10a9100, 0x912700c, 0x10e9100, 0xd12700c
    .long 0x1049100, 0x1112700d, 0x22b100, 0x1436e00e, 0x34b100, 0x1836e00c, 0x22b100, 0x1c36e00d
    .long 0x43069104, 0x312700d, 0x4224b140, 0x636e00d, 0x43089110, 0xb12700d, 0x4226b3fc, 0x36e00d
    .long 0x30a9101, 0x1712700d, 0x4428b3fc, 0x1036e00d, 0x30c9503, 0x1512700d, 0x42ab503, 0x1c36e00d
    .long 0x470e93fc, 0x312700d, 0x62cb503, 0x636e00d, 0x491093fc, 0xb12700d, 0x830b503, 0x36e00e
    .long 0x4a32b3fc, 0x1636e00e, 0xa34b503, 0x1036e00e, 0x4c36b3fc, 0x1a36e00e, 0x0, 0x0
    .long 0x0, 0x0, 0x0, 0x0, 0x0, 0x0, 0x0, 0x0
    .long 0x0, 0x0, 0x0, 0x0, 0x0, 0x0, 0x0, 0x0
    .long 0x1049100, 0x312700c, 0x1089100, 0x712700c, 0x10c9100, 0xb12700c, 0x1109100, 0xf12700c
    .long 0x1069100, 0x1312700e, 0x32b100, 0x1636e00c, 0x36b100, 0x1a36e00c, 0x24b100, 0x1e36e00e
    .long 0x43089108, 0x512700e, 0x4226b300, 0x836e00e, 0x430a9120, 0xd12700e, 0x4228b180, 0xe36e00e
    .long 0x30c9102, 0x1912700e, 0x442ab3fc, 0x1236e00e, 0x30e9500, 0x1b12700e, 0x42cb503, 0x1e36e00e
    .long 0x471093fc, 0x512700e, 0x62eb503, 0x836e00e, 0x482eb3fc, 0xc36e00d, 0x830b503, 0xe36e00d
    .long 0x4a32b3fc, 0x1836e00d, 0xa34b503, 0x1236e00d, 0x4c36b3fc, 0x1436e00d, 0x0, 0x0
    .long 0x0, 0x0, 0x0, 0x0, 0x0, 0x0, 0x0, 0x0
    .long 0x0, 0x0, 0x0, 0x0, 0x0, 0x0, 0x0, 0x0
    .long 0x10a9100, 0x1f100, 0xc0000000, 0x400d380, 0x6005000, 0x20000000, 0x90127e0, 0x15700
    .long 0x11ff19e0, 0xffff19e0, 0x15008380, 0x8380, 0x1900c540, 0xc540, 0x1d0020e0, 0xffffdf20
    .long 0x21fe9660, 0xfffed820, 0x24000000, 0x8380, 0x0, 0x0, 0x0, 0x0
    .long 0x0, 0xff000000, 0x0, 0x0, 0x0, 0x0, 0x0, 0x0
    .long 0x0, 0x0, 0x0, 0x0, 0x0, 0x0, 0x0, 0x0
    .long 0x0, 0x0, 0x0, 0x0, 0x0, 0x0, 0x0, 0x0
    .long 0x0, 0x0, 0x0, 0x0, 0x0, 0x0, 0x0, 0x0
    .long 0x0, 0x0, 0x0, 0x0, 0x0, 0x0, 0x0, 0x0
    .long 0x36b100, 0x2100, 0xfffffff8, 0xd01fb60, 0xa0198c0, 0x1100, 0xf00a460, 0x21c40
    .long 0x13fe9660, 0xfffe9660, 0x170062a0, 0xffff9d60, 0x1b0041c0, 0x10700, 0x1f00c540, 0xc540
    .long 0x23fe9660, 0xfffe9660, 0x26ff7c80, 0x62a0, 0x280169a0, 0x20e0, 0x2aff9d60, 0xa460
    .long 0x2c00a460, 0xffff9d60, 0x2d000000, 0x20e0, 0x0, 0x0, 0x0, 0x0
    .long 0x0, 0xff000000, 0x0, 0x0, 0x0, 0x0, 0x0, 0x0
    .long 0x0, 0x0, 0x0, 0x0, 0x0, 0x0, 0x0, 0x0
    .long 0x0, 0x0, 0x0, 0x0, 0x0, 0x0, 0x0, 0x0
    .long 0x0, 0x0, 0x0, 0x0, 0x0, 0x0, 0x0, 0x0
    .long 0x32b100, 0x1f100, 0xfffffff8, 0xb01b9a0, 0xa0198c0, 0x1c00, 0xf00a460, 0x21c40
    .long 0x13fe9660, 0xfffe9660, 0x170062a0, 0xffff9d60, 0x1b0041c0, 0x10700, 0x1f00c540, 0xc540
    .long 0x23fe9660, 0xfffe9660, 0x26ff7c80, 0x62a0, 0x280169a0, 0x20e0, 0x2aff9d60, 0xa460
    .long 0x2c00a460, 0xffff9d60, 0x2d000000, 0x20e0, 0x0, 0x0, 0x0, 0x0
    .long 0x0, 0xff000000, 0x0, 0x0, 0x0, 0x0, 0x0, 0x0
    .long 0x0, 0x0, 0x0, 0x0, 0x0, 0x0, 0x0, 0x0
    .long 0x0, 0x0, 0x0, 0x0, 0x0, 0x0, 0x0, 0x0
    .long 0x0, 0x0, 0x0, 0x0, 0x0, 0x0, 0x0, 0x0
    .long 0x34b100, 0x1f100, 0xfffffff8, 0xc01da80, 0xa0198c0, 0x1c00, 0xf00a460, 0x21c40
    .long 0x13fe9660, 0xfffe9660, 0x170062a0, 0xffff9d60, 0x1b0041c0, 0x10700, 0x1f00c540, 0xc540
    .long 0x23fe9660, 0xfffe9660, 0x26ff7c80, 0x62a0, 0x280169a0, 0x20e0, 0x2aff9d60, 0xa460
    .long 0x2c00a460, 0xffff9d60, 0x2d000000, 0x20e0, 0x0, 0x0, 0x0, 0x0
    .long 0x0, 0xff000000, 0x0, 0x0, 0x0, 0x0, 0x0, 0x0
    .long 0x0, 0x0, 0x0, 0x0, 0x0, 0x0, 0x0, 0x0
    .long 0x0, 0x0, 0x0, 0x0, 0x0, 0x0, 0x0, 0x0
    .long 0x0, 0x0, 0x0, 0x0, 0x0, 0x0, 0x0, 0x0
    .long 0x1049100, 0x1f100, 0xc0000000, 0x10070e0, 0x6005000, 0x20000c00, 0x90127e0, 0x15700
    .long 0x11ff19e0, 0xffff19e0, 0x15008380, 0x8380, 0x1900c540, 0xc540, 0x1d0020e0, 0xffffdf20
    .long 0x21fe9660, 0xfffed820, 0x24000000, 0x8380, 0x0, 0x0, 0x0, 0x0
    .long 0x0, 0xff000000, 0x0, 0x0, 0x0, 0x0, 0x0, 0x0
    .long 0x0, 0x0, 0x0, 0x0, 0x0, 0x0, 0x0, 0x0
    .long 0x0, 0x0, 0x0, 0x0, 0x0, 0x0, 0x0, 0x0
    .long 0x0, 0x0, 0x0, 0x0, 0x0, 0x0, 0x0, 0x0
    .long 0x0, 0x0, 0x0, 0x0, 0x0, 0x0, 0x0, 0x0
    .long 0x1069100, 0x1f100, 0xc0000000, 0x20091c0, 0x6005000, 0x20000c00, 0x90127e0, 0x15700
    .long 0x11ff19e0, 0xffff19e0, 0x15008380, 0x8380, 0x1900c540, 0xc540, 0x1d0020e0, 0xffffdf20
    .long 0x21fe9660, 0xfffed820, 0x24000000, 0x8380, 0x0, 0x0, 0x0, 0x0
    .long 0x0, 0xff000000, 0x0, 0x0, 0x0, 0x0, 0x0, 0x0
    .long 0x0, 0x0, 0x0, 0x0, 0x0, 0x0, 0x0, 0x0
    .long 0x0, 0x0, 0x0, 0x0, 0x0, 0x0, 0x0, 0x0
    .long 0x0, 0x0, 0x0, 0x0, 0x0, 0x0, 0x0, 0x0
    .long 0x0, 0x0, 0x0, 0x0, 0x0, 0x0, 0x0, 0x0
    .long 0x10c9100, 0x1f100, 0xc0000000, 0x500f460, 0x6005000, 0x20000000, 0x90127e0, 0x15700
    .long 0x11ff19e0, 0xffff19e0, 0x15008380, 0x8380, 0x1900c540, 0xc540, 0x1d0020e0, 0xffffdf20
    .long 0x21fe9660, 0xfffed820, 0x24000000, 0x8380, 0x0, 0x0, 0x0, 0x0
    .long 0x0, 0xff000000, 0x0, 0x0, 0x0, 0x0, 0x0, 0x0
    .long 0x0, 0x0, 0x0, 0x0, 0x0, 0x0, 0x0, 0x0
    .long 0x0, 0x0, 0x0, 0x0, 0x0, 0x0, 0x0, 0x0
    .long 0x0, 0x0, 0x0, 0x0, 0x0, 0x0, 0x0, 0x0
    .long 0x0, 0x0, 0x0, 0x0, 0x0, 0x0, 0x0, 0x0
    .long 0x10e9100, 0x1f100, 0xc0000000, 0x6011540, 0x6005000, 0x20000000, 0x90127e0, 0x15700
    .long 0x11ff19e0, 0xffff19e0, 0x15008380, 0x8380, 0x1900c540, 0xc540, 0x1d0020e0, 0xffffdf20
    .long 0x21fe9660, 0xfffed820, 0x24000000, 0x8380, 0x0, 0x0, 0x0, 0x0
    .long 0x0, 0xff000000, 0x0, 0x0, 0x0, 0x0, 0x0, 0x0
    .long 0x0, 0x0, 0x0, 0x0, 0x0, 0x0, 0x0, 0x0
    .long 0x0, 0x0, 0x0, 0x0, 0x0, 0x0, 0x0, 0x0
    .long 0x0, 0x0, 0x0, 0x0, 0x0, 0x0, 0x0, 0x0
    .long 0x0, 0x0, 0x0, 0x0, 0x0, 0x0, 0x0, 0x0
    .long 0x1089100, 0x1f100, 0xc0000000, 0x300b2a0, 0x6005000, 0x20000000, 0x90127e0, 0x15700
    .long 0x11ff19e0, 0xffff19e0, 0x15008380, 0x8380, 0x1900c540, 0xc540, 0x1d0020e0, 0xffffdf20
    .long 0x21fe9660, 0xfffed820, 0x24000000, 0x8380, 0x0, 0x0, 0x0, 0x0
    .long 0x0, 0xff000000, 0x0, 0x0, 0x0, 0x0, 0x0, 0x0
    .long 0x0, 0x0, 0x0, 0x0, 0x0, 0x0, 0x0, 0x0
    .long 0x0, 0x0, 0x0, 0x0, 0x0, 0x0, 0x0, 0x0
    .long 0x0, 0x0, 0x0, 0x0, 0x0, 0x0, 0x0, 0x0
    .long 0x0, 0x0, 0x0, 0x0, 0x0, 0x0, 0x0, 0x0
    .long 0x1109100, 0x1d100, 0xc0000000, 0x7013620, 0x6005000, 0x20000000, 0x90127e0, 0x15700
    .long 0x11ff19e0, 0xffff19e0, 0x15008380, 0x8380, 0x1900c540, 0xc540, 0x1d0020e0, 0xffffdf20
    .long 0x21fe9660, 0xfffed820, 0x24000000, 0x8380, 0x0, 0x0, 0x0, 0x0
    .long 0x0, 0xff000000, 0x0, 0x0, 0x0, 0x0, 0x0, 0x0
    .long 0x0, 0x0, 0x0, 0x0, 0x0, 0x0, 0x0, 0x0
    .long 0x0, 0x0, 0x0, 0x0, 0x0, 0x0, 0x0, 0x0
    .long 0x0, 0x0, 0x0, 0x0, 0x0, 0x0, 0x0, 0x0
    .long 0x0, 0x0, 0x0, 0x0, 0x0, 0x0, 0x0, 0x0
    .long 0x36e100, 0x51300e, 0x46e100, 0x451300c, 0x4ce100, 0x851300c, 0x50e100, 0xc51300c
    .long 0x38e100, 0x1051300e, 0x3ae100, 0x1451300e, 0x3ce100, 0x1851300e, 0x23ce102, 0x451300d
    .long 0x23ee110, 0x851300d, 0x240e140, 0xc51300d, 0x242e17f, 0x51300d, 0x444e17f, 0x1051300d
    .long 0x646e17f, 0x1451300d, 0x848e17f, 0x1851300d, 0xa4ae17f, 0x651300d, 0xc4ce17f, 0xa51300d
    .long 0xe4ee17f, 0xc51300d, 0x1050e17f, 0xe51300d, 0x0, 0x0, 0x0, 0x0
    .long 0x0, 0x0, 0x0, 0x0, 0x0, 0x0, 0x0, 0x0
    .long 0x0, 0x0, 0x0, 0x0, 0x0, 0x0, 0x0, 0x0
    .long 0x0, 0x0, 0x0, 0x0, 0x0, 0x0, 0x0, 0x0
    .long 0x44e100, 0x251300c, 0x48e100, 0x651300c, 0x4ee100, 0xa51300c, 0x36e100, 0xe51300d
    .long 0x38e100, 0x1251300d, 0x3ae100, 0x1651300d, 0x24ae101, 0x251300c, 0x23ee104, 0x651300e
    .long 0x240e120, 0xa51300e, 0x242e108, 0x251300e, 0x444e17f, 0xe51300e, 0x646e17f, 0x1251300e
    .long 0x848e17f, 0x1651300e, 0xa4ae17f, 0x451300e, 0xc4ce17f, 0x851300e, 0xe4ee17f, 0x251300e
    .long 0x1050e17f, 0x51300e, 0x0, 0x0, 0x0, 0x0, 0x0, 0x0
    .long 0x0, 0x0, 0x0, 0x0, 0x0, 0x0, 0x0, 0x0
    .long 0x0, 0x0, 0x0, 0x0, 0x0, 0x0, 0x0, 0x0
    .long 0x0, 0x0, 0x0, 0x0, 0x0, 0x0, 0x0, 0x0
    .long 0x0, 0x0, 0x0, 0x0, 0x0, 0xff000000, 0x0, 0x0
    .long 0x0, 0x0, 0x0, 0x0, 0x0, 0x0, 0x0, 0x0
    .long 0x0, 0x0, 0x0, 0x0, 0x0, 0x0, 0x0, 0x0
    .long 0x0, 0x0, 0x0, 0x0, 0x0, 0x0, 0x0, 0x0
    .long 0x0, 0x0, 0x0, 0x0, 0x0, 0x0, 0x0, 0x0
    .long 0x0, 0x0, 0x0, 0x0, 0x0, 0x0, 0x0, 0x0
    .long 0x0, 0x0, 0x0, 0x0, 0x0, 0x0, 0x0, 0x0
    .long 0x0, 0x0, 0x0, 0x0, 0x0, 0x0, 0x0, 0x0
    .long 0x0, 0x0, 0x0, 0x0, 0x0, 0xff000000, 0x0, 0x0
    .long 0x0, 0x0, 0x0, 0x0, 0x0, 0x0, 0x0, 0x0
    .long 0x0, 0x0, 0x0, 0x0, 0x0, 0x0, 0x0, 0x0
    .long 0x0, 0x0, 0x0, 0x0, 0x0, 0x0, 0x0, 0x0
    .long 0x0, 0x0, 0x0, 0x0, 0x0, 0x0, 0x0, 0x0
    .long 0x0, 0x0, 0x0, 0x0, 0x0, 0x0, 0x0, 0x0
    .long 0x0, 0x0, 0x0, 0x0, 0x0, 0x0, 0x0, 0x0
    .long 0x0, 0x0, 0x0, 0x0, 0x0, 0x0, 0x0, 0x0
    .long 0x44e100, 0x1f100, 0xffffffe0, 0x10070e0, 0xd005000, 0x1c00, 0x8010700, 0x13620
    .long 0xa0041c0, 0x41c0, 0xc0041c0, 0x41c0, 0xffed820, 0xfffed820, 0x110041c0, 0x41c0
    .long 0x13ff7c80, 0x41c0, 0x1500c540, 0xffff3ac0, 0x170041c0, 0x10700, 0x190041c0, 0x41c0
    .long 0x1bfed820, 0x41c0, 0x1d0041c0, 0xfffed820, 0x1fff9d60, 0x41c0, 0x21ffdf20, 0x20e0
    .long 0x22000000, 0x20e0, 0x0, 0x0, 0x0, 0x0, 0x0, 0xff000000
    .long 0x0, 0x0, 0x0, 0x0, 0x0, 0x0, 0x0, 0x0
    .long 0x0, 0x0, 0x0, 0x0, 0x0, 0x0, 0x0, 0x0
    .long 0x0, 0x0, 0x0, 0x0, 0x0, 0x0, 0x0, 0x0
    .long 0x46e100, 0x1f100, 0xffffffe0, 0x20091c0, 0xd005000, 0x1c00, 0x8010700, 0x13620
    .long 0xa0041c0, 0x41c0, 0xc0041c0, 0x41c0, 0xffed820, 0xfffed820, 0x110041c0, 0x41c0
    .long 0x13ff7c80, 0x41c0, 0x1500c540, 0xffff3ac0, 0x170041c0, 0x10700, 0x190041c0, 0x41c0
    .long 0x1bfed820, 0x41c0, 0x1d0041c0, 0xfffed820, 0x1fff9d60, 0x41c0, 0x21ffdf20, 0x20e0
    .long 0x22000000, 0x20e0, 0x0, 0x0, 0x0, 0x0, 0x0, 0xff000000
    .long 0x0, 0x0, 0x0, 0x0, 0x0, 0x0, 0x0, 0x0
    .long 0x0, 0x0, 0x0, 0x0, 0x0, 0x0, 0x0, 0x0
    .long 0x0, 0x0, 0x0, 0x0, 0x0, 0x0, 0x0, 0x0
    .long 0x48e100, 0x1f100, 0xffffffe0, 0x300b2a0, 0xd005000, 0x1c00, 0x8010700, 0x13620
    .long 0xa0041c0, 0x41c0, 0xc0041c0, 0x41c0, 0xffed820, 0xfffed820, 0x110041c0, 0x41c0
    .long 0x13ff7c80, 0x41c0, 0x1500c540, 0xffff3ac0, 0x170041c0, 0x10700, 0x190041c0, 0x41c0
    .long 0x1bfed820, 0x41c0, 0x1d0041c0, 0xfffed820, 0x1fff9d60, 0x41c0, 0x21ffdf20, 0x20e0
    .long 0x22000000, 0x20e0, 0x0, 0x0, 0x0, 0x0, 0x0, 0xff000000
    .long 0x0, 0x0, 0x0, 0x0, 0x0, 0x0, 0x0, 0x0
    .long 0x0, 0x0, 0x0, 0x0, 0x0, 0x0, 0x0, 0x0
    .long 0x0, 0x0, 0x0, 0x0, 0x0, 0x0, 0x0, 0x0
    .long 0x4ae100, 0x1f100, 0xffffffe0, 0xd0070e0, 0xd005000, 0x1c00, 0x8010700, 0x13620
    .long 0xa0041c0, 0x41c0, 0xc0041c0, 0x41c0, 0xffed820, 0xfffed820, 0x110041c0, 0x41c0
    .long 0x13ff7c80, 0x41c0, 0x1500c540, 0xffff3ac0, 0x170041c0, 0x10700, 0x190041c0, 0x41c0
    .long 0x1bfed820, 0x41c0, 0x1d0041c0, 0xfffed820, 0x1fff9d60, 0x41c0, 0x21ffdf20, 0x20e0
    .long 0x22000000, 0x20e0, 0x0, 0x0, 0x0, 0x0, 0x0, 0xff000000
    .long 0x0, 0x0, 0x0, 0x0, 0x0, 0x0, 0x0, 0x0
    .long 0x0, 0x0, 0x0, 0x0, 0x0, 0x0, 0x0, 0x0
    .long 0x0, 0x0, 0x0, 0x0, 0x0, 0x0, 0x0, 0x0
    .long 0x4ce100, 0x1f100, 0xffffffe0, 0x400d380, 0xd005000, 0x1000, 0x8010700, 0x13620
    .long 0xa0041c0, 0x41c0, 0xc0041c0, 0x41c0, 0xffed820, 0xfffed820, 0x110041c0, 0x41c0
    .long 0x13ff7c80, 0x41c0, 0x1500c540, 0xffff3ac0, 0x170041c0, 0x10700, 0x190041c0, 0x41c0
    .long 0x1bfed820, 0x41c0, 0x1d0041c0, 0xfffed820, 0x1fff9d60, 0x41c0, 0x21ffdf20, 0x20e0
    .long 0x22000000, 0x20e0, 0x0, 0x0, 0x0, 0x0, 0x0, 0xff000000
    .long 0x0, 0x0, 0x0, 0x0, 0x0, 0x0, 0x0, 0x0
    .long 0x0, 0x0, 0x0, 0x0, 0x0, 0x0, 0x0, 0x0
    .long 0x0, 0x0, 0x0, 0x0, 0x0, 0x0, 0x0, 0x0
    .long 0x4ee100, 0x1f100, 0xffffffe0, 0x500f460, 0xd005000, 0x1000, 0x8010700, 0x13620
    .long 0xa0041c0, 0x41c0, 0xc0041c0, 0x41c0, 0xffed820, 0xfffed820, 0x110041c0, 0x41c0
    .long 0x13ff7c80, 0x41c0, 0x1500c540, 0xffff3ac0, 0x170041c0, 0x10700, 0x190041c0, 0x41c0
    .long 0x1bfed820, 0x41c0, 0x1d0041c0, 0xfffed820, 0x1fff9d60, 0x41c0, 0x21ffdf20, 0x20e0
    .long 0x22000000, 0x20e0, 0x0, 0x0, 0x0, 0x0, 0x0, 0xff000000
    .long 0x0, 0x0, 0x0, 0x0, 0x0, 0x0, 0x0, 0x0
    .long 0x0, 0x0, 0x0, 0x0, 0x0, 0x0, 0x0, 0x0
    .long 0x0, 0x0, 0x0, 0x0, 0x0, 0x0, 0x0, 0x0
    .long 0x50e100, 0x4100, 0xffffffe0, 0x6011540, 0xd005000, 0x1100, 0x8010700, 0x13620
    .long 0xa0041c0, 0x41c0, 0xc0041c0, 0x41c0, 0xffed820, 0xfffed820, 0x110041c0, 0x41c0
    .long 0x13ff7c80, 0x41c0, 0x1500c540, 0xffff3ac0, 0x170041c0, 0x10700, 0x190041c0, 0x41c0
    .long 0x1bfed820, 0x41c0, 0x1d0041c0, 0xfffed820, 0x1fff9d60, 0x41c0, 0x21ffdf20, 0x20e0
    .long 0x22000000, 0x20e0, 0x0, 0x0, 0x0, 0x0, 0x0, 0xff000000
    .long 0x0, 0x0, 0x0, 0x0, 0x0, 0x0, 0x0, 0x0
    .long 0x0, 0x0, 0x0, 0x0, 0x0, 0x0, 0x0, 0x0
    .long 0x0, 0x0, 0x0, 0x0, 0x0, 0x0, 0x0, 0x0
    .long 0x0, 0x0, 0x0, 0x0, 0x0, 0xff000000, 0x0, 0x0
    .long 0x0, 0x0, 0x0, 0x0, 0x0, 0x0, 0x0, 0x0
    .long 0x0, 0x0, 0x0, 0x0, 0x0, 0x0, 0x0, 0x0
    .long 0x0, 0x0, 0x0, 0x0, 0x0, 0x0, 0x0, 0x0
    .long 0x0, 0x0, 0x0, 0x0, 0x0, 0x0, 0x0, 0x0
    .long 0x0, 0x0, 0x0, 0x0, 0x0, 0x0, 0x0, 0x0
    .long 0x0, 0x0, 0x0, 0x0, 0x0, 0x0, 0x0, 0x0
    .long 0x0, 0x0, 0x0, 0x0, 0x0, 0x0, 0x0, 0x0
    .long 0xafa000, 0xcb000e, 0xbfa000, 0x4cb000c, 0xc3a000, 0x8cb000c, 0xc7a000, 0xccb000c
    .long 0xafa000, 0x10cb000d, 0xb1a000, 0x14cb000d, 0xb3a000, 0x18cb000d, 0xb5a000, 0x1ccb000e
    .long 0x260f101, 0x268600e, 0x2b7a004, 0x6cb000d, 0x2b9a010, 0xacb000e, 0x260f17f, 0x68600d
    .long 0x4bba07f, 0x10cb000d, 0x6bda07f, 0x14cb000e, 0x862f17f, 0x1868600d, 0x8bfa07f, 0x1ccb000d
    .long 0x42c1a400, 0x8cb000e, 0xa64f17f, 0x1e68600d, 0xcc3a07f, 0xacb000d, 0xec5a07f, 0xecb000e
    .long 0x4466f580, 0x1268600d, 0x10c7a07f, 0x14cb000d, 0x46c9a480, 0x18cb000d, 0x0, 0x0
    .long 0x0, 0x0, 0x0, 0x0, 0x0, 0x0, 0x0, 0x0
    .long 0x0, 0x0, 0x0, 0x0, 0x0, 0x0, 0x0, 0x0
    .long 0xbda000, 0x2cb000c, 0xc1a000, 0x6cb000c, 0xc5a000, 0xacb000c, 0xc9a000, 0xecb000c
    .long 0xb1a000, 0x12cb000e, 0xb3a000, 0x16cb000e, 0x64f100, 0x1a68600c, 0xb5a000, 0x1ecb000d
    .long 0x2b7a002, 0x4cb000e, 0x266f108, 0x868600c, 0x2b9a020, 0xccb000d, 0x2bba040, 0xecb000e
    .long 0x462f17f, 0x1268600e, 0x6bda07f, 0x16cb000d, 0x42bfa080, 0x1acb000e, 0x4264f580, 0x268600e
    .long 0xac1a07f, 0x4cb000d, 0xcc3a07f, 0x6cb000e, 0xe66f17f, 0xc68600e, 0x44c5a480, 0xcb000d
    .long 0x10c7a07f, 0x10cb000e, 0x46c9a480, 0x2cb000e, 0x0, 0x0, 0x0, 0x0
    .long 0x0, 0x0, 0x0, 0x0, 0x0, 0x0, 0x0, 0x0
    .long 0x0, 0x0, 0x0, 0x0, 0x0, 0x0, 0x0, 0x0
    .long 0x0, 0x0, 0x0, 0x0, 0x0, 0xff000000, 0x0, 0x0
    .long 0x0, 0x0, 0x0, 0x0, 0x0, 0x0, 0x0, 0x0
    .long 0x0, 0x0, 0x0, 0x0, 0x0, 0x0, 0x0, 0x0
    .long 0x0, 0x0, 0x0, 0x0, 0x0, 0x0, 0x0, 0x0
    .long 0x0, 0x0, 0x0, 0x0, 0x0, 0x0, 0x0, 0x0
    .long 0x0, 0x0, 0x0, 0x0, 0x0, 0x0, 0x0, 0x0
    .long 0x0, 0x0, 0x0, 0x0, 0x0, 0x0, 0x0, 0x0
    .long 0x0, 0x0, 0x0, 0x0, 0x0, 0x0, 0x0, 0x0
    .long 0x66f100, 0x16100, 0xff800000, 0x1300d380, 0x30070e0, 0x20000000, 0x19010700, 0x5000
    .long 0x1ffef900, 0x18a80, 0x2500a460, 0x62a0, 0x28000000, 0xffff3ac0, 0x0, 0x0
    .long 0x0, 0x0, 0x0, 0xff000000, 0x0, 0x0, 0x0, 0x0
    .long 0x0, 0x0, 0x0, 0x0, 0x0, 0x0, 0x0, 0x0
    .long 0x0, 0x0, 0x0, 0x0, 0x0, 0x0, 0x0, 0x0
    .long 0x0, 0x0, 0x0, 0x0, 0x0, 0x0, 0x0, 0x0
    .long 0x0, 0x0, 0x0, 0x0, 0x0, 0x0, 0x0, 0x0
    .long 0x0, 0x0, 0x0, 0x0, 0x0, 0x0, 0x0, 0x0
    .long 0xbda000, 0x1f100, 0xffc00000, 0x10070e0, 0xd005000, 0xc00, 0x90127e0, 0x15700
    .long 0xb0041c0, 0x41c0, 0xe0062a0, 0x41c0, 0x11fe7580, 0x62a0, 0x140062a0, 0xfffe7580
    .long 0x170041c0, 0x62a0, 0x1a0062a0, 0x41c0, 0x1d0062a0, 0x62a0, 0x20fed820, 0x62a0
    .long 0x23ffdf20, 0xfffe7580, 0x26008380, 0x62a0, 0x290020e0, 0xffff5ba0, 0x2bff19e0, 0x148c0
    .long 0x2c000000, 0x41c0, 0x0, 0x0, 0x0, 0x0, 0x0, 0xff000000
    .long 0x0, 0x0, 0x0, 0x0, 0x0, 0x0, 0x0, 0x0
    .long 0x0, 0x0, 0x0, 0x0, 0x0, 0x0, 0x0, 0x0
    .long 0x0, 0x0, 0x0, 0x0, 0x0, 0x0, 0x0, 0x0
    .long 0xbfa000, 0x1f100, 0xffc00000, 0x20091c0, 0xd005000, 0xc00, 0x90127e0, 0x15700
    .long 0xb0041c0, 0x41c0, 0xe0062a0, 0x41c0, 0x11fe7580, 0x62a0, 0x140062a0, 0xfffe7580
    .long 0x170041c0, 0x62a0, 0x1a0062a0, 0x41c0, 0x1d0062a0, 0x62a0, 0x20fed820, 0x62a0
    .long 0x23ffdf20, 0xfffe7580, 0x26008380, 0x62a0, 0x290020e0, 0xffff5ba0, 0x2bff19e0, 0x148c0
    .long 0x2c000000, 0x41c0, 0x0, 0x0, 0x0, 0x0, 0x0, 0xff000000
    .long 0x0, 0x0, 0x0, 0x0, 0x0, 0x0, 0x0, 0x0
    .long 0x0, 0x0, 0x0, 0x0, 0x0, 0x0, 0x0, 0x0
    .long 0x0, 0x0, 0x0, 0x0, 0x0, 0x0, 0x0, 0x0
    .long 0xc1a000, 0x1f100, 0xffc00000, 0x300b2a0, 0xd005000, 0xc00, 0x90127e0, 0x15700
    .long 0xb0041c0, 0x41c0, 0xe0062a0, 0x41c0, 0x11fe7580, 0x62a0, 0x140062a0, 0xfffe7580
    .long 0x170041c0, 0x62a0, 0x1a0062a0, 0x41c0, 0x1d0062a0, 0x62a0, 0x20fed820, 0x62a0
    .long 0x23ffdf20, 0xfffe7580, 0x26008380, 0x62a0, 0x290020e0, 0xffff5ba0, 0x2bff19e0, 0x148c0
    .long 0x2c000000, 0x41c0, 0x0, 0x0, 0x0, 0x0, 0x0, 0xff000000
    .long 0x0, 0x0, 0x0, 0x0, 0x0, 0x0, 0x0, 0x0
    .long 0x0, 0x0, 0x0, 0x0, 0x0, 0x0, 0x0, 0x0
    .long 0x0, 0x0, 0x0, 0x0, 0x0, 0x0, 0x0, 0x0
    .long 0xc3a000, 0x1f100, 0xffc00000, 0x400d380, 0xd005000, 0xc00, 0x90127e0, 0x15700
    .long 0xb0041c0, 0x41c0, 0xe0062a0, 0x41c0, 0x11fe7580, 0x62a0, 0x140062a0, 0xfffe7580
    .long 0x170041c0, 0x62a0, 0x1a0062a0, 0x41c0, 0x1d0062a0, 0x62a0, 0x20fed820, 0x62a0
    .long 0x23ffdf20, 0xfffe7580, 0x26008380, 0x62a0, 0x290020e0, 0xffff5ba0, 0x2bff19e0, 0x148c0
    .long 0x2c000000, 0x41c0, 0x0, 0x0, 0x0, 0x0, 0x0, 0xff000000
    .long 0x0, 0x0, 0x0, 0x0, 0x0, 0x0, 0x0, 0x0
    .long 0x0, 0x0, 0x0, 0x0, 0x0, 0x0, 0x0, 0x0
    .long 0x0, 0x0, 0x0, 0x0, 0x0, 0x0, 0x0, 0x0
    .long 0xc5a000, 0x1f100, 0xffc00000, 0x500f460, 0xd005000, 0x0, 0x90127e0, 0x15700
    .long 0xb0041c0, 0x41c0, 0xe0062a0, 0x41c0, 0x11fe7580, 0x62a0, 0x140062a0, 0xfffe7580
    .long 0x170041c0, 0x62a0, 0x1a0062a0, 0x41c0, 0x1d0062a0, 0x62a0, 0x20fed820, 0x62a0
    .long 0x23ffdf20, 0xfffe7580, 0x26008380, 0x62a0, 0x290020e0, 0xffff5ba0, 0x2bff19e0, 0x148c0
    .long 0x2c000000, 0x41c0, 0x0, 0x0, 0x0, 0x0, 0x0, 0xff000000
    .long 0x0, 0x0, 0x0, 0x0, 0x0, 0x0, 0x0, 0x0
    .long 0x0, 0x0, 0x0, 0x0, 0x0, 0x0, 0x0, 0x0
    .long 0x0, 0x0, 0x0, 0x0, 0x0, 0x0, 0x0, 0x0
    .long 0xc7a000, 0x1f100, 0xffc00000, 0x6011540, 0xd005000, 0x0, 0x90127e0, 0x15700
    .long 0xb0041c0, 0x41c0, 0xe0062a0, 0x41c0, 0x11fe7580, 0x62a0, 0x140062a0, 0xfffe7580
    .long 0x170041c0, 0x62a0, 0x1a0062a0, 0x41c0, 0x1d0062a0, 0x62a0, 0x20fed820, 0x62a0
    .long 0x23ffdf20, 0xfffe7580, 0x26008380, 0x62a0, 0x290020e0, 0xffff5ba0, 0x2bff19e0, 0x148c0
    .long 0x2c000000, 0x41c0, 0x0, 0x0, 0x0, 0x0, 0x0, 0xff000000
    .long 0x0, 0x0, 0x0, 0x0, 0x0, 0x0, 0x0, 0x0
    .long 0x0, 0x0, 0x0, 0x0, 0x0, 0x0, 0x0, 0x0
    .long 0x0, 0x0, 0x0, 0x0, 0x0, 0x0, 0x0, 0x0
    .long 0xc9a000, 0x15100, 0xffc00000, 0x7013620, 0xd005000, 0x0, 0x90127e0, 0x15700
    .long 0xb0041c0, 0x41c0, 0xe0062a0, 0x41c0, 0x11fe7580, 0x62a0, 0x140062a0, 0xfffe7580
    .long 0x170041c0, 0x62a0, 0x1a0062a0, 0x41c0, 0x1d0062a0, 0x62a0, 0x20fed820, 0x62a0
    .long 0x23ffdf20, 0xfffe7580, 0x26008380, 0x62a0, 0x290020e0, 0xffff5ba0, 0x2bff19e0, 0x148c0
    .long 0x2c000000, 0x41c0, 0x0, 0x0, 0x0, 0x0, 0x0, 0xff000000
    .long 0x0, 0x0, 0x0, 0x0, 0x0, 0x0, 0x0, 0x0
    .long 0x0, 0x0, 0x0, 0x0, 0x0, 0x0, 0x0, 0x0
    .long 0x0, 0x0, 0x0, 0x0, 0x0, 0x0, 0x0, 0x0
    .long 0x64f100, 0x1f100, 0xff800000, 0x1001fb60, 0x30070e0, 0x20000000, 0x19010700, 0x5000
    .long 0x1ffef900, 0x18a80, 0x2500a460, 0x62a0, 0x28000000, 0xffff3ac0, 0x0, 0x0
    .long 0x0, 0x0, 0x0, 0xff000000, 0x0, 0x0, 0x0, 0x0
    .long 0x0, 0x0, 0x0, 0x0, 0x0, 0x0, 0x0, 0x0
    .long 0x0, 0x0, 0x0, 0x0, 0x0, 0x0, 0x0, 0x0
    .long 0x0, 0x0, 0x0, 0x0, 0x0, 0x0, 0x0, 0x0
    .long 0x0, 0x0, 0x0, 0x0, 0x0, 0x0, 0x0, 0x0
    .long 0x0, 0x0, 0x0, 0x0, 0x0, 0x0, 0x0, 0x0
    .long 0x1049000, 0x112700a, 0x1069000, 0x5127008, 0x10a9000, 0x9127008, 0x10e9000, 0xd127008
    .long 0x1049000, 0x11127009, 0x22b000, 0x1436e00a, 0x34b000, 0x1836e008, 0x22b000, 0x1a36e00d
    .long 0x43069004, 0x312700d, 0x4224b040, 0x636e00d, 0x43089200, 0x912700d, 0x4226b2fc, 0x36e00d
    .long 0x30a9001, 0x1712700d, 0x228b002, 0x1836e00d, 0x30c9403, 0x1512700d, 0x42ab403, 0x1a36e00d
    .long 0x470e92fc, 0x312700d, 0x62cb403, 0xa36e00d, 0x491092fc, 0xd12700d, 0x830b403, 0xe36e00e
    .long 0x4a32b2fc, 0x1636e00e, 0xa34b403, 0x1236e00e, 0x4c36b2fc, 0x1436e00e, 0x0, 0x0
    .long 0x0, 0x0, 0x0, 0x0, 0x0, 0x0, 0x0, 0x0
    .long 0x0, 0x0, 0x0, 0x0, 0x0, 0x0, 0x0, 0x0
    .long 0x1049000, 0x3127008, 0x1089000, 0x7127008, 0x10c9000, 0xb127008, 0x1109000, 0xf127008
    .long 0x1069000, 0x1312700a, 0x32b000, 0x1636e008, 0x36b000, 0x1c36e008, 0x24b000, 0x1e36e00e
    .long 0x43089008, 0x512700e, 0x4226b010, 0xa36e00e, 0x430a9020, 0xd12700e, 0x4228b080, 0xe36e00e
    .long 0x450c92fc, 0x1112700e, 0x442ab2fc, 0x1236e00e, 0x30e9400, 0x1d12700e, 0x42cb403, 0x1e36e00e
    .long 0x471092fc, 0x512700e, 0x62eb403, 0x636e00e, 0x482eb2fc, 0x836e00d, 0x830b403, 0x36e00d
    .long 0x4a32b2fc, 0x1036e00d, 0xa34b403, 0x1836e00d, 0x4c36b2fc, 0x1c36e00d, 0x0, 0x0
    .long 0x0, 0x0, 0x0, 0x0, 0x0, 0x0, 0x0, 0x0
    .long 0x0, 0x0, 0x0, 0x0, 0x0, 0x0, 0x0, 0x0
    .long 0x10a9000, 0x1f100, 0xc0000000, 0x400d380, 0x6005000, 0x20000000, 0x90127e0, 0x15700
    .long 0x11ff19e0, 0xffff19e0, 0x15008380, 0x62a0, 0x190041c0, 0xe620, 0x1d00c540, 0xffffdf20
    .long 0x21fe7580, 0xfffed820, 0x24000000, 0xa460, 0x0, 0x0, 0x0, 0x0
    .long 0x0, 0xff000000, 0x0, 0x0, 0x0, 0x0, 0x0, 0x0
    .long 0x0, 0x0, 0x0, 0x0, 0x0, 0x0, 0x0, 0x0
    .long 0x0, 0x0, 0x0, 0x0, 0x0, 0x0, 0x0, 0x0
    .long 0x0, 0x0, 0x0, 0x0, 0x0, 0x0, 0x0, 0x0
    .long 0x0, 0x0, 0x0, 0x0, 0x0, 0x0, 0x0, 0x0
    .long 0x36b000, 0x2100, 0xfffffff8, 0xd021c40, 0xa0198c0, 0x1100, 0xf00a460, 0x1fb60
    .long 0x13feb740, 0xfffeb740, 0x170041c0, 0xffff9d60, 0x1b0041c0, 0x18a80, 0x1f00c540, 0x20e0
    .long 0x23fe7580, 0xfffef900, 0x26008380, 0xffffdf20, 0x28008380, 0xffff7c80, 0x2affbe40, 0x10700
    .long 0x2c0020e0, 0x8380, 0x2d000000, 0x41c0, 0x0, 0x0, 0x0, 0x0
    .long 0x0, 0xff000000, 0x0, 0x0, 0x0, 0x0, 0x0, 0x0
    .long 0x0, 0x0, 0x0, 0x0, 0x0, 0x0, 0x0, 0x0
    .long 0x0, 0x0, 0x0, 0x0, 0x0, 0x0, 0x0, 0x0
    .long 0x0, 0x0, 0x0, 0x0, 0x0, 0x0, 0x0, 0x0
    .long 0x32b000, 0x1f100, 0xfffffff8, 0xb01b9a0, 0xa0198c0, 0x1c00, 0xf00a460, 0x1fb60
    .long 0x13feb740, 0xfffeb740, 0x170041c0, 0xffff9d60, 0x1b0041c0, 0x18a80, 0x1f00c540, 0x20e0
    .long 0x23fe7580, 0xfffef900, 0x26008380, 0xffffdf20, 0x28008380, 0xffff7c80, 0x2affbe40, 0x10700
    .long 0x2c0020e0, 0x8380, 0x2d000000, 0x41c0, 0x0, 0x0, 0x0, 0x0
    .long 0x0, 0xff000000, 0x0, 0x0, 0x0, 0x0, 0x0, 0x0
    .long 0x0, 0x0, 0x0, 0x0, 0x0, 0x0, 0x0, 0x0
    .long 0x0, 0x0, 0x0, 0x0, 0x0, 0x0, 0x0, 0x0
    .long 0x0, 0x0, 0x0, 0x0, 0x0, 0x0, 0x0, 0x0
    .long 0x34b000, 0x1f100, 0xfffffff8, 0xc01da80, 0xa0198c0, 0x1c00, 0xf00a460, 0x1fb60
    .long 0x13feb740, 0xfffeb740, 0x170041c0, 0xffff9d60, 0x1b0041c0, 0x18a80, 0x1f00c540, 0x20e0
    .long 0x23fe7580, 0xfffef900, 0x26008380, 0xffffdf20, 0x28008380, 0xffff7c80, 0x2affbe40, 0x10700
    .long 0x2c0020e0, 0x8380, 0x2d000000, 0x41c0, 0x0, 0x0, 0x0, 0x0
    .long 0x0, 0xff000000, 0x0, 0x0, 0x0, 0x0, 0x0, 0x0
    .long 0x0, 0x0, 0x0, 0x0, 0x0, 0x0, 0x0, 0x0
    .long 0x0, 0x0, 0x0, 0x0, 0x0, 0x0, 0x0, 0x0
    .long 0x0, 0x0, 0x0, 0x0, 0x0, 0x0, 0x0, 0x0
    .long 0x1049000, 0x1f100, 0xc0000000, 0x10070e0, 0x6005000, 0x20000c00, 0x90127e0, 0x15700
    .long 0x11ff19e0, 0xffff19e0, 0x15008380, 0x62a0, 0x190041c0, 0xe620, 0x1d00c540, 0xffffdf20
    .long 0x21fe7580, 0xfffed820, 0x24000000, 0xa460, 0x0, 0x0, 0x0, 0x0
    .long 0x0, 0xff000000, 0x0, 0x0, 0x0, 0x0, 0x0, 0x0
    .long 0x0, 0x0, 0x0, 0x0, 0x0, 0x0, 0x0, 0x0
    .long 0x0, 0x0, 0x0, 0x0, 0x0, 0x0, 0x0, 0x0
    .long 0x0, 0x0, 0x0, 0x0, 0x0, 0x0, 0x0, 0x0
    .long 0x0, 0x0, 0x0, 0x0, 0x0, 0x0, 0x0, 0x0
    .long 0x1069000, 0x1f100, 0xc0000000, 0x20091c0, 0x6005000, 0x20000c00, 0x90127e0, 0x15700
    .long 0x11ff19e0, 0xffff19e0, 0x15008380, 0x62a0, 0x190041c0, 0xe620, 0x1d00c540, 0xffffdf20
    .long 0x21fe7580, 0xfffed820, 0x24000000, 0xa460, 0x0, 0x0, 0x0, 0x0
    .long 0x0, 0xff000000, 0x0, 0x0, 0x0, 0x0, 0x0, 0x0
    .long 0x0, 0x0, 0x0, 0x0, 0x0, 0x0, 0x0, 0x0
    .long 0x0, 0x0, 0x0, 0x0, 0x0, 0x0, 0x0, 0x0
    .long 0x0, 0x0, 0x0, 0x0, 0x0, 0x0, 0x0, 0x0
    .long 0x0, 0x0, 0x0, 0x0, 0x0, 0x0, 0x0, 0x0
    .long 0x10c9000, 0x1f100, 0xc0000000, 0x500f460, 0x6005000, 0x20000000, 0x90127e0, 0x15700
    .long 0x11ff19e0, 0xffff19e0, 0x15008380, 0x62a0, 0x190041c0, 0xe620, 0x1d00c540, 0xffffdf20
    .long 0x21fe7580, 0xfffed820, 0x24000000, 0xa460, 0x0, 0x0, 0x0, 0x0
    .long 0x0, 0xff000000, 0x0, 0x0, 0x0, 0x0, 0x0, 0x0
    .long 0x0, 0x0, 0x0, 0x0, 0x0, 0x0, 0x0, 0x0
    .long 0x0, 0x0, 0x0, 0x0, 0x0, 0x0, 0x0, 0x0
    .long 0x0, 0x0, 0x0, 0x0, 0x0, 0x0, 0x0, 0x0
    .long 0x0, 0x0, 0x0, 0x0, 0x0, 0x0, 0x0, 0x0
    .long 0x10e9000, 0x1f100, 0xc0000000, 0x6011540, 0x6005000, 0x20000000, 0x90127e0, 0x15700
    .long 0x11ff19e0, 0xffff19e0, 0x15008380, 0x62a0, 0x190041c0, 0xe620, 0x1d00c540, 0xffffdf20
    .long 0x21fe7580, 0xfffed820, 0x24000000, 0xa460, 0x0, 0x0, 0x0, 0x0
    .long 0x0, 0xff000000, 0x0, 0x0, 0x0, 0x0, 0x0, 0x0
    .long 0x0, 0x0, 0x0, 0x0, 0x0, 0x0, 0x0, 0x0
    .long 0x0, 0x0, 0x0, 0x0, 0x0, 0x0, 0x0, 0x0
    .long 0x0, 0x0, 0x0, 0x0, 0x0, 0x0, 0x0, 0x0
    .long 0x0, 0x0, 0x0, 0x0, 0x0, 0x0, 0x0, 0x0
    .long 0x1089000, 0x1f100, 0xc0000000, 0x300b2a0, 0x6005000, 0x20000000, 0x90127e0, 0x15700
    .long 0x11ff19e0, 0xffff19e0, 0x15008380, 0x62a0, 0x190041c0, 0xe620, 0x1d00c540, 0xffffdf20
    .long 0x21fe7580, 0xfffed820, 0x24000000, 0xa460, 0x0, 0x0, 0x0, 0x0
    .long 0x0, 0xff000000, 0x0, 0x0, 0x0, 0x0, 0x0, 0x0
    .long 0x0, 0x0, 0x0, 0x0, 0x0, 0x0, 0x0, 0x0
    .long 0x0, 0x0, 0x0, 0x0, 0x0, 0x0, 0x0, 0x0
    .long 0x0, 0x0, 0x0, 0x0, 0x0, 0x0, 0x0, 0x0
    .long 0x0, 0x0, 0x0, 0x0, 0x0, 0x0, 0x0, 0x0
    .long 0x1109000, 0x1d100, 0xc0000000, 0x7013620, 0x6005000, 0x20000000, 0x90127e0, 0x15700
    .long 0x11ff19e0, 0xffff19e0, 0x15008380, 0x62a0, 0x190041c0, 0xe620, 0x1d00c540, 0xffffdf20
    .long 0x21fe7580, 0xfffed820, 0x24000000, 0xa460, 0x0, 0x0, 0x0, 0x0
    .long 0x0, 0xff000000, 0x0, 0x0, 0x0, 0x0, 0x0, 0x0
    .long 0x0, 0x0, 0x0, 0x0, 0x0, 0x0, 0x0, 0x0
    .long 0x0, 0x0, 0x0, 0x0, 0x0, 0x0, 0x0, 0x0
    .long 0x0, 0x0, 0x0, 0x0, 0x0, 0x0, 0x0, 0x0
    .long 0x0, 0x0, 0x0, 0x0, 0x0, 0x0, 0x0, 0x0
    .long 0x1049000, 0x112700a, 0x1069000, 0x5127008, 0x10a9000, 0x9127008, 0x10e9000, 0xd127008
    .long 0x1049000, 0x11127009, 0x22b000, 0x1436e00a, 0x34b000, 0x1836e008, 0x22b000, 0x1a36e00d
    .long 0x43069004, 0x312700d, 0x4224b040, 0x636e00d, 0x43089200, 0x912700d, 0x4226b2fc, 0x36e00d
    .long 0x30a9001, 0x1712700d, 0x228b002, 0x1836e00d, 0x30c9403, 0x1512700d, 0x42ab403, 0x1a36e00d
    .long 0x470e92fc, 0x312700d, 0x62cb403, 0x636e00d, 0x491092fc, 0x912700d, 0x830b403, 0xe36e00e
    .long 0x4a32b2fc, 0x1636e00e, 0xa34b403, 0x1236e00e, 0x4c36b2fc, 0x1436e00e, 0x0, 0x0
    .long 0x0, 0x0, 0x0, 0x0, 0x0, 0x0, 0x0, 0x0
    .long 0x0, 0x0, 0x0, 0x0, 0x0, 0x0, 0x0, 0x0
    .long 0x1049000, 0x3127008, 0x1089000, 0x7127008, 0x10c9000, 0xb127008, 0x1109000, 0xf127008
    .long 0x1069000, 0x1312700a, 0x32b000, 0x1636e008, 0x36b000, 0x1c36e008, 0x24b000, 0x1e36e00e
    .long 0x43089008, 0x512700e, 0x4226b010, 0xa36e00e, 0x430a9020, 0xd12700e, 0x4228b080, 0xe36e00e
    .long 0x450c92fc, 0x1112700e, 0x442ab2fc, 0x1236e00e, 0x30e9400, 0x1d12700e, 0x42cb403, 0x1e36e00e
    .long 0x471092fc, 0x512700e, 0x62eb403, 0xa36e00e, 0x482eb2fc, 0xc36e00d, 0x830b403, 0x36e00d
    .long 0x4a32b2fc, 0x1036e00d, 0xa34b403, 0x1836e00d, 0x4c36b2fc, 0x1c36e00d, 0x0, 0x0
    .long 0x0, 0x0, 0x0, 0x0, 0x0, 0x0, 0x0, 0x0
    .long 0x0, 0x0, 0x0, 0x0, 0x0, 0x0, 0x0, 0x0
    .long 0x10a9000, 0x1f100, 0xc0000000, 0x400d380, 0x6005000, 0x20000000, 0x90127e0, 0x15700
    .long 0x11ff19e0, 0xffff19e0, 0x15008380, 0x62a0, 0x190041c0, 0xe620, 0x1d00c540, 0xffffdf20
    .long 0x21fe7580, 0xfffed820, 0x24000000, 0x62a0, 0x0, 0x0, 0x0, 0x0
    .long 0x0, 0xff000000, 0x0, 0x0, 0x0, 0x0, 0x0, 0x0
    .long 0x0, 0x0, 0x0, 0x0, 0x0, 0x0, 0x0, 0x0
    .long 0x0, 0x0, 0x0, 0x0, 0x0, 0x0, 0x0, 0x0
    .long 0x0, 0x0, 0x0, 0x0, 0x0, 0x0, 0x0, 0x0
    .long 0x0, 0x0, 0x0, 0x0, 0x0, 0x0, 0x0, 0x0
    .long 0x36b000, 0x2100, 0xfffffff8, 0xd021c40, 0xa0198c0, 0x1100, 0xf00a460, 0x1fb60
    .long 0x13feb740, 0xfffeb740, 0x170041c0, 0xffff9d60, 0x1b0041c0, 0x18a80, 0x1f00c540, 0x20e0
    .long 0x23feb740, 0xfffeb740, 0x260041c0, 0x62a0, 0x28008380, 0xffff3ac0, 0x2affbe40, 0x10700
    .long 0x2c0020e0, 0x8380, 0x2d000000, 0x41c0, 0x0, 0x0, 0x0, 0x0
    .long 0x0, 0xff000000, 0x0, 0x0, 0x0, 0x0, 0x0, 0x0
    .long 0x0, 0x0, 0x0, 0x0, 0x0, 0x0, 0x0, 0x0
    .long 0x0, 0x0, 0x0, 0x0, 0x0, 0x0, 0x0, 0x0
    .long 0x0, 0x0, 0x0, 0x0, 0x0, 0x0, 0x0, 0x0
    .long 0x32b000, 0x1f100, 0xfffffff8, 0xb01b9a0, 0xa0198c0, 0x1c00, 0xf00a460, 0x1fb60
    .long 0x13feb740, 0xfffeb740, 0x170041c0, 0xffff9d60, 0x1b0041c0, 0x18a80, 0x1f00c540, 0x20e0
    .long 0x23feb740, 0xfffeb740, 0x260041c0, 0x62a0, 0x28008380, 0xffff3ac0, 0x2affbe40, 0x10700
    .long 0x2c0020e0, 0x8380, 0x2d000000, 0x41c0, 0x0, 0x0, 0x0, 0x0
    .long 0x0, 0xff000000, 0x0, 0x0, 0x0, 0x0, 0x0, 0x0
    .long 0x0, 0x0, 0x0, 0x0, 0x0, 0x0, 0x0, 0x0
    .long 0x0, 0x0, 0x0, 0x0, 0x0, 0x0, 0x0, 0x0
    .long 0x0, 0x0, 0x0, 0x0, 0x0, 0x0, 0x0, 0x0
    .long 0x34b000, 0x1f100, 0xfffffff8, 0xc01da80, 0xa0198c0, 0x1c00, 0xf00a460, 0x1fb60
    .long 0x13feb740, 0xfffeb740, 0x170041c0, 0xffff9d60, 0x1b0041c0, 0x18a80, 0x1f00c540, 0x20e0
    .long 0x23feb740, 0xfffeb740, 0x260041c0, 0x62a0, 0x28008380, 0xffff3ac0, 0x2affbe40, 0x10700
    .long 0x2c0020e0, 0x8380, 0x2d000000, 0x41c0, 0x0, 0x0, 0x0, 0x0
    .long 0x0, 0xff000000, 0x0, 0x0, 0x0, 0x0, 0x0, 0x0
    .long 0x0, 0x0, 0x0, 0x0, 0x0, 0x0, 0x0, 0x0
    .long 0x0, 0x0, 0x0, 0x0, 0x0, 0x0, 0x0, 0x0
    .long 0x0, 0x0, 0x0, 0x0, 0x0, 0x0, 0x0, 0x0
    .long 0x1049000, 0x1f100, 0xc0000000, 0x10070e0, 0x6005000, 0x20000c00, 0x90127e0, 0x15700
    .long 0x11ff19e0, 0xffff19e0, 0x15008380, 0x62a0, 0x190041c0, 0xe620, 0x1d00c540, 0xffffdf20
    .long 0x21fe7580, 0xfffed820, 0x24000000, 0x62a0, 0x0, 0x0, 0x0, 0x0
    .long 0x0, 0xff000000, 0x0, 0x0, 0x0, 0x0, 0x0, 0x0
    .long 0x0, 0x0, 0x0, 0x0, 0x0, 0x0, 0x0, 0x0
    .long 0x0, 0x0, 0x0, 0x0, 0x0, 0x0, 0x0, 0x0
    .long 0x0, 0x0, 0x0, 0x0, 0x0, 0x0, 0x0, 0x0
    .long 0x0, 0x0, 0x0, 0x0, 0x0, 0x0, 0x0, 0x0
    .long 0x1069000, 0x1f100, 0xc0000000, 0x20091c0, 0x6005000, 0x20000c00, 0x90127e0, 0x15700
    .long 0x11ff19e0, 0xffff19e0, 0x15008380, 0x62a0, 0x190041c0, 0xe620, 0x1d00c540, 0xffffdf20
    .long 0x21fe7580, 0xfffed820, 0x24000000, 0x62a0, 0x0, 0x0, 0x0, 0x0
    .long 0x0, 0xff000000, 0x0, 0x0, 0x0, 0x0, 0x0, 0x0
    .long 0x0, 0x0, 0x0, 0x0, 0x0, 0x0, 0x0, 0x0
    .long 0x0, 0x0, 0x0, 0x0, 0x0, 0x0, 0x0, 0x0
    .long 0x0, 0x0, 0x0, 0x0, 0x0, 0x0, 0x0, 0x0
    .long 0x0, 0x0, 0x0, 0x0, 0x0, 0x0, 0x0, 0x0
    .long 0x10c9000, 0x1f100, 0xc0000000, 0x500f460, 0x6005000, 0x20000000, 0x90127e0, 0x15700
    .long 0x11ff19e0, 0xffff19e0, 0x15008380, 0x62a0, 0x190041c0, 0xe620, 0x1d00c540, 0xffffdf20
    .long 0x21fe7580, 0xfffed820, 0x24000000, 0x62a0, 0x0, 0x0, 0x0, 0x0
    .long 0x0, 0xff000000, 0x0, 0x0, 0x0, 0x0, 0x0, 0x0
    .long 0x0, 0x0, 0x0, 0x0, 0x0, 0x0, 0x0, 0x0
    .long 0x0, 0x0, 0x0, 0x0, 0x0, 0x0, 0x0, 0x0
    .long 0x0, 0x0, 0x0, 0x0, 0x0, 0x0, 0x0, 0x0
    .long 0x0, 0x0, 0x0, 0x0, 0x0, 0x0, 0x0, 0x0
    .long 0x10e9000, 0x1f100, 0xc0000000, 0x6011540, 0x6005000, 0x20000000, 0x90127e0, 0x15700
    .long 0x11ff19e0, 0xffff19e0, 0x15008380, 0x62a0, 0x190041c0, 0xe620, 0x1d00c540, 0xffffdf20
    .long 0x21fe7580, 0xfffed820, 0x24000000, 0x62a0, 0x0, 0x0, 0x0, 0x0
    .long 0x0, 0xff000000, 0x0, 0x0, 0x0, 0x0, 0x0, 0x0
    .long 0x0, 0x0, 0x0, 0x0, 0x0, 0x0, 0x0, 0x0
    .long 0x0, 0x0, 0x0, 0x0, 0x0, 0x0, 0x0, 0x0
    .long 0x0, 0x0, 0x0, 0x0, 0x0, 0x0, 0x0, 0x0
    .long 0x0, 0x0, 0x0, 0x0, 0x0, 0x0, 0x0, 0x0
    .long 0x1089000, 0x1f100, 0xc0000000, 0x300b2a0, 0x6005000, 0x20000000, 0x90127e0, 0x15700
    .long 0x11ff19e0, 0xffff19e0, 0x15008380, 0x62a0, 0x190041c0, 0xe620, 0x1d00c540, 0xffffdf20
    .long 0x21fe7580, 0xfffed820, 0x24000000, 0x62a0, 0x0, 0x0, 0x0, 0x0
    .long 0x0, 0xff000000, 0x0, 0x0, 0x0, 0x0, 0x0, 0x0
    .long 0x0, 0x0, 0x0, 0x0, 0x0, 0x0, 0x0, 0x0
    .long 0x0, 0x0, 0x0, 0x0, 0x0, 0x0, 0x0, 0x0
    .long 0x0, 0x0, 0x0, 0x0, 0x0, 0x0, 0x0, 0x0
    .long 0x0, 0x0, 0x0, 0x0, 0x0, 0x0, 0x0, 0x0
    .long 0x1109000, 0x1d100, 0xc0000000, 0x7013620, 0x6005000, 0x20000000, 0x90127e0, 0x15700
    .long 0x11ff19e0, 0xffff19e0, 0x15008380, 0x62a0, 0x190041c0, 0xe620, 0x1d00c540, 0xffffdf20
    .long 0x21fe7580, 0xfffed820, 0x24000000, 0x62a0, 0x0, 0x0, 0x0, 0x0
    .long 0x0, 0xff000000, 0x0, 0x0, 0x0, 0x0, 0x0, 0x0
    .long 0x0, 0x0, 0x0, 0x0, 0x0, 0x0, 0x0, 0x0
    .long 0x0, 0x0, 0x0, 0x0, 0x0, 0x0, 0x0, 0x0
    .long 0x0, 0x0, 0x0, 0x0, 0x0, 0x0, 0x0, 0x0
    .long 0x0, 0x0, 0x0, 0x0, 0x0, 0x0, 0x0, 0x0
    .long 0xafa000, 0xcb000e, 0xb1a000, 0x4cb000c, 0xb5a000, 0x8cb000c, 0xb9a000, 0xccb000c
    .long 0xafa000, 0x10cb000d, 0xb1a000, 0x14cb000d, 0xb3a000, 0x18cb000d, 0xb5a000, 0x1ccb000e
    .long 0x260f101, 0x268600e, 0x2b7a004, 0x6cb000d, 0x2b9a010, 0xacb000e, 0x260f17f, 0x68600d
    .long 0x4bba07f, 0x10cb000d, 0x6bda07f, 0x14cb000e, 0x4262f180, 0x1a68600d, 0x8bfa07f, 0x1ccb000d
    .long 0x42c1a400, 0x8cb000e, 0xa64f17f, 0x1e68600d, 0xcc3a07f, 0xacb000d, 0xec5a07f, 0xecb000e
    .long 0x4466f580, 0x1268600d, 0x10c7a07f, 0x14cb000d, 0x46c9a480, 0x1acb000d, 0x0, 0x0
    .long 0x0, 0x0, 0x0, 0x0, 0x0, 0x0, 0x0, 0x0
    .long 0x0, 0x0, 0x0, 0x0, 0x0, 0x0, 0x0, 0x0
    .long 0xafa000, 0x2cb000c, 0xb3a000, 0x6cb000c, 0xb7a000, 0xacb000c, 0xbba000, 0xecb000c
    .long 0xb1a000, 0x12cb000e, 0xb3a000, 0x16cb000e, 0x60f100, 0x1a68600c, 0xb5a000, 0x1ecb000d
    .long 0x2b7a002, 0x4cb000e, 0x262f108, 0x868600c, 0x2b9a020, 0xccb000d, 0x2bba040, 0xecb000e
    .long 0x462f17f, 0x1268600e, 0x6bda07f, 0x16cb000d, 0x8bfa07f, 0x18cb000e, 0x4264f580, 0x268600e
    .long 0xac1a07f, 0x4cb000d, 0xcc3a07f, 0x6cb000e, 0xe66f17f, 0xc68600e, 0x44c5a480, 0xcb000d
    .long 0x10c7a07f, 0x10cb000e, 0x46c9a480, 0x2cb000e, 0x0, 0x0, 0x0, 0x0
    .long 0x0, 0x0, 0x0, 0x0, 0x0, 0x0, 0x0, 0x0
    .long 0x0, 0x0, 0x0, 0x0, 0x0, 0x0, 0x0, 0x0
    .long 0x0, 0x0, 0x0, 0x0, 0x0, 0xff000000, 0x0, 0x0
    .long 0x0, 0x0, 0x0, 0x0, 0x0, 0x0, 0x0, 0x0
    .long 0x0, 0x0, 0x0, 0x0, 0x0, 0x0, 0x0, 0x0
    .long 0x0, 0x0, 0x0, 0x0, 0x0, 0x0, 0x0, 0x0
    .long 0x0, 0x0, 0x0, 0x0, 0x0, 0x0, 0x0, 0x0
    .long 0x0, 0x0, 0x0, 0x0, 0x0, 0x0, 0x0, 0x0
    .long 0x0, 0x0, 0x0, 0x0, 0x0, 0x0, 0x0, 0x0
    .long 0x0, 0x0, 0x0, 0x0, 0x0, 0x0, 0x0, 0x0
    .long 0x62f100, 0x1f100, 0xff800000, 0x1300d380, 0x30070e0, 0x20000000, 0x19010700, 0x5000
    .long 0x1ffef900, 0x1ab60, 0x2500a460, 0x41c0, 0x28000000, 0xffff3ac0, 0x0, 0x0
    .long 0x0, 0x0, 0x0, 0xff000000, 0x0, 0x0, 0x0, 0x0
    .long 0x0, 0x0, 0x0, 0x0, 0x0, 0x0, 0x0, 0x0
    .long 0x0, 0x0, 0x0, 0x0, 0x0, 0x0, 0x0, 0x0
    .long 0x0, 0x0, 0x0, 0x0, 0x0, 0x0, 0x0, 0x0
    .long 0x0, 0x0, 0x0, 0x0, 0x0, 0x0, 0x0, 0x0
    .long 0x0, 0x0, 0x0, 0x0, 0x0, 0x0, 0x0, 0x0
    .long 0xafa000, 0x1f100, 0xffc00000, 0x10070e0, 0xd005000, 0xc00, 0x90127e0, 0x15700
    .long 0xb0041c0, 0x41c0, 0xe0062a0, 0x41c0, 0x11fe7580, 0x62a0, 0x140062a0, 0xfffe7580
    .long 0x170041c0, 0x62a0, 0x1a0062a0, 0x41c0, 0x1d0041c0, 0x62a0, 0x20fef900, 0x62a0
    .long 0x23ffdf20, 0xfffe7580, 0x26008380, 0x62a0, 0x290020e0, 0xffff5ba0, 0x2bff19e0, 0x148c0
    .long 0x2c000000, 0x62a0, 0x0, 0x0, 0x0, 0x0, 0x0, 0xff000000
    .long 0x0, 0x0, 0x0, 0x0, 0x0, 0x0, 0x0, 0x0
    .long 0x0, 0x0, 0x0, 0x0, 0x0, 0x0, 0x0, 0x0
    .long 0x0, 0x0, 0x0, 0x0, 0x0, 0x0, 0x0, 0x0
    .long 0xb1a000, 0x1f100, 0xffc00000, 0x20091c0, 0xd005000, 0xc00, 0x90127e0, 0x15700
    .long 0xb0041c0, 0x41c0, 0xe0062a0, 0x41c0, 0x11fe7580, 0x62a0, 0x140062a0, 0xfffe7580
    .long 0x170041c0, 0x62a0, 0x1a0062a0, 0x41c0, 0x1d0041c0, 0x62a0, 0x20fef900, 0x62a0
    .long 0x23ffdf20, 0xfffe7580, 0x26008380, 0x62a0, 0x290020e0, 0xffff5ba0, 0x2bff19e0, 0x148c0
    .long 0x2c000000, 0x62a0, 0x0, 0x0, 0x0, 0x0, 0x0, 0xff000000
    .long 0x0, 0x0, 0x0, 0x0, 0x0, 0x0, 0x0, 0x0
    .long 0x0, 0x0, 0x0, 0x0, 0x0, 0x0, 0x0, 0x0
    .long 0x0, 0x0, 0x0, 0x0, 0x0, 0x0, 0x0, 0x0
    .long 0xb3a000, 0x1f100, 0xffc00000, 0x300b2a0, 0xd005000, 0xc00, 0x90127e0, 0x15700
    .long 0xb0041c0, 0x41c0, 0xe0062a0, 0x41c0, 0x11fe7580, 0x62a0, 0x140062a0, 0xfffe7580
    .long 0x170041c0, 0x62a0, 0x1a0062a0, 0x41c0, 0x1d0041c0, 0x62a0, 0x20fef900, 0x62a0
    .long 0x23ffdf20, 0xfffe7580, 0x26008380, 0x62a0, 0x290020e0, 0xffff5ba0, 0x2bff19e0, 0x148c0
    .long 0x2c000000, 0x62a0, 0x0, 0x0, 0x0, 0x0, 0x0, 0xff000000
    .long 0x0, 0x0, 0x0, 0x0, 0x0, 0x0, 0x0, 0x0
    .long 0x0, 0x0, 0x0, 0x0, 0x0, 0x0, 0x0, 0x0
    .long 0x0, 0x0, 0x0, 0x0, 0x0, 0x0, 0x0, 0x0
    .long 0xb5a000, 0x1f100, 0xffc00000, 0x400d380, 0xd005000, 0xc00, 0x90127e0, 0x15700
    .long 0xb0041c0, 0x41c0, 0xe0062a0, 0x41c0, 0x11fe7580, 0x62a0, 0x140062a0, 0xfffe7580
    .long 0x170041c0, 0x62a0, 0x1a0062a0, 0x41c0, 0x1d0041c0, 0x62a0, 0x20fef900, 0x62a0
    .long 0x23ffdf20, 0xfffe7580, 0x26008380, 0x62a0, 0x290020e0, 0xffff5ba0, 0x2bff19e0, 0x148c0
    .long 0x2c000000, 0x62a0, 0x0, 0x0, 0x0, 0x0, 0x0, 0xff000000
    .long 0x0, 0x0, 0x0, 0x0, 0x0, 0x0, 0x0, 0x0
    .long 0x0, 0x0, 0x0, 0x0, 0x0, 0x0, 0x0, 0x0
    .long 0x0, 0x0, 0x0, 0x0, 0x0, 0x0, 0x0, 0x0
    .long 0xb7a000, 0x1f100, 0xffc00000, 0x500f460, 0xd005000, 0x0, 0x90127e0, 0x15700
    .long 0xb0041c0, 0x41c0, 0xe0062a0, 0x41c0, 0x11fe7580, 0x62a0, 0x140062a0, 0xfffe7580
    .long 0x170041c0, 0x62a0, 0x1a0062a0, 0x41c0, 0x1d0041c0, 0x62a0, 0x20fef900, 0x62a0
    .long 0x23ffdf20, 0xfffe7580, 0x26008380, 0x62a0, 0x290020e0, 0xffff5ba0, 0x2bff19e0, 0x148c0
    .long 0x2c000000, 0x62a0, 0x0, 0x0, 0x0, 0x0, 0x0, 0xff000000
    .long 0x0, 0x0, 0x0, 0x0, 0x0, 0x0, 0x0, 0x0
    .long 0x0, 0x0, 0x0, 0x0, 0x0, 0x0, 0x0, 0x0
    .long 0x0, 0x0, 0x0, 0x0, 0x0, 0x0, 0x0, 0x0
    .long 0xb9a000, 0x1f100, 0xffc00000, 0x6011540, 0xd005000, 0x0, 0x90127e0, 0x15700
    .long 0xb0041c0, 0x41c0, 0xe0062a0, 0x41c0, 0x11fe7580, 0x62a0, 0x140062a0, 0xfffe7580
    .long 0x170041c0, 0x62a0, 0x1a0062a0, 0x41c0, 0x1d0041c0, 0x62a0, 0x20fef900, 0x62a0
    .long 0x23ffdf20, 0xfffe7580, 0x26008380, 0x62a0, 0x290020e0, 0xffff5ba0, 0x2bff19e0, 0x148c0
    .long 0x2c000000, 0x62a0, 0x0, 0x0, 0x0, 0x0, 0x0, 0xff000000
    .long 0x0, 0x0, 0x0, 0x0, 0x0, 0x0, 0x0, 0x0
    .long 0x0, 0x0, 0x0, 0x0, 0x0, 0x0, 0x0, 0x0
    .long 0x0, 0x0, 0x0, 0x0, 0x0, 0x0, 0x0, 0x0
    .long 0xbba000, 0x1f100, 0xffc00000, 0x7013620, 0xd005000, 0x0, 0x90127e0, 0x15700
    .long 0xb0041c0, 0x41c0, 0xe0062a0, 0x41c0, 0x11fe7580, 0x62a0, 0x140062a0, 0xfffe7580
    .long 0x170041c0, 0x62a0, 0x1a0062a0, 0x41c0, 0x1d0041c0, 0x62a0, 0x20fef900, 0x62a0
    .long 0x23ffdf20, 0xfffe7580, 0x26008380, 0x62a0, 0x290020e0, 0xffff5ba0, 0x2bff19e0, 0x148c0
    .long 0x2c000000, 0x62a0, 0x0, 0x0, 0x0, 0x0, 0x0, 0xff000000
    .long 0x0, 0x0, 0x0, 0x0, 0x0, 0x0, 0x0, 0x0
    .long 0x0, 0x0, 0x0, 0x0, 0x0, 0x0, 0x0, 0x0
    .long 0x0, 0x0, 0x0, 0x0, 0x0, 0x0, 0x0, 0x0
    .long 0x60f100, 0x1f100, 0xff800000, 0x1001fb60, 0x30070e0, 0x20000000, 0x19010700, 0x5000
    .long 0x1ffef900, 0x1ab60, 0x2500a460, 0x41c0, 0x28000000, 0xffff3ac0, 0x0, 0x0
    .long 0x0, 0x0, 0x0, 0xff000000, 0x0, 0x0, 0x0, 0x0
    .long 0x0, 0x0, 0x0, 0x0, 0x0, 0x0, 0x0, 0x0
    .long 0x0, 0x0, 0x0, 0x0, 0x0, 0x0, 0x0, 0x0
    .long 0x0, 0x0, 0x0, 0x0, 0x0, 0x0, 0x0, 0x0
    .long 0x0, 0x0, 0x0, 0x0, 0x0, 0x0, 0x0, 0x0
    .long 0x0, 0x0, 0x0, 0x0, 0x0, 0x0, 0x0, 0x0
    .long 0x36e000, 0x51300e, 0x38e000, 0x451300c, 0x3ce000, 0x851300c, 0x40e000, 0xc51300c
    .long 0x36e000, 0x1051300d, 0x38e000, 0x1451300d, 0x3ae000, 0x1851300d, 0x3ce000, 0x1c51300e
    .long 0x260f001, 0x268600e, 0x23ee004, 0x651300d, 0x240e010, 0xa51300e, 0x260f07f, 0x68600d
    .long 0x442e07f, 0x1051300d, 0x644e07f, 0x1451300e, 0x4262f080, 0x1a68600d, 0x846e07f, 0x1c51300d
    .long 0x4248e400, 0x851300e, 0xa64f07f, 0x1e68600d, 0xc4ae07f, 0xa51300d, 0xe4ce07f, 0xe51300e
    .long 0x4466f480, 0x1268600d, 0x104ee07f, 0x1451300d, 0x4650e480, 0x1a51300d, 0x0, 0x0
    .long 0x0, 0x0, 0x0, 0x0, 0x0, 0x0, 0x0, 0x0
    .long 0x0, 0x0, 0x0, 0x0, 0x0, 0x0, 0x0, 0x0
    .long 0x36e000, 0x251300c, 0x3ae000, 0x651300c, 0x3ee000, 0xa51300c, 0x42e000, 0xe51300c
    .long 0x38e000, 0x1251300e, 0x3ae000, 0x1651300e, 0x60f000, 0x1a68600c, 0x3ce000, 0x1e51300d
    .long 0x23ee002, 0x451300e, 0x262f008, 0x868600c, 0x240e020, 0xc51300d, 0x242e040, 0xe51300e
    .long 0x462f07f, 0x1268600e, 0x644e07f, 0x1651300d, 0x846e07f, 0x1851300e, 0x4264f480, 0x268600e
    .long 0xa48e07f, 0x451300d, 0xc4ae07f, 0x651300e, 0xe66f07f, 0xc68600e, 0x444ce480, 0x51300d
    .long 0x104ee07f, 0x1051300e, 0x4650e480, 0x251300e, 0x0, 0x0, 0x0, 0x0
    .long 0x0, 0x0, 0x0, 0x0, 0x0, 0x0, 0x0, 0x0
    .long 0x0, 0x0, 0x0, 0x0, 0x0, 0x0, 0x0, 0x0
    .long 0x0, 0x0, 0x0, 0x0, 0x0, 0xff000000, 0x0, 0x0
    .long 0x0, 0x0, 0x0, 0x0, 0x0, 0x0, 0x0, 0x0
    .long 0x0, 0x0, 0x0, 0x0, 0x0, 0x0, 0x0, 0x0
    .long 0x0, 0x0, 0x0, 0x0, 0x0, 0x0, 0x0, 0x0
    .long 0x0, 0x0, 0x0, 0x0, 0x0, 0x0, 0x0, 0x0
    .long 0x0, 0x0, 0x0, 0x0, 0x0, 0x0, 0x0, 0x0
    .long 0x0, 0x0, 0x0, 0x0, 0x0, 0x0, 0x0, 0x0
    .long 0x0, 0x0, 0x0, 0x0, 0x0, 0x0, 0x0, 0x0
    .long 0x62f000, 0x1f100, 0xff800000, 0x1300d380, 0x30070e0, 0x20000000, 0x19010700, 0x5000
    .long 0x1ffef900, 0x1ab60, 0x2500a460, 0x41c0, 0x28000000, 0xffff3ac0, 0x0, 0x0
    .long 0x0, 0x0, 0x0, 0xff000000, 0x0, 0x0, 0x0, 0x0
    .long 0x0, 0x0, 0x0, 0x0, 0x0, 0x0, 0x0, 0x0
    .long 0x0, 0x0, 0x0, 0x0, 0x0, 0x0, 0x0, 0x0
    .long 0x0, 0x0, 0x0, 0x0, 0x0, 0x0, 0x0, 0x0
    .long 0x0, 0x0, 0x0, 0x0, 0x0, 0x0, 0x0, 0x0
    .long 0x0, 0x0, 0x0, 0x0, 0x0, 0x0, 0x0, 0x0
    .long 0x36e000, 0x1f100, 0xffffffe0, 0x10070e0, 0xd005000, 0x1c00, 0x90127e0, 0x15700
    .long 0xb0041c0, 0x41c0, 0xe0062a0, 0x41c0, 0x11fe7580, 0x62a0, 0x140062a0, 0xfffe7580
    .long 0x170041c0, 0x62a0, 0x1a0062a0, 0x41c0, 0x1d0041c0, 0x62a0, 0x20fef900, 0x62a0
    .long 0x23ffdf20, 0xfffe7580, 0x26008380, 0x62a0, 0x290020e0, 0xffff5ba0, 0x2bff19e0, 0x148c0
    .long 0x2c000000, 0x62a0, 0x0, 0x0, 0x0, 0x0, 0x0, 0xff000000
    .long 0x0, 0x0, 0x0, 0x0, 0x0, 0x0, 0x0, 0x0
    .long 0x0, 0x0, 0x0, 0x0, 0x0, 0x0, 0x0, 0x0
    .long 0x0, 0x0, 0x0, 0x0, 0x0, 0x0, 0x0, 0x0
    .long 0x38e000, 0x1f100, 0xffffffe0, 0x20091c0, 0xd005000, 0x1c00, 0x90127e0, 0x15700
    .long 0xb0041c0, 0x41c0, 0xe0062a0, 0x41c0, 0x11fe7580, 0x62a0, 0x140062a0, 0xfffe7580
    .long 0x170041c0, 0x62a0, 0x1a0062a0, 0x41c0, 0x1d0041c0, 0x62a0, 0x20fef900, 0x62a0
    .long 0x23ffdf20, 0xfffe7580, 0x26008380, 0x62a0, 0x290020e0, 0xffff5ba0, 0x2bff19e0, 0x148c0
    .long 0x2c000000, 0x62a0, 0x0, 0x0, 0x0, 0x0, 0x0, 0xff000000
    .long 0x0, 0x0, 0x0, 0x0, 0x0, 0x0, 0x0, 0x0
    .long 0x0, 0x0, 0x0, 0x0, 0x0, 0x0, 0x0, 0x0
    .long 0x0, 0x0, 0x0, 0x0, 0x0, 0x0, 0x0, 0x0
    .long 0x3ae000, 0x1f100, 0xffffffe0, 0x300b2a0, 0xd005000, 0x1c00, 0x90127e0, 0x15700
    .long 0xb0041c0, 0x41c0, 0xe0062a0, 0x41c0, 0x11fe7580, 0x62a0, 0x140062a0, 0xfffe7580
    .long 0x170041c0, 0x62a0, 0x1a0062a0, 0x41c0, 0x1d0041c0, 0x62a0, 0x20fef900, 0x62a0
    .long 0x23ffdf20, 0xfffe7580, 0x26008380, 0x62a0, 0x290020e0, 0xffff5ba0, 0x2bff19e0, 0x148c0
    .long 0x2c000000, 0x62a0, 0x0, 0x0, 0x0, 0x0, 0x0, 0xff000000
    .long 0x0, 0x0, 0x0, 0x0, 0x0, 0x0, 0x0, 0x0
    .long 0x0, 0x0, 0x0, 0x0, 0x0, 0x0, 0x0, 0x0
    .long 0x0, 0x0, 0x0, 0x0, 0x0, 0x0, 0x0, 0x0
    .long 0x3ce000, 0x1f100, 0xffffffe0, 0x400d380, 0xd005000, 0x1c00, 0x90127e0, 0x15700
    .long 0xb0041c0, 0x41c0, 0xe0062a0, 0x41c0, 0x11fe7580, 0x62a0, 0x140062a0, 0xfffe7580
    .long 0x170041c0, 0x62a0, 0x1a0062a0, 0x41c0, 0x1d0041c0, 0x62a0, 0x20fef900, 0x62a0
    .long 0x23ffdf20, 0xfffe7580, 0x26008380, 0x62a0, 0x290020e0, 0xffff5ba0, 0x2bff19e0, 0x148c0
    .long 0x2c000000, 0x62a0, 0x0, 0x0, 0x0, 0x0, 0x0, 0xff000000
    .long 0x0, 0x0, 0x0, 0x0, 0x0, 0x0, 0x0, 0x0
    .long 0x0, 0x0, 0x0, 0x0, 0x0, 0x0, 0x0, 0x0
    .long 0x0, 0x0, 0x0, 0x0, 0x0, 0x0, 0x0, 0x0
    .long 0x3ee000, 0x1f100, 0xffffffe0, 0x500f460, 0xd005000, 0x1000, 0x90127e0, 0x15700
    .long 0xb0041c0, 0x41c0, 0xe0062a0, 0x41c0, 0x11fe7580, 0x62a0, 0x140062a0, 0xfffe7580
    .long 0x170041c0, 0x62a0, 0x1a0062a0, 0x41c0, 0x1d0041c0, 0x62a0, 0x20fef900, 0x62a0
    .long 0x23ffdf20, 0xfffe7580, 0x26008380, 0x62a0, 0x290020e0, 0xffff5ba0, 0x2bff19e0, 0x148c0
    .long 0x2c000000, 0x62a0, 0x0, 0x0, 0x0, 0x0, 0x0, 0xff000000
    .long 0x0, 0x0, 0x0, 0x0, 0x0, 0x0, 0x0, 0x0
    .long 0x0, 0x0, 0x0, 0x0, 0x0, 0x0, 0x0, 0x0
    .long 0x0, 0x0, 0x0, 0x0, 0x0, 0x0, 0x0, 0x0
    .long 0x40e000, 0x1f100, 0xffffffe0, 0x6011540, 0xd005000, 0x1000, 0x90127e0, 0x15700
    .long 0xb0041c0, 0x41c0, 0xe0062a0, 0x41c0, 0x11fe7580, 0x62a0, 0x140062a0, 0xfffe7580
    .long 0x170041c0, 0x62a0, 0x1a0062a0, 0x41c0, 0x1d0041c0, 0x62a0, 0x20fef900, 0x62a0
    .long 0x23ffdf20, 0xfffe7580, 0x26008380, 0x62a0, 0x290020e0, 0xffff5ba0, 0x2bff19e0, 0x148c0
    .long 0x2c000000, 0x62a0, 0x0, 0x0, 0x0, 0x0, 0x0, 0xff000000
    .long 0x0, 0x0, 0x0, 0x0, 0x0, 0x0, 0x0, 0x0
    .long 0x0, 0x0, 0x0, 0x0, 0x0, 0x0, 0x0, 0x0
    .long 0x0, 0x0, 0x0, 0x0, 0x0, 0x0, 0x0, 0x0
    .long 0x42e000, 0x1f100, 0xffffffe0, 0x7013620, 0xd005000, 0x1000, 0x90127e0, 0x15700
    .long 0xb0041c0, 0x41c0, 0xe0062a0, 0x41c0, 0x11fe7580, 0x62a0, 0x140062a0, 0xfffe7580
    .long 0x170041c0, 0x62a0, 0x1a0062a0, 0x41c0, 0x1d0041c0, 0x62a0, 0x20fef900, 0x62a0
    .long 0x23ffdf20, 0xfffe7580, 0x26008380, 0x62a0, 0x290020e0, 0xffff5ba0, 0x2bff19e0, 0x148c0
    .long 0x2c000000, 0x62a0, 0x0, 0x0, 0x0, 0x0, 0x0, 0xff000000
    .long 0x0, 0x0, 0x0, 0x0, 0x0, 0x0, 0x0, 0x0
    .long 0x0, 0x0, 0x0, 0x0, 0x0, 0x0, 0x0, 0x0
    .long 0x0, 0x0, 0x0, 0x0, 0x0, 0x0, 0x0, 0x0
    .long 0x60f000, 0x1f100, 0xff800000, 0x1001fb60, 0x30070e0, 0x20000000, 0x19010700, 0x5000
    .long 0x1ffef900, 0x1ab60, 0x2500a460, 0x41c0, 0x28000000, 0xffff3ac0, 0x0, 0x0
    .long 0x0, 0x0, 0x0, 0xff000000, 0x0, 0x0, 0x0, 0x0
    .long 0x0, 0x0, 0x0, 0x0, 0x0, 0x0, 0x0, 0x0
    .long 0x0, 0x0, 0x0, 0x0, 0x0, 0x0, 0x0, 0x0
    .long 0x0, 0x0, 0x0, 0x0, 0x0, 0x0, 0x0, 0x0
    .long 0x0, 0x0, 0x0, 0x0, 0x0, 0x0, 0x0, 0x0
    .long 0x0, 0x0, 0x0, 0x0, 0x0, 0x0, 0x0, 0x0
    .long 0x686100, 0x75600e, 0x6a6100, 0x475600c, 0x6e6100, 0x875600c, 0x726100, 0xc75600c
    .long 0x686100, 0x1075600d, 0xd8f100, 0x14ee300e, 0xeaf100, 0x18ee300c, 0xd8f100, 0x1cee300d
    .long 0x426a6104, 0x275600d, 0x42daf140, 0x6ee300d, 0x426c6110, 0xa75600d, 0x42dcf3fc, 0xee300d
    .long 0x26e6101, 0x1675600d, 0x44def3fc, 0x10ee300d, 0x2706503, 0x1475600d, 0x4e0f503, 0x1cee300d
    .long 0x467263fc, 0x275600d, 0x6e2f503, 0x6ee300d, 0x487463fc, 0xa75600d, 0x8e6f503, 0xee300e
    .long 0x4ae8f3fc, 0x18ee300e, 0xaeaf503, 0x12ee300e, 0x4cecf3fc, 0x1aee300e, 0x0, 0x0
    .long 0x0, 0x0, 0x0, 0x0, 0x0, 0x0, 0x0, 0x0
    .long 0x0, 0x0, 0x0, 0x0, 0x0, 0x0, 0x0, 0x0
    .long 0x686100, 0x275600c, 0x6c6100, 0x675600c, 0x706100, 0xa75600c, 0x746100, 0xe75600c
    .long 0x6a6100, 0x1275600e, 0xe8f100, 0x16ee300c, 0xecf100, 0x1aee300c, 0xdaf100, 0x1eee300e
    .long 0x426c6108, 0x475600e, 0x42dcf300, 0x8ee300e, 0x426e6120, 0xc75600e, 0x42def180, 0xeee300e
    .long 0x2706102, 0x1875600e, 0x44e0f3fc, 0x12ee300e, 0x2726500, 0x1a75600e, 0x4e2f503, 0x1eee300e
    .long 0x467463fc, 0x475600e, 0x6e4f503, 0x8ee300e, 0x48e4f3fc, 0xcee300d, 0x8e6f503, 0xeee300d
    .long 0x4ae8f3fc, 0x16ee300d, 0xaeaf503, 0x10ee300d, 0x4cecf3fc, 0x14ee300d, 0x0, 0x0
    .long 0x0, 0x0, 0x0, 0x0, 0x0, 0x0, 0x0, 0x0
    .long 0x0, 0x0, 0x0, 0x0, 0x0, 0x0, 0x0, 0x0
    .long 0x6e6100, 0x1f100, 0xffff0000, 0x400d380, 0x6005000, 0x20001000, 0x90127e0, 0x15700
    .long 0x11ff19e0, 0xffff19e0, 0x15008380, 0x8380, 0x1900c540, 0xc540, 0x1d0020e0, 0xffffdf20
    .long 0x21fe9660, 0xfffed820, 0x24000000, 0x8380, 0x0, 0x0, 0x0, 0x0
    .long 0x0, 0xff000000, 0x0, 0x0, 0x0, 0x0, 0x0, 0x0
    .long 0x0, 0x0, 0x0, 0x0, 0x0, 0x0, 0x0, 0x0
    .long 0x0, 0x0, 0x0, 0x0, 0x0, 0x0, 0x0, 0x0
    .long 0x0, 0x0, 0x0, 0x0, 0x0, 0x0, 0x0, 0x0
    .long 0x0, 0x0, 0x0, 0x0, 0x0, 0x0, 0x0, 0x0
    .long 0xecf100, 0x13100, 0xfff00000, 0xd01fb60, 0xa0198c0, 0x0, 0xf00a460, 0x21c40
    .long 0x13fe9660, 0xfffe9660, 0x170062a0, 0xffff9d60, 0x1b0041c0, 0x10700, 0x1f00c540, 0xc540
    .long 0x23fe9660, 0xfffe9660, 0x26ff7c80, 0x62a0, 0x28018a80, 0x20e0, 0x2aff9d60, 0x8380
    .long 0x2c008380, 0xffff9d60, 0x2d000000, 0x41c0, 0x0, 0x0, 0x0, 0x0
    .long 0x0, 0xff000000, 0x0, 0x0, 0x0, 0x0, 0x0, 0x0
    .long 0x0, 0x0, 0x0, 0x0, 0x0, 0x0, 0x0, 0x0
    .long 0x0, 0x0, 0x0, 0x0, 0x0, 0x0, 0x0, 0x0
    .long 0x0, 0x0, 0x0, 0x0, 0x0, 0x0, 0x0, 0x0
    .long 0xe8f100, 0x1f100, 0xfff00000, 0xb01b9a0, 0xa0198c0, 0xc00, 0xf00a460, 0x21c40
    .long 0x13fe9660, 0xfffe9660, 0x170062a0, 0xffff9d60, 0x1b0041c0, 0x10700, 0x1f00c540, 0xc540
    .long 0x23fe9660, 0xfffe9660, 0x26ff7c80, 0x62a0, 0x28018a80, 0x20e0, 0x2aff9d60, 0x8380
    .long 0x2c008380, 0xffff9d60, 0x2d000000, 0x41c0, 0x0, 0x0, 0x0, 0x0
    .long 0x0, 0xff000000, 0x0, 0x0, 0x0, 0x0, 0x0, 0x0
    .long 0x0, 0x0, 0x0, 0x0, 0x0, 0x0, 0x0, 0x0
    .long 0x0, 0x0, 0x0, 0x0, 0x0, 0x0, 0x0, 0x0
    .long 0x0, 0x0, 0x0, 0x0, 0x0, 0x0, 0x0, 0x0
    .long 0xeaf100, 0x1f100, 0xfff00000, 0xc01da80, 0xa0198c0, 0xc00, 0xf00a460, 0x21c40
    .long 0x13fe9660, 0xfffe9660, 0x170062a0, 0xffff9d60, 0x1b0041c0, 0x10700, 0x1f00c540, 0xc540
    .long 0x23fe9660, 0xfffe9660, 0x26ff7c80, 0x62a0, 0x28018a80, 0x20e0, 0x2aff9d60, 0x8380
    .long 0x2c008380, 0xffff9d60, 0x2d000000, 0x41c0, 0x0, 0x0, 0x0, 0x0
    .long 0x0, 0xff000000, 0x0, 0x0, 0x0, 0x0, 0x0, 0x0
    .long 0x0, 0x0, 0x0, 0x0, 0x0, 0x0, 0x0, 0x0
    .long 0x0, 0x0, 0x0, 0x0, 0x0, 0x0, 0x0, 0x0
    .long 0x0, 0x0, 0x0, 0x0, 0x0, 0x0, 0x0, 0x0
    .long 0x686100, 0x1f100, 0xffff0000, 0x10070e0, 0x6005000, 0x20001c00, 0x90127e0, 0x15700
    .long 0x11ff19e0, 0xffff19e0, 0x15008380, 0x8380, 0x1900c540, 0xc540, 0x1d0020e0, 0xffffdf20
    .long 0x21fe9660, 0xfffed820, 0x24000000, 0x8380, 0x0, 0x0, 0x0, 0x0
    .long 0x0, 0xff000000, 0x0, 0x0, 0x0, 0x0, 0x0, 0x0
    .long 0x0, 0x0, 0x0, 0x0, 0x0, 0x0, 0x0, 0x0
    .long 0x0, 0x0, 0x0, 0x0, 0x0, 0x0, 0x0, 0x0
    .long 0x0, 0x0, 0x0, 0x0, 0x0, 0x0, 0x0, 0x0
    .long 0x0, 0x0, 0x0, 0x0, 0x0, 0x0, 0x0, 0x0
    .long 0x6a6100, 0x1f100, 0xffff0000, 0x20091c0, 0x6005000, 0x20001c00, 0x90127e0, 0x15700
    .long 0x11ff19e0, 0xffff19e0, 0x15008380, 0x8380, 0x1900c540, 0xc540, 0x1d0020e0, 0xffffdf20
    .long 0x21fe9660, 0xfffed820, 0x24000000, 0x8380, 0x0, 0x0, 0x0, 0x0
    .long 0x0, 0xff000000, 0x0, 0x0, 0x0, 0x0, 0x0, 0x0
    .long 0x0, 0x0, 0x0, 0x0, 0x0, 0x0, 0x0, 0x0
    .long 0x0, 0x0, 0x0, 0x0, 0x0, 0x0, 0x0, 0x0
    .long 0x0, 0x0, 0x0, 0x0, 0x0, 0x0, 0x0, 0x0
    .long 0x0, 0x0, 0x0, 0x0, 0x0, 0x0, 0x0, 0x0
    .long 0x706100, 0x1f100, 0xffff0000, 0x500f460, 0x6005000, 0x20001000, 0x90127e0, 0x15700
    .long 0x11ff19e0, 0xffff19e0, 0x15008380, 0x8380, 0x1900c540, 0xc540, 0x1d0020e0, 0xffffdf20
    .long 0x21fe9660, 0xfffed820, 0x24000000, 0x8380, 0x0, 0x0, 0x0, 0x0
    .long 0x0, 0xff000000, 0x0, 0x0, 0x0, 0x0, 0x0, 0x0
    .long 0x0, 0x0, 0x0, 0x0, 0x0, 0x0, 0x0, 0x0
    .long 0x0, 0x0, 0x0, 0x0, 0x0, 0x0, 0x0, 0x0
    .long 0x0, 0x0, 0x0, 0x0, 0x0, 0x0, 0x0, 0x0
    .long 0x0, 0x0, 0x0, 0x0, 0x0, 0x0, 0x0, 0x0
    .long 0x726100, 0x1f100, 0xffff0000, 0x6011540, 0x6005000, 0x20001000, 0x90127e0, 0x15700
    .long 0x11ff19e0, 0xffff19e0, 0x15008380, 0x8380, 0x1900c540, 0xc540, 0x1d0020e0, 0xffffdf20
    .long 0x21fe9660, 0xfffed820, 0x24000000, 0x8380, 0x0, 0x0, 0x0, 0x0
    .long 0x0, 0xff000000, 0x0, 0x0, 0x0, 0x0, 0x0, 0x0
    .long 0x0, 0x0, 0x0, 0x0, 0x0, 0x0, 0x0, 0x0
    .long 0x0, 0x0, 0x0, 0x0, 0x0, 0x0, 0x0, 0x0
    .long 0x0, 0x0, 0x0, 0x0, 0x0, 0x0, 0x0, 0x0
    .long 0x0, 0x0, 0x0, 0x0, 0x0, 0x0, 0x0, 0x0
    .long 0x6c6100, 0x1f100, 0xffff0000, 0x300b2a0, 0x6005000, 0x20001000, 0x90127e0, 0x15700
    .long 0x11ff19e0, 0xffff19e0, 0x15008380, 0x8380, 0x1900c540, 0xc540, 0x1d0020e0, 0xffffdf20
    .long 0x21fe9660, 0xfffed820, 0x24000000, 0x8380, 0x0, 0x0, 0x0, 0x0
    .long 0x0, 0xff000000, 0x0, 0x0, 0x0, 0x0, 0x0, 0x0
    .long 0x0, 0x0, 0x0, 0x0, 0x0, 0x0, 0x0, 0x0
    .long 0x0, 0x0, 0x0, 0x0, 0x0, 0x0, 0x0, 0x0
    .long 0x0, 0x0, 0x0, 0x0, 0x0, 0x0, 0x0, 0x0
    .long 0x0, 0x0, 0x0, 0x0, 0x0, 0x0, 0x0, 0x0
    .long 0x746100, 0xf100, 0xffff0000, 0x7013620, 0x6005000, 0x20001100, 0x90127e0, 0x15700
    .long 0x11ff19e0, 0xffff19e0, 0x15008380, 0x8380, 0x1900c540, 0xc540, 0x1d0020e0, 0xffffdf20
    .long 0x21fe9660, 0xfffed820, 0x24000000, 0x8380, 0x0, 0x0, 0x0, 0x0
    .long 0x0, 0xff000000, 0x0, 0x0, 0x0, 0x0, 0x0, 0x0
    .long 0x0, 0x0, 0x0, 0x0, 0x0, 0x0, 0x0, 0x0
    .long 0x0, 0x0, 0x0, 0x0, 0x0, 0x0, 0x0, 0x0
    .long 0x0, 0x0, 0x0, 0x0, 0x0, 0x0, 0x0, 0x0
    .long 0x0, 0x0, 0x0, 0x0, 0x0, 0x0, 0x0, 0x0
    .long 0x686100, 0x75600e, 0x6a6100, 0x475600c, 0x6e6100, 0x875600c, 0x726100, 0xc75600c
    .long 0x686100, 0x1075600d, 0xd8f100, 0x14ee300e, 0xeaf100, 0x18ee300c, 0xd8f100, 0x1cee300d
    .long 0x426a6104, 0x275600d, 0x42daf140, 0x6ee300d, 0x426c6110, 0xa75600d, 0x42dcf3fc, 0xee300d
    .long 0x26e6101, 0x1675600d, 0x44def3fc, 0x10ee300d, 0x2706503, 0x1475600d, 0x4e0f503, 0x1cee300d
    .long 0x467263fc, 0x275600d, 0x6e2f503, 0x6ee300d, 0x487463fc, 0xa75600d, 0x8e6f503, 0xee300e
    .long 0x4ae8f3fc, 0x16ee300e, 0xaeaf503, 0x10ee300e, 0x4cecf3fc, 0x1aee300e, 0x0, 0x0
    .long 0x0, 0x0, 0x0, 0x0, 0x0, 0x0, 0x0, 0x0
    .long 0x0, 0x0, 0x0, 0x0, 0x0, 0x0, 0x0, 0x0
    .long 0x686100, 0x275600c, 0x6c6100, 0x675600c, 0x706100, 0xa75600c, 0x746100, 0xe75600c
    .long 0x6a6100, 0x1275600e, 0xe8f100, 0x16ee300c, 0xecf100, 0x1aee300c, 0xdaf100, 0x1eee300e
    .long 0x426c6108, 0x475600e, 0x42dcf300, 0x8ee300e, 0x426e6120, 0xc75600e, 0x42def180, 0xeee300e
    .long 0x2706102, 0x1875600e, 0x44e0f3fc, 0x12ee300e, 0x2726500, 0x1a75600e, 0x4e2f503, 0x1eee300e
    .long 0x467463fc, 0x475600e, 0x6e4f503, 0x8ee300e, 0x48e4f3fc, 0xcee300d, 0x8e6f503, 0xeee300d
    .long 0x4ae8f3fc, 0x18ee300d, 0xaeaf503, 0x12ee300d, 0x4cecf3fc, 0x14ee300d, 0x0, 0x0
    .long 0x0, 0x0, 0x0, 0x0, 0x0, 0x0, 0x0, 0x0
    .long 0x0, 0x0, 0x0, 0x0, 0x0, 0x0, 0x0, 0x0
    .long 0x6e6100, 0x1f100, 0xffff0000, 0x400d380, 0x6005000, 0x20001000, 0x90127e0, 0x15700
    .long 0x11ff19e0, 0xffff19e0, 0x15008380, 0x8380, 0x1900c540, 0xc540, 0x1d0020e0, 0xffffdf20
    .long 0x21fe9660, 0xfffed820, 0x24000000, 0x8380, 0x0, 0x0, 0x0, 0x0
    .long 0x0, 0xff000000, 0x0, 0x0, 0x0, 0x0, 0x0, 0x0
    .long 0x0, 0x0, 0x0, 0x0, 0x0, 0x0, 0x0, 0x0
    .long 0x0, 0x0, 0x0, 0x0, 0x0, 0x0, 0x0, 0x0
    .long 0x0, 0x0, 0x0, 0x0, 0x0, 0x0, 0x0, 0x0
    .long 0x0, 0x0, 0x0, 0x0, 0x0, 0x0, 0x0, 0x0
    .long 0xecf100, 0x13100, 0xfff00000, 0xd01fb60, 0xa0198c0, 0x0, 0xf00a460, 0x21c40
    .long 0x13fe9660, 0xfffe9660, 0x170062a0, 0xffff9d60, 0x1b0041c0, 0x10700, 0x1f00c540, 0xc540
    .long 0x23fe9660, 0xfffe9660, 0x26ff7c80, 0x62a0, 0x280169a0, 0x20e0, 0x2aff9d60, 0xa460
    .long 0x2c00a460, 0xffff9d60, 0x2d000000, 0x20e0, 0x0, 0x0, 0x0, 0x0
    .long 0x0, 0xff000000, 0x0, 0x0, 0x0, 0x0, 0x0, 0x0
    .long 0x0, 0x0, 0x0, 0x0, 0x0, 0x0, 0x0, 0x0
    .long 0x0, 0x0, 0x0, 0x0, 0x0, 0x0, 0x0, 0x0
    .long 0x0, 0x0, 0x0, 0x0, 0x0, 0x0, 0x0, 0x0
    .long 0xe8f100, 0x1f100, 0xfff00000, 0xb01b9a0, 0xa0198c0, 0xc00, 0xf00a460, 0x21c40
    .long 0x13fe9660, 0xfffe9660, 0x170062a0, 0xffff9d60, 0x1b0041c0, 0x10700, 0x1f00c540, 0xc540
    .long 0x23fe9660, 0xfffe9660, 0x26ff7c80, 0x62a0, 0x280169a0, 0x20e0, 0x2aff9d60, 0xa460
    .long 0x2c00a460, 0xffff9d60, 0x2d000000, 0x20e0, 0x0, 0x0, 0x0, 0x0
    .long 0x0, 0xff000000, 0x0, 0x0, 0x0, 0x0, 0x0, 0x0
    .long 0x0, 0x0, 0x0, 0x0, 0x0, 0x0, 0x0, 0x0
    .long 0x0, 0x0, 0x0, 0x0, 0x0, 0x0, 0x0, 0x0
    .long 0x0, 0x0, 0x0, 0x0, 0x0, 0x0, 0x0, 0x0
    .long 0xeaf100, 0x1f100, 0xfff00000, 0xc01da80, 0xa0198c0, 0xc00, 0xf00a460, 0x21c40
    .long 0x13fe9660, 0xfffe9660, 0x170062a0, 0xffff9d60, 0x1b0041c0, 0x10700, 0x1f00c540, 0xc540
    .long 0x23fe9660, 0xfffe9660, 0x26ff7c80, 0x62a0, 0x280169a0, 0x20e0, 0x2aff9d60, 0xa460
    .long 0x2c00a460, 0xffff9d60, 0x2d000000, 0x20e0, 0x0, 0x0, 0x0, 0x0
    .long 0x0, 0xff000000, 0x0, 0x0, 0x0, 0x0, 0x0, 0x0
    .long 0x0, 0x0, 0x0, 0x0, 0x0, 0x0, 0x0, 0x0
    .long 0x0, 0x0, 0x0, 0x0, 0x0, 0x0, 0x0, 0x0
    .long 0x0, 0x0, 0x0, 0x0, 0x0, 0x0, 0x0, 0x0
    .long 0x686100, 0x1f100, 0xffff0000, 0x10070e0, 0x6005000, 0x20001c00, 0x90127e0, 0x15700
    .long 0x11ff19e0, 0xffff19e0, 0x15008380, 0x8380, 0x1900c540, 0xc540, 0x1d0020e0, 0xffffdf20
    .long 0x21fe9660, 0xfffed820, 0x24000000, 0x8380, 0x0, 0x0, 0x0, 0x0
    .long 0x0, 0xff000000, 0x0, 0x0, 0x0, 0x0, 0x0, 0x0
    .long 0x0, 0x0, 0x0, 0x0, 0x0, 0x0, 0x0, 0x0
    .long 0x0, 0x0, 0x0, 0x0, 0x0, 0x0, 0x0, 0x0
    .long 0x0, 0x0, 0x0, 0x0, 0x0, 0x0, 0x0, 0x0
    .long 0x0, 0x0, 0x0, 0x0, 0x0, 0x0, 0x0, 0x0
    .long 0x6a6100, 0x1f100, 0xffff0000, 0x20091c0, 0x6005000, 0x20001c00, 0x90127e0, 0x15700
    .long 0x11ff19e0, 0xffff19e0, 0x15008380, 0x8380, 0x1900c540, 0xc540, 0x1d0020e0, 0xffffdf20
    .long 0x21fe9660, 0xfffed820, 0x24000000, 0x8380, 0x0, 0x0, 0x0, 0x0
    .long 0x0, 0xff000000, 0x0, 0x0, 0x0, 0x0, 0x0, 0x0
    .long 0x0, 0x0, 0x0, 0x0, 0x0, 0x0, 0x0, 0x0
    .long 0x0, 0x0, 0x0, 0x0, 0x0, 0x0, 0x0, 0x0
    .long 0x0, 0x0, 0x0, 0x0, 0x0, 0x0, 0x0, 0x0
    .long 0x0, 0x0, 0x0, 0x0, 0x0, 0x0, 0x0, 0x0
    .long 0x706100, 0x1f100, 0xffff0000, 0x500f460, 0x6005000, 0x20001000, 0x90127e0, 0x15700
    .long 0x11ff19e0, 0xffff19e0, 0x15008380, 0x8380, 0x1900c540, 0xc540, 0x1d0020e0, 0xffffdf20
    .long 0x21fe9660, 0xfffed820, 0x24000000, 0x8380, 0x0, 0x0, 0x0, 0x0
    .long 0x0, 0xff000000, 0x0, 0x0, 0x0, 0x0, 0x0, 0x0
    .long 0x0, 0x0, 0x0, 0x0, 0x0, 0x0, 0x0, 0x0
    .long 0x0, 0x0, 0x0, 0x0, 0x0, 0x0, 0x0, 0x0
    .long 0x0, 0x0, 0x0, 0x0, 0x0, 0x0, 0x0, 0x0
    .long 0x0, 0x0, 0x0, 0x0, 0x0, 0x0, 0x0, 0x0
    .long 0x726100, 0x1f100, 0xffff0000, 0x6011540, 0x6005000, 0x20001000, 0x90127e0, 0x15700
    .long 0x11ff19e0, 0xffff19e0, 0x15008380, 0x8380, 0x1900c540, 0xc540, 0x1d0020e0, 0xffffdf20
    .long 0x21fe9660, 0xfffed820, 0x24000000, 0x8380, 0x0, 0x0, 0x0, 0x0
    .long 0x0, 0xff000000, 0x0, 0x0, 0x0, 0x0, 0x0, 0x0
    .long 0x0, 0x0, 0x0, 0x0, 0x0, 0x0, 0x0, 0x0
    .long 0x0, 0x0, 0x0, 0x0, 0x0, 0x0, 0x0, 0x0
    .long 0x0, 0x0, 0x0, 0x0, 0x0, 0x0, 0x0, 0x0
    .long 0x0, 0x0, 0x0, 0x0, 0x0, 0x0, 0x0, 0x0
    .long 0x6c6100, 0x1f100, 0xffff0000, 0x300b2a0, 0x6005000, 0x20001000, 0x90127e0, 0x15700
    .long 0x11ff19e0, 0xffff19e0, 0x15008380, 0x8380, 0x1900c540, 0xc540, 0x1d0020e0, 0xffffdf20
    .long 0x21fe9660, 0xfffed820, 0x24000000, 0x8380, 0x0, 0x0, 0x0, 0x0
    .long 0x0, 0xff000000, 0x0, 0x0, 0x0, 0x0, 0x0, 0x0
    .long 0x0, 0x0, 0x0, 0x0, 0x0, 0x0, 0x0, 0x0
    .long 0x0, 0x0, 0x0, 0x0, 0x0, 0x0, 0x0, 0x0
    .long 0x0, 0x0, 0x0, 0x0, 0x0, 0x0, 0x0, 0x0
    .long 0x0, 0x0, 0x0, 0x0, 0x0, 0x0, 0x0, 0x0
    .long 0x746100, 0xf100, 0xffff0000, 0x7013620, 0x6005000, 0x20001100, 0x90127e0, 0x15700
    .long 0x11ff19e0, 0xffff19e0, 0x15008380, 0x8380, 0x1900c540, 0xc540, 0x1d0020e0, 0xffffdf20
    .long 0x21fe9660, 0xfffed820, 0x24000000, 0x8380, 0x0, 0x0, 0x0, 0x0
    .long 0x0, 0xff000000, 0x0, 0x0, 0x0, 0x0, 0x0, 0x0
    .long 0x0, 0x0, 0x0, 0x0, 0x0, 0x0, 0x0, 0x0
    .long 0x0, 0x0, 0x0, 0x0, 0x0, 0x0, 0x0, 0x0
    .long 0x0, 0x0, 0x0, 0x0, 0x0, 0x0, 0x0, 0x0
    .long 0x0, 0x0, 0x0, 0x0, 0x0, 0x0, 0x0, 0x0
    .long 0xafa100, 0xcb000e, 0xb1a100, 0x4cb000c, 0xb7a100, 0x8cb000c, 0xbba100, 0xccb000c
    .long 0xb1a100, 0x10cb000e, 0xb3a100, 0x14cb000e, 0xb5a100, 0x18cb000e, 0x2b5a102, 0x4cb000d
    .long 0x2b7a110, 0x8cb000d, 0x2b9a140, 0xccb000d, 0x2bba17f, 0xcb000d, 0x4bda17f, 0x10cb000d
    .long 0x6bfa17f, 0x14cb000d, 0x8c1a17f, 0x18cb000d, 0xac3a17f, 0x4cb000d, 0xcc5a17f, 0x8cb000d
    .long 0xec7a17f, 0x2cb000d, 0x10c9a17f, 0xcb000d, 0x0, 0x0, 0x0, 0x0
    .long 0x0, 0x0, 0x0, 0x0, 0x0, 0x0, 0x0, 0x0
    .long 0x0, 0x0, 0x0, 0x0, 0x0, 0x0, 0x0, 0x0
    .long 0x0, 0x0, 0x0, 0x0, 0x0, 0x0, 0x0, 0x0
    .long 0xafa100, 0x2cb000c, 0xb3a100, 0x6cb000c, 0xb9a100, 0xacb000c, 0xafa100, 0xecb000d
    .long 0xb1a100, 0x12cb000d, 0xb3a100, 0x16cb000d, 0x2b5a101, 0x2cb000c, 0x2b7a104, 0x6cb000e
    .long 0x2b9a120, 0xacb000e, 0x2bba108, 0x2cb000e, 0x4bda17f, 0xecb000e, 0x6bfa17f, 0x12cb000e
    .long 0x8c1a17f, 0x16cb000e, 0xac3a17f, 0x6cb000e, 0xcc5a17f, 0xacb000e, 0xec7a17f, 0xccb000e
    .long 0x10c9a17f, 0xecb000e, 0x0, 0x0, 0x0, 0x0, 0x0, 0x0
    .long 0x0, 0x0, 0x0, 0x0, 0x0, 0x0, 0x0, 0x0
    .long 0x0, 0x0, 0x0, 0x0, 0x0, 0x0, 0x0, 0x0
    .long 0x0, 0x0, 0x0, 0x0, 0x0, 0x0, 0x0, 0x0
    .long 0x0, 0x0, 0x0, 0x0, 0x0, 0xff000000, 0x0, 0x0
    .long 0x0, 0x0, 0x0, 0x0, 0x0, 0x0, 0x0, 0x0
    .long 0x0, 0x0, 0x0, 0x0, 0x0, 0x0, 0x0, 0x0
    .long 0x0, 0x0, 0x0, 0x0, 0x0, 0x0, 0x0, 0x0
    .long 0x0, 0x0, 0x0, 0x0, 0x0, 0x0, 0x0, 0x0
    .long 0x0, 0x0, 0x0, 0x0, 0x0, 0x0, 0x0, 0x0
    .long 0x0, 0x0, 0x0, 0x0, 0x0, 0x0, 0x0, 0x0
    .long 0x0, 0x0, 0x0, 0x0, 0x0, 0x0, 0x0, 0x0
    .long 0x0, 0x0, 0x0, 0x0, 0x0, 0xff000000, 0x0, 0x0
    .long 0x0, 0x0, 0x0, 0x0, 0x0, 0x0, 0x0, 0x0
    .long 0x0, 0x0, 0x0, 0x0, 0x0, 0x0, 0x0, 0x0
    .long 0x0, 0x0, 0x0, 0x0, 0x0, 0x0, 0x0, 0x0
    .long 0x0, 0x0, 0x0, 0x0, 0x0, 0x0, 0x0, 0x0
    .long 0x0, 0x0, 0x0, 0x0, 0x0, 0x0, 0x0, 0x0
    .long 0x0, 0x0, 0x0, 0x0, 0x0, 0x0, 0x0, 0x0
    .long 0x0, 0x0, 0x0, 0x0, 0x0, 0x0, 0x0, 0x0
    .long 0xafa100, 0x1f100, 0xffc00000, 0x10070e0, 0xd005000, 0xc00, 0x8010700, 0x13620
    .long 0xa0041c0, 0x41c0, 0xc0041c0, 0x41c0, 0xffed820, 0xfffed820, 0x110041c0, 0x41c0
    .long 0x13ff7c80, 0x41c0, 0x1500c540, 0xffff3ac0, 0x170041c0, 0x10700, 0x190041c0, 0x41c0
    .long 0x1bfef900, 0x41c0, 0x1d0041c0, 0xfffeb740, 0x1f0020e0, 0x41c0, 0x210020e0, 0xffff9d60
    .long 0x22000000, 0xffffdf20, 0x0, 0x0, 0x0, 0x0, 0x0, 0xff000000
    .long 0x0, 0x0, 0x0, 0x0, 0x0, 0x0, 0x0, 0x0
    .long 0x0, 0x0, 0x0, 0x0, 0x0, 0x0, 0x0, 0x0
    .long 0x0, 0x0, 0x0, 0x0, 0x0, 0x0, 0x0, 0x0
    .long 0xb1a100, 0x1f100, 0xffc00000, 0x20091c0, 0xd005000, 0xc00, 0x8010700, 0x13620
    .long 0xa0041c0, 0x41c0, 0xc0041c0, 0x41c0, 0xffed820, 0xfffed820, 0x110041c0, 0x41c0
    .long 0x13ff7c80, 0x41c0, 0x1500c540, 0xffff3ac0, 0x170041c0, 0x10700, 0x190041c0, 0x41c0
    .long 0x1bfef900, 0x41c0, 0x1d0041c0, 0xfffeb740, 0x1f0020e0, 0x41c0, 0x210020e0, 0xffff9d60
    .long 0x22000000, 0xffffdf20, 0x0, 0x0, 0x0, 0x0, 0x0, 0xff000000
    .long 0x0, 0x0, 0x0, 0x0, 0x0, 0x0, 0x0, 0x0
    .long 0x0, 0x0, 0x0, 0x0, 0x0, 0x0, 0x0, 0x0
    .long 0x0, 0x0, 0x0, 0x0, 0x0, 0x0, 0x0, 0x0
    .long 0xb3a100, 0x1f100, 0xffc00000, 0x300b2a0, 0xd005000, 0xc00, 0x8010700, 0x13620
    .long 0xa0041c0, 0x41c0, 0xc0041c0, 0x41c0, 0xffed820, 0xfffed820, 0x110041c0, 0x41c0
    .long 0x13ff7c80, 0x41c0, 0x1500c540, 0xffff3ac0, 0x170041c0, 0x10700, 0x190041c0, 0x41c0
    .long 0x1bfef900, 0x41c0, 0x1d0041c0, 0xfffeb740, 0x1f0020e0, 0x41c0, 0x210020e0, 0xffff9d60
    .long 0x22000000, 0xffffdf20, 0x0, 0x0, 0x0, 0x0, 0x0, 0xff000000
    .long 0x0, 0x0, 0x0, 0x0, 0x0, 0x0, 0x0, 0x0
    .long 0x0, 0x0, 0x0, 0x0, 0x0, 0x0, 0x0, 0x0
    .long 0x0, 0x0, 0x0, 0x0, 0x0, 0x0, 0x0, 0x0
    .long 0xb5a100, 0x1f100, 0xffc00000, 0xd0070e0, 0xd005000, 0xc00, 0x8010700, 0x13620
    .long 0xa0041c0, 0x41c0, 0xc0041c0, 0x41c0, 0xffed820, 0xfffed820, 0x110041c0, 0x41c0
    .long 0x13ff7c80, 0x41c0, 0x1500c540, 0xffff3ac0, 0x170041c0, 0x10700, 0x190041c0, 0x41c0
    .long 0x1bfef900, 0x41c0, 0x1d0041c0, 0xfffeb740, 0x1f0020e0, 0x41c0, 0x210020e0, 0xffff9d60
    .long 0x22000000, 0xffffdf20, 0x0, 0x0, 0x0, 0x0, 0x0, 0xff000000
    .long 0x0, 0x0, 0x0, 0x0, 0x0, 0x0, 0x0, 0x0
    .long 0x0, 0x0, 0x0, 0x0, 0x0, 0x0, 0x0, 0x0
    .long 0x0, 0x0, 0x0, 0x0, 0x0, 0x0, 0x0, 0x0
    .long 0xb7a100, 0x1f100, 0xffc00000, 0x400d380, 0xd005000, 0x0, 0x8010700, 0x13620
    .long 0xa0041c0, 0x41c0, 0xc0041c0, 0x41c0, 0xffed820, 0xfffed820, 0x110041c0, 0x41c0
    .long 0x13ff7c80, 0x41c0, 0x1500c540, 0xffff3ac0, 0x170041c0, 0x10700, 0x190041c0, 0x41c0
    .long 0x1bfef900, 0x41c0, 0x1d0041c0, 0xfffeb740, 0x1f0020e0, 0x41c0, 0x210020e0, 0xffff9d60
    .long 0x22000000, 0xffffdf20, 0x0, 0x0, 0x0, 0x0, 0x0, 0xff000000
    .long 0x0, 0x0, 0x0, 0x0, 0x0, 0x0, 0x0, 0x0
    .long 0x0, 0x0, 0x0, 0x0, 0x0, 0x0, 0x0, 0x0
    .long 0x0, 0x0, 0x0, 0x0, 0x0, 0x0, 0x0, 0x0
    .long 0xb9a100, 0x1f100, 0xffc00000, 0x500f460, 0xd005000, 0x0, 0x8010700, 0x13620
    .long 0xa0041c0, 0x41c0, 0xc0041c0, 0x41c0, 0xffed820, 0xfffed820, 0x110041c0, 0x41c0
    .long 0x13ff7c80, 0x41c0, 0x1500c540, 0xffff3ac0, 0x170041c0, 0x10700, 0x190041c0, 0x41c0
    .long 0x1bfef900, 0x41c0, 0x1d0041c0, 0xfffeb740, 0x1f0020e0, 0x41c0, 0x210020e0, 0xffff9d60
    .long 0x22000000, 0xffffdf20, 0x0, 0x0, 0x0, 0x0, 0x0, 0xff000000
    .long 0x0, 0x0, 0x0, 0x0, 0x0, 0x0, 0x0, 0x0
    .long 0x0, 0x0, 0x0, 0x0, 0x0, 0x0, 0x0, 0x0
    .long 0x0, 0x0, 0x0, 0x0, 0x0, 0x0, 0x0, 0x0
    .long 0xbba100, 0x1f100, 0xffc00000, 0x6011540, 0xd005000, 0x0, 0x8010700, 0x13620
    .long 0xa0041c0, 0x41c0, 0xc0041c0, 0x41c0, 0xffed820, 0xfffed820, 0x110041c0, 0x41c0
    .long 0x13ff7c80, 0x41c0, 0x1500c540, 0xffff3ac0, 0x170041c0, 0x10700, 0x190041c0, 0x41c0
    .long 0x1bfef900, 0x41c0, 0x1d0041c0, 0xfffeb740, 0x1f0020e0, 0x41c0, 0x210020e0, 0xffff9d60
    .long 0x22000000, 0xffffdf20, 0x0, 0x0, 0x0, 0x0, 0x0, 0xff000000
    .long 0x0, 0x0, 0x0, 0x0, 0x0, 0x0, 0x0, 0x0
    .long 0x0, 0x0, 0x0, 0x0, 0x0, 0x0, 0x0, 0x0
    .long 0x0, 0x0, 0x0, 0x0, 0x0, 0x0, 0x0, 0x0
    .long 0x0, 0x0, 0x0, 0x0, 0x0, 0xff000000, 0x0, 0x0
    .long 0x0, 0x0, 0x0, 0x0, 0x0, 0x0, 0x0, 0x0
    .long 0x0, 0x0, 0x0, 0x0, 0x0, 0x0, 0x0, 0x0
    .long 0x0, 0x0, 0x0, 0x0, 0x0, 0x0, 0x0, 0x0
    .long 0x0, 0x0, 0x0, 0x0, 0x0, 0x0, 0x0, 0x0
    .long 0x0, 0x0, 0x0, 0x0, 0x0, 0x0, 0x0, 0x0
    .long 0x0, 0x0, 0x0, 0x0, 0x0, 0x0, 0x0, 0x0
    .long 0x0, 0x0, 0x0, 0x0, 0x0, 0x0, 0x0, 0x0
    .long 0x36e100, 0x51300e, 0x38e100, 0x451300c, 0x3ee100, 0x851300c, 0x42e100, 0xc51300c
    .long 0x38e100, 0x1051300e, 0x3ae100, 0x1451300e, 0x3ce100, 0x1851300e, 0x23ce102, 0x451300d
    .long 0x23ee110, 0x851300d, 0x240e140, 0xc51300d, 0x242e17f, 0x51300d, 0x444e17f, 0x1051300d
    .long 0x646e17f, 0x1451300d, 0x848e17f, 0x1851300d, 0xa4ae17f, 0x651300d, 0xc4ce17f, 0xa51300d
    .long 0xe4ee17f, 0xc51300d, 0x1050e17f, 0xe51300d, 0x0, 0x0, 0x0, 0x0
    .long 0x0, 0x0, 0x0, 0x0, 0x0, 0x0, 0x0, 0x0
    .long 0x0, 0x0, 0x0, 0x0, 0x0, 0x0, 0x0, 0x0
    .long 0x0, 0x0, 0x0, 0x0, 0x0, 0x0, 0x0, 0x0
    .long 0x36e100, 0x251300c, 0x3ae100, 0x651300c, 0x40e100, 0xa51300c, 0x36e100, 0xe51300d
    .long 0x38e100, 0x1251300d, 0x3ae100, 0x1651300d, 0x23ce101, 0x251300c, 0x23ee104, 0x651300e
    .long 0x240e120, 0xa51300e, 0x242e108, 0x251300e, 0x444e17f, 0xe51300e, 0x646e17f, 0x1251300e
    .long 0x848e17f, 0x1651300e, 0xa4ae17f, 0x451300e, 0xc4ce17f, 0x851300e, 0xe4ee17f, 0x251300e
    .long 0x1050e17f, 0x51300e, 0x0, 0x0, 0x0, 0x0, 0x0, 0x0
    .long 0x0, 0x0, 0x0, 0x0, 0x0, 0x0, 0x0, 0x0
    .long 0x0, 0x0, 0x0, 0x0, 0x0, 0x0, 0x0, 0x0
    .long 0x0, 0x0, 0x0, 0x0, 0x0, 0x0, 0x0, 0x0
    .long 0x0, 0x0, 0x0, 0x0, 0x0, 0xff000000, 0x0, 0x0
    .long 0x0, 0x0, 0x0, 0x0, 0x0, 0x0, 0x0, 0x0
    .long 0x0, 0x0, 0x0, 0x0, 0x0, 0x0, 0x0, 0x0
    .long 0x0, 0x0, 0x0, 0x0, 0x0, 0x0, 0x0, 0x0
    .long 0x0, 0x0, 0x0, 0x0, 0x0, 0x0, 0x0, 0x0
    .long 0x0, 0x0, 0x0, 0x0, 0x0, 0x0, 0x0, 0x0
    .long 0x0, 0x0, 0x0, 0x0, 0x0, 0x0, 0x0, 0x0
    .long 0x0, 0x0, 0x0, 0x0, 0x0, 0x0, 0x0, 0x0
    .long 0x0, 0x0, 0x0, 0x0, 0x0, 0xff000000, 0x0, 0x0
    .long 0x0, 0x0, 0x0, 0x0, 0x0, 0x0, 0x0, 0x0
    .long 0x0, 0x0, 0x0, 0x0, 0x0, 0x0, 0x0, 0x0
    .long 0x0, 0x0, 0x0, 0x0, 0x0, 0x0, 0x0, 0x0
    .long 0x0, 0x0, 0x0, 0x0, 0x0, 0x0, 0x0, 0x0
    .long 0x0, 0x0, 0x0, 0x0, 0x0, 0x0, 0x0, 0x0
    .long 0x0, 0x0, 0x0, 0x0, 0x0, 0x0, 0x0, 0x0
    .long 0x0, 0x0, 0x0, 0x0, 0x0, 0x0, 0x0, 0x0
    .long 0x36e100, 0x1f100, 0xffffffe0, 0x10070e0, 0xd005000, 0x1c00, 0x8010700, 0x13620
    .long 0xa0041c0, 0x41c0, 0xc0041c0, 0x41c0, 0xffed820, 0xfffed820, 0x110041c0, 0x41c0
    .long 0x13ff7c80, 0x41c0, 0x1500c540, 0xffff3ac0, 0x170041c0, 0x10700, 0x190041c0, 0x41c0
    .long 0x1bfed820, 0x41c0, 0x1d0041c0, 0xfffed820, 0x1fff9d60, 0x41c0, 0x21ffdf20, 0x20e0
    .long 0x22000000, 0x20e0, 0x0, 0x0, 0x0, 0x0, 0x0, 0xff000000
    .long 0x0, 0x0, 0x0, 0x0, 0x0, 0x0, 0x0, 0x0
    .long 0x0, 0x0, 0x0, 0x0, 0x0, 0x0, 0x0, 0x0
    .long 0x0, 0x0, 0x0, 0x0, 0x0, 0x0, 0x0, 0x0
    .long 0x38e100, 0x1f100, 0xffffffe0, 0x20091c0, 0xd005000, 0x1c00, 0x8010700, 0x13620
    .long 0xa0041c0, 0x41c0, 0xc0041c0, 0x41c0, 0xffed820, 0xfffed820, 0x110041c0, 0x41c0
    .long 0x13ff7c80, 0x41c0, 0x1500c540, 0xffff3ac0, 0x170041c0, 0x10700, 0x190041c0, 0x41c0
    .long 0x1bfed820, 0x41c0, 0x1d0041c0, 0xfffed820, 0x1fff9d60, 0x41c0, 0x21ffdf20, 0x20e0
    .long 0x22000000, 0x20e0, 0x0, 0x0, 0x0, 0x0, 0x0, 0xff000000
    .long 0x0, 0x0, 0x0, 0x0, 0x0, 0x0, 0x0, 0x0
    .long 0x0, 0x0, 0x0, 0x0, 0x0, 0x0, 0x0, 0x0
    .long 0x0, 0x0, 0x0, 0x0, 0x0, 0x0, 0x0, 0x0
    .long 0x3ae100, 0x1f100, 0xffffffe0, 0x300b2a0, 0xd005000, 0x1c00, 0x8010700, 0x13620
    .long 0xa0041c0, 0x41c0, 0xc0041c0, 0x41c0, 0xffed820, 0xfffed820, 0x110041c0, 0x41c0
    .long 0x13ff7c80, 0x41c0, 0x1500c540, 0xffff3ac0, 0x170041c0, 0x10700, 0x190041c0, 0x41c0
    .long 0x1bfed820, 0x41c0, 0x1d0041c0, 0xfffed820, 0x1fff9d60, 0x41c0, 0x21ffdf20, 0x20e0
    .long 0x22000000, 0x20e0, 0x0, 0x0, 0x0, 0x0, 0x0, 0xff000000
    .long 0x0, 0x0, 0x0, 0x0, 0x0, 0x0, 0x0, 0x0
    .long 0x0, 0x0, 0x0, 0x0, 0x0, 0x0, 0x0, 0x0
    .long 0x0, 0x0, 0x0, 0x0, 0x0, 0x0, 0x0, 0x0
    .long 0x3ce100, 0x1f100, 0xffffffe0, 0xd0070e0, 0xd005000, 0x1c00, 0x8010700, 0x13620
    .long 0xa0041c0, 0x41c0, 0xc0041c0, 0x41c0, 0xffed820, 0xfffed820, 0x110041c0, 0x41c0
    .long 0x13ff7c80, 0x41c0, 0x1500c540, 0xffff3ac0, 0x170041c0, 0x10700, 0x190041c0, 0x41c0
    .long 0x1bfed820, 0x41c0, 0x1d0041c0, 0xfffed820, 0x1fff9d60, 0x41c0, 0x21ffdf20, 0x20e0
    .long 0x22000000, 0x20e0, 0x0, 0x0, 0x0, 0x0, 0x0, 0xff000000
    .long 0x0, 0x0, 0x0, 0x0, 0x0, 0x0, 0x0, 0x0
    .long 0x0, 0x0, 0x0, 0x0, 0x0, 0x0, 0x0, 0x0
    .long 0x0, 0x0, 0x0, 0x0, 0x0, 0x0, 0x0, 0x0
    .long 0x3ee100, 0x1f100, 0xffffffe0, 0x400d380, 0xd005000, 0x1000, 0x8010700, 0x13620
    .long 0xa0041c0, 0x41c0, 0xc0041c0, 0x41c0, 0xffed820, 0xfffed820, 0x110041c0, 0x41c0
    .long 0x13ff7c80, 0x41c0, 0x1500c540, 0xffff3ac0, 0x170041c0, 0x10700, 0x190041c0, 0x41c0
    .long 0x1bfed820, 0x41c0, 0x1d0041c0, 0xfffed820, 0x1fff9d60, 0x41c0, 0x21ffdf20, 0x20e0
    .long 0x22000000, 0x20e0, 0x0, 0x0, 0x0, 0x0, 0x0, 0xff000000
    .long 0x0, 0x0, 0x0, 0x0, 0x0, 0x0, 0x0, 0x0
    .long 0x0, 0x0, 0x0, 0x0, 0x0, 0x0, 0x0, 0x0
    .long 0x0, 0x0, 0x0, 0x0, 0x0, 0x0, 0x0, 0x0
    .long 0x40e100, 0x1f100, 0xffffffe0, 0x500f460, 0xd005000, 0x1000, 0x8010700, 0x13620
    .long 0xa0041c0, 0x41c0, 0xc0041c0, 0x41c0, 0xffed820, 0xfffed820, 0x110041c0, 0x41c0
    .long 0x13ff7c80, 0x41c0, 0x1500c540, 0xffff3ac0, 0x170041c0, 0x10700, 0x190041c0, 0x41c0
    .long 0x1bfed820, 0x41c0, 0x1d0041c0, 0xfffed820, 0x1fff9d60, 0x41c0, 0x21ffdf20, 0x20e0
    .long 0x22000000, 0x20e0, 0x0, 0x0, 0x0, 0x0, 0x0, 0xff000000
    .long 0x0, 0x0, 0x0, 0x0, 0x0, 0x0, 0x0, 0x0
    .long 0x0, 0x0, 0x0, 0x0, 0x0, 0x0, 0x0, 0x0
    .long 0x0, 0x0, 0x0, 0x0, 0x0, 0x0, 0x0, 0x0
    .long 0x42e100, 0x1f100, 0xffffffe0, 0x6011540, 0xd005000, 0x1000, 0x8010700, 0x13620
    .long 0xa0041c0, 0x41c0, 0xc0041c0, 0x41c0, 0xffed820, 0xfffed820, 0x110041c0, 0x41c0
    .long 0x13ff7c80, 0x41c0, 0x1500c540, 0xffff3ac0, 0x170041c0, 0x10700, 0x190041c0, 0x41c0
    .long 0x1bfed820, 0x41c0, 0x1d0041c0, 0xfffed820, 0x1fff9d60, 0x41c0, 0x21ffdf20, 0x20e0
    .long 0x22000000, 0x20e0, 0x0, 0x0, 0x0, 0x0, 0x0, 0xff000000
    .long 0x0, 0x0, 0x0, 0x0, 0x0, 0x0, 0x0, 0x0
    .long 0x0, 0x0, 0x0, 0x0, 0x0, 0x0, 0x0, 0x0
    .long 0x0, 0x0, 0x0, 0x0, 0x0, 0x0, 0x0, 0x0
    .long 0x0, 0x0, 0x0, 0x0, 0x0, 0xff000000, 0x0, 0x0
    .long 0x0, 0x0, 0x0, 0x0, 0x0, 0x0, 0x0, 0x0
    .long 0x0, 0x0, 0x0, 0x0, 0x0, 0x0, 0x0, 0x0
    .long 0x0, 0x0, 0x0, 0x0, 0x0, 0x0, 0x0, 0x0
    .long 0x0, 0x0, 0x0, 0x0, 0x0, 0x0, 0x0, 0x0
    .long 0x0, 0x0, 0x0, 0x0, 0x0, 0x0, 0x0, 0x0
    .long 0x0, 0x0, 0x0, 0x0, 0x0, 0x0, 0x0, 0x0
    .long 0x0, 0x0, 0x0, 0x0, 0x0, 0x0, 0x0, 0x0
    .long 0x686000, 0x75600a, 0x6a6000, 0x4756008, 0x6e6000, 0x8756008, 0x726000, 0xc756008
    .long 0x686000, 0x10756009, 0xd8f000, 0x14ee300a, 0xeaf000, 0x18ee3008, 0xd8f000, 0x1aee300d
    .long 0x426a6004, 0x275600d, 0x42daf040, 0x6ee300d, 0x426c6200, 0x875600d, 0x42dcf2fc, 0xee300d
    .long 0x26e6001, 0x1675600d, 0x2def002, 0x18ee300d, 0x2706403, 0x1475600d, 0x4e0f403, 0x1aee300d
    .long 0x467262fc, 0x275600d, 0x6e2f403, 0x6ee300d, 0x487462fc, 0x875600d, 0x8e6f403, 0xeee300e
    .long 0x4ae8f2fc, 0x16ee300e, 0xaeaf403, 0x12ee300e, 0x4cecf2fc, 0x14ee300e, 0x0, 0x0
    .long 0x0, 0x0, 0x0, 0x0, 0x0, 0x0, 0x0, 0x0
    .long 0x0, 0x0, 0x0, 0x0, 0x0, 0x0, 0x0, 0x0
    .long 0x686000, 0x2756008, 0x6c6000, 0x6756008, 0x706000, 0xa756008, 0x746000, 0xe756008
    .long 0x6a6000, 0x1275600a, 0xe8f000, 0x16ee3008, 0xecf000, 0x1cee3008, 0xdaf000, 0x1eee300e
    .long 0x426c6008, 0x475600e, 0x42dcf010, 0xaee300e, 0x426e6020, 0xc75600e, 0x42def080, 0xeee300e
    .long 0x447062fc, 0x1075600e, 0x44e0f2fc, 0x12ee300e, 0x2726400, 0x1c75600e, 0x4e2f403, 0x1eee300e
    .long 0x467462fc, 0x475600e, 0x6e4f403, 0xaee300e, 0x48e4f2fc, 0xcee300d, 0x8e6f403, 0xee300d
    .long 0x4ae8f2fc, 0x10ee300d, 0xaeaf403, 0x18ee300d, 0x4cecf2fc, 0x1cee300d, 0x0, 0x0
    .long 0x0, 0x0, 0x0, 0x0, 0x0, 0x0, 0x0, 0x0
    .long 0x0, 0x0, 0x0, 0x0, 0x0, 0x0, 0x0, 0x0
    .long 0x6e6000, 0x1f100, 0xffff0000, 0x400d380, 0x6005000, 0x20001000, 0x90127e0, 0x15700
    .long 0x11ff19e0, 0xffff19e0, 0x15008380, 0x62a0, 0x190041c0, 0xe620, 0x1d00c540, 0xffffdf20
    .long 0x21fe7580, 0xfffed820, 0x24000000, 0x62a0, 0x0, 0x0, 0x0, 0x0
    .long 0x0, 0xff000000, 0x0, 0x0, 0x0, 0x0, 0x0, 0x0
    .long 0x0, 0x0, 0x0, 0x0, 0x0, 0x0, 0x0, 0x0
    .long 0x0, 0x0, 0x0, 0x0, 0x0, 0x0, 0x0, 0x0
    .long 0x0, 0x0, 0x0, 0x0, 0x0, 0x0, 0x0, 0x0
    .long 0x0, 0x0, 0x0, 0x0, 0x0, 0x0, 0x0, 0x0
    .long 0xecf000, 0x13100, 0xfff00000, 0xd021c40, 0xa0198c0, 0x0, 0xf00a460, 0x1fb60
    .long 0x13feb740, 0xfffeb740, 0x170041c0, 0xffff9d60, 0x1b0041c0, 0x18a80, 0x1f00c540, 0x20e0
    .long 0x23feb740, 0xfffeb740, 0x260041c0, 0x62a0, 0x28008380, 0xffff3ac0, 0x2affbe40, 0x10700
    .long 0x2c0020e0, 0x8380, 0x2d000000, 0x41c0, 0x0, 0x0, 0x0, 0x0
    .long 0x0, 0xff000000, 0x0, 0x0, 0x0, 0x0, 0x0, 0x0
    .long 0x0, 0x0, 0x0, 0x0, 0x0, 0x0, 0x0, 0x0
    .long 0x0, 0x0, 0x0, 0x0, 0x0, 0x0, 0x0, 0x0
    .long 0x0, 0x0, 0x0, 0x0, 0x0, 0x0, 0x0, 0x0
    .long 0xe8f000, 0x1f100, 0xfff00000, 0xb01b9a0, 0xa0198c0, 0xc00, 0xf00a460, 0x1fb60
    .long 0x13feb740, 0xfffeb740, 0x170041c0, 0xffff9d60, 0x1b0041c0, 0x18a80, 0x1f00c540, 0x20e0
    .long 0x23feb740, 0xfffeb740, 0x260041c0, 0x62a0, 0x28008380, 0xffff3ac0, 0x2affbe40, 0x10700
    .long 0x2c0020e0, 0x8380, 0x2d000000, 0x41c0, 0x0, 0x0, 0x0, 0x0
    .long 0x0, 0xff000000, 0x0, 0x0, 0x0, 0x0, 0x0, 0x0
    .long 0x0, 0x0, 0x0, 0x0, 0x0, 0x0, 0x0, 0x0
    .long 0x0, 0x0, 0x0, 0x0, 0x0, 0x0, 0x0, 0x0
    .long 0x0, 0x0, 0x0, 0x0, 0x0, 0x0, 0x0, 0x0
    .long 0xeaf000, 0x1f100, 0xfff00000, 0xc01da80, 0xa0198c0, 0xc00, 0xf00a460, 0x1fb60
    .long 0x13feb740, 0xfffeb740, 0x170041c0, 0xffff9d60, 0x1b0041c0, 0x18a80, 0x1f00c540, 0x20e0
    .long 0x23feb740, 0xfffeb740, 0x260041c0, 0x62a0, 0x28008380, 0xffff3ac0, 0x2affbe40, 0x10700
    .long 0x2c0020e0, 0x8380, 0x2d000000, 0x41c0, 0x0, 0x0, 0x0, 0x0
    .long 0x0, 0xff000000, 0x0, 0x0, 0x0, 0x0, 0x0, 0x0
    .long 0x0, 0x0, 0x0, 0x0, 0x0, 0x0, 0x0, 0x0
    .long 0x0, 0x0, 0x0, 0x0, 0x0, 0x0, 0x0, 0x0
    .long 0x0, 0x0, 0x0, 0x0, 0x0, 0x0, 0x0, 0x0
    .long 0x686000, 0x1f100, 0xffff0000, 0x10070e0, 0x6005000, 0x20001c00, 0x90127e0, 0x15700
    .long 0x11ff19e0, 0xffff19e0, 0x15008380, 0x62a0, 0x190041c0, 0xe620, 0x1d00c540, 0xffffdf20
    .long 0x21fe7580, 0xfffed820, 0x24000000, 0x62a0, 0x0, 0x0, 0x0, 0x0
    .long 0x0, 0xff000000, 0x0, 0x0, 0x0, 0x0, 0x0, 0x0
    .long 0x0, 0x0, 0x0, 0x0, 0x0, 0x0, 0x0, 0x0
    .long 0x0, 0x0, 0x0, 0x0, 0x0, 0x0, 0x0, 0x0
    .long 0x0, 0x0, 0x0, 0x0, 0x0, 0x0, 0x0, 0x0
    .long 0x0, 0x0, 0x0, 0x0, 0x0, 0x0, 0x0, 0x0
    .long 0x6a6000, 0x1f100, 0xffff0000, 0x20091c0, 0x6005000, 0x20001c00, 0x90127e0, 0x15700
    .long 0x11ff19e0, 0xffff19e0, 0x15008380, 0x62a0, 0x190041c0, 0xe620, 0x1d00c540, 0xffffdf20
    .long 0x21fe7580, 0xfffed820, 0x24000000, 0x62a0, 0x0, 0x0, 0x0, 0x0
    .long 0x0, 0xff000000, 0x0, 0x0, 0x0, 0x0, 0x0, 0x0
    .long 0x0, 0x0, 0x0, 0x0, 0x0, 0x0, 0x0, 0x0
    .long 0x0, 0x0, 0x0, 0x0, 0x0, 0x0, 0x0, 0x0
    .long 0x0, 0x0, 0x0, 0x0, 0x0, 0x0, 0x0, 0x0
    .long 0x0, 0x0, 0x0, 0x0, 0x0, 0x0, 0x0, 0x0
    .long 0x706000, 0x1f100, 0xffff0000, 0x500f460, 0x6005000, 0x20001000, 0x90127e0, 0x15700
    .long 0x11ff19e0, 0xffff19e0, 0x15008380, 0x62a0, 0x190041c0, 0xe620, 0x1d00c540, 0xffffdf20
    .long 0x21fe7580, 0xfffed820, 0x24000000, 0x62a0, 0x0, 0x0, 0x0, 0x0
    .long 0x0, 0xff000000, 0x0, 0x0, 0x0, 0x0, 0x0, 0x0
    .long 0x0, 0x0, 0x0, 0x0, 0x0, 0x0, 0x0, 0x0
    .long 0x0, 0x0, 0x0, 0x0, 0x0, 0x0, 0x0, 0x0
    .long 0x0, 0x0, 0x0, 0x0, 0x0, 0x0, 0x0, 0x0
    .long 0x0, 0x0, 0x0, 0x0, 0x0, 0x0, 0x0, 0x0
    .long 0x726000, 0x1f100, 0xffff0000, 0x6011540, 0x6005000, 0x20001000, 0x90127e0, 0x15700
    .long 0x11ff19e0, 0xffff19e0, 0x15008380, 0x62a0, 0x190041c0, 0xe620, 0x1d00c540, 0xffffdf20
    .long 0x21fe7580, 0xfffed820, 0x24000000, 0x62a0, 0x0, 0x0, 0x0, 0x0
    .long 0x0, 0xff000000, 0x0, 0x0, 0x0, 0x0, 0x0, 0x0
    .long 0x0, 0x0, 0x0, 0x0, 0x0, 0x0, 0x0, 0x0
    .long 0x0, 0x0, 0x0, 0x0, 0x0, 0x0, 0x0, 0x0
    .long 0x0, 0x0, 0x0, 0x0, 0x0, 0x0, 0x0, 0x0
    .long 0x0, 0x0, 0x0, 0x0, 0x0, 0x0, 0x0, 0x0
    .long 0x6c6000, 0x1f100, 0xffff0000, 0x300b2a0, 0x6005000, 0x20001000, 0x90127e0, 0x15700
    .long 0x11ff19e0, 0xffff19e0, 0x15008380, 0x62a0, 0x190041c0, 0xe620, 0x1d00c540, 0xffffdf20
    .long 0x21fe7580, 0xfffed820, 0x24000000, 0x62a0, 0x0, 0x0, 0x0, 0x0
    .long 0x0, 0xff000000, 0x0, 0x0, 0x0, 0x0, 0x0, 0x0
    .long 0x0, 0x0, 0x0, 0x0, 0x0, 0x0, 0x0, 0x0
    .long 0x0, 0x0, 0x0, 0x0, 0x0, 0x0, 0x0, 0x0
    .long 0x0, 0x0, 0x0, 0x0, 0x0, 0x0, 0x0, 0x0
    .long 0x0, 0x0, 0x0, 0x0, 0x0, 0x0, 0x0, 0x0
    .long 0x746000, 0xf100, 0xffff0000, 0x7013620, 0x6005000, 0x20001100, 0x90127e0, 0x15700
    .long 0x11ff19e0, 0xffff19e0, 0x15008380, 0x62a0, 0x190041c0, 0xe620, 0x1d00c540, 0xffffdf20
    .long 0x21fe7580, 0xfffed820, 0x24000000, 0x62a0, 0x0, 0x0, 0x0, 0x0
    .long 0x0, 0xff000000, 0x0, 0x0, 0x0, 0x0, 0x0, 0x0
    .long 0x0, 0x0, 0x0, 0x0, 0x0, 0x0, 0x0, 0x0
    .long 0x0, 0x0, 0x0, 0x0, 0x0, 0x0, 0x0, 0x0
    .long 0x0, 0x0, 0x0, 0x0, 0x0, 0x0, 0x0, 0x0
    .long 0x0, 0x0, 0x0, 0x0, 0x0, 0x0, 0x0, 0x0
    .long 0x686000, 0x75600a, 0x6a6000, 0x4756008, 0x6e6000, 0x8756008, 0x726000, 0xc756008
    .long 0x686000, 0x10756009, 0xd8f000, 0x14ee300a, 0xeaf000, 0x18ee3008, 0xd8f000, 0x1aee300d
    .long 0x426a6004, 0x275600d, 0x42daf040, 0x6ee300d, 0x426c6200, 0x875600d, 0x42dcf2fc, 0xee300d
    .long 0x26e6001, 0x1675600d, 0x2def002, 0x18ee300d, 0x2706403, 0x1475600d, 0x4e0f403, 0x1aee300d
    .long 0x467262fc, 0x275600d, 0x6e2f403, 0x6ee300d, 0x487462fc, 0x875600d, 0x8e6f403, 0xeee300e
    .long 0x4ae8f2fc, 0x16ee300e, 0xaeaf403, 0x12ee300e, 0x4cecf2fc, 0x14ee300e, 0x0, 0x0
    .long 0x0, 0x0, 0x0, 0x0, 0x0, 0x0, 0x0, 0x0
    .long 0x0, 0x0, 0x0, 0x0, 0x0, 0x0, 0x0, 0x0
    .long 0x686000, 0x2756008, 0x6c6000, 0x6756008, 0x706000, 0xa756008, 0x746000, 0xe756008
    .long 0x6a6000, 0x1275600a, 0xe8f000, 0x16ee3008, 0xecf000, 0x1cee3008, 0xdaf000, 0x1eee300e
    .long 0x426c6008, 0x475600e, 0x42dcf010, 0xaee300e, 0x426e6020, 0xc75600e, 0x42def080, 0xeee300e
    .long 0x447062fc, 0x1075600e, 0x44e0f2fc, 0x12ee300e, 0x2726400, 0x1c75600e, 0x4e2f403, 0x1eee300e
    .long 0x467462fc, 0x475600e, 0x6e4f403, 0xaee300e, 0x48e4f2fc, 0xcee300d, 0x8e6f403, 0xee300d
    .long 0x4ae8f2fc, 0x10ee300d, 0xaeaf403, 0x18ee300d, 0x4cecf2fc, 0x1cee300d, 0x0, 0x0
    .long 0x0, 0x0, 0x0, 0x0, 0x0, 0x0, 0x0, 0x0
    .long 0x0, 0x0, 0x0, 0x0, 0x0, 0x0, 0x0, 0x0
    .long 0x6e6000, 0x1f100, 0xffff0000, 0x400d380, 0x6005000, 0x20001000, 0x90127e0, 0x15700
    .long 0x11ff19e0, 0xffff19e0, 0x15008380, 0x62a0, 0x190041c0, 0xe620, 0x1d00c540, 0xffffdf20
    .long 0x21fe7580, 0xfffed820, 0x24000000, 0x62a0, 0x0, 0x0, 0x0, 0x0
    .long 0x0, 0xff000000, 0x0, 0x0, 0x0, 0x0, 0x0, 0x0
    .long 0x0, 0x0, 0x0, 0x0, 0x0, 0x0, 0x0, 0x0
    .long 0x0, 0x0, 0x0, 0x0, 0x0, 0x0, 0x0, 0x0
    .long 0x0, 0x0, 0x0, 0x0, 0x0, 0x0, 0x0, 0x0
    .long 0x0, 0x0, 0x0, 0x0, 0x0, 0x0, 0x0, 0x0
    .long 0xecf000, 0x13100, 0xfff00000, 0xd021c40, 0xa0198c0, 0x0, 0xf00a460, 0x1fb60
    .long 0x13feb740, 0xfffeb740, 0x170041c0, 0xffff9d60, 0x1b0041c0, 0x18a80, 0x1f00c540, 0x20e0
    .long 0x23feb740, 0xfffeb740, 0x260041c0, 0x62a0, 0x28008380, 0xffff3ac0, 0x2affbe40, 0x10700
    .long 0x2c0020e0, 0x8380, 0x2d000000, 0x41c0, 0x0, 0x0, 0x0, 0x0
    .long 0x0, 0xff000000, 0x0, 0x0, 0x0, 0x0, 0x0, 0x0
    .long 0x0, 0x0, 0x0, 0x0, 0x0, 0x0, 0x0, 0x0
    .long 0x0, 0x0, 0x0, 0x0, 0x0, 0x0, 0x0, 0x0
    .long 0x0, 0x0, 0x0, 0x0, 0x0, 0x0, 0x0, 0x0
    .long 0xe8f000, 0x1f100, 0xfff00000, 0xb01b9a0, 0xa0198c0, 0xc00, 0xf00a460, 0x1fb60
    .long 0x13feb740, 0xfffeb740, 0x170041c0, 0xffff9d60, 0x1b0041c0, 0x18a80, 0x1f00c540, 0x20e0
    .long 0x23feb740, 0xfffeb740, 0x260041c0, 0x62a0, 0x28008380, 0xffff3ac0, 0x2affbe40, 0x10700
    .long 0x2c0020e0, 0x8380, 0x2d000000, 0x41c0, 0x0, 0x0, 0x0, 0x0
    .long 0x0, 0xff000000, 0x0, 0x0, 0x0, 0x0, 0x0, 0x0
    .long 0x0, 0x0, 0x0, 0x0, 0x0, 0x0, 0x0, 0x0
    .long 0x0, 0x0, 0x0, 0x0, 0x0, 0x0, 0x0, 0x0
    .long 0x0, 0x0, 0x0, 0x0, 0x0, 0x0, 0x0, 0x0
    .long 0xeaf000, 0x1f100, 0xfff00000, 0xc01da80, 0xa0198c0, 0xc00, 0xf00a460, 0x1fb60
    .long 0x13feb740, 0xfffeb740, 0x170041c0, 0xffff9d60, 0x1b0041c0, 0x18a80, 0x1f00c540, 0x20e0
    .long 0x23feb740, 0xfffeb740, 0x260041c0, 0x62a0, 0x28008380, 0xffff3ac0, 0x2affbe40, 0x10700
    .long 0x2c0020e0, 0x8380, 0x2d000000, 0x41c0, 0x0, 0x0, 0x0, 0x0
    .long 0x0, 0xff000000, 0x0, 0x0, 0x0, 0x0, 0x0, 0x0
    .long 0x0, 0x0, 0x0, 0x0, 0x0, 0x0, 0x0, 0x0
    .long 0x0, 0x0, 0x0, 0x0, 0x0, 0x0, 0x0, 0x0
    .long 0x0, 0x0, 0x0, 0x0, 0x0, 0x0, 0x0, 0x0
    .long 0x686000, 0x1f100, 0xffff0000, 0x10070e0, 0x6005000, 0x20001c00, 0x90127e0, 0x15700
    .long 0x11ff19e0, 0xffff19e0, 0x15008380, 0x62a0, 0x190041c0, 0xe620, 0x1d00c540, 0xffffdf20
    .long 0x21fe7580, 0xfffed820, 0x24000000, 0x62a0, 0x0, 0x0, 0x0, 0x0
    .long 0x0, 0xff000000, 0x0, 0x0, 0x0, 0x0, 0x0, 0x0
    .long 0x0, 0x0, 0x0, 0x0, 0x0, 0x0, 0x0, 0x0
    .long 0x0, 0x0, 0x0, 0x0, 0x0, 0x0, 0x0, 0x0
    .long 0x0, 0x0, 0x0, 0x0, 0x0, 0x0, 0x0, 0x0
    .long 0x0, 0x0, 0x0, 0x0, 0x0, 0x0, 0x0, 0x0
    .long 0x6a6000, 0x1f100, 0xffff0000, 0x20091c0, 0x6005000, 0x20001c00, 0x90127e0, 0x15700
    .long 0x11ff19e0, 0xffff19e0, 0x15008380, 0x62a0, 0x190041c0, 0xe620, 0x1d00c540, 0xffffdf20
    .long 0x21fe7580, 0xfffed820, 0x24000000, 0x62a0, 0x0, 0x0, 0x0, 0x0
    .long 0x0, 0xff000000, 0x0, 0x0, 0x0, 0x0, 0x0, 0x0
    .long 0x0, 0x0, 0x0, 0x0, 0x0, 0x0, 0x0, 0x0
    .long 0x0, 0x0, 0x0, 0x0, 0x0, 0x0, 0x0, 0x0
    .long 0x0, 0x0, 0x0, 0x0, 0x0, 0x0, 0x0, 0x0
    .long 0x0, 0x0, 0x0, 0x0, 0x0, 0x0, 0x0, 0x0
    .long 0x706000, 0x1f100, 0xffff0000, 0x500f460, 0x6005000, 0x20001000, 0x90127e0, 0x15700
    .long 0x11ff19e0, 0xffff19e0, 0x15008380, 0x62a0, 0x190041c0, 0xe620, 0x1d00c540, 0xffffdf20
    .long 0x21fe7580, 0xfffed820, 0x24000000, 0x62a0, 0x0, 0x0, 0x0, 0x0
    .long 0x0, 0xff000000, 0x0, 0x0, 0x0, 0x0, 0x0, 0x0
    .long 0x0, 0x0, 0x0, 0x0, 0x0, 0x0, 0x0, 0x0
    .long 0x0, 0x0, 0x0, 0x0, 0x0, 0x0, 0x0, 0x0
    .long 0x0, 0x0, 0x0, 0x0, 0x0, 0x0, 0x0, 0x0
    .long 0x0, 0x0, 0x0, 0x0, 0x0, 0x0, 0x0, 0x0
    .long 0x726000, 0x1f100, 0xffff0000, 0x6011540, 0x6005000, 0x20001000, 0x90127e0, 0x15700
    .long 0x11ff19e0, 0xffff19e0, 0x15008380, 0x62a0, 0x190041c0, 0xe620, 0x1d00c540, 0xffffdf20
    .long 0x21fe7580, 0xfffed820, 0x24000000, 0x62a0, 0x0, 0x0, 0x0, 0x0
    .long 0x0, 0xff000000, 0x0, 0x0, 0x0, 0x0, 0x0, 0x0
    .long 0x0, 0x0, 0x0, 0x0, 0x0, 0x0, 0x0, 0x0
    .long 0x0, 0x0, 0x0, 0x0, 0x0, 0x0, 0x0, 0x0
    .long 0x0, 0x0, 0x0, 0x0, 0x0, 0x0, 0x0, 0x0
    .long 0x0, 0x0, 0x0, 0x0, 0x0, 0x0, 0x0, 0x0
    .long 0x6c6000, 0x1f100, 0xffff0000, 0x300b2a0, 0x6005000, 0x20001000, 0x90127e0, 0x15700
    .long 0x11ff19e0, 0xffff19e0, 0x15008380, 0x62a0, 0x190041c0, 0xe620, 0x1d00c540, 0xffffdf20
    .long 0x21fe7580, 0xfffed820, 0x24000000, 0x62a0, 0x0, 0x0, 0x0, 0x0
    .long 0x0, 0xff000000, 0x0, 0x0, 0x0, 0x0, 0x0, 0x0
    .long 0x0, 0x0, 0x0, 0x0, 0x0, 0x0, 0x0, 0x0
    .long 0x0, 0x0, 0x0, 0x0, 0x0, 0x0, 0x0, 0x0
    .long 0x0, 0x0, 0x0, 0x0, 0x0, 0x0, 0x0, 0x0
    .long 0x0, 0x0, 0x0, 0x0, 0x0, 0x0, 0x0, 0x0
    .long 0x746000, 0xf100, 0xffff0000, 0x7013620, 0x6005000, 0x20001100, 0x90127e0, 0x15700
    .long 0x11ff19e0, 0xffff19e0, 0x15008380, 0x62a0, 0x190041c0, 0xe620, 0x1d00c540, 0xffffdf20
    .long 0x21fe7580, 0xfffed820, 0x24000000, 0x62a0, 0x0, 0x0, 0x0, 0x0
    .long 0x0, 0xff000000, 0x0, 0x0, 0x0, 0x0, 0x0, 0x0
    .long 0x0, 0x0, 0x0, 0x0, 0x0, 0x0, 0x0, 0x0
    .long 0x0, 0x0, 0x0, 0x0, 0x0, 0x0, 0x0, 0x0
    .long 0x0, 0x0, 0x0, 0x0, 0x0, 0x0, 0x0, 0x0
    .long 0x0, 0x0, 0x0, 0x0, 0x0, 0x0, 0x0, 0x0
    .long 0xafa000, 0xcb000e, 0xbfa000, 0x4cb000c, 0xc3a000, 0x8cb000c, 0xc7a000, 0xccb000c
    .long 0xafa000, 0x10cb000d, 0xb1a000, 0x14cb000d, 0xb3a000, 0x18cb000d, 0xb5a000, 0x1ccb000e
    .long 0x260f101, 0x268600e, 0x2b7a004, 0x6cb000d, 0x2b9a010, 0xacb000e, 0x260f17f, 0x68600d
    .long 0x4bba07f, 0x10cb000d, 0x6bda07f, 0x14cb000e, 0x4262f180, 0x1a68600d, 0x8bfa07f, 0x1ccb000d
    .long 0x42c1a400, 0x8cb000e, 0xa64f17f, 0x1e68600d, 0xcc3a07f, 0xacb000d, 0xec5a07f, 0xecb000e
    .long 0x4466f580, 0x1268600d, 0x10c7a07f, 0x14cb000d, 0x46c9a480, 0x1acb000d, 0x0, 0x0
    .long 0x0, 0x0, 0x0, 0x0, 0x0, 0x0, 0x0, 0x0
    .long 0x0, 0x0, 0x0, 0x0, 0x0, 0x0, 0x0, 0x0
    .long 0xbda000, 0x2cb000c, 0xc1a000, 0x6cb000c, 0xc5a000, 0xacb000c, 0xc9a000, 0xecb000c
    .long 0xb1a000, 0x12cb000e, 0xb3a000, 0x16cb000e, 0x64f100, 0x1a68600c, 0xb5a000, 0x1ecb000d
    .long 0x2b7a002, 0x4cb000e, 0x266f108, 0x868600c, 0x2b9a020, 0xccb000d, 0x2bba040, 0xecb000e
    .long 0x462f17f, 0x1268600e, 0x6bda07f, 0x16cb000d, 0x8bfa07f, 0x18cb000e, 0x4264f580, 0x268600e
    .long 0xac1a07f, 0x4cb000d, 0xcc3a07f, 0x6cb000e, 0xe66f17f, 0xc68600e, 0x44c5a480, 0xcb000d
    .long 0x10c7a07f, 0x10cb000e, 0x46c9a480, 0x2cb000e, 0x0, 0x0, 0x0, 0x0
    .long 0x0, 0x0, 0x0, 0x0, 0x0, 0x0, 0x0, 0x0
    .long 0x0, 0x0, 0x0, 0x0, 0x0, 0x0, 0x0, 0x0
    .long 0x0, 0x0, 0x0, 0x0, 0x0, 0xff000000, 0x0, 0x0
    .long 0x0, 0x0, 0x0, 0x0, 0x0, 0x0, 0x0, 0x0
    .long 0x0, 0x0, 0x0, 0x0, 0x0, 0x0, 0x0, 0x0
    .long 0x0, 0x0, 0x0, 0x0, 0x0, 0x0, 0x0, 0x0
    .long 0x0, 0x0, 0x0, 0x0, 0x0, 0x0, 0x0, 0x0
    .long 0x0, 0x0, 0x0, 0x0, 0x0, 0x0, 0x0, 0x0
    .long 0x0, 0x0, 0x0, 0x0, 0x0, 0x0, 0x0, 0x0
    .long 0x0, 0x0, 0x0, 0x0, 0x0, 0x0, 0x0, 0x0
    .long 0x66f100, 0x16100, 0xff800000, 0x1300d380, 0x30070e0, 0x20000000, 0x19010700, 0x5000
    .long 0x1ffef900, 0x1ab60, 0x2500a460, 0x41c0, 0x28000000, 0xffff3ac0, 0x0, 0x0
    .long 0x0, 0x0, 0x0, 0xff000000, 0x0, 0x0, 0x0, 0x0
    .long 0x0, 0x0, 0x0, 0x0, 0x0, 0x0, 0x0, 0x0
    .long 0x0, 0x0, 0x0, 0x0, 0x0, 0x0, 0x0, 0x0
    .long 0x0, 0x0, 0x0, 0x0, 0x0, 0x0, 0x0, 0x0
    .long 0x0, 0x0, 0x0, 0x0, 0x0, 0x0, 0x0, 0x0
    .long 0x0, 0x0, 0x0, 0x0, 0x0, 0x0, 0x0, 0x0
    .long 0xbda000, 0x1f100, 0xffc00000, 0x10070e0, 0xd005000, 0xc00, 0x90127e0, 0x15700
    .long 0xb0041c0, 0x41c0, 0xe0062a0, 0x41c0, 0x11fe7580, 0x62a0, 0x140062a0, 0xfffe7580
    .long 0x170041c0, 0x62a0, 0x1a0062a0, 0x41c0, 0x1d0041c0, 0x62a0, 0x20fef900, 0x62a0
    .long 0x23ffdf20, 0xfffe7580, 0x26008380, 0x62a0, 0x290020e0, 0xffff5ba0, 0x2bff19e0, 0x148c0
    .long 0x2c000000, 0x62a0, 0x0, 0x0, 0x0, 0x0, 0x0, 0xff000000
    .long 0x0, 0x0, 0x0, 0x0, 0x0, 0x0, 0x0, 0x0
    .long 0x0, 0x0, 0x0, 0x0, 0x0, 0x0, 0x0, 0x0
    .long 0x0, 0x0, 0x0, 0x0, 0x0, 0x0, 0x0, 0x0
    .long 0xbfa000, 0x1f100, 0xffc00000, 0x20091c0, 0xd005000, 0xc00, 0x90127e0, 0x15700
    .long 0xb0041c0, 0x41c0, 0xe0062a0, 0x41c0, 0x11fe7580, 0x62a0, 0x140062a0, 0xfffe7580
    .long 0x170041c0, 0x62a0, 0x1a0062a0, 0x41c0, 0x1d0041c0, 0x62a0, 0x20fef900, 0x62a0
    .long 0x23ffdf20, 0xfffe7580, 0x26008380, 0x62a0, 0x290020e0, 0xffff5ba0, 0x2bff19e0, 0x148c0
    .long 0x2c000000, 0x62a0, 0x0, 0x0, 0x0, 0x0, 0x0, 0xff000000
    .long 0x0, 0x0, 0x0, 0x0, 0x0, 0x0, 0x0, 0x0
    .long 0x0, 0x0, 0x0, 0x0, 0x0, 0x0, 0x0, 0x0
    .long 0x0, 0x0, 0x0, 0x0, 0x0, 0x0, 0x0, 0x0
    .long 0xc1a000, 0x1f100, 0xffc00000, 0x300b2a0, 0xd005000, 0xc00, 0x90127e0, 0x15700
    .long 0xb0041c0, 0x41c0, 0xe0062a0, 0x41c0, 0x11fe7580, 0x62a0, 0x140062a0, 0xfffe7580
    .long 0x170041c0, 0x62a0, 0x1a0062a0, 0x41c0, 0x1d0041c0, 0x62a0, 0x20fef900, 0x62a0
    .long 0x23ffdf20, 0xfffe7580, 0x26008380, 0x62a0, 0x290020e0, 0xffff5ba0, 0x2bff19e0, 0x148c0
    .long 0x2c000000, 0x62a0, 0x0, 0x0, 0x0, 0x0, 0x0, 0xff000000
    .long 0x0, 0x0, 0x0, 0x0, 0x0, 0x0, 0x0, 0x0
    .long 0x0, 0x0, 0x0, 0x0, 0x0, 0x0, 0x0, 0x0
    .long 0x0, 0x0, 0x0, 0x0, 0x0, 0x0, 0x0, 0x0
    .long 0xc3a000, 0x1f100, 0xffc00000, 0x400d380, 0xd005000, 0xc00, 0x90127e0, 0x15700
    .long 0xb0041c0, 0x41c0, 0xe0062a0, 0x41c0, 0x11fe7580, 0x62a0, 0x140062a0, 0xfffe7580
    .long 0x170041c0, 0x62a0, 0x1a0062a0, 0x41c0, 0x1d0041c0, 0x62a0, 0x20fef900, 0x62a0
    .long 0x23ffdf20, 0xfffe7580, 0x26008380, 0x62a0, 0x290020e0, 0xffff5ba0, 0x2bff19e0, 0x148c0
    .long 0x2c000000, 0x62a0, 0x0, 0x0, 0x0, 0x0, 0x0, 0xff000000
    .long 0x0, 0x0, 0x0, 0x0, 0x0, 0x0, 0x0, 0x0
    .long 0x0, 0x0, 0x0, 0x0, 0x0, 0x0, 0x0, 0x0
    .long 0x0, 0x0, 0x0, 0x0, 0x0, 0x0, 0x0, 0x0
    .long 0xc5a000, 0x1f100, 0xffc00000, 0x500f460, 0xd005000, 0x0, 0x90127e0, 0x15700
    .long 0xb0041c0, 0x41c0, 0xe0062a0, 0x41c0, 0x11fe7580, 0x62a0, 0x140062a0, 0xfffe7580
    .long 0x170041c0, 0x62a0, 0x1a0062a0, 0x41c0, 0x1d0041c0, 0x62a0, 0x20fef900, 0x62a0
    .long 0x23ffdf20, 0xfffe7580, 0x26008380, 0x62a0, 0x290020e0, 0xffff5ba0, 0x2bff19e0, 0x148c0
    .long 0x2c000000, 0x62a0, 0x0, 0x0, 0x0, 0x0, 0x0, 0xff000000
    .long 0x0, 0x0, 0x0, 0x0, 0x0, 0x0, 0x0, 0x0
    .long 0x0, 0x0, 0x0, 0x0, 0x0, 0x0, 0x0, 0x0
    .long 0x0, 0x0, 0x0, 0x0, 0x0, 0x0, 0x0, 0x0
    .long 0xc7a000, 0x1f100, 0xffc00000, 0x6011540, 0xd005000, 0x0, 0x90127e0, 0x15700
    .long 0xb0041c0, 0x41c0, 0xe0062a0, 0x41c0, 0x11fe7580, 0x62a0, 0x140062a0, 0xfffe7580
    .long 0x170041c0, 0x62a0, 0x1a0062a0, 0x41c0, 0x1d0041c0, 0x62a0, 0x20fef900, 0x62a0
    .long 0x23ffdf20, 0xfffe7580, 0x26008380, 0x62a0, 0x290020e0, 0xffff5ba0, 0x2bff19e0, 0x148c0
    .long 0x2c000000, 0x62a0, 0x0, 0x0, 0x0, 0x0, 0x0, 0xff000000
    .long 0x0, 0x0, 0x0, 0x0, 0x0, 0x0, 0x0, 0x0
    .long 0x0, 0x0, 0x0, 0x0, 0x0, 0x0, 0x0, 0x0
    .long 0x0, 0x0, 0x0, 0x0, 0x0, 0x0, 0x0, 0x0
    .long 0xc9a000, 0x15100, 0xffc00000, 0x7013620, 0xd005000, 0x0, 0x90127e0, 0x15700
    .long 0xb0041c0, 0x41c0, 0xe0062a0, 0x41c0, 0x11fe7580, 0x62a0, 0x140062a0, 0xfffe7580
    .long 0x170041c0, 0x62a0, 0x1a0062a0, 0x41c0, 0x1d0041c0, 0x62a0, 0x20fef900, 0x62a0
    .long 0x23ffdf20, 0xfffe7580, 0x26008380, 0x62a0, 0x290020e0, 0xffff5ba0, 0x2bff19e0, 0x148c0
    .long 0x2c000000, 0x62a0, 0x0, 0x0, 0x0, 0x0, 0x0, 0xff000000
    .long 0x0, 0x0, 0x0, 0x0, 0x0, 0x0, 0x0, 0x0
    .long 0x0, 0x0, 0x0, 0x0, 0x0, 0x0, 0x0, 0x0
    .long 0x0, 0x0, 0x0, 0x0, 0x0, 0x0, 0x0, 0x0
    .long 0x64f100, 0x1f100, 0xff800000, 0x1001fb60, 0x30070e0, 0x20000000, 0x19010700, 0x5000
    .long 0x1ffef900, 0x1ab60, 0x2500a460, 0x41c0, 0x28000000, 0xffff3ac0, 0x0, 0x0
    .long 0x0, 0x0, 0x0, 0xff000000, 0x0, 0x0, 0x0, 0x0
    .long 0x0, 0x0, 0x0, 0x0, 0x0, 0x0, 0x0, 0x0
    .long 0x0, 0x0, 0x0, 0x0, 0x0, 0x0, 0x0, 0x0
    .long 0x0, 0x0, 0x0, 0x0, 0x0, 0x0, 0x0, 0x0
    .long 0x0, 0x0, 0x0, 0x0, 0x0, 0x0, 0x0, 0x0
    .long 0x0, 0x0, 0x0, 0x0, 0x0, 0x0, 0x0, 0x0
    .long 0x36e000, 0x51300e, 0x46e000, 0x451300c, 0x4ae000, 0x851300c, 0x4ee000, 0xc51300c
    .long 0x36e000, 0x1051300d, 0x38e000, 0x1451300d, 0x3ae000, 0x1851300d, 0x3ce000, 0x1c51300e
    .long 0x260f001, 0x268600e, 0x23ee004, 0x651300d, 0x240e010, 0xa51300e, 0x260f07f, 0x68600d
    .long 0x442e07f, 0x1051300d, 0x644e07f, 0x1451300e, 0x862f07f, 0x1868600d, 0x4246e080, 0x1a51300d
    .long 0x4248e400, 0x851300e, 0xa64f07f, 0x1e68600d, 0xc4ae07f, 0xa51300d, 0xe4ce07f, 0xe51300e
    .long 0x4466f480, 0x1268600d, 0x104ee07f, 0x1451300d, 0x4650e480, 0x1851300d, 0x0, 0x0
    .long 0x0, 0x0, 0x0, 0x0, 0x0, 0x0, 0x0, 0x0
    .long 0x0, 0x0, 0x0, 0x0, 0x0, 0x0, 0x0, 0x0
    .long 0x44e000, 0x251300c, 0x48e000, 0x651300c, 0x4ce000, 0xa51300c, 0x50e000, 0xe51300c
    .long 0x38e000, 0x1251300e, 0x3ae000, 0x1651300e, 0x64f000, 0x1a68600c, 0x3ce000, 0x1e51300d
    .long 0x23ee002, 0x451300e, 0x266f008, 0x868600c, 0x240e020, 0xc51300d, 0x242e040, 0xe51300e
    .long 0x462f07f, 0x1268600e, 0x644e07f, 0x1651300d, 0x846e07f, 0x1c51300e, 0x4264f480, 0x268600e
    .long 0xa48e07f, 0x451300d, 0xc4ae07f, 0x651300e, 0xe66f07f, 0xc68600e, 0x444ce480, 0x51300d
    .long 0x104ee07f, 0x1051300e, 0x4650e480, 0x251300e, 0x0, 0x0, 0x0, 0x0
    .long 0x0, 0x0, 0x0, 0x0, 0x0, 0x0, 0x0, 0x0
    .long 0x0, 0x0, 0x0, 0x0, 0x0, 0x0, 0x0, 0x0
    .long 0x0, 0x0, 0x0, 0x0, 0x0, 0xff000000, 0x0, 0x0
    .long 0x0, 0x0, 0x0, 0x0, 0x0, 0x0, 0x0, 0x0
    .long 0x0, 0x0, 0x0, 0x0, 0x0, 0x0, 0x0, 0x0
    .long 0x0, 0x0, 0x0, 0x0, 0x0, 0x0, 0x0, 0x0
    .long 0x0, 0x0, 0x0, 0x0, 0x0, 0x0, 0x0, 0x0
    .long 0x0, 0x0, 0x0, 0x0, 0x0, 0x0, 0x0, 0x0
    .long 0x0, 0x0, 0x0, 0x0, 0x0, 0x0, 0x0, 0x0
    .long 0x0, 0x0, 0x0, 0x0, 0x0, 0x0, 0x0, 0x0
    .long 0x66f000, 0x16100, 0xff800000, 0x1300d380, 0x30070e0, 0x20000000, 0x19010700, 0x5000
    .long 0x1ffef900, 0x18a80, 0x2500a460, 0x62a0, 0x28000000, 0xffff3ac0, 0x0, 0x0
    .long 0x0, 0x0, 0x0, 0xff000000, 0x0, 0x0, 0x0, 0x0
    .long 0x0, 0x0, 0x0, 0x0, 0x0, 0x0, 0x0, 0x0
    .long 0x0, 0x0, 0x0, 0x0, 0x0, 0x0, 0x0, 0x0
    .long 0x0, 0x0, 0x0, 0x0, 0x0, 0x0, 0x0, 0x0
    .long 0x0, 0x0, 0x0, 0x0, 0x0, 0x0, 0x0, 0x0
    .long 0x0, 0x0, 0x0, 0x0, 0x0, 0x0, 0x0, 0x0
    .long 0x44e000, 0x1f100, 0xffffffe0, 0x10070e0, 0xd005000, 0x1c00, 0x90127e0, 0x15700
    .long 0xb0041c0, 0x41c0, 0xe0062a0, 0x41c0, 0x11fe7580, 0x62a0, 0x140062a0, 0xfffe7580
    .long 0x170041c0, 0x62a0, 0x1a0062a0, 0x41c0, 0x1d008380, 0x62a0, 0x20feb740, 0x41c0
    .long 0x23ffdf20, 0xfffe9660, 0x26008380, 0x62a0, 0x290020e0, 0xffff5ba0, 0x2bff19e0, 0x148c0
    .long 0x2c000000, 0x41c0, 0x0, 0x0, 0x0, 0x0, 0x0, 0xff000000
    .long 0x0, 0x0, 0x0, 0x0, 0x0, 0x0, 0x0, 0x0
    .long 0x0, 0x0, 0x0, 0x0, 0x0, 0x0, 0x0, 0x0
    .long 0x0, 0x0, 0x0, 0x0, 0x0, 0x0, 0x0, 0x0
    .long 0x46e000, 0x1f100, 0xffffffe0, 0x20091c0, 0xd005000, 0x1c00, 0x90127e0, 0x15700
    .long 0xb0041c0, 0x41c0, 0xe0062a0, 0x41c0, 0x11fe7580, 0x62a0, 0x140062a0, 0xfffe7580
    .long 0x170041c0, 0x62a0, 0x1a0062a0, 0x41c0, 0x1d008380, 0x62a0, 0x20feb740, 0x41c0
    .long 0x23ffdf20, 0xfffe9660, 0x26008380, 0x62a0, 0x290020e0, 0xffff5ba0, 0x2bff19e0, 0x148c0
    .long 0x2c000000, 0x41c0, 0x0, 0x0, 0x0, 0x0, 0x0, 0xff000000
    .long 0x0, 0x0, 0x0, 0x0, 0x0, 0x0, 0x0, 0x0
    .long 0x0, 0x0, 0x0, 0x0, 0x0, 0x0, 0x0, 0x0
    .long 0x0, 0x0, 0x0, 0x0, 0x0, 0x0, 0x0, 0x0
    .long 0x48e000, 0x1f100, 0xffffffe0, 0x300b2a0, 0xd005000, 0x1c00, 0x90127e0, 0x15700
    .long 0xb0041c0, 0x41c0, 0xe0062a0, 0x41c0, 0x11fe7580, 0x62a0, 0x140062a0, 0xfffe7580
    .long 0x170041c0, 0x62a0, 0x1a0062a0, 0x41c0, 0x1d008380, 0x62a0, 0x20feb740, 0x41c0
    .long 0x23ffdf20, 0xfffe9660, 0x26008380, 0x62a0, 0x290020e0, 0xffff5ba0, 0x2bff19e0, 0x148c0
    .long 0x2c000000, 0x41c0, 0x0, 0x0, 0x0, 0x0, 0x0, 0xff000000
    .long 0x0, 0x0, 0x0, 0x0, 0x0, 0x0, 0x0, 0x0
    .long 0x0, 0x0, 0x0, 0x0, 0x0, 0x0, 0x0, 0x0
    .long 0x0, 0x0, 0x0, 0x0, 0x0, 0x0, 0x0, 0x0
    .long 0x4ae000, 0x1f100, 0xffffffe0, 0x400d380, 0xd005000, 0x1c00, 0x90127e0, 0x15700
    .long 0xb0041c0, 0x41c0, 0xe0062a0, 0x41c0, 0x11fe7580, 0x62a0, 0x140062a0, 0xfffe7580
    .long 0x170041c0, 0x62a0, 0x1a0062a0, 0x41c0, 0x1d008380, 0x62a0, 0x20feb740, 0x41c0
    .long 0x23ffdf20, 0xfffe9660, 0x26008380, 0x62a0, 0x290020e0, 0xffff5ba0, 0x2bff19e0, 0x148c0
    .long 0x2c000000, 0x41c0, 0x0, 0x0, 0x0, 0x0, 0x0, 0xff000000
    .long 0x0, 0x0, 0x0, 0x0, 0x0, 0x0, 0x0, 0x0
    .long 0x0, 0x0, 0x0, 0x0, 0x0, 0x0, 0x0, 0x0
    .long 0x0, 0x0, 0x0, 0x0, 0x0, 0x0, 0x0, 0x0
    .long 0x4ce000, 0x1f100, 0xffffffe0, 0x500f460, 0xd005000, 0x1000, 0x90127e0, 0x15700
    .long 0xb0041c0, 0x41c0, 0xe0062a0, 0x41c0, 0x11fe7580, 0x62a0, 0x140062a0, 0xfffe7580
    .long 0x170041c0, 0x62a0, 0x1a0062a0, 0x41c0, 0x1d008380, 0x62a0, 0x20feb740, 0x41c0
    .long 0x23ffdf20, 0xfffe9660, 0x26008380, 0x62a0, 0x290020e0, 0xffff5ba0, 0x2bff19e0, 0x148c0
    .long 0x2c000000, 0x41c0, 0x0, 0x0, 0x0, 0x0, 0x0, 0xff000000
    .long 0x0, 0x0, 0x0, 0x0, 0x0, 0x0, 0x0, 0x0
    .long 0x0, 0x0, 0x0, 0x0, 0x0, 0x0, 0x0, 0x0
    .long 0x0, 0x0, 0x0, 0x0, 0x0, 0x0, 0x0, 0x0
    .long 0x4ee000, 0x1f100, 0xffffffe0, 0x6011540, 0xd005000, 0x1000, 0x90127e0, 0x15700
    .long 0xb0041c0, 0x41c0, 0xe0062a0, 0x41c0, 0x11fe7580, 0x62a0, 0x140062a0, 0xfffe7580
    .long 0x170041c0, 0x62a0, 0x1a0062a0, 0x41c0, 0x1d008380, 0x62a0, 0x20feb740, 0x41c0
    .long 0x23ffdf20, 0xfffe9660, 0x26008380, 0x62a0, 0x290020e0, 0xffff5ba0, 0x2bff19e0, 0x148c0
    .long 0x2c000000, 0x41c0, 0x0, 0x0, 0x0, 0x0, 0x0, 0xff000000
    .long 0x0, 0x0, 0x0, 0x0, 0x0, 0x0, 0x0, 0x0
    .long 0x0, 0x0, 0x0, 0x0, 0x0, 0x0, 0x0, 0x0
    .long 0x0, 0x0, 0x0, 0x0, 0x0, 0x0, 0x0, 0x0
    .long 0x50e000, 0x4100, 0xffffffe0, 0x7013620, 0xd005000, 0x1100, 0x90127e0, 0x15700
    .long 0xb0041c0, 0x41c0, 0xe0062a0, 0x41c0, 0x11fe7580, 0x62a0, 0x140062a0, 0xfffe7580
    .long 0x170041c0, 0x62a0, 0x1a0062a0, 0x41c0, 0x1d008380, 0x62a0, 0x20feb740, 0x41c0
    .long 0x23ffdf20, 0xfffe9660, 0x26008380, 0x62a0, 0x290020e0, 0xffff5ba0, 0x2bff19e0, 0x148c0
    .long 0x2c000000, 0x41c0, 0x0, 0x0, 0x0, 0x0, 0x0, 0xff000000
    .long 0x0, 0x0, 0x0, 0x0, 0x0, 0x0, 0x0, 0x0
    .long 0x0, 0x0, 0x0, 0x0, 0x0, 0x0, 0x0, 0x0
    .long 0x0, 0x0, 0x0, 0x0, 0x0, 0x0, 0x0, 0x0
    .long 0x64f000, 0x1f100, 0xff800000, 0x1001fb60, 0x30070e0, 0x20000000, 0x19010700, 0x5000
    .long 0x1ffef900, 0x18a80, 0x2500a460, 0x62a0, 0x28000000, 0xffff3ac0, 0x0, 0x0
    .long 0x0, 0x0, 0x0, 0xff000000, 0x0, 0x0, 0x0, 0x0
    .long 0x0, 0x0, 0x0, 0x0, 0x0, 0x0, 0x0, 0x0
    .long 0x0, 0x0, 0x0, 0x0, 0x0, 0x0, 0x0, 0x0
    .long 0x0, 0x0, 0x0, 0x0, 0x0, 0x0, 0x0, 0x0
    .long 0x0, 0x0, 0x0, 0x0, 0x0, 0x0, 0x0, 0x0
    .long 0x0, 0x0, 0x0, 0x0, 0x0, 0x0, 0x0, 0x0
    .long 0xee3100, 0x104900e, 0x1003100, 0x504900c, 0x1043100, 0x904900c, 0xf03100, 0xd04900e
    .long 0x885100, 0x1092f00c, 0xf03100, 0x1504900d, 0x8c5100, 0x1892f00c, 0x905100, 0x1c92f00c
    .long 0x2f43101, 0x304900e, 0x2885104, 0x692f00d, 0x2f43108, 0x904900d, 0x48a510f, 0xc92f00d
    .long 0x42f63500, 0x1304900d, 0x68c510f, 0x1692f00d, 0x42f83110, 0x1b04900d, 0x428e5300, 0x492f00d
    .long 0x8fa310f, 0x304900d, 0xa90510f, 0x892f00d, 0x44fc37f0, 0x104900d, 0xc92510f, 0x1292f00d
    .long 0x470037f0, 0xd04900e, 0xf02310f, 0x1d04900e, 0x490437f0, 0x1704900e, 0x0, 0x0
    .long 0x0, 0x0, 0x0, 0x0, 0x0, 0x0, 0x0, 0x0
    .long 0x0, 0x0, 0x0, 0x0, 0x0, 0x0, 0x0, 0x0
    .long 0xfe3100, 0x304900c, 0x1023100, 0x704900c, 0xee3100, 0xb04900d, 0x885100, 0xe92f00e
    .long 0x8a5100, 0x1292f00c, 0xf23100, 0x1704900e, 0x8e5100, 0x1a92f00c, 0xf23100, 0x1f04900d
    .long 0x2925102, 0x492f00c, 0x28a510f, 0x92f00e, 0x4f6310f, 0xb04900e, 0x428c5180, 0x1092f00e
    .long 0x6f8310f, 0x1504900e, 0x428e5140, 0x1892f00e, 0x42fa3120, 0x1d04900e, 0x429057f0, 0xe92f00e
    .long 0x8fc310f, 0x1f04900e, 0xa92510f, 0xa92f00e, 0x44fe37f0, 0x704900e, 0xcfe310f, 0x1504900d
    .long 0x470037f0, 0x1104900d, 0xf02310f, 0x1b04900d, 0x490437f0, 0x1904900d, 0x0, 0x0
    .long 0x0, 0x0, 0x0, 0x0, 0x0, 0x0, 0x0, 0x0
    .long 0x0, 0x0, 0x0, 0x0, 0x0, 0x0, 0x0, 0x0
    .long 0x925100, 0x9100, 0xfffffc00, 0x110091c0, 0x5013620, 0x20001100, 0x13ff19e0, 0xb2a0
    .long 0x17010700, 0x62a0, 0x1b008380, 0xa460, 0x1fff5ba0, 0xfffed820, 0x23ffbe40, 0x41c0
    .long 0x26000000, 0xa460, 0x0, 0x0, 0x0, 0x0, 0x0, 0xff000000
    .long 0x0, 0x0, 0x0, 0x0, 0x0, 0x0, 0x0, 0x0
    .long 0x0, 0x0, 0x0, 0x0, 0x0, 0x0, 0x0, 0x0
    .long 0x0, 0x0, 0x0, 0x0, 0x0, 0x0, 0x0, 0x0
    .long 0x0, 0x0, 0x0, 0x0, 0x0, 0x0, 0x0, 0x0
    .long 0x0, 0x0, 0x0, 0x0, 0x0, 0x0, 0x0, 0x0
    .long 0x8a5100, 0x1f100, 0xfffffc00, 0x90177e0, 0x5013620, 0x20001000, 0x13ff19e0, 0xb2a0
    .long 0x17010700, 0x62a0, 0x1b008380, 0xa460, 0x1fff5ba0, 0xfffed820, 0x23ffbe40, 0x41c0
    .long 0x26000000, 0xa460, 0x0, 0x0, 0x0, 0x0, 0x0, 0xff000000
    .long 0x0, 0x0, 0x0, 0x0, 0x0, 0x0, 0x0, 0x0
    .long 0x0, 0x0, 0x0, 0x0, 0x0, 0x0, 0x0, 0x0
    .long 0x0, 0x0, 0x0, 0x0, 0x0, 0x0, 0x0, 0x0
    .long 0x0, 0x0, 0x0, 0x0, 0x0, 0x0, 0x0, 0x0
    .long 0x0, 0x0, 0x0, 0x0, 0x0, 0x0, 0x0, 0x0
    .long 0xfe3100, 0x1f100, 0xffffffc0, 0x10070e0, 0xb005000, 0x1c00, 0x600c540, 0xf460
    .long 0xb00a460, 0xa460, 0x10feb740, 0xa460, 0x15008380, 0xfffe9660, 0x1900a460, 0xa460
    .long 0x1d008380, 0x8380, 0x210020e0, 0xfffe7580, 0x25fe7580, 0xffffdf20, 0x280062a0, 0x148c0
    .long 0x2a010700, 0xffffbe40, 0x2cff9d60, 0xa460, 0x2d000000, 0xffffdf20, 0x0, 0x0
    .long 0x0, 0x0, 0x0, 0xff000000, 0x0, 0x0, 0x0, 0x0
    .long 0x0, 0x0, 0x0, 0x0, 0x0, 0x0, 0x0, 0x0
    .long 0x0, 0x0, 0x0, 0x0, 0x0, 0x0, 0x0, 0x0
    .long 0x0, 0x0, 0x0, 0x0, 0x0, 0x0, 0x0, 0x0
    .long 0x1003100, 0x1f100, 0xffffffc0, 0x20091c0, 0xb005000, 0x1c00, 0x600c540, 0xf460
    .long 0xb00a460, 0xa460, 0x10feb740, 0xa460, 0x15008380, 0xfffe9660, 0x1900a460, 0xa460
    .long 0x1d008380, 0x8380, 0x210020e0, 0xfffe7580, 0x25fe7580, 0xffffdf20, 0x280062a0, 0x148c0
    .long 0x2a010700, 0xffffbe40, 0x2cff9d60, 0xa460, 0x2d000000, 0xffffdf20, 0x0, 0x0
    .long 0x0, 0x0, 0x0, 0xff000000, 0x0, 0x0, 0x0, 0x0
    .long 0x0, 0x0, 0x0, 0x0, 0x0, 0x0, 0x0, 0x0
    .long 0x0, 0x0, 0x0, 0x0, 0x0, 0x0, 0x0, 0x0
    .long 0x0, 0x0, 0x0, 0x0, 0x0, 0x0, 0x0, 0x0
    .long 0x1023100, 0x1f100, 0xffffffc0, 0x300b2a0, 0xb005000, 0x1c00, 0x600c540, 0xf460
    .long 0xb00a460, 0xa460, 0x10feb740, 0xa460, 0x15008380, 0xfffe9660, 0x1900a460, 0xa460
    .long 0x1d008380, 0x8380, 0x210020e0, 0xfffe7580, 0x25fe7580, 0xffffdf20, 0x280062a0, 0x148c0
    .long 0x2a010700, 0xffffbe40, 0x2cff9d60, 0xa460, 0x2d000000, 0xffffdf20, 0x0, 0x0
    .long 0x0, 0x0, 0x0, 0xff000000, 0x0, 0x0, 0x0, 0x0
    .long 0x0, 0x0, 0x0, 0x0, 0x0, 0x0, 0x0, 0x0
    .long 0x0, 0x0, 0x0, 0x0, 0x0, 0x0, 0x0, 0x0
    .long 0x0, 0x0, 0x0, 0x0, 0x0, 0x0, 0x0, 0x0
    .long 0x1043100, 0x5100, 0xffffffc0, 0x400d380, 0xb005000, 0x1d00, 0x600c540, 0xf460
    .long 0xb00a460, 0xa460, 0x10feb740, 0xa460, 0x15008380, 0xfffe9660, 0x1900a460, 0xa460
    .long 0x1d008380, 0x8380, 0x210020e0, 0xfffe7580, 0x25fe7580, 0xffffdf20, 0x280062a0, 0x148c0
    .long 0x2a010700, 0xffffbe40, 0x2cff9d60, 0xa460, 0x2d000000, 0xffffdf20, 0x0, 0x0
    .long 0x0, 0x0, 0x0, 0xff000000, 0x0, 0x0, 0x0, 0x0
    .long 0x0, 0x0, 0x0, 0x0, 0x0, 0x0, 0x0, 0x0
    .long 0x0, 0x0, 0x0, 0x0, 0x0, 0x0, 0x0, 0x0
    .long 0x0, 0x0, 0x0, 0x0, 0x0, 0x0, 0x0, 0x0
    .long 0x8e5100, 0x1f100, 0xfffffc00, 0xd01fb60, 0x5013620, 0x20001000, 0x13ff19e0, 0xb2a0
    .long 0x17010700, 0x62a0, 0x1b008380, 0xa460, 0x1fff5ba0, 0xfffed820, 0x23ffbe40, 0x41c0
    .long 0x26000000, 0xa460, 0x0, 0x0, 0x0, 0x0, 0x0, 0xff000000
    .long 0x0, 0x0, 0x0, 0x0, 0x0, 0x0, 0x0, 0x0
    .long 0x0, 0x0, 0x0, 0x0, 0x0, 0x0, 0x0, 0x0
    .long 0x0, 0x0, 0x0, 0x0, 0x0, 0x0, 0x0, 0x0
    .long 0x0, 0x0, 0x0, 0x0, 0x0, 0x0, 0x0, 0x0
    .long 0x0, 0x0, 0x0, 0x0, 0x0, 0x0, 0x0, 0x0
    .long 0x905100, 0x1f100, 0xfffffc00, 0xe021c40, 0x5013620, 0x20001000, 0x13ff19e0, 0xb2a0
    .long 0x17010700, 0x62a0, 0x1b008380, 0xa460, 0x1fff5ba0, 0xfffed820, 0x23ffbe40, 0x41c0
    .long 0x26000000, 0xa460, 0x0, 0x0, 0x0, 0x0, 0x0, 0xff000000
    .long 0x0, 0x0, 0x0, 0x0, 0x0, 0x0, 0x0, 0x0
    .long 0x0, 0x0, 0x0, 0x0, 0x0, 0x0, 0x0, 0x0
    .long 0x0, 0x0, 0x0, 0x0, 0x0, 0x0, 0x0, 0x0
    .long 0x0, 0x0, 0x0, 0x0, 0x0, 0x0, 0x0, 0x0
    .long 0x0, 0x0, 0x0, 0x0, 0x0, 0x0, 0x0, 0x0
    .long 0x8c5100, 0x1f100, 0xfffffc00, 0xc01da80, 0x5013620, 0x20001000, 0x13ff19e0, 0xb2a0
    .long 0x17010700, 0x62a0, 0x1b008380, 0xa460, 0x1fff5ba0, 0xfffed820, 0x23ffbe40, 0x41c0
    .long 0x26000000, 0xa460, 0x0, 0x0, 0x0, 0x0, 0x0, 0xff000000
    .long 0x0, 0x0, 0x0, 0x0, 0x0, 0x0, 0x0, 0x0
    .long 0x0, 0x0, 0x0, 0x0, 0x0, 0x0, 0x0, 0x0
    .long 0x0, 0x0, 0x0, 0x0, 0x0, 0x0, 0x0, 0x0
    .long 0x0, 0x0, 0x0, 0x0, 0x0, 0x0, 0x0, 0x0
    .long 0x0, 0x0, 0x0, 0x0, 0x0, 0x0, 0x0, 0x0
    .long 0x885100, 0x1f100, 0xfffffc00, 0x8015700, 0x5013620, 0x20001000, 0x13ff19e0, 0xb2a0
    .long 0x17010700, 0x62a0, 0x1b008380, 0xa460, 0x1fff5ba0, 0xfffed820, 0x23ffbe40, 0x41c0
    .long 0x26000000, 0xa460, 0x0, 0x0, 0x0, 0x0, 0x0, 0xff000000
    .long 0x0, 0x0, 0x0, 0x0, 0x0, 0x0, 0x0, 0x0
    .long 0x0, 0x0, 0x0, 0x0, 0x0, 0x0, 0x0, 0x0
    .long 0x0, 0x0, 0x0, 0x0, 0x0, 0x0, 0x0, 0x0
    .long 0x0, 0x0, 0x0, 0x0, 0x0, 0x0, 0x0, 0x0
    .long 0x0, 0x0, 0x0, 0x0, 0x0, 0x0, 0x0, 0x0
    .long 0xee3100, 0x104900e, 0x1003100, 0x504900c, 0x1043100, 0x904900c, 0xf03100, 0xd04900e
    .long 0x885100, 0x1092f00c, 0xf03100, 0x1504900d, 0x8c5100, 0x1892f00c, 0x905100, 0x1c92f00c
    .long 0x2f43101, 0x304900e, 0x2885104, 0x692f00d, 0x2f43108, 0x904900d, 0x48a510f, 0xc92f00d
    .long 0x42f63500, 0x1304900d, 0x68c510f, 0x1492f00d, 0x42f83110, 0x1b04900d, 0x88e510f, 0x292f00d
    .long 0x42fa3300, 0x504900d, 0xa90510f, 0x892f00d, 0x44fc37f0, 0x104900d, 0xc92510f, 0x1892f00d
    .long 0x470037f0, 0xd04900e, 0xf02310f, 0x1d04900e, 0x490437f0, 0x1504900e, 0x0, 0x0
    .long 0x0, 0x0, 0x0, 0x0, 0x0, 0x0, 0x0, 0x0
    .long 0x0, 0x0, 0x0, 0x0, 0x0, 0x0, 0x0, 0x0
    .long 0xfe3100, 0x304900c, 0x1023100, 0x704900c, 0xee3100, 0xb04900d, 0x885100, 0xe92f00e
    .long 0x8a5100, 0x1292f00c, 0xf23100, 0x1704900e, 0x8e5100, 0x1a92f00c, 0xf23100, 0x1f04900d
    .long 0x2925102, 0x492f00c, 0x28a510f, 0x92f00e, 0x4f6310f, 0xb04900e, 0x428c5180, 0x1092f00e
    .long 0x42f83140, 0x1904900e, 0x68e510f, 0x1692f00e, 0x42fa3120, 0x1d04900e, 0x890510f, 0x1e92f00e
    .long 0x42fc37f0, 0xf04900e, 0xa92510f, 0xa92f00e, 0x44fe37f0, 0x704900e, 0xcfe310f, 0x1304900d
    .long 0x470037f0, 0x1104900d, 0xf02310f, 0x1b04900d, 0x490437f0, 0x1704900d, 0x0, 0x0
    .long 0x0, 0x0, 0x0, 0x0, 0x0, 0x0, 0x0, 0x0
    .long 0x0, 0x0, 0x0, 0x0, 0x0, 0x0, 0x0, 0x0
    .long 0x925100, 0x9100, 0xfffffc00, 0x110091c0, 0x5013620, 0x20001100, 0x13ff19e0, 0xb2a0
    .long 0x17010700, 0x62a0, 0x1b0062a0, 0x8380, 0x1f008380, 0xfffed820, 0x23feb740, 0x62a0
    .long 0x26000000, 0x10700, 0x0, 0x0, 0x0, 0x0, 0x0, 0xff000000
    .long 0x0, 0x0, 0x0, 0x0, 0x0, 0x0, 0x0, 0x0
    .long 0x0, 0x0, 0x0, 0x0, 0x0, 0x0, 0x0, 0x0
    .long 0x0, 0x0, 0x0, 0x0, 0x0, 0x0, 0x0, 0x0
    .long 0x0, 0x0, 0x0, 0x0, 0x0, 0x0, 0x0, 0x0
    .long 0x0, 0x0, 0x0, 0x0, 0x0, 0x0, 0x0, 0x0
    .long 0x8a5100, 0x1f100, 0xfffffc00, 0x90177e0, 0x5013620, 0x20001000, 0x13ff19e0, 0xb2a0
    .long 0x17010700, 0x62a0, 0x1b0062a0, 0x8380, 0x1f008380, 0xfffed820, 0x23feb740, 0x62a0
    .long 0x26000000, 0x10700, 0x0, 0x0, 0x0, 0x0, 0x0, 0xff000000
    .long 0x0, 0x0, 0x0, 0x0, 0x0, 0x0, 0x0, 0x0
    .long 0x0, 0x0, 0x0, 0x0, 0x0, 0x0, 0x0, 0x0
    .long 0x0, 0x0, 0x0, 0x0, 0x0, 0x0, 0x0, 0x0
    .long 0x0, 0x0, 0x0, 0x0, 0x0, 0x0, 0x0, 0x0
    .long 0x0, 0x0, 0x0, 0x0, 0x0, 0x0, 0x0, 0x0
    .long 0xfe3100, 0x1f100, 0xffffffc0, 0x10070e0, 0xb005000, 0x1c00, 0x600c540, 0xf460
    .long 0xb00a460, 0xa460, 0x10feb740, 0xa460, 0x15008380, 0xfffe9660, 0x1900e620, 0xa460
    .long 0x1d0041c0, 0x8380, 0x21ff19e0, 0xfffe9660, 0x25ff7c80, 0xffffbe40, 0x280062a0, 0x127e0
    .long 0x2a010700, 0xffffdf20, 0x2cff7c80, 0xa460, 0x2d000000, 0xffffbe40, 0x0, 0x0
    .long 0x0, 0x0, 0x0, 0xff000000, 0x0, 0x0, 0x0, 0x0
    .long 0x0, 0x0, 0x0, 0x0, 0x0, 0x0, 0x0, 0x0
    .long 0x0, 0x0, 0x0, 0x0, 0x0, 0x0, 0x0, 0x0
    .long 0x0, 0x0, 0x0, 0x0, 0x0, 0x0, 0x0, 0x0
    .long 0x1003100, 0x1f100, 0xffffffc0, 0x20091c0, 0xb005000, 0x1c00, 0x600c540, 0xf460
    .long 0xb00a460, 0xa460, 0x10feb740, 0xa460, 0x15008380, 0xfffe9660, 0x1900e620, 0xa460
    .long 0x1d0041c0, 0x8380, 0x21ff19e0, 0xfffe9660, 0x25ff7c80, 0xffffbe40, 0x280062a0, 0x127e0
    .long 0x2a010700, 0xffffdf20, 0x2cff7c80, 0xa460, 0x2d000000, 0xffffbe40, 0x0, 0x0
    .long 0x0, 0x0, 0x0, 0xff000000, 0x0, 0x0, 0x0, 0x0
    .long 0x0, 0x0, 0x0, 0x0, 0x0, 0x0, 0x0, 0x0
    .long 0x0, 0x0, 0x0, 0x0, 0x0, 0x0, 0x0, 0x0
    .long 0x0, 0x0, 0x0, 0x0, 0x0, 0x0, 0x0, 0x0
    .long 0x1023100, 0x1f100, 0xffffffc0, 0x300b2a0, 0xb005000, 0x1c00, 0x600c540, 0xf460
    .long 0xb00a460, 0xa460, 0x10feb740, 0xa460, 0x15008380, 0xfffe9660, 0x1900e620, 0xa460
    .long 0x1d0041c0, 0x8380, 0x21ff19e0, 0xfffe9660, 0x25ff7c80, 0xffffbe40, 0x280062a0, 0x127e0
    .long 0x2a010700, 0xffffdf20, 0x2cff7c80, 0xa460, 0x2d000000, 0xffffbe40, 0x0, 0x0
    .long 0x0, 0x0, 0x0, 0xff000000, 0x0, 0x0, 0x0, 0x0
    .long 0x0, 0x0, 0x0, 0x0, 0x0, 0x0, 0x0, 0x0
    .long 0x0, 0x0, 0x0, 0x0, 0x0, 0x0, 0x0, 0x0
    .long 0x0, 0x0, 0x0, 0x0, 0x0, 0x0, 0x0, 0x0
    .long 0x1043100, 0x5100, 0xffffffc0, 0x400d380, 0xb005000, 0x1d00, 0x600c540, 0xf460
    .long 0xb00a460, 0xa460, 0x10feb740, 0xa460, 0x15008380, 0xfffe9660, 0x1900e620, 0xa460
    .long 0x1d0041c0, 0x8380, 0x21ff19e0, 0xfffe9660, 0x25ff7c80, 0xffffbe40, 0x280062a0, 0x127e0
    .long 0x2a010700, 0xffffdf20, 0x2cff7c80, 0xa460, 0x2d000000, 0xffffbe40, 0x0, 0x0
    .long 0x0, 0x0, 0x0, 0xff000000, 0x0, 0x0, 0x0, 0x0
    .long 0x0, 0x0, 0x0, 0x0, 0x0, 0x0, 0x0, 0x0
    .long 0x0, 0x0, 0x0, 0x0, 0x0, 0x0, 0x0, 0x0
    .long 0x0, 0x0, 0x0, 0x0, 0x0, 0x0, 0x0, 0x0
    .long 0x8e5100, 0x1f100, 0xfffffc00, 0xd01fb60, 0x5013620, 0x20001000, 0x13ff19e0, 0xb2a0
    .long 0x17010700, 0x62a0, 0x1b0062a0, 0x8380, 0x1f008380, 0xfffed820, 0x23feb740, 0x62a0
    .long 0x26000000, 0x10700, 0x0, 0x0, 0x0, 0x0, 0x0, 0xff000000
    .long 0x0, 0x0, 0x0, 0x0, 0x0, 0x0, 0x0, 0x0
    .long 0x0, 0x0, 0x0, 0x0, 0x0, 0x0, 0x0, 0x0
    .long 0x0, 0x0, 0x0, 0x0, 0x0, 0x0, 0x0, 0x0
    .long 0x0, 0x0, 0x0, 0x0, 0x0, 0x0, 0x0, 0x0
    .long 0x0, 0x0, 0x0, 0x0, 0x0, 0x0, 0x0, 0x0
    .long 0x905100, 0x1f100, 0xfffffc00, 0xe021c40, 0x5013620, 0x20001000, 0x13ff19e0, 0xb2a0
    .long 0x17010700, 0x62a0, 0x1b0062a0, 0x8380, 0x1f008380, 0xfffed820, 0x23feb740, 0x62a0
    .long 0x26000000, 0x10700, 0x0, 0x0, 0x0, 0x0, 0x0, 0xff000000
    .long 0x0, 0x0, 0x0, 0x0, 0x0, 0x0, 0x0, 0x0
    .long 0x0, 0x0, 0x0, 0x0, 0x0, 0x0, 0x0, 0x0
    .long 0x0, 0x0, 0x0, 0x0, 0x0, 0x0, 0x0, 0x0
    .long 0x0, 0x0, 0x0, 0x0, 0x0, 0x0, 0x0, 0x0
    .long 0x0, 0x0, 0x0, 0x0, 0x0, 0x0, 0x0, 0x0
    .long 0x8c5100, 0x1f100, 0xfffffc00, 0xc01da80, 0x5013620, 0x20001000, 0x13ff19e0, 0xb2a0
    .long 0x17010700, 0x62a0, 0x1b0062a0, 0x8380, 0x1f008380, 0xfffed820, 0x23feb740, 0x62a0
    .long 0x26000000, 0x10700, 0x0, 0x0, 0x0, 0x0, 0x0, 0xff000000
    .long 0x0, 0x0, 0x0, 0x0, 0x0, 0x0, 0x0, 0x0
    .long 0x0, 0x0, 0x0, 0x0, 0x0, 0x0, 0x0, 0x0
    .long 0x0, 0x0, 0x0, 0x0, 0x0, 0x0, 0x0, 0x0
    .long 0x0, 0x0, 0x0, 0x0, 0x0, 0x0, 0x0, 0x0
    .long 0x0, 0x0, 0x0, 0x0, 0x0, 0x0, 0x0, 0x0
    .long 0x885100, 0x1f100, 0xfffffc00, 0x8015700, 0x5013620, 0x20001000, 0x13ff19e0, 0xb2a0
    .long 0x17010700, 0x62a0, 0x1b0062a0, 0x8380, 0x1f008380, 0xfffed820, 0x23feb740, 0x62a0
    .long 0x26000000, 0x10700, 0x0, 0x0, 0x0, 0x0, 0x0, 0xff000000
    .long 0x0, 0x0, 0x0, 0x0, 0x0, 0x0, 0x0, 0x0
    .long 0x0, 0x0, 0x0, 0x0, 0x0, 0x0, 0x0, 0x0
    .long 0x0, 0x0, 0x0, 0x0, 0x0, 0x0, 0x0, 0x0
    .long 0x0, 0x0, 0x0, 0x0, 0x0, 0x0, 0x0, 0x0
    .long 0x0, 0x0, 0x0, 0x0, 0x0, 0x0, 0x0, 0x0
    .long 0xafa100, 0xcb000e, 0xbfa100, 0x4cb000c, 0xc5a100, 0x8cb000c, 0xc9a100, 0xccb000c
    .long 0xb1a100, 0x10cb000e, 0xb3a100, 0x14cb000e, 0xb5a100, 0x18cb000e, 0x2b5a102, 0x4cb000d
    .long 0x2b7a110, 0x8cb000d, 0x2b9a140, 0xccb000d, 0x2bba17f, 0xcb000d, 0x4bda17f, 0x10cb000d
    .long 0x6bfa17f, 0x14cb000d, 0x8c1a17f, 0x18cb000d, 0xac3a17f, 0x6cb000d, 0xcc5a17f, 0xacb000d
    .long 0xec7a17f, 0xccb000d, 0x10c9a17f, 0xcb000d, 0x0, 0x0, 0x0, 0x0
    .long 0x0, 0x0, 0x0, 0x0, 0x0, 0x0, 0x0, 0x0
    .long 0x0, 0x0, 0x0, 0x0, 0x0, 0x0, 0x0, 0x0
    .long 0x0, 0x0, 0x0, 0x0, 0x0, 0x0, 0x0, 0x0
    .long 0xbda100, 0x2cb000c, 0xc1a100, 0x6cb000c, 0xc7a100, 0xacb000c, 0xafa100, 0xecb000d
    .long 0xb1a100, 0x12cb000d, 0xb3a100, 0x16cb000d, 0x2c3a101, 0x2cb000c, 0x2b7a104, 0x6cb000e
    .long 0x2b9a120, 0xacb000e, 0x2bba108, 0x2cb000e, 0x4bda17f, 0xecb000e, 0x6bfa17f, 0x12cb000e
    .long 0x8c1a17f, 0x16cb000e, 0xac3a17f, 0x4cb000e, 0xcc5a17f, 0x8cb000e, 0xec7a17f, 0x2cb000e
    .long 0x10c9a17f, 0xecb000e, 0x0, 0x0, 0x0, 0x0, 0x0, 0x0
    .long 0x0, 0x0, 0x0, 0x0, 0x0, 0x0, 0x0, 0x0
    .long 0x0, 0x0, 0x0, 0x0, 0x0, 0x0, 0x0, 0x0
    .long 0x0, 0x0, 0x0, 0x0, 0x0, 0x0, 0x0, 0x0
    .long 0x0, 0x0, 0x0, 0x0, 0x0, 0xff000000, 0x0, 0x0
    .long 0x0, 0x0, 0x0, 0x0, 0x0, 0x0, 0x0, 0x0
    .long 0x0, 0x0, 0x0, 0x0, 0x0, 0x0, 0x0, 0x0
    .long 0x0, 0x0, 0x0, 0x0, 0x0, 0x0, 0x0, 0x0
    .long 0x0, 0x0, 0x0, 0x0, 0x0, 0x0, 0x0, 0x0
    .long 0x0, 0x0, 0x0, 0x0, 0x0, 0x0, 0x0, 0x0
    .long 0x0, 0x0, 0x0, 0x0, 0x0, 0x0, 0x0, 0x0
    .long 0x0, 0x0, 0x0, 0x0, 0x0, 0x0, 0x0, 0x0
    .long 0x0, 0x0, 0x0, 0x0, 0x0, 0xff000000, 0x0, 0x0
    .long 0x0, 0x0, 0x0, 0x0, 0x0, 0x0, 0x0, 0x0
    .long 0x0, 0x0, 0x0, 0x0, 0x0, 0x0, 0x0, 0x0
    .long 0x0, 0x0, 0x0, 0x0, 0x0, 0x0, 0x0, 0x0
    .long 0x0, 0x0, 0x0, 0x0, 0x0, 0x0, 0x0, 0x0
    .long 0x0, 0x0, 0x0, 0x0, 0x0, 0x0, 0x0, 0x0
    .long 0x0, 0x0, 0x0, 0x0, 0x0, 0x0, 0x0, 0x0
    .long 0x0, 0x0, 0x0, 0x0, 0x0, 0x0, 0x0, 0x0
    .long 0xbda100, 0x1f100, 0xffc00000, 0x10070e0, 0xd005000, 0xc00, 0x8010700, 0x13620
    .long 0xa0041c0, 0x41c0, 0xc0041c0, 0x41c0, 0xffed820, 0xfffed820, 0x110041c0, 0x41c0
    .long 0x13ff7c80, 0x41c0, 0x1500c540, 0xffff3ac0, 0x170041c0, 0x10700, 0x190041c0, 0x41c0
    .long 0x1bfed820, 0x41c0, 0x1d0041c0, 0xfffed820, 0x1fff9d60, 0x41c0, 0x2100c540, 0x20e0
    .long 0x22000000, 0xffff3ac0, 0x0, 0x0, 0x0, 0x0, 0x0, 0xff000000
    .long 0x0, 0x0, 0x0, 0x0, 0x0, 0x0, 0x0, 0x0
    .long 0x0, 0x0, 0x0, 0x0, 0x0, 0x0, 0x0, 0x0
    .long 0x0, 0x0, 0x0, 0x0, 0x0, 0x0, 0x0, 0x0
    .long 0xbfa100, 0x1f100, 0xffc00000, 0x20091c0, 0xd005000, 0xc00, 0x8010700, 0x13620
    .long 0xa0041c0, 0x41c0, 0xc0041c0, 0x41c0, 0xffed820, 0xfffed820, 0x110041c0, 0x41c0
    .long 0x13ff7c80, 0x41c0, 0x1500c540, 0xffff3ac0, 0x170041c0, 0x10700, 0x190041c0, 0x41c0
    .long 0x1bfed820, 0x41c0, 0x1d0041c0, 0xfffed820, 0x1fff9d60, 0x41c0, 0x2100c540, 0x20e0
    .long 0x22000000, 0xffff3ac0, 0x0, 0x0, 0x0, 0x0, 0x0, 0xff000000
    .long 0x0, 0x0, 0x0, 0x0, 0x0, 0x0, 0x0, 0x0
    .long 0x0, 0x0, 0x0, 0x0, 0x0, 0x0, 0x0, 0x0
    .long 0x0, 0x0, 0x0, 0x0, 0x0, 0x0, 0x0, 0x0
    .long 0xc1a100, 0x1f100, 0xffc00000, 0x300b2a0, 0xd005000, 0xc00, 0x8010700, 0x13620
    .long 0xa0041c0, 0x41c0, 0xc0041c0, 0x41c0, 0xffed820, 0xfffed820, 0x110041c0, 0x41c0
    .long 0x13ff7c80, 0x41c0, 0x1500c540, 0xffff3ac0, 0x170041c0, 0x10700, 0x190041c0, 0x41c0
    .long 0x1bfed820, 0x41c0, 0x1d0041c0, 0xfffed820, 0x1fff9d60, 0x41c0, 0x2100c540, 0x20e0
    .long 0x22000000, 0xffff3ac0, 0x0, 0x0, 0x0, 0x0, 0x0, 0xff000000
    .long 0x0, 0x0, 0x0, 0x0, 0x0, 0x0, 0x0, 0x0
    .long 0x0, 0x0, 0x0, 0x0, 0x0, 0x0, 0x0, 0x0
    .long 0x0, 0x0, 0x0, 0x0, 0x0, 0x0, 0x0, 0x0
    .long 0xc3a100, 0x1f100, 0xffc00000, 0xd0070e0, 0xd005000, 0xc00, 0x8010700, 0x13620
    .long 0xa0041c0, 0x41c0, 0xc0041c0, 0x41c0, 0xffed820, 0xfffed820, 0x110041c0, 0x41c0
    .long 0x13ff7c80, 0x41c0, 0x1500c540, 0xffff3ac0, 0x170041c0, 0x10700, 0x190041c0, 0x41c0
    .long 0x1bfed820, 0x41c0, 0x1d0041c0, 0xfffed820, 0x1fff9d60, 0x41c0, 0x2100c540, 0x20e0
    .long 0x22000000, 0xffff3ac0, 0x0, 0x0, 0x0, 0x0, 0x0, 0xff000000
    .long 0x0, 0x0, 0x0, 0x0, 0x0, 0x0, 0x0, 0x0
    .long 0x0, 0x0, 0x0, 0x0, 0x0, 0x0, 0x0, 0x0
    .long 0x0, 0x0, 0x0, 0x0, 0x0, 0x0, 0x0, 0x0
    .long 0xc5a100, 0x1f100, 0xffc00000, 0x400d380, 0xd005000, 0x0, 0x8010700, 0x13620
    .long 0xa0041c0, 0x41c0, 0xc0041c0, 0x41c0, 0xffed820, 0xfffed820, 0x110041c0, 0x41c0
    .long 0x13ff7c80, 0x41c0, 0x1500c540, 0xffff3ac0, 0x170041c0, 0x10700, 0x190041c0, 0x41c0
    .long 0x1bfed820, 0x41c0, 0x1d0041c0, 0xfffed820, 0x1fff9d60, 0x41c0, 0x2100c540, 0x20e0
    .long 0x22000000, 0xffff3ac0, 0x0, 0x0, 0x0, 0x0, 0x0, 0xff000000
    .long 0x0, 0x0, 0x0, 0x0, 0x0, 0x0, 0x0, 0x0
    .long 0x0, 0x0, 0x0, 0x0, 0x0, 0x0, 0x0, 0x0
    .long 0x0, 0x0, 0x0, 0x0, 0x0, 0x0, 0x0, 0x0
    .long 0xc7a100, 0x1f100, 0xffc00000, 0x500f460, 0xd005000, 0x0, 0x8010700, 0x13620
    .long 0xa0041c0, 0x41c0, 0xc0041c0, 0x41c0, 0xffed820, 0xfffed820, 0x110041c0, 0x41c0
    .long 0x13ff7c80, 0x41c0, 0x1500c540, 0xffff3ac0, 0x170041c0, 0x10700, 0x190041c0, 0x41c0
    .long 0x1bfed820, 0x41c0, 0x1d0041c0, 0xfffed820, 0x1fff9d60, 0x41c0, 0x2100c540, 0x20e0
    .long 0x22000000, 0xffff3ac0, 0x0, 0x0, 0x0, 0x0, 0x0, 0xff000000
    .long 0x0, 0x0, 0x0, 0x0, 0x0, 0x0, 0x0, 0x0
    .long 0x0, 0x0, 0x0, 0x0, 0x0, 0x0, 0x0, 0x0
    .long 0x0, 0x0, 0x0, 0x0, 0x0, 0x0, 0x0, 0x0
    .long 0xc9a100, 0x15100, 0xffc00000, 0x6011540, 0xd005000, 0x0, 0x8010700, 0x13620
    .long 0xa0041c0, 0x41c0, 0xc0041c0, 0x41c0, 0xffed820, 0xfffed820, 0x110041c0, 0x41c0
    .long 0x13ff7c80, 0x41c0, 0x1500c540, 0xffff3ac0, 0x170041c0, 0x10700, 0x190041c0, 0x41c0
    .long 0x1bfed820, 0x41c0, 0x1d0041c0, 0xfffed820, 0x1fff9d60, 0x41c0, 0x2100c540, 0x20e0
    .long 0x22000000, 0xffff3ac0, 0x0, 0x0, 0x0, 0x0, 0x0, 0xff000000
    .long 0x0, 0x0, 0x0, 0x0, 0x0, 0x0, 0x0, 0x0
    .long 0x0, 0x0, 0x0, 0x0, 0x0, 0x0, 0x0, 0x0
    .long 0x0, 0x0, 0x0, 0x0, 0x0, 0x0, 0x0, 0x0
    .long 0x0, 0x0, 0x0, 0x0, 0x0, 0xff000000, 0x0, 0x0
    .long 0x0, 0x0, 0x0, 0x0, 0x0, 0x0, 0x0, 0x0
    .long 0x0, 0x0, 0x0, 0x0, 0x0, 0x0, 0x0, 0x0
    .long 0x0, 0x0, 0x0, 0x0, 0x0, 0x0, 0x0, 0x0
    .long 0x0, 0x0, 0x0, 0x0, 0x0, 0x0, 0x0, 0x0
    .long 0x0, 0x0, 0x0, 0x0, 0x0, 0x0, 0x0, 0x0
    .long 0x0, 0x0, 0x0, 0x0, 0x0, 0x0, 0x0, 0x0
    .long 0x0, 0x0, 0x0, 0x0, 0x0, 0x0, 0x0, 0x0
    .long 0x36e100, 0x51300e, 0x46e100, 0x451300c, 0x4ce100, 0x851300c, 0x50e100, 0xc51300c
    .long 0x38e100, 0x1051300e, 0x3ae100, 0x1451300e, 0x3ce100, 0x1851300e, 0x23ce102, 0x451300d
    .long 0x23ee110, 0x851300d, 0x240e140, 0xc51300d, 0x242e17f, 0x51300d, 0x444e17f, 0x1051300d
    .long 0x646e17f, 0x1451300d, 0x848e17f, 0x1851300d, 0xa4ae17f, 0x651300d, 0xc4ce17f, 0xa51300d
    .long 0xe4ee17f, 0xc51300d, 0x1050e17f, 0xe51300d, 0x0, 0x0, 0x0, 0x0
    .long 0x0, 0x0, 0x0, 0x0, 0x0, 0x0, 0x0, 0x0
    .long 0x0, 0x0, 0x0, 0x0, 0x0, 0x0, 0x0, 0x0
    .long 0x0, 0x0, 0x0, 0x0, 0x0, 0x0, 0x0, 0x0
    .long 0x44e100, 0x251300c, 0x48e100, 0x651300c, 0x4ee100, 0xa51300c, 0x36e100, 0xe51300d
    .long 0x38e100, 0x1251300d, 0x3ae100, 0x1651300d, 0x24ae101, 0x251300c, 0x23ee104, 0x651300e
    .long 0x240e120, 0xa51300e, 0x242e108, 0x251300e, 0x444e17f, 0xe51300e, 0x646e17f, 0x1251300e
    .long 0x848e17f, 0x1651300e, 0xa4ae17f, 0x451300e, 0xc4ce17f, 0x851300e, 0xe4ee17f, 0x251300e
    .long 0x1050e17f, 0x51300e, 0x0, 0x0, 0x0, 0x0, 0x0, 0x0
    .long 0x0, 0x0, 0x0, 0x0, 0x0, 0x0, 0x0, 0x0
    .long 0x0, 0x0, 0x0, 0x0, 0x0, 0x0, 0x0, 0x0
    .long 0x0, 0x0, 0x0, 0x0, 0x0, 0x0, 0x0, 0x0
    .long 0x0, 0x0, 0x0, 0x0, 0x0, 0xff000000, 0x0, 0x0
    .long 0x0, 0x0, 0x0, 0x0, 0x0, 0x0, 0x0, 0x0
    .long 0x0, 0x0, 0x0, 0x0, 0x0, 0x0, 0x0, 0x0
    .long 0x0, 0x0, 0x0, 0x0, 0x0, 0x0, 0x0, 0x0
    .long 0x0, 0x0, 0x0, 0x0, 0x0, 0x0, 0x0, 0x0
    .long 0x0, 0x0, 0x0, 0x0, 0x0, 0x0, 0x0, 0x0
    .long 0x0, 0x0, 0x0, 0x0, 0x0, 0x0, 0x0, 0x0
    .long 0x0, 0x0, 0x0, 0x0, 0x0, 0x0, 0x0, 0x0
    .long 0x0, 0x0, 0x0, 0x0, 0x0, 0xff000000, 0x0, 0x0
    .long 0x0, 0x0, 0x0, 0x0, 0x0, 0x0, 0x0, 0x0
    .long 0x0, 0x0, 0x0, 0x0, 0x0, 0x0, 0x0, 0x0
    .long 0x0, 0x0, 0x0, 0x0, 0x0, 0x0, 0x0, 0x0
    .long 0x0, 0x0, 0x0, 0x0, 0x0, 0x0, 0x0, 0x0
    .long 0x0, 0x0, 0x0, 0x0, 0x0, 0x0, 0x0, 0x0
    .long 0x0, 0x0, 0x0, 0x0, 0x0, 0x0, 0x0, 0x0
    .long 0x0, 0x0, 0x0, 0x0, 0x0, 0x0, 0x0, 0x0
    .long 0x44e100, 0x1f100, 0xffffffe0, 0x10070e0, 0xd005000, 0x1c00, 0x8010700, 0x13620
    .long 0xa0041c0, 0x41c0, 0xc0041c0, 0x41c0, 0xffed820, 0xfffed820, 0x110041c0, 0x41c0
    .long 0x13ff7c80, 0x41c0, 0x1500c540, 0xffff3ac0, 0x170041c0, 0x10700, 0x190041c0, 0x41c0
    .long 0x1bfed820, 0x41c0, 0x1d0041c0, 0xfffed820, 0x1fff9d60, 0x41c0, 0x21ffdf20, 0x20e0
    .long 0x22000000, 0x20e0, 0x0, 0x0, 0x0, 0x0, 0x0, 0xff000000
    .long 0x0, 0x0, 0x0, 0x0, 0x0, 0x0, 0x0, 0x0
    .long 0x0, 0x0, 0x0, 0x0, 0x0, 0x0, 0x0, 0x0
    .long 0x0, 0x0, 0x0, 0x0, 0x0, 0x0, 0x0, 0x0
    .long 0x46e100, 0x1f100, 0xffffffe0, 0x20091c0, 0xd005000, 0x1c00, 0x8010700, 0x13620
    .long 0xa0041c0, 0x41c0, 0xc0041c0, 0x41c0, 0xffed820, 0xfffed820, 0x110041c0, 0x41c0
    .long 0x13ff7c80, 0x41c0, 0x1500c540, 0xffff3ac0, 0x170041c0, 0x10700, 0x190041c0, 0x41c0
    .long 0x1bfed820, 0x41c0, 0x1d0041c0, 0xfffed820, 0x1fff9d60, 0x41c0, 0x21ffdf20, 0x20e0
    .long 0x22000000, 0x20e0, 0x0, 0x0, 0x0, 0x0, 0x0, 0xff000000
    .long 0x0, 0x0, 0x0, 0x0, 0x0, 0x0, 0x0, 0x0
    .long 0x0, 0x0, 0x0, 0x0, 0x0, 0x0, 0x0, 0x0
    .long 0x0, 0x0, 0x0, 0x0, 0x0, 0x0, 0x0, 0x0
    .long 0x48e100, 0x1f100, 0xffffffe0, 0x300b2a0, 0xd005000, 0x1c00, 0x8010700, 0x13620
    .long 0xa0041c0, 0x41c0, 0xc0041c0, 0x41c0, 0xffed820, 0xfffed820, 0x110041c0, 0x41c0
    .long 0x13ff7c80, 0x41c0, 0x1500c540, 0xffff3ac0, 0x170041c0, 0x10700, 0x190041c0, 0x41c0
    .long 0x1bfed820, 0x41c0, 0x1d0041c0, 0xfffed820, 0x1fff9d60, 0x41c0, 0x21ffdf20, 0x20e0
    .long 0x22000000, 0x20e0, 0x0, 0x0, 0x0, 0x0, 0x0, 0xff000000
    .long 0x0, 0x0, 0x0, 0x0, 0x0, 0x0, 0x0, 0x0
    .long 0x0, 0x0, 0x0, 0x0, 0x0, 0x0, 0x0, 0x0
    .long 0x0, 0x0, 0x0, 0x0, 0x0, 0x0, 0x0, 0x0
    .long 0x4ae100, 0x1f100, 0xffffffe0, 0xd0070e0, 0xd005000, 0x1c00, 0x8010700, 0x13620
    .long 0xa0041c0, 0x41c0, 0xc0041c0, 0x41c0, 0xffed820, 0xfffed820, 0x110041c0, 0x41c0
    .long 0x13ff7c80, 0x41c0, 0x1500c540, 0xffff3ac0, 0x170041c0, 0x10700, 0x190041c0, 0x41c0
    .long 0x1bfed820, 0x41c0, 0x1d0041c0, 0xfffed820, 0x1fff9d60, 0x41c0, 0x21ffdf20, 0x20e0
    .long 0x22000000, 0x20e0, 0x0, 0x0, 0x0, 0x0, 0x0, 0xff000000
    .long 0x0, 0x0, 0x0, 0x0, 0x0, 0x0, 0x0, 0x0
    .long 0x0, 0x0, 0x0, 0x0, 0x0, 0x0, 0x0, 0x0
    .long 0x0, 0x0, 0x0, 0x0, 0x0, 0x0, 0x0, 0x0
    .long 0x4ce100, 0x1f100, 0xffffffe0, 0x400d380, 0xd005000, 0x1000, 0x8010700, 0x13620
    .long 0xa0041c0, 0x41c0, 0xc0041c0, 0x41c0, 0xffed820, 0xfffed820, 0x110041c0, 0x41c0
    .long 0x13ff7c80, 0x41c0, 0x1500c540, 0xffff3ac0, 0x170041c0, 0x10700, 0x190041c0, 0x41c0
    .long 0x1bfed820, 0x41c0, 0x1d0041c0, 0xfffed820, 0x1fff9d60, 0x41c0, 0x21ffdf20, 0x20e0
    .long 0x22000000, 0x20e0, 0x0, 0x0, 0x0, 0x0, 0x0, 0xff000000
    .long 0x0, 0x0, 0x0, 0x0, 0x0, 0x0, 0x0, 0x0
    .long 0x0, 0x0, 0x0, 0x0, 0x0, 0x0, 0x0, 0x0
    .long 0x0, 0x0, 0x0, 0x0, 0x0, 0x0, 0x0, 0x0
    .long 0x4ee100, 0x1f100, 0xffffffe0, 0x500f460, 0xd005000, 0x1000, 0x8010700, 0x13620
    .long 0xa0041c0, 0x41c0, 0xc0041c0, 0x41c0, 0xffed820, 0xfffed820, 0x110041c0, 0x41c0
    .long 0x13ff7c80, 0x41c0, 0x1500c540, 0xffff3ac0, 0x170041c0, 0x10700, 0x190041c0, 0x41c0
    .long 0x1bfed820, 0x41c0, 0x1d0041c0, 0xfffed820, 0x1fff9d60, 0x41c0, 0x21ffdf20, 0x20e0
    .long 0x22000000, 0x20e0, 0x0, 0x0, 0x0, 0x0, 0x0, 0xff000000
    .long 0x0, 0x0, 0x0, 0x0, 0x0, 0x0, 0x0, 0x0
    .long 0x0, 0x0, 0x0, 0x0, 0x0, 0x0, 0x0, 0x0
    .long 0x0, 0x0, 0x0, 0x0, 0x0, 0x0, 0x0, 0x0
    .long 0x50e100, 0x4100, 0xffffffe0, 0x6011540, 0xd005000, 0x1100, 0x8010700, 0x13620
    .long 0xa0041c0, 0x41c0, 0xc0041c0, 0x41c0, 0xffed820, 0xfffed820, 0x110041c0, 0x41c0
    .long 0x13ff7c80, 0x41c0, 0x1500c540, 0xffff3ac0, 0x170041c0, 0x10700, 0x190041c0, 0x41c0
    .long 0x1bfed820, 0x41c0, 0x1d0041c0, 0xfffed820, 0x1fff9d60, 0x41c0, 0x21ffdf20, 0x20e0
    .long 0x22000000, 0x20e0, 0x0, 0x0, 0x0, 0x0, 0x0, 0xff000000
    .long 0x0, 0x0, 0x0, 0x0, 0x0, 0x0, 0x0, 0x0
    .long 0x0, 0x0, 0x0, 0x0, 0x0, 0x0, 0x0, 0x0
    .long 0x0, 0x0, 0x0, 0x0, 0x0, 0x0, 0x0, 0x0
    .long 0x0, 0x0, 0x0, 0x0, 0x0, 0xff000000, 0x0, 0x0
    .long 0x0, 0x0, 0x0, 0x0, 0x0, 0x0, 0x0, 0x0
    .long 0x0, 0x0, 0x0, 0x0, 0x0, 0x0, 0x0, 0x0
    .long 0x0, 0x0, 0x0, 0x0, 0x0, 0x0, 0x0, 0x0
    .long 0x0, 0x0, 0x0, 0x0, 0x0, 0x0, 0x0, 0x0
    .long 0x0, 0x0, 0x0, 0x0, 0x0, 0x0, 0x0, 0x0
    .long 0x0, 0x0, 0x0, 0x0, 0x0, 0x0, 0x0, 0x0
    .long 0x0, 0x0, 0x0, 0x0, 0x0, 0x0, 0x0, 0x0
    .long 0xee3000, 0x104900a, 0x1003000, 0x5049008, 0x1043000, 0x9049008, 0xf03000, 0xd04900a
    .long 0x885000, 0x1092f008, 0xf03000, 0x15049009, 0x8c5000, 0x1892f008, 0x905000, 0x1c92f00c
    .long 0x2f43001, 0x304900e, 0x2885004, 0x692f00d, 0x2f43008, 0x904900d, 0x48a500f, 0xc92f00d
    .long 0x42f63400, 0x1304900d, 0x68c500f, 0x1692f00d, 0x42f83010, 0x1b04900d, 0x88e500f, 0x292f00d
    .long 0x42fa3200, 0x504900d, 0xa90500f, 0x892f00d, 0x44fc36f0, 0x104900d, 0xc92500f, 0x1292f00d
    .long 0x470036f0, 0xd04900e, 0xf02300f, 0x1b04900e, 0x490436f0, 0x1704900e, 0x0, 0x0
    .long 0x0, 0x0, 0x0, 0x0, 0x0, 0x0, 0x0, 0x0
    .long 0x0, 0x0, 0x0, 0x0, 0x0, 0x0, 0x0, 0x0
    .long 0xfe3000, 0x3049008, 0x1023000, 0x7049008, 0xee3000, 0xb049009, 0x885000, 0xe92f00a
    .long 0x8a5000, 0x1292f008, 0xf23000, 0x1704900a, 0x8e5000, 0x1a92f008, 0xf23000, 0x1f04900d
    .long 0x2925002, 0x492f00c, 0x28a500f, 0x92f00e, 0x4f6300f, 0xb04900e, 0x428c5080, 0x1092f00e
    .long 0x6f8300f, 0x1504900e, 0x428e5040, 0x1892f00e, 0x42fa3020, 0x1d04900e, 0x890500f, 0x1e92f00e
    .long 0x42fc36f0, 0xf04900e, 0xa92500f, 0xa92f00e, 0x44fe36f0, 0x704900e, 0xcfe300f, 0x1504900d
    .long 0x470036f0, 0x1104900d, 0xf02300f, 0x1d04900d, 0x490436f0, 0x1904900d, 0x0, 0x0
    .long 0x0, 0x0, 0x0, 0x0, 0x0, 0x0, 0x0, 0x0
    .long 0x0, 0x0, 0x0, 0x0, 0x0, 0x0, 0x0, 0x0
    .long 0x925000, 0x9100, 0xfffffc00, 0x110091c0, 0x5013620, 0x20001100, 0x13ff19e0, 0xb2a0
    .long 0x17010700, 0x62a0, 0x1b008380, 0xa460, 0x1f0062a0, 0xfffeb740, 0x23feb740, 0x62a0
    .long 0x26000000, 0xa460, 0x0, 0x0, 0x0, 0x0, 0x0, 0xff000000
    .long 0x0, 0x0, 0x0, 0x0, 0x0, 0x0, 0x0, 0x0
    .long 0x0, 0x0, 0x0, 0x0, 0x0, 0x0, 0x0, 0x0
    .long 0x0, 0x0, 0x0, 0x0, 0x0, 0x0, 0x0, 0x0
    .long 0x0, 0x0, 0x0, 0x0, 0x0, 0x0, 0x0, 0x0
    .long 0x0, 0x0, 0x0, 0x0, 0x0, 0x0, 0x0, 0x0
    .long 0x8a5000, 0x1f100, 0xfffffc00, 0x90177e0, 0x5013620, 0x20001000, 0x13ff19e0, 0xb2a0
    .long 0x17010700, 0x62a0, 0x1b008380, 0xa460, 0x1f0062a0, 0xfffeb740, 0x23feb740, 0x62a0
    .long 0x26000000, 0xa460, 0x0, 0x0, 0x0, 0x0, 0x0, 0xff000000
    .long 0x0, 0x0, 0x0, 0x0, 0x0, 0x0, 0x0, 0x0
    .long 0x0, 0x0, 0x0, 0x0, 0x0, 0x0, 0x0, 0x0
    .long 0x0, 0x0, 0x0, 0x0, 0x0, 0x0, 0x0, 0x0
    .long 0x0, 0x0, 0x0, 0x0, 0x0, 0x0, 0x0, 0x0
    .long 0x0, 0x0, 0x0, 0x0, 0x0, 0x0, 0x0, 0x0
    .long 0xfe3000, 0x1f100, 0xffffffc0, 0x10070e0, 0xb005000, 0x1c00, 0x600c540, 0xf460
    .long 0xb00a460, 0xa460, 0x10feb740, 0xa460, 0x15008380, 0xfffe9660, 0x1900a460, 0xa460
    .long 0x1d008380, 0x8380, 0x21ff19e0, 0xfffe9660, 0x25ff7c80, 0xffffbe40, 0x280062a0, 0x148c0
    .long 0x2a00e620, 0xffffbe40, 0x2cffbe40, 0xc540, 0x2d000000, 0xffffbe40, 0x0, 0x0
    .long 0x0, 0x0, 0x0, 0xff000000, 0x0, 0x0, 0x0, 0x0
    .long 0x0, 0x0, 0x0, 0x0, 0x0, 0x0, 0x0, 0x0
    .long 0x0, 0x0, 0x0, 0x0, 0x0, 0x0, 0x0, 0x0
    .long 0x0, 0x0, 0x0, 0x0, 0x0, 0x0, 0x0, 0x0
    .long 0x1003000, 0x1f100, 0xffffffc0, 0x20091c0, 0xb005000, 0x1c00, 0x600c540, 0xf460
    .long 0xb00a460, 0xa460, 0x10feb740, 0xa460, 0x15008380, 0xfffe9660, 0x1900a460, 0xa460
    .long 0x1d008380, 0x8380, 0x21ff19e0, 0xfffe9660, 0x25ff7c80, 0xffffbe40, 0x280062a0, 0x148c0
    .long 0x2a00e620, 0xffffbe40, 0x2cffbe40, 0xc540, 0x2d000000, 0xffffbe40, 0x0, 0x0
    .long 0x0, 0x0, 0x0, 0xff000000, 0x0, 0x0, 0x0, 0x0
    .long 0x0, 0x0, 0x0, 0x0, 0x0, 0x0, 0x0, 0x0
    .long 0x0, 0x0, 0x0, 0x0, 0x0, 0x0, 0x0, 0x0
    .long 0x0, 0x0, 0x0, 0x0, 0x0, 0x0, 0x0, 0x0
    .long 0x1023000, 0x1f100, 0xffffffc0, 0x300b2a0, 0xb005000, 0x1c00, 0x600c540, 0xf460
    .long 0xb00a460, 0xa460, 0x10feb740, 0xa460, 0x15008380, 0xfffe9660, 0x1900a460, 0xa460
    .long 0x1d008380, 0x8380, 0x21ff19e0, 0xfffe9660, 0x25ff7c80, 0xffffbe40, 0x280062a0, 0x148c0
    .long 0x2a00e620, 0xffffbe40, 0x2cffbe40, 0xc540, 0x2d000000, 0xffffbe40, 0x0, 0x0
    .long 0x0, 0x0, 0x0, 0xff000000, 0x0, 0x0, 0x0, 0x0
    .long 0x0, 0x0, 0x0, 0x0, 0x0, 0x0, 0x0, 0x0
    .long 0x0, 0x0, 0x0, 0x0, 0x0, 0x0, 0x0, 0x0
    .long 0x0, 0x0, 0x0, 0x0, 0x0, 0x0, 0x0, 0x0
    .long 0x1043000, 0x5100, 0xffffffc0, 0x400d380, 0xb005000, 0x1d00, 0x600c540, 0xf460
    .long 0xb00a460, 0xa460, 0x10feb740, 0xa460, 0x15008380, 0xfffe9660, 0x1900a460, 0xa460
    .long 0x1d008380, 0x8380, 0x21ff19e0, 0xfffe9660, 0x25ff7c80, 0xffffbe40, 0x280062a0, 0x148c0
    .long 0x2a00e620, 0xffffbe40, 0x2cffbe40, 0xc540, 0x2d000000, 0xffffbe40, 0x0, 0x0
    .long 0x0, 0x0, 0x0, 0xff000000, 0x0, 0x0, 0x0, 0x0
    .long 0x0, 0x0, 0x0, 0x0, 0x0, 0x0, 0x0, 0x0
    .long 0x0, 0x0, 0x0, 0x0, 0x0, 0x0, 0x0, 0x0
    .long 0x0, 0x0, 0x0, 0x0, 0x0, 0x0, 0x0, 0x0
    .long 0x8e5000, 0x1f100, 0xfffffc00, 0xd01fb60, 0x5013620, 0x20001000, 0x13ff19e0, 0xb2a0
    .long 0x17010700, 0x62a0, 0x1b008380, 0xa460, 0x1f0062a0, 0xfffeb740, 0x23feb740, 0x62a0
    .long 0x26000000, 0xa460, 0x0, 0x0, 0x0, 0x0, 0x0, 0xff000000
    .long 0x0, 0x0, 0x0, 0x0, 0x0, 0x0, 0x0, 0x0
    .long 0x0, 0x0, 0x0, 0x0, 0x0, 0x0, 0x0, 0x0
    .long 0x0, 0x0, 0x0, 0x0, 0x0, 0x0, 0x0, 0x0
    .long 0x0, 0x0, 0x0, 0x0, 0x0, 0x0, 0x0, 0x0
    .long 0x0, 0x0, 0x0, 0x0, 0x0, 0x0, 0x0, 0x0
    .long 0x905000, 0x1f100, 0xfffffc00, 0xe021c40, 0x5013620, 0x20001000, 0x13ff19e0, 0xb2a0
    .long 0x17010700, 0x62a0, 0x1b008380, 0xa460, 0x1f0062a0, 0xfffeb740, 0x23feb740, 0x62a0
    .long 0x26000000, 0xa460, 0x0, 0x0, 0x0, 0x0, 0x0, 0xff000000
    .long 0x0, 0x0, 0x0, 0x0, 0x0, 0x0, 0x0, 0x0
    .long 0x0, 0x0, 0x0, 0x0, 0x0, 0x0, 0x0, 0x0
    .long 0x0, 0x0, 0x0, 0x0, 0x0, 0x0, 0x0, 0x0
    .long 0x0, 0x0, 0x0, 0x0, 0x0, 0x0, 0x0, 0x0
    .long 0x0, 0x0, 0x0, 0x0, 0x0, 0x0, 0x0, 0x0
    .long 0x8c5000, 0x1f100, 0xfffffc00, 0xc01da80, 0x5013620, 0x20001000, 0x13ff19e0, 0xb2a0
    .long 0x17010700, 0x62a0, 0x1b008380, 0xa460, 0x1f0062a0, 0xfffeb740, 0x23feb740, 0x62a0
    .long 0x26000000, 0xa460, 0x0, 0x0, 0x0, 0x0, 0x0, 0xff000000
    .long 0x0, 0x0, 0x0, 0x0, 0x0, 0x0, 0x0, 0x0
    .long 0x0, 0x0, 0x0, 0x0, 0x0, 0x0, 0x0, 0x0
    .long 0x0, 0x0, 0x0, 0x0, 0x0, 0x0, 0x0, 0x0
    .long 0x0, 0x0, 0x0, 0x0, 0x0, 0x0, 0x0, 0x0
    .long 0x0, 0x0, 0x0, 0x0, 0x0, 0x0, 0x0, 0x0
    .long 0x885000, 0x1f100, 0xfffffc00, 0x8015700, 0x5013620, 0x20001000, 0x13ff19e0, 0xb2a0
    .long 0x17010700, 0x62a0, 0x1b008380, 0xa460, 0x1f0062a0, 0xfffeb740, 0x23feb740, 0x62a0
    .long 0x26000000, 0xa460, 0x0, 0x0, 0x0, 0x0, 0x0, 0xff000000
    .long 0x0, 0x0, 0x0, 0x0, 0x0, 0x0, 0x0, 0x0
    .long 0x0, 0x0, 0x0, 0x0, 0x0, 0x0, 0x0, 0x0
    .long 0x0, 0x0, 0x0, 0x0, 0x0, 0x0, 0x0, 0x0
    .long 0x0, 0x0, 0x0, 0x0, 0x0, 0x0, 0x0, 0x0
    .long 0x0, 0x0, 0x0, 0x0, 0x0, 0x0, 0x0, 0x0
    .long 0xee3000, 0x104900a, 0x1003000, 0x5049008, 0x1043000, 0x9049008, 0xf03000, 0xd04900a
    .long 0x885000, 0x1092f008, 0xf03000, 0x15049009, 0x8c5000, 0x1892f008, 0x905000, 0x1c92f00c
    .long 0x2f43001, 0x304900e, 0x2885004, 0x692f00d, 0x2f43008, 0x904900d, 0x48a500f, 0xc92f00d
    .long 0x42f63400, 0x1304900d, 0x68c500f, 0x1692f00d, 0x42f83010, 0x1b04900d, 0x88e500f, 0x292f00d
    .long 0x42fa3200, 0x504900d, 0xa90500f, 0x892f00d, 0x44fc36f0, 0x104900d, 0xc92500f, 0x1492f00d
    .long 0x470036f0, 0x1104900e, 0xf02300f, 0x1d04900e, 0x490436f0, 0x1904900e, 0x0, 0x0
    .long 0x0, 0x0, 0x0, 0x0, 0x0, 0x0, 0x0, 0x0
    .long 0x0, 0x0, 0x0, 0x0, 0x0, 0x0, 0x0, 0x0
    .long 0xfe3000, 0x3049008, 0x1023000, 0x7049008, 0xee3000, 0xb049009, 0x885000, 0xe92f00a
    .long 0x8a5000, 0x1292f008, 0xf23000, 0x1704900a, 0x8e5000, 0x1a92f008, 0xf23000, 0x1f04900d
    .long 0x2925002, 0x492f00c, 0x28a500f, 0x92f00e, 0x4f6300f, 0xb04900e, 0x428c5080, 0x1092f00e
    .long 0x6f8300f, 0x1504900e, 0x428e5040, 0x1892f00e, 0x42fa3020, 0x1d04900e, 0x890500f, 0x1e92f00e
    .long 0x42fc36f0, 0xf04900e, 0xa92500f, 0xa92f00e, 0x44fe36f0, 0x704900e, 0xcfe300f, 0x1304900d
    .long 0x470036f0, 0xd04900d, 0xf02300f, 0x1b04900d, 0x490436f0, 0x1704900d, 0x0, 0x0
    .long 0x0, 0x0, 0x0, 0x0, 0x0, 0x0, 0x0, 0x0
    .long 0x0, 0x0, 0x0, 0x0, 0x0, 0x0, 0x0, 0x0
    .long 0x925000, 0x9100, 0xfffffc00, 0x110091c0, 0x5013620, 0x20001100, 0x13ff19e0, 0xb2a0
    .long 0x17010700, 0x62a0, 0x1b008380, 0xa460, 0x1f0062a0, 0xfffeb740, 0x23feb740, 0x62a0
    .long 0x26000000, 0xc540, 0x0, 0x0, 0x0, 0x0, 0x0, 0xff000000
    .long 0x0, 0x0, 0x0, 0x0, 0x0, 0x0, 0x0, 0x0
    .long 0x0, 0x0, 0x0, 0x0, 0x0, 0x0, 0x0, 0x0
    .long 0x0, 0x0, 0x0, 0x0, 0x0, 0x0, 0x0, 0x0
    .long 0x0, 0x0, 0x0, 0x0, 0x0, 0x0, 0x0, 0x0
    .long 0x0, 0x0, 0x0, 0x0, 0x0, 0x0, 0x0, 0x0
    .long 0x8a5000, 0x1f100, 0xfffffc00, 0x90177e0, 0x5013620, 0x20001000, 0x13ff19e0, 0xb2a0
    .long 0x17010700, 0x62a0, 0x1b008380, 0xa460, 0x1f0062a0, 0xfffeb740, 0x23feb740, 0x62a0
    .long 0x26000000, 0xc540, 0x0, 0x0, 0x0, 0x0, 0x0, 0xff000000
    .long 0x0, 0x0, 0x0, 0x0, 0x0, 0x0, 0x0, 0x0
    .long 0x0, 0x0, 0x0, 0x0, 0x0, 0x0, 0x0, 0x0
    .long 0x0, 0x0, 0x0, 0x0, 0x0, 0x0, 0x0, 0x0
    .long 0x0, 0x0, 0x0, 0x0, 0x0, 0x0, 0x0, 0x0
    .long 0x0, 0x0, 0x0, 0x0, 0x0, 0x0, 0x0, 0x0
    .long 0xfe3000, 0x1f100, 0xffffffc0, 0x10070e0, 0xb005000, 0x1c00, 0x600c540, 0xf460
    .long 0xb00a460, 0xa460, 0x10feb740, 0xa460, 0x15008380, 0xfffe9660, 0x1900a460, 0xa460
    .long 0x1d008380, 0x8380, 0x21ff19e0, 0xfffe9660, 0x25ff7c80, 0xffffbe40, 0x2800a460, 0x127e0
    .long 0x2a00c540, 0xffff9d60, 0x2cffbe40, 0xe620, 0x2d000000, 0xffffbe40, 0x0, 0x0
    .long 0x0, 0x0, 0x0, 0xff000000, 0x0, 0x0, 0x0, 0x0
    .long 0x0, 0x0, 0x0, 0x0, 0x0, 0x0, 0x0, 0x0
    .long 0x0, 0x0, 0x0, 0x0, 0x0, 0x0, 0x0, 0x0
    .long 0x0, 0x0, 0x0, 0x0, 0x0, 0x0, 0x0, 0x0
    .long 0x1003000, 0x1f100, 0xffffffc0, 0x20091c0, 0xb005000, 0x1c00, 0x600c540, 0xf460
    .long 0xb00a460, 0xa460, 0x10feb740, 0xa460, 0x15008380, 0xfffe9660, 0x1900a460, 0xa460
    .long 0x1d008380, 0x8380, 0x21ff19e0, 0xfffe9660, 0x25ff7c80, 0xffffbe40, 0x2800a460, 0x127e0
    .long 0x2a00c540, 0xffff9d60, 0x2cffbe40, 0xe620, 0x2d000000, 0xffffbe40, 0x0, 0x0
    .long 0x0, 0x0, 0x0, 0xff000000, 0x0, 0x0, 0x0, 0x0
    .long 0x0, 0x0, 0x0, 0x0, 0x0, 0x0, 0x0, 0x0
    .long 0x0, 0x0, 0x0, 0x0, 0x0, 0x0, 0x0, 0x0
    .long 0x0, 0x0, 0x0, 0x0, 0x0, 0x0, 0x0, 0x0
    .long 0x1023000, 0x1f100, 0xffffffc0, 0x300b2a0, 0xb005000, 0x1c00, 0x600c540, 0xf460
    .long 0xb00a460, 0xa460, 0x10feb740, 0xa460, 0x15008380, 0xfffe9660, 0x1900a460, 0xa460
    .long 0x1d008380, 0x8380, 0x21ff19e0, 0xfffe9660, 0x25ff7c80, 0xffffbe40, 0x2800a460, 0x127e0
    .long 0x2a00c540, 0xffff9d60, 0x2cffbe40, 0xe620, 0x2d000000, 0xffffbe40, 0x0, 0x0
    .long 0x0, 0x0, 0x0, 0xff000000, 0x0, 0x0, 0x0, 0x0
    .long 0x0, 0x0, 0x0, 0x0, 0x0, 0x0, 0x0, 0x0
    .long 0x0, 0x0, 0x0, 0x0, 0x0, 0x0, 0x0, 0x0
    .long 0x0, 0x0, 0x0, 0x0, 0x0, 0x0, 0x0, 0x0
    .long 0x1043000, 0x5100, 0xffffffc0, 0x400d380, 0xb005000, 0x1d00, 0x600c540, 0xf460
    .long 0xb00a460, 0xa460, 0x10feb740, 0xa460, 0x15008380, 0xfffe9660, 0x1900a460, 0xa460
    .long 0x1d008380, 0x8380, 0x21ff19e0, 0xfffe9660, 0x25ff7c80, 0xffffbe40, 0x2800a460, 0x127e0
    .long 0x2a00c540, 0xffff9d60, 0x2cffbe40, 0xe620, 0x2d000000, 0xffffbe40, 0x0, 0x0
    .long 0x0, 0x0, 0x0, 0xff000000, 0x0, 0x0, 0x0, 0x0
    .long 0x0, 0x0, 0x0, 0x0, 0x0, 0x0, 0x0, 0x0
    .long 0x0, 0x0, 0x0, 0x0, 0x0, 0x0, 0x0, 0x0
    .long 0x0, 0x0, 0x0, 0x0, 0x0, 0x0, 0x0, 0x0
    .long 0x8e5000, 0x1f100, 0xfffffc00, 0xd01fb60, 0x5013620, 0x20001000, 0x13ff19e0, 0xb2a0
    .long 0x17010700, 0x62a0, 0x1b008380, 0xa460, 0x1f0062a0, 0xfffeb740, 0x23feb740, 0x62a0
    .long 0x26000000, 0xc540, 0x0, 0x0, 0x0, 0x0, 0x0, 0xff000000
    .long 0x0, 0x0, 0x0, 0x0, 0x0, 0x0, 0x0, 0x0
    .long 0x0, 0x0, 0x0, 0x0, 0x0, 0x0, 0x0, 0x0
    .long 0x0, 0x0, 0x0, 0x0, 0x0, 0x0, 0x0, 0x0
    .long 0x0, 0x0, 0x0, 0x0, 0x0, 0x0, 0x0, 0x0
    .long 0x0, 0x0, 0x0, 0x0, 0x0, 0x0, 0x0, 0x0
    .long 0x905000, 0x1f100, 0xfffffc00, 0xe021c40, 0x5013620, 0x20001000, 0x13ff19e0, 0xb2a0
    .long 0x17010700, 0x62a0, 0x1b008380, 0xa460, 0x1f0062a0, 0xfffeb740, 0x23feb740, 0x62a0
    .long 0x26000000, 0xc540, 0x0, 0x0, 0x0, 0x0, 0x0, 0xff000000
    .long 0x0, 0x0, 0x0, 0x0, 0x0, 0x0, 0x0, 0x0
    .long 0x0, 0x0, 0x0, 0x0, 0x0, 0x0, 0x0, 0x0
    .long 0x0, 0x0, 0x0, 0x0, 0x0, 0x0, 0x0, 0x0
    .long 0x0, 0x0, 0x0, 0x0, 0x0, 0x0, 0x0, 0x0
    .long 0x0, 0x0, 0x0, 0x0, 0x0, 0x0, 0x0, 0x0
    .long 0x8c5000, 0x1f100, 0xfffffc00, 0xc01da80, 0x5013620, 0x20001000, 0x13ff19e0, 0xb2a0
    .long 0x17010700, 0x62a0, 0x1b008380, 0xa460, 0x1f0062a0, 0xfffeb740, 0x23feb740, 0x62a0
    .long 0x26000000, 0xc540, 0x0, 0x0, 0x0, 0x0, 0x0, 0xff000000
    .long 0x0, 0x0, 0x0, 0x0, 0x0, 0x0, 0x0, 0x0
    .long 0x0, 0x0, 0x0, 0x0, 0x0, 0x0, 0x0, 0x0
    .long 0x0, 0x0, 0x0, 0x0, 0x0, 0x0, 0x0, 0x0
    .long 0x0, 0x0, 0x0, 0x0, 0x0, 0x0, 0x0, 0x0
    .long 0x0, 0x0, 0x0, 0x0, 0x0, 0x0, 0x0, 0x0
    .long 0x885000, 0x1f100, 0xfffffc00, 0x8015700, 0x5013620, 0x20001000, 0x13ff19e0, 0xb2a0
    .long 0x17010700, 0x62a0, 0x1b008380, 0xa460, 0x1f0062a0, 0xfffeb740, 0x23feb740, 0x62a0
    .long 0x26000000, 0xc540, 0x0, 0x0, 0x0, 0x0, 0x0, 0xff000000
    .long 0x0, 0x0, 0x0, 0x0, 0x0, 0x0, 0x0, 0x0
    .long 0x0, 0x0, 0x0, 0x0, 0x0, 0x0, 0x0, 0x0
    .long 0x0, 0x0, 0x0, 0x0, 0x0, 0x0, 0x0, 0x0
    .long 0x0, 0x0, 0x0, 0x0, 0x0, 0x0, 0x0, 0x0
    .long 0x0, 0x0, 0x0, 0x0, 0x0, 0x0, 0x0, 0x0
    .long 0x756100, 0x88500e, 0x776100, 0x488500c, 0x7b6100, 0x888500c, 0x776100, 0xc88500e
    .long 0x876100, 0x1088500c, 0x796100, 0x1488500e, 0x816100, 0x1888500c, 0x27b6104, 0x288500e
    .long 0x2856140, 0x688500c, 0x27d6300, 0xe88500e, 0x27f6101, 0x1688500e, 0x2816110, 0x488500e
    .long 0x28367ff, 0x88500e, 0x48567ff, 0xa88500e, 0x68767ff, 0x1288500e, 0x0, 0x0
    .long 0x0, 0x0, 0x0, 0x0, 0x0, 0x0, 0x0, 0x0
    .long 0x0, 0x0, 0x0, 0x0, 0x0, 0x0, 0x0, 0x0
    .long 0x0, 0x0, 0x0, 0x0, 0x0, 0x0, 0x0, 0x0
    .long 0x0, 0x0, 0x0, 0x0, 0x0, 0x0, 0x0, 0x0
    .long 0x756100, 0x288500c, 0x796100, 0x688500c, 0x756100, 0xa88500d, 0x7d6100, 0xe88500c
    .long 0x776100, 0x1288500d, 0x7f6100, 0x1688500c, 0x796100, 0x1a88500d, 0x2836108, 0x488500c
    .long 0x27b6180, 0x888500d, 0x27d6500, 0x1088500d, 0x27f6102, 0x1888500d, 0x2816120, 0x688500d
    .long 0x48367ff, 0xc88500d, 0x68567ff, 0x1488500d, 0x88767ff, 0x288500d, 0x0, 0x0
    .long 0x0, 0x0, 0x0, 0x0, 0x0, 0x0, 0x0, 0x0
    .long 0x0, 0x0, 0x0, 0x0, 0x0, 0x0, 0x0, 0x0
    .long 0x0, 0x0, 0x0, 0x0, 0x0, 0x0, 0x0, 0x0
    .long 0x0, 0x0, 0x0, 0x0, 0x0, 0x0, 0x0, 0x0
    .long 0x7d6100, 0x1f100, 0xffff8000, 0x7013620, 0x9005000, 0x1000, 0x600c540, 0xf460
    .long 0xa008380, 0x8380, 0xefed820, 0x8380, 0x1200c540, 0xfffed820, 0x14008380, 0x8380
    .long 0x16fed820, 0x8380, 0x18ffbe40, 0xfffed820, 0x1a00a460, 0x62a0, 0x1c008380, 0x8380
    .long 0x1d000000, 0xfffed820, 0x0, 0x0, 0x0, 0x0, 0x0, 0xff000000
    .long 0x0, 0x0, 0x0, 0x0, 0x0, 0x0, 0x0, 0x0
    .long 0x0, 0x0, 0x0, 0x0, 0x0, 0x0, 0x0, 0x0
    .long 0x0, 0x0, 0x0, 0x0, 0x0, 0x0, 0x0, 0x0
    .long 0x0, 0x0, 0x0, 0x0, 0x0, 0x0, 0x0, 0x0
    .long 0x876100, 0xe100, 0xffff8000, 0x8015700, 0x9005000, 0x1100, 0x600c540, 0xf460
    .long 0xa008380, 0x8380, 0xefed820, 0x8380, 0x1200c540, 0xfffed820, 0x14008380, 0x8380
    .long 0x16fed820, 0x8380, 0x18ffbe40, 0xfffed820, 0x1a00a460, 0x62a0, 0x1c008380, 0x8380
    .long 0x1d000000, 0xfffed820, 0x0, 0x0, 0x0, 0x0, 0x0, 0xff000000
    .long 0x0, 0x0, 0x0, 0x0, 0x0, 0x0, 0x0, 0x0
    .long 0x0, 0x0, 0x0, 0x0, 0x0, 0x0, 0x0, 0x0
    .long 0x0, 0x0, 0x0, 0x0, 0x0, 0x0, 0x0, 0x0
    .long 0x0, 0x0, 0x0, 0x0, 0x0, 0x0, 0x0, 0x0
    .long 0x7f6100, 0x1f100, 0xffff8000, 0xb01b9a0, 0x9005000, 0x1c00, 0x600c540, 0xf460
    .long 0xa008380, 0x8380, 0xefed820, 0x8380, 0x1200c540, 0xfffed820, 0x14008380, 0x8380
    .long 0x16fed820, 0x8380, 0x18ffbe40, 0xfffed820, 0x1a00a460, 0x62a0, 0x1c008380, 0x8380
    .long 0x1d000000, 0xfffed820, 0x0, 0x0, 0x0, 0x0, 0x0, 0xff000000
    .long 0x0, 0x0, 0x0, 0x0, 0x0, 0x0, 0x0, 0x0
    .long 0x0, 0x0, 0x0, 0x0, 0x0, 0x0, 0x0, 0x0
    .long 0x0, 0x0, 0x0, 0x0, 0x0, 0x0, 0x0, 0x0
    .long 0x0, 0x0, 0x0, 0x0, 0x0, 0x0, 0x0, 0x0
    .long 0x816100, 0x1f100, 0xffff8000, 0xc01da80, 0x9005000, 0x1c00, 0x600c540, 0xf460
    .long 0xa008380, 0x8380, 0xefed820, 0x8380, 0x1200c540, 0xfffed820, 0x14008380, 0x8380
    .long 0x16fed820, 0x8380, 0x18ffbe40, 0xfffed820, 0x1a00a460, 0x62a0, 0x1c008380, 0x8380
    .long 0x1d000000, 0xfffed820, 0x0, 0x0, 0x0, 0x0, 0x0, 0xff000000
    .long 0x0, 0x0, 0x0, 0x0, 0x0, 0x0, 0x0, 0x0
    .long 0x0, 0x0, 0x0, 0x0, 0x0, 0x0, 0x0, 0x0
    .long 0x0, 0x0, 0x0, 0x0, 0x0, 0x0, 0x0, 0x0
    .long 0x0, 0x0, 0x0, 0x0, 0x0, 0x0, 0x0, 0x0
    .long 0x756100, 0x1f100, 0xffff8000, 0x10070e0, 0x9005000, 0x1c00, 0x600c540, 0xf460
    .long 0xa008380, 0x8380, 0xefed820, 0x8380, 0x1200c540, 0xfffed820, 0x14008380, 0x8380
    .long 0x16fed820, 0x8380, 0x18ffbe40, 0xfffed820, 0x1a00a460, 0x62a0, 0x1c008380, 0x8380
    .long 0x1d000000, 0xfffed820, 0x0, 0x0, 0x0, 0x0, 0x0, 0xff000000
    .long 0x0, 0x0, 0x0, 0x0, 0x0, 0x0, 0x0, 0x0
    .long 0x0, 0x0, 0x0, 0x0, 0x0, 0x0, 0x0, 0x0
    .long 0x0, 0x0, 0x0, 0x0, 0x0, 0x0, 0x0, 0x0
    .long 0x0, 0x0, 0x0, 0x0, 0x0, 0x0, 0x0, 0x0
    .long 0x776100, 0x1f100, 0xffff8000, 0x20091c0, 0x9005000, 0x1c00, 0x600c540, 0xf460
    .long 0xa008380, 0x8380, 0xefed820, 0x8380, 0x1200c540, 0xfffed820, 0x14008380, 0x8380
    .long 0x16fed820, 0x8380, 0x18ffbe40, 0xfffed820, 0x1a00a460, 0x62a0, 0x1c008380, 0x8380
    .long 0x1d000000, 0xfffed820, 0x0, 0x0, 0x0, 0x0, 0x0, 0xff000000
    .long 0x0, 0x0, 0x0, 0x0, 0x0, 0x0, 0x0, 0x0
    .long 0x0, 0x0, 0x0, 0x0, 0x0, 0x0, 0x0, 0x0
    .long 0x0, 0x0, 0x0, 0x0, 0x0, 0x0, 0x0, 0x0
    .long 0x0, 0x0, 0x0, 0x0, 0x0, 0x0, 0x0, 0x0
    .long 0x836100, 0x1f100, 0xffff8000, 0xf0091c0, 0x9005000, 0x1000, 0x600c540, 0xf460
    .long 0xa008380, 0x8380, 0xefed820, 0x8380, 0x1200c540, 0xfffed820, 0x14008380, 0x8380
    .long 0x16fed820, 0x8380, 0x18ffbe40, 0xfffed820, 0x1a00a460, 0x62a0, 0x1c008380, 0x8380
    .long 0x1d000000, 0xfffed820, 0x0, 0x0, 0x0, 0x0, 0x0, 0xff000000
    .long 0x0, 0x0, 0x0, 0x0, 0x0, 0x0, 0x0, 0x0
    .long 0x0, 0x0, 0x0, 0x0, 0x0, 0x0, 0x0, 0x0
    .long 0x0, 0x0, 0x0, 0x0, 0x0, 0x0, 0x0, 0x0
    .long 0x0, 0x0, 0x0, 0x0, 0x0, 0x0, 0x0, 0x0
    .long 0x856100, 0x1f100, 0xffff8000, 0x1000b2a0, 0x9005000, 0x1000, 0x600c540, 0xf460
    .long 0xa008380, 0x8380, 0xefed820, 0x8380, 0x1200c540, 0xfffed820, 0x14008380, 0x8380
    .long 0x16fed820, 0x8380, 0x18ffbe40, 0xfffed820, 0x1a00a460, 0x62a0, 0x1c008380, 0x8380
    .long 0x1d000000, 0xfffed820, 0x0, 0x0, 0x0, 0x0, 0x0, 0xff000000
    .long 0x0, 0x0, 0x0, 0x0, 0x0, 0x0, 0x0, 0x0
    .long 0x0, 0x0, 0x0, 0x0, 0x0, 0x0, 0x0, 0x0
    .long 0x0, 0x0, 0x0, 0x0, 0x0, 0x0, 0x0, 0x0
    .long 0x0, 0x0, 0x0, 0x0, 0x0, 0x0, 0x0, 0x0
    .long 0x796100, 0x1f100, 0xffff8000, 0x300b2a0, 0x9005000, 0x1000, 0x600c540, 0xf460
    .long 0xa008380, 0x8380, 0xefed820, 0x8380, 0x1200c540, 0xfffed820, 0x14008380, 0x8380
    .long 0x16fed820, 0x8380, 0x18ffbe40, 0xfffed820, 0x1a00a460, 0x62a0, 0x1c008380, 0x8380
    .long 0x1d000000, 0xfffed820, 0x0, 0x0, 0x0, 0x0, 0x0, 0xff000000
    .long 0x0, 0x0, 0x0, 0x0, 0x0, 0x0, 0x0, 0x0
    .long 0x0, 0x0, 0x0, 0x0, 0x0, 0x0, 0x0, 0x0
    .long 0x0, 0x0, 0x0, 0x0, 0x0, 0x0, 0x0, 0x0
    .long 0x0, 0x0, 0x0, 0x0, 0x0, 0x0, 0x0, 0x0
    .long 0x7b6100, 0x1f100, 0xffff8000, 0x400d380, 0x9005000, 0x1000, 0x600c540, 0xf460
    .long 0xa008380, 0x8380, 0xefed820, 0x8380, 0x1200c540, 0xfffed820, 0x14008380, 0x8380
    .long 0x16fed820, 0x8380, 0x18ffbe40, 0xfffed820, 0x1a00a460, 0x62a0, 0x1c008380, 0x8380
    .long 0x1d000000, 0xfffed820, 0x0, 0x0, 0x0, 0x0, 0x0, 0xff000000
    .long 0x0, 0x0, 0x0, 0x0, 0x0, 0x0, 0x0, 0x0
    .long 0x0, 0x0, 0x0, 0x0, 0x0, 0x0, 0x0, 0x0
    .long 0x0, 0x0, 0x0, 0x0, 0x0, 0x0, 0x0, 0x0
    .long 0x0, 0x0, 0x0, 0x0, 0x0, 0x0, 0x0, 0x0
    .long 0x756100, 0x88500e, 0x776100, 0x488500c, 0x7b6100, 0x888500c, 0x776100, 0xc88500e
    .long 0x876100, 0x1088500c, 0x796100, 0x1488500e, 0x816100, 0x1888500c, 0x27b6104, 0x288500e
    .long 0x2856140, 0x688500c, 0x27d6300, 0xe88500e, 0x27f6101, 0x1688500e, 0x2816110, 0x488500e
    .long 0x28367ff, 0x88500e, 0x48567ff, 0xa88500e, 0x68767ff, 0x1288500e, 0x0, 0x0
    .long 0x0, 0x0, 0x0, 0x0, 0x0, 0x0, 0x0, 0x0
    .long 0x0, 0x0, 0x0, 0x0, 0x0, 0x0, 0x0, 0x0
    .long 0x0, 0x0, 0x0, 0x0, 0x0, 0x0, 0x0, 0x0
    .long 0x0, 0x0, 0x0, 0x0, 0x0, 0x0, 0x0, 0x0
    .long 0x756100, 0x288500c, 0x796100, 0x688500c, 0x756100, 0xa88500d, 0x7d6100, 0xe88500c
    .long 0x776100, 0x1288500d, 0x7f6100, 0x1688500c, 0x796100, 0x1a88500d, 0x2836108, 0x488500c
    .long 0x27b6180, 0x888500d, 0x27d6500, 0x1088500d, 0x27f6102, 0x1888500d, 0x2816120, 0x688500d
    .long 0x48367ff, 0xc88500d, 0x68567ff, 0x1488500d, 0x88767ff, 0x288500d, 0x0, 0x0
    .long 0x0, 0x0, 0x0, 0x0, 0x0, 0x0, 0x0, 0x0
    .long 0x0, 0x0, 0x0, 0x0, 0x0, 0x0, 0x0, 0x0
    .long 0x0, 0x0, 0x0, 0x0, 0x0, 0x0, 0x0, 0x0
    .long 0x0, 0x0, 0x0, 0x0, 0x0, 0x0, 0x0, 0x0
    .long 0x7d6100, 0x1f100, 0xffff8000, 0x7013620, 0x9005000, 0x1000, 0x600c540, 0xf460
    .long 0xa008380, 0x8380, 0xefed820, 0x8380, 0x1200c540, 0xfffed820, 0x14008380, 0x8380
    .long 0x16fed820, 0x8380, 0x18ffbe40, 0xfffed820, 0x1a00a460, 0x62a0, 0x1c008380, 0x8380
    .long 0x1d000000, 0xfffed820, 0x0, 0x0, 0x0, 0x0, 0x0, 0xff000000
    .long 0x0, 0x0, 0x0, 0x0, 0x0, 0x0, 0x0, 0x0
    .long 0x0, 0x0, 0x0, 0x0, 0x0, 0x0, 0x0, 0x0
    .long 0x0, 0x0, 0x0, 0x0, 0x0, 0x0, 0x0, 0x0
    .long 0x0, 0x0, 0x0, 0x0, 0x0, 0x0, 0x0, 0x0
    .long 0x876100, 0xe100, 0xffff8000, 0x8015700, 0x9005000, 0x1100, 0x600c540, 0xf460
    .long 0xa008380, 0x8380, 0xefed820, 0x8380, 0x1200c540, 0xfffed820, 0x14008380, 0x8380
    .long 0x16fed820, 0x8380, 0x18ffbe40, 0xfffed820, 0x1a00a460, 0x62a0, 0x1c008380, 0x8380
    .long 0x1d000000, 0xfffed820, 0x0, 0x0, 0x0, 0x0, 0x0, 0xff000000
    .long 0x0, 0x0, 0x0, 0x0, 0x0, 0x0, 0x0, 0x0
    .long 0x0, 0x0, 0x0, 0x0, 0x0, 0x0, 0x0, 0x0
    .long 0x0, 0x0, 0x0, 0x0, 0x0, 0x0, 0x0, 0x0
    .long 0x0, 0x0, 0x0, 0x0, 0x0, 0x0, 0x0, 0x0
    .long 0x7f6100, 0x1f100, 0xffff8000, 0xb01b9a0, 0x9005000, 0x1c00, 0x600c540, 0xf460
    .long 0xa008380, 0x8380, 0xefed820, 0x8380, 0x1200c540, 0xfffed820, 0x14008380, 0x8380
    .long 0x16fed820, 0x8380, 0x18ffbe40, 0xfffed820, 0x1a00a460, 0x62a0, 0x1c008380, 0x8380
    .long 0x1d000000, 0xfffed820, 0x0, 0x0, 0x0, 0x0, 0x0, 0xff000000
    .long 0x0, 0x0, 0x0, 0x0, 0x0, 0x0, 0x0, 0x0
    .long 0x0, 0x0, 0x0, 0x0, 0x0, 0x0, 0x0, 0x0
    .long 0x0, 0x0, 0x0, 0x0, 0x0, 0x0, 0x0, 0x0
    .long 0x0, 0x0, 0x0, 0x0, 0x0, 0x0, 0x0, 0x0
    .long 0x816100, 0x1f100, 0xffff8000, 0xc01da80, 0x9005000, 0x1c00, 0x600c540, 0xf460
    .long 0xa008380, 0x8380, 0xefed820, 0x8380, 0x1200c540, 0xfffed820, 0x14008380, 0x8380
    .long 0x16fed820, 0x8380, 0x18ffbe40, 0xfffed820, 0x1a00a460, 0x62a0, 0x1c008380, 0x8380
    .long 0x1d000000, 0xfffed820, 0x0, 0x0, 0x0, 0x0, 0x0, 0xff000000
    .long 0x0, 0x0, 0x0, 0x0, 0x0, 0x0, 0x0, 0x0
    .long 0x0, 0x0, 0x0, 0x0, 0x0, 0x0, 0x0, 0x0
    .long 0x0, 0x0, 0x0, 0x0, 0x0, 0x0, 0x0, 0x0
    .long 0x0, 0x0, 0x0, 0x0, 0x0, 0x0, 0x0, 0x0
    .long 0x756100, 0x1f100, 0xffff8000, 0x10070e0, 0x9005000, 0x1c00, 0x600c540, 0xf460
    .long 0xa008380, 0x8380, 0xefed820, 0x8380, 0x1200c540, 0xfffed820, 0x14008380, 0x8380
    .long 0x16fed820, 0x8380, 0x18ffbe40, 0xfffed820, 0x1a00a460, 0x62a0, 0x1c008380, 0x8380
    .long 0x1d000000, 0xfffed820, 0x0, 0x0, 0x0, 0x0, 0x0, 0xff000000
    .long 0x0, 0x0, 0x0, 0x0, 0x0, 0x0, 0x0, 0x0
    .long 0x0, 0x0, 0x0, 0x0, 0x0, 0x0, 0x0, 0x0
    .long 0x0, 0x0, 0x0, 0x0, 0x0, 0x0, 0x0, 0x0
    .long 0x0, 0x0, 0x0, 0x0, 0x0, 0x0, 0x0, 0x0
    .long 0x776100, 0x1f100, 0xffff8000, 0x20091c0, 0x9005000, 0x1c00, 0x600c540, 0xf460
    .long 0xa008380, 0x8380, 0xefed820, 0x8380, 0x1200c540, 0xfffed820, 0x14008380, 0x8380
    .long 0x16fed820, 0x8380, 0x18ffbe40, 0xfffed820, 0x1a00a460, 0x62a0, 0x1c008380, 0x8380
    .long 0x1d000000, 0xfffed820, 0x0, 0x0, 0x0, 0x0, 0x0, 0xff000000
    .long 0x0, 0x0, 0x0, 0x0, 0x0, 0x0, 0x0, 0x0
    .long 0x0, 0x0, 0x0, 0x0, 0x0, 0x0, 0x0, 0x0
    .long 0x0, 0x0, 0x0, 0x0, 0x0, 0x0, 0x0, 0x0
    .long 0x0, 0x0, 0x0, 0x0, 0x0, 0x0, 0x0, 0x0
    .long 0x836100, 0x1f100, 0xffff8000, 0xf0091c0, 0x9005000, 0x1000, 0x600c540, 0xf460
    .long 0xa008380, 0x8380, 0xefed820, 0x8380, 0x1200c540, 0xfffed820, 0x14008380, 0x8380
    .long 0x16fed820, 0x8380, 0x18ffbe40, 0xfffed820, 0x1a00a460, 0x62a0, 0x1c008380, 0x8380
    .long 0x1d000000, 0xfffed820, 0x0, 0x0, 0x0, 0x0, 0x0, 0xff000000
    .long 0x0, 0x0, 0x0, 0x0, 0x0, 0x0, 0x0, 0x0
    .long 0x0, 0x0, 0x0, 0x0, 0x0, 0x0, 0x0, 0x0
    .long 0x0, 0x0, 0x0, 0x0, 0x0, 0x0, 0x0, 0x0
    .long 0x0, 0x0, 0x0, 0x0, 0x0, 0x0, 0x0, 0x0
    .long 0x856100, 0x1f100, 0xffff8000, 0x1000b2a0, 0x9005000, 0x1000, 0x600c540, 0xf460
    .long 0xa008380, 0x8380, 0xefed820, 0x8380, 0x1200c540, 0xfffed820, 0x14008380, 0x8380
    .long 0x16fed820, 0x8380, 0x18ffbe40, 0xfffed820, 0x1a00a460, 0x62a0, 0x1c008380, 0x8380
    .long 0x1d000000, 0xfffed820, 0x0, 0x0, 0x0, 0x0, 0x0, 0xff000000
    .long 0x0, 0x0, 0x0, 0x0, 0x0, 0x0, 0x0, 0x0
    .long 0x0, 0x0, 0x0, 0x0, 0x0, 0x0, 0x0, 0x0
    .long 0x0, 0x0, 0x0, 0x0, 0x0, 0x0, 0x0, 0x0
    .long 0x0, 0x0, 0x0, 0x0, 0x0, 0x0, 0x0, 0x0
    .long 0x796100, 0x1f100, 0xffff8000, 0x300b2a0, 0x9005000, 0x1000, 0x600c540, 0xf460
    .long 0xa008380, 0x8380, 0xefed820, 0x8380, 0x1200c540, 0xfffed820, 0x14008380, 0x8380
    .long 0x16fed820, 0x8380, 0x18ffbe40, 0xfffed820, 0x1a00a460, 0x62a0, 0x1c008380, 0x8380
    .long 0x1d000000, 0xfffed820, 0x0, 0x0, 0x0, 0x0, 0x0, 0xff000000
    .long 0x0, 0x0, 0x0, 0x0, 0x0, 0x0, 0x0, 0x0
    .long 0x0, 0x0, 0x0, 0x0, 0x0, 0x0, 0x0, 0x0
    .long 0x0, 0x0, 0x0, 0x0, 0x0, 0x0, 0x0, 0x0
    .long 0x0, 0x0, 0x0, 0x0, 0x0, 0x0, 0x0, 0x0
    .long 0x7b6100, 0x1f100, 0xffff8000, 0x400d380, 0x9005000, 0x1000, 0x600c540, 0xf460
    .long 0xa008380, 0x8380, 0xefed820, 0x8380, 0x1200c540, 0xfffed820, 0x14008380, 0x8380
    .long 0x16fed820, 0x8380, 0x18ffbe40, 0xfffed820, 0x1a00a460, 0x62a0, 0x1c008380, 0x8380
    .long 0x1d000000, 0xfffed820, 0x0, 0x0, 0x0, 0x0, 0x0, 0xff000000
    .long 0x0, 0x0, 0x0, 0x0, 0x0, 0x0, 0x0, 0x0
    .long 0x0, 0x0, 0x0, 0x0, 0x0, 0x0, 0x0, 0x0
    .long 0x0, 0x0, 0x0, 0x0, 0x0, 0x0, 0x0, 0x0
    .long 0x0, 0x0, 0x0, 0x0, 0x0, 0x0, 0x0, 0x0
    .long 0xee3100, 0x104900e, 0xf03100, 0x504900c, 0xf43100, 0x904900c, 0xf03100, 0xd04900e
    .long 0xf23100, 0x1104900e, 0xf83100, 0x1504900c, 0x2fc3101, 0x304900c, 0x2f43104, 0x704900e
    .long 0x2f63110, 0x1304900e, 0x2f83140, 0x1704900e, 0x2fa31ff, 0x104900e, 0x4fc31ff, 0xd04900e
    .long 0x6fe31ff, 0x1104900e, 0x90031ff, 0x704900e, 0xb0231ff, 0x904900e, 0xd0431ff, 0x1704900e
    .long 0x0, 0x0, 0x0, 0x0, 0x0, 0x0, 0x0, 0x0
    .long 0x0, 0x0, 0x0, 0x0, 0x0, 0x0, 0x0, 0x0
    .long 0x0, 0x0, 0x0, 0x0, 0x0, 0x0, 0x0, 0x0
    .long 0x0, 0x0, 0x0, 0x0, 0x0, 0x0, 0x0, 0x0
    .long 0xee3100, 0x304900c, 0xf23100, 0x704900c, 0xee3100, 0xb04900d, 0xf03100, 0xf04900d
    .long 0xf63100, 0x1304900c, 0xfa3100, 0x1704900c, 0x2f23102, 0x504900d, 0x2f43108, 0x904900d
    .long 0x2f63120, 0x1504900d, 0x2f83180, 0x304900d, 0x4fa31ff, 0xb04900d, 0x6fc31ff, 0xf04900d
    .long 0x8fe31ff, 0x504900d, 0xb0031ff, 0x1304900d, 0xd0231ff, 0x1504900d, 0xf0431ff, 0x104900d
    .long 0x0, 0x0, 0x0, 0x0, 0x0, 0x0, 0x0, 0x0
    .long 0x0, 0x0, 0x0, 0x0, 0x0, 0x0, 0x0, 0x0
    .long 0x0, 0x0, 0x0, 0x0, 0x0, 0x0, 0x0, 0x0
    .long 0x0, 0x0, 0x0, 0x0, 0x0, 0x0, 0x0, 0x0
    .long 0x0, 0x0, 0x0, 0x0, 0x0, 0xff000000, 0x0, 0x0
    .long 0x0, 0x0, 0x0, 0x0, 0x0, 0x0, 0x0, 0x0
    .long 0x0, 0x0, 0x0, 0x0, 0x0, 0x0, 0x0, 0x0
    .long 0x0, 0x0, 0x0, 0x0, 0x0, 0x0, 0x0, 0x0
    .long 0x0, 0x0, 0x0, 0x0, 0x0, 0x0, 0x0, 0x0
    .long 0x0, 0x0, 0x0, 0x0, 0x0, 0x0, 0x0, 0x0
    .long 0x0, 0x0, 0x0, 0x0, 0x0, 0x0, 0x0, 0x0
    .long 0x0, 0x0, 0x0, 0x0, 0x0, 0x0, 0x0, 0x0
    .long 0x0, 0x0, 0x0, 0x0, 0x0, 0xff000000, 0x0, 0x0
    .long 0x0, 0x0, 0x0, 0x0, 0x0, 0x0, 0x0, 0x0
    .long 0x0, 0x0, 0x0, 0x0, 0x0, 0x0, 0x0, 0x0
    .long 0x0, 0x0, 0x0, 0x0, 0x0, 0x0, 0x0, 0x0
    .long 0x0, 0x0, 0x0, 0x0, 0x0, 0x0, 0x0, 0x0
    .long 0x0, 0x0, 0x0, 0x0, 0x0, 0x0, 0x0, 0x0
    .long 0x0, 0x0, 0x0, 0x0, 0x0, 0x0, 0x0, 0x0
    .long 0x0, 0x0, 0x0, 0x0, 0x0, 0x0, 0x0, 0x0
    .long 0xee3100, 0x1f100, 0xffffffc0, 0x10070e0, 0xb005000, 0x1c00, 0x600c540, 0xf460
    .long 0x80041c0, 0x41c0, 0xeff5ba0, 0xffff5ba0, 0x1000c540, 0x41c0, 0x120041c0, 0xc540
    .long 0x14fe9660, 0xfffed820, 0x1600c540, 0x8380, 0x180041c0, 0x41c0, 0x1aff5ba0, 0xffff5ba0
    .long 0x1c0020e0, 0xe620, 0x1e00e620, 0x20e0, 0x1f000000, 0xfffeb740, 0x0, 0x0
    .long 0x0, 0x0, 0x0, 0xff000000, 0x0, 0x0, 0x0, 0x0
    .long 0x0, 0x0, 0x0, 0x0, 0x0, 0x0, 0x0, 0x0
    .long 0x0, 0x0, 0x0, 0x0, 0x0, 0x0, 0x0, 0x0
    .long 0x0, 0x0, 0x0, 0x0, 0x0, 0x0, 0x0, 0x0
    .long 0xf03100, 0x1f100, 0xffffffc0, 0x20091c0, 0xb005000, 0x1c00, 0x600c540, 0xf460
    .long 0x80041c0, 0x41c0, 0xeff5ba0, 0xffff5ba0, 0x1000c540, 0x41c0, 0x120041c0, 0xc540
    .long 0x14fe9660, 0xfffed820, 0x1600c540, 0x8380, 0x180041c0, 0x41c0, 0x1aff5ba0, 0xffff5ba0
    .long 0x1c0020e0, 0xe620, 0x1e00e620, 0x20e0, 0x1f000000, 0xfffeb740, 0x0, 0x0
    .long 0x0, 0x0, 0x0, 0xff000000, 0x0, 0x0, 0x0, 0x0
    .long 0x0, 0x0, 0x0, 0x0, 0x0, 0x0, 0x0, 0x0
    .long 0x0, 0x0, 0x0, 0x0, 0x0, 0x0, 0x0, 0x0
    .long 0x0, 0x0, 0x0, 0x0, 0x0, 0x0, 0x0, 0x0
    .long 0xf23100, 0x1f100, 0xffffffc0, 0x300b2a0, 0xb005000, 0x1c00, 0x600c540, 0xf460
    .long 0x80041c0, 0x41c0, 0xeff5ba0, 0xffff5ba0, 0x1000c540, 0x41c0, 0x120041c0, 0xc540
    .long 0x14fe9660, 0xfffed820, 0x1600c540, 0x8380, 0x180041c0, 0x41c0, 0x1aff5ba0, 0xffff5ba0
    .long 0x1c0020e0, 0xe620, 0x1e00e620, 0x20e0, 0x1f000000, 0xfffeb740, 0x0, 0x0
    .long 0x0, 0x0, 0x0, 0xff000000, 0x0, 0x0, 0x0, 0x0
    .long 0x0, 0x0, 0x0, 0x0, 0x0, 0x0, 0x0, 0x0
    .long 0x0, 0x0, 0x0, 0x0, 0x0, 0x0, 0x0, 0x0
    .long 0x0, 0x0, 0x0, 0x0, 0x0, 0x0, 0x0, 0x0
    .long 0xf43100, 0x1f100, 0xffffffc0, 0x400d380, 0xb005000, 0x1c00, 0x600c540, 0xf460
    .long 0x80041c0, 0x41c0, 0xeff5ba0, 0xffff5ba0, 0x1000c540, 0x41c0, 0x120041c0, 0xc540
    .long 0x14fe9660, 0xfffed820, 0x1600c540, 0x8380, 0x180041c0, 0x41c0, 0x1aff5ba0, 0xffff5ba0
    .long 0x1c0020e0, 0xe620, 0x1e00e620, 0x20e0, 0x1f000000, 0xfffeb740, 0x0, 0x0
    .long 0x0, 0x0, 0x0, 0xff000000, 0x0, 0x0, 0x0, 0x0
    .long 0x0, 0x0, 0x0, 0x0, 0x0, 0x0, 0x0, 0x0
    .long 0x0, 0x0, 0x0, 0x0, 0x0, 0x0, 0x0, 0x0
    .long 0x0, 0x0, 0x0, 0x0, 0x0, 0x0, 0x0, 0x0
    .long 0xf63100, 0x1f100, 0xffffffc0, 0x90177e0, 0xb005000, 0x1000, 0x600c540, 0xf460
    .long 0x80041c0, 0x41c0, 0xeff5ba0, 0xffff5ba0, 0x1000c540, 0x41c0, 0x120041c0, 0xc540
    .long 0x14fe9660, 0xfffed820, 0x1600c540, 0x8380, 0x180041c0, 0x41c0, 0x1aff5ba0, 0xffff5ba0
    .long 0x1c0020e0, 0xe620, 0x1e00e620, 0x20e0, 0x1f000000, 0xfffeb740, 0x0, 0x0
    .long 0x0, 0x0, 0x0, 0xff000000, 0x0, 0x0, 0x0, 0x0
    .long 0x0, 0x0, 0x0, 0x0, 0x0, 0x0, 0x0, 0x0
    .long 0x0, 0x0, 0x0, 0x0, 0x0, 0x0, 0x0, 0x0
    .long 0x0, 0x0, 0x0, 0x0, 0x0, 0x0, 0x0, 0x0
    .long 0xf83100, 0x1f100, 0xffffffc0, 0xa0198c0, 0xb005000, 0x1000, 0x600c540, 0xf460
    .long 0x80041c0, 0x41c0, 0xeff5ba0, 0xffff5ba0, 0x1000c540, 0x41c0, 0x120041c0, 0xc540
    .long 0x14fe9660, 0xfffed820, 0x1600c540, 0x8380, 0x180041c0, 0x41c0, 0x1aff5ba0, 0xffff5ba0
    .long 0x1c0020e0, 0xe620, 0x1e00e620, 0x20e0, 0x1f000000, 0xfffeb740, 0x0, 0x0
    .long 0x0, 0x0, 0x0, 0xff000000, 0x0, 0x0, 0x0, 0x0
    .long 0x0, 0x0, 0x0, 0x0, 0x0, 0x0, 0x0, 0x0
    .long 0x0, 0x0, 0x0, 0x0, 0x0, 0x0, 0x0, 0x0
    .long 0x0, 0x0, 0x0, 0x0, 0x0, 0x0, 0x0, 0x0
    .long 0xfa3100, 0x1f100, 0xffffffc0, 0xb01b9a0, 0xb005000, 0x1000, 0x600c540, 0xf460
    .long 0x80041c0, 0x41c0, 0xeff5ba0, 0xffff5ba0, 0x1000c540, 0x41c0, 0x120041c0, 0xc540
    .long 0x14fe9660, 0xfffed820, 0x1600c540, 0x8380, 0x180041c0, 0x41c0, 0x1aff5ba0, 0xffff5ba0
    .long 0x1c0020e0, 0xe620, 0x1e00e620, 0x20e0, 0x1f000000, 0xfffeb740, 0x0, 0x0
    .long 0x0, 0x0, 0x0, 0xff000000, 0x0, 0x0, 0x0, 0x0
    .long 0x0, 0x0, 0x0, 0x0, 0x0, 0x0, 0x0, 0x0
    .long 0x0, 0x0, 0x0, 0x0, 0x0, 0x0, 0x0, 0x0
    .long 0x0, 0x0, 0x0, 0x0, 0x0, 0x0, 0x0, 0x0
    .long 0xfc3100, 0x1f100, 0xffffffc0, 0xc0070e0, 0xb005000, 0x1000, 0x600c540, 0xf460
    .long 0x80041c0, 0x41c0, 0xeff5ba0, 0xffff5ba0, 0x1000c540, 0x41c0, 0x120041c0, 0xc540
    .long 0x14fe9660, 0xfffed820, 0x1600c540, 0x8380, 0x180041c0, 0x41c0, 0x1aff5ba0, 0xffff5ba0
    .long 0x1c0020e0, 0xe620, 0x1e00e620, 0x20e0, 0x1f000000, 0xfffeb740, 0x0, 0x0
    .long 0x0, 0x0, 0x0, 0xff000000, 0x0, 0x0, 0x0, 0x0
    .long 0x0, 0x0, 0x0, 0x0, 0x0, 0x0, 0x0, 0x0
    .long 0x0, 0x0, 0x0, 0x0, 0x0, 0x0, 0x0, 0x0
    .long 0x0, 0x0, 0x0, 0x0, 0x0, 0x0, 0x0, 0x0
    .long 0xee3100, 0x104900e, 0xf03100, 0x504900c, 0xf43100, 0x904900c, 0xf03100, 0xd04900e
    .long 0xf83100, 0x1104900c, 0xfc3100, 0x1504900c, 0x2f23101, 0x304900e, 0x2f43104, 0x704900e
    .long 0x2f63110, 0xf04900e, 0x2f83140, 0x1304900e, 0x2fa3180, 0x1504900e, 0x4fc31ff, 0xb04900e
    .long 0x6fe31ff, 0x304900e, 0x90031ff, 0x704900e, 0xb0231ff, 0x904900e, 0xd0431ff, 0x1104900e
    .long 0x0, 0x0, 0x0, 0x0, 0x0, 0x0, 0x0, 0x0
    .long 0x0, 0x0, 0x0, 0x0, 0x0, 0x0, 0x0, 0x0
    .long 0x0, 0x0, 0x0, 0x0, 0x0, 0x0, 0x0, 0x0
    .long 0x0, 0x0, 0x0, 0x0, 0x0, 0x0, 0x0, 0x0
    .long 0xee3100, 0x304900c, 0xf23100, 0x704900c, 0xee3100, 0xb04900d, 0xf63100, 0xf04900c
    .long 0xfa3100, 0x1304900c, 0xf03100, 0x1704900d, 0x2f23102, 0x504900d, 0x2f43108, 0x904900d
    .long 0x2f63120, 0x1104900d, 0x2f831ff, 0x104900d, 0x4fa31ff, 0xd04900d, 0x6fc31ff, 0x1704900d
    .long 0x8fe31ff, 0x504900d, 0xb0031ff, 0xf04900d, 0xd0231ff, 0x1304900d, 0xf0431ff, 0x104900d
    .long 0x0, 0x0, 0x0, 0x0, 0x0, 0x0, 0x0, 0x0
    .long 0x0, 0x0, 0x0, 0x0, 0x0, 0x0, 0x0, 0x0
    .long 0x0, 0x0, 0x0, 0x0, 0x0, 0x0, 0x0, 0x0
    .long 0x0, 0x0, 0x0, 0x0, 0x0, 0x0, 0x0, 0x0
    .long 0x0, 0x0, 0x0, 0x0, 0x0, 0xff000000, 0x0, 0x0
    .long 0x0, 0x0, 0x0, 0x0, 0x0, 0x0, 0x0, 0x0
    .long 0x0, 0x0, 0x0, 0x0, 0x0, 0x0, 0x0, 0x0
    .long 0x0, 0x0, 0x0, 0x0, 0x0, 0x0, 0x0, 0x0
    .long 0x0, 0x0, 0x0, 0x0, 0x0, 0x0, 0x0, 0x0
    .long 0x0, 0x0, 0x0, 0x0, 0x0, 0x0, 0x0, 0x0
    .long 0x0, 0x0, 0x0, 0x0, 0x0, 0x0, 0x0, 0x0
    .long 0x0, 0x0, 0x0, 0x0, 0x0, 0x0, 0x0, 0x0
    .long 0x0, 0x0, 0x0, 0x0, 0x0, 0xff000000, 0x0, 0x0
    .long 0x0, 0x0, 0x0, 0x0, 0x0, 0x0, 0x0, 0x0
    .long 0x0, 0x0, 0x0, 0x0, 0x0, 0x0, 0x0, 0x0
    .long 0x0, 0x0, 0x0, 0x0, 0x0, 0x0, 0x0, 0x0
    .long 0x0, 0x0, 0x0, 0x0, 0x0, 0x0, 0x0, 0x0
    .long 0x0, 0x0, 0x0, 0x0, 0x0, 0x0, 0x0, 0x0
    .long 0x0, 0x0, 0x0, 0x0, 0x0, 0x0, 0x0, 0x0
    .long 0x0, 0x0, 0x0, 0x0, 0x0, 0x0, 0x0, 0x0
    .long 0xee3100, 0x1f100, 0xffffffc0, 0x10070e0, 0xb005000, 0x1c00, 0x600c540, 0xf460
    .long 0xcff5ba0, 0xc540, 0xe0041c0, 0xfffed820, 0x10008380, 0x41c0, 0x120041c0, 0x8380
    .long 0x140020e0, 0xfffef900, 0x16ff5ba0, 0xc540, 0x18ff7c80, 0xa460, 0x1a0041c0, 0xfffed820
    .long 0x1c0020e0, 0xa460, 0x1e008380, 0x41c0, 0x1f000000, 0xfffed820, 0x0, 0x0
    .long 0x0, 0x0, 0x0, 0xff000000, 0x0, 0x0, 0x0, 0x0
    .long 0x0, 0x0, 0x0, 0x0, 0x0, 0x0, 0x0, 0x0
    .long 0x0, 0x0, 0x0, 0x0, 0x0, 0x0, 0x0, 0x0
    .long 0x0, 0x0, 0x0, 0x0, 0x0, 0x0, 0x0, 0x0
    .long 0xf03100, 0x1f100, 0xffffffc0, 0x20091c0, 0xb005000, 0x1c00, 0x600c540, 0xf460
    .long 0xcff5ba0, 0xc540, 0xe0041c0, 0xfffed820, 0x10008380, 0x41c0, 0x120041c0, 0x8380
    .long 0x140020e0, 0xfffef900, 0x16ff5ba0, 0xc540, 0x18ff7c80, 0xa460, 0x1a0041c0, 0xfffed820
    .long 0x1c0020e0, 0xa460, 0x1e008380, 0x41c0, 0x1f000000, 0xfffed820, 0x0, 0x0
    .long 0x0, 0x0, 0x0, 0xff000000, 0x0, 0x0, 0x0, 0x0
    .long 0x0, 0x0, 0x0, 0x0, 0x0, 0x0, 0x0, 0x0
    .long 0x0, 0x0, 0x0, 0x0, 0x0, 0x0, 0x0, 0x0
    .long 0x0, 0x0, 0x0, 0x0, 0x0, 0x0, 0x0, 0x0
    .long 0xf23100, 0x1f100, 0xffffffc0, 0x300b2a0, 0xb005000, 0x1c00, 0x600c540, 0xf460
    .long 0xcff5ba0, 0xc540, 0xe0041c0, 0xfffed820, 0x10008380, 0x41c0, 0x120041c0, 0x8380
    .long 0x140020e0, 0xfffef900, 0x16ff5ba0, 0xc540, 0x18ff7c80, 0xa460, 0x1a0041c0, 0xfffed820
    .long 0x1c0020e0, 0xa460, 0x1e008380, 0x41c0, 0x1f000000, 0xfffed820, 0x0, 0x0
    .long 0x0, 0x0, 0x0, 0xff000000, 0x0, 0x0, 0x0, 0x0
    .long 0x0, 0x0, 0x0, 0x0, 0x0, 0x0, 0x0, 0x0
    .long 0x0, 0x0, 0x0, 0x0, 0x0, 0x0, 0x0, 0x0
    .long 0x0, 0x0, 0x0, 0x0, 0x0, 0x0, 0x0, 0x0
    .long 0xf43100, 0x1f100, 0xffffffc0, 0x400d380, 0xb005000, 0x1c00, 0x600c540, 0xf460
    .long 0xcff5ba0, 0xc540, 0xe0041c0, 0xfffed820, 0x10008380, 0x41c0, 0x120041c0, 0x8380
    .long 0x140020e0, 0xfffef900, 0x16ff5ba0, 0xc540, 0x18ff7c80, 0xa460, 0x1a0041c0, 0xfffed820
    .long 0x1c0020e0, 0xa460, 0x1e008380, 0x41c0, 0x1f000000, 0xfffed820, 0x0, 0x0
    .long 0x0, 0x0, 0x0, 0xff000000, 0x0, 0x0, 0x0, 0x0
    .long 0x0, 0x0, 0x0, 0x0, 0x0, 0x0, 0x0, 0x0
    .long 0x0, 0x0, 0x0, 0x0, 0x0, 0x0, 0x0, 0x0
    .long 0x0, 0x0, 0x0, 0x0, 0x0, 0x0, 0x0, 0x0
    .long 0xf63100, 0x1f100, 0xffffffc0, 0x7013620, 0xb005000, 0x1000, 0x600c540, 0xf460
    .long 0xcff5ba0, 0xc540, 0xe0041c0, 0xfffed820, 0x10008380, 0x41c0, 0x120041c0, 0x8380
    .long 0x140020e0, 0xfffef900, 0x16ff5ba0, 0xc540, 0x18ff7c80, 0xa460, 0x1a0041c0, 0xfffed820
    .long 0x1c0020e0, 0xa460, 0x1e008380, 0x41c0, 0x1f000000, 0xfffed820, 0x0, 0x0
    .long 0x0, 0x0, 0x0, 0xff000000, 0x0, 0x0, 0x0, 0x0
    .long 0x0, 0x0, 0x0, 0x0, 0x0, 0x0, 0x0, 0x0
    .long 0x0, 0x0, 0x0, 0x0, 0x0, 0x0, 0x0, 0x0
    .long 0x0, 0x0, 0x0, 0x0, 0x0, 0x0, 0x0, 0x0
    .long 0xf83100, 0x1f100, 0xffffffc0, 0x8015700, 0xb005000, 0x1000, 0x600c540, 0xf460
    .long 0xcff5ba0, 0xc540, 0xe0041c0, 0xfffed820, 0x10008380, 0x41c0, 0x120041c0, 0x8380
    .long 0x140020e0, 0xfffef900, 0x16ff5ba0, 0xc540, 0x18ff7c80, 0xa460, 0x1a0041c0, 0xfffed820
    .long 0x1c0020e0, 0xa460, 0x1e008380, 0x41c0, 0x1f000000, 0xfffed820, 0x0, 0x0
    .long 0x0, 0x0, 0x0, 0xff000000, 0x0, 0x0, 0x0, 0x0
    .long 0x0, 0x0, 0x0, 0x0, 0x0, 0x0, 0x0, 0x0
    .long 0x0, 0x0, 0x0, 0x0, 0x0, 0x0, 0x0, 0x0
    .long 0x0, 0x0, 0x0, 0x0, 0x0, 0x0, 0x0, 0x0
    .long 0xfa3100, 0x1f100, 0xffffffc0, 0x90177e0, 0xb005000, 0x1000, 0x600c540, 0xf460
    .long 0xcff5ba0, 0xc540, 0xe0041c0, 0xfffed820, 0x10008380, 0x41c0, 0x120041c0, 0x8380
    .long 0x140020e0, 0xfffef900, 0x16ff5ba0, 0xc540, 0x18ff7c80, 0xa460, 0x1a0041c0, 0xfffed820
    .long 0x1c0020e0, 0xa460, 0x1e008380, 0x41c0, 0x1f000000, 0xfffed820, 0x0, 0x0
    .long 0x0, 0x0, 0x0, 0xff000000, 0x0, 0x0, 0x0, 0x0
    .long 0x0, 0x0, 0x0, 0x0, 0x0, 0x0, 0x0, 0x0
    .long 0x0, 0x0, 0x0, 0x0, 0x0, 0x0, 0x0, 0x0
    .long 0x0, 0x0, 0x0, 0x0, 0x0, 0x0, 0x0, 0x0
    .long 0xfc3100, 0x1f100, 0xffffffc0, 0xa0198c0, 0xb005000, 0x1000, 0x600c540, 0xf460
    .long 0xcff5ba0, 0xc540, 0xe0041c0, 0xfffed820, 0x10008380, 0x41c0, 0x120041c0, 0x8380
    .long 0x140020e0, 0xfffef900, 0x16ff5ba0, 0xc540, 0x18ff7c80, 0xa460, 0x1a0041c0, 0xfffed820
    .long 0x1c0020e0, 0xa460, 0x1e008380, 0x41c0, 0x1f000000, 0xfffed820, 0x0, 0x0
    .long 0x0, 0x0, 0x0, 0xff000000, 0x0, 0x0, 0x0, 0x0
    .long 0x0, 0x0, 0x0, 0x0, 0x0, 0x0, 0x0, 0x0
    .long 0x0, 0x0, 0x0, 0x0, 0x0, 0x0, 0x0, 0x0
    .long 0x0, 0x0, 0x0, 0x0, 0x0, 0x0, 0x0, 0x0
    .long 0x756000, 0x88500e, 0x776000, 0x488500c, 0x7b6000, 0x888500c, 0x776000, 0xc88500e
    .long 0x876000, 0x1088500c, 0x796000, 0x1488500e, 0x816000, 0x1888500c, 0x27b6004, 0x288500e
    .long 0x2856040, 0x688500c, 0x27d6200, 0xe88500e, 0x27f6001, 0x1688500e, 0x2816010, 0x488500e
    .long 0x28366ff, 0x88500e, 0x48566ff, 0xa88500e, 0x68766ff, 0x1288500e, 0x0, 0x0
    .long 0x0, 0x0, 0x0, 0x0, 0x0, 0x0, 0x0, 0x0
    .long 0x0, 0x0, 0x0, 0x0, 0x0, 0x0, 0x0, 0x0
    .long 0x0, 0x0, 0x0, 0x0, 0x0, 0x0, 0x0, 0x0
    .long 0x0, 0x0, 0x0, 0x0, 0x0, 0x0, 0x0, 0x0
    .long 0x756000, 0x288500c, 0x796000, 0x688500c, 0x756000, 0xa88500d, 0x7d6000, 0xe88500c
    .long 0x776000, 0x1288500d, 0x7f6000, 0x1688500c, 0x796000, 0x1a88500d, 0x2836008, 0x488500c
    .long 0x27b6080, 0x888500d, 0x27d6400, 0x1088500d, 0x27f6002, 0x1888500d, 0x2816020, 0x688500d
    .long 0x48366ff, 0xc88500d, 0x68566ff, 0x1488500d, 0x88766ff, 0x288500d, 0x0, 0x0
    .long 0x0, 0x0, 0x0, 0x0, 0x0, 0x0, 0x0, 0x0
    .long 0x0, 0x0, 0x0, 0x0, 0x0, 0x0, 0x0, 0x0
    .long 0x0, 0x0, 0x0, 0x0, 0x0, 0x0, 0x0, 0x0
    .long 0x0, 0x0, 0x0, 0x0, 0x0, 0x0, 0x0, 0x0
    .long 0x7d6000, 0x1f100, 0xffff8000, 0x7013620, 0x9005000, 0x1000, 0x600c540, 0xf460
    .long 0xa008380, 0x8380, 0xefed820, 0x8380, 0x1200c540, 0xfffed820, 0x14008380, 0x8380
    .long 0x16fed820, 0x8380, 0x18ffbe40, 0xfffed820, 0x1a00a460, 0x62a0, 0x1c008380, 0x8380
    .long 0x1d000000, 0xfffed820, 0x0, 0x0, 0x0, 0x0, 0x0, 0xff000000
    .long 0x0, 0x0, 0x0, 0x0, 0x0, 0x0, 0x0, 0x0
    .long 0x0, 0x0, 0x0, 0x0, 0x0, 0x0, 0x0, 0x0
    .long 0x0, 0x0, 0x0, 0x0, 0x0, 0x0, 0x0, 0x0
    .long 0x0, 0x0, 0x0, 0x0, 0x0, 0x0, 0x0, 0x0
    .long 0x876000, 0xe100, 0xffff8000, 0x8015700, 0x9005000, 0x1100, 0x600c540, 0xf460
    .long 0xa008380, 0x8380, 0xefed820, 0x8380, 0x1200c540, 0xfffed820, 0x14008380, 0x8380
    .long 0x16fed820, 0x8380, 0x18ffbe40, 0xfffed820, 0x1a00a460, 0x62a0, 0x1c008380, 0x8380
    .long 0x1d000000, 0xfffed820, 0x0, 0x0, 0x0, 0x0, 0x0, 0xff000000
    .long 0x0, 0x0, 0x0, 0x0, 0x0, 0x0, 0x0, 0x0
    .long 0x0, 0x0, 0x0, 0x0, 0x0, 0x0, 0x0, 0x0
    .long 0x0, 0x0, 0x0, 0x0, 0x0, 0x0, 0x0, 0x0
    .long 0x0, 0x0, 0x0, 0x0, 0x0, 0x0, 0x0, 0x0
    .long 0x7f6000, 0x1f100, 0xffff8000, 0xb01b9a0, 0x9005000, 0x1c00, 0x600c540, 0xf460
    .long 0xa008380, 0x8380, 0xefed820, 0x8380, 0x1200c540, 0xfffed820, 0x14008380, 0x8380
    .long 0x16fed820, 0x8380, 0x18ffbe40, 0xfffed820, 0x1a00a460, 0x62a0, 0x1c008380, 0x8380
    .long 0x1d000000, 0xfffed820, 0x0, 0x0, 0x0, 0x0, 0x0, 0xff000000
    .long 0x0, 0x0, 0x0, 0x0, 0x0, 0x0, 0x0, 0x0
    .long 0x0, 0x0, 0x0, 0x0, 0x0, 0x0, 0x0, 0x0
    .long 0x0, 0x0, 0x0, 0x0, 0x0, 0x0, 0x0, 0x0
    .long 0x0, 0x0, 0x0, 0x0, 0x0, 0x0, 0x0, 0x0
    .long 0x816000, 0x1f100, 0xffff8000, 0xc01da80, 0x9005000, 0x1c00, 0x600c540, 0xf460
    .long 0xa008380, 0x8380, 0xefed820, 0x8380, 0x1200c540, 0xfffed820, 0x14008380, 0x8380
    .long 0x16fed820, 0x8380, 0x18ffbe40, 0xfffed820, 0x1a00a460, 0x62a0, 0x1c008380, 0x8380
    .long 0x1d000000, 0xfffed820, 0x0, 0x0, 0x0, 0x0, 0x0, 0xff000000
    .long 0x0, 0x0, 0x0, 0x0, 0x0, 0x0, 0x0, 0x0
    .long 0x0, 0x0, 0x0, 0x0, 0x0, 0x0, 0x0, 0x0
    .long 0x0, 0x0, 0x0, 0x0, 0x0, 0x0, 0x0, 0x0
    .long 0x0, 0x0, 0x0, 0x0, 0x0, 0x0, 0x0, 0x0
    .long 0x756000, 0x1f100, 0xffff8000, 0x10070e0, 0x9005000, 0x1c00, 0x600c540, 0xf460
    .long 0xa008380, 0x8380, 0xefed820, 0x8380, 0x1200c540, 0xfffed820, 0x14008380, 0x8380
    .long 0x16fed820, 0x8380, 0x18ffbe40, 0xfffed820, 0x1a00a460, 0x62a0, 0x1c008380, 0x8380
    .long 0x1d000000, 0xfffed820, 0x0, 0x0, 0x0, 0x0, 0x0, 0xff000000
    .long 0x0, 0x0, 0x0, 0x0, 0x0, 0x0, 0x0, 0x0
    .long 0x0, 0x0, 0x0, 0x0, 0x0, 0x0, 0x0, 0x0
    .long 0x0, 0x0, 0x0, 0x0, 0x0, 0x0, 0x0, 0x0
    .long 0x0, 0x0, 0x0, 0x0, 0x0, 0x0, 0x0, 0x0
    .long 0x776000, 0x1f100, 0xffff8000, 0x20091c0, 0x9005000, 0x1c00, 0x600c540, 0xf460
    .long 0xa008380, 0x8380, 0xefed820, 0x8380, 0x1200c540, 0xfffed820, 0x14008380, 0x8380
    .long 0x16fed820, 0x8380, 0x18ffbe40, 0xfffed820, 0x1a00a460, 0x62a0, 0x1c008380, 0x8380
    .long 0x1d000000, 0xfffed820, 0x0, 0x0, 0x0, 0x0, 0x0, 0xff000000
    .long 0x0, 0x0, 0x0, 0x0, 0x0, 0x0, 0x0, 0x0
    .long 0x0, 0x0, 0x0, 0x0, 0x0, 0x0, 0x0, 0x0
    .long 0x0, 0x0, 0x0, 0x0, 0x0, 0x0, 0x0, 0x0
    .long 0x0, 0x0, 0x0, 0x0, 0x0, 0x0, 0x0, 0x0
    .long 0x836000, 0x1f100, 0xffff8000, 0xf0091c0, 0x9005000, 0x1000, 0x600c540, 0xf460
    .long 0xa008380, 0x8380, 0xefed820, 0x8380, 0x1200c540, 0xfffed820, 0x14008380, 0x8380
    .long 0x16fed820, 0x8380, 0x18ffbe40, 0xfffed820, 0x1a00a460, 0x62a0, 0x1c008380, 0x8380
    .long 0x1d000000, 0xfffed820, 0x0, 0x0, 0x0, 0x0, 0x0, 0xff000000
    .long 0x0, 0x0, 0x0, 0x0, 0x0, 0x0, 0x0, 0x0
    .long 0x0, 0x0, 0x0, 0x0, 0x0, 0x0, 0x0, 0x0
    .long 0x0, 0x0, 0x0, 0x0, 0x0, 0x0, 0x0, 0x0
    .long 0x0, 0x0, 0x0, 0x0, 0x0, 0x0, 0x0, 0x0
    .long 0x856000, 0x1f100, 0xffff8000, 0x1000b2a0, 0x9005000, 0x1000, 0x600c540, 0xf460
    .long 0xa008380, 0x8380, 0xefed820, 0x8380, 0x1200c540, 0xfffed820, 0x14008380, 0x8380
    .long 0x16fed820, 0x8380, 0x18ffbe40, 0xfffed820, 0x1a00a460, 0x62a0, 0x1c008380, 0x8380
    .long 0x1d000000, 0xfffed820, 0x0, 0x0, 0x0, 0x0, 0x0, 0xff000000
    .long 0x0, 0x0, 0x0, 0x0, 0x0, 0x0, 0x0, 0x0
    .long 0x0, 0x0, 0x0, 0x0, 0x0, 0x0, 0x0, 0x0
    .long 0x0, 0x0, 0x0, 0x0, 0x0, 0x0, 0x0, 0x0
    .long 0x0, 0x0, 0x0, 0x0, 0x0, 0x0, 0x0, 0x0
    .long 0x796000, 0x1f100, 0xffff8000, 0x300b2a0, 0x9005000, 0x1000, 0x600c540, 0xf460
    .long 0xa008380, 0x8380, 0xefed820, 0x8380, 0x1200c540, 0xfffed820, 0x14008380, 0x8380
    .long 0x16fed820, 0x8380, 0x18ffbe40, 0xfffed820, 0x1a00a460, 0x62a0, 0x1c008380, 0x8380
    .long 0x1d000000, 0xfffed820, 0x0, 0x0, 0x0, 0x0, 0x0, 0xff000000
    .long 0x0, 0x0, 0x0, 0x0, 0x0, 0x0, 0x0, 0x0
    .long 0x0, 0x0, 0x0, 0x0, 0x0, 0x0, 0x0, 0x0
    .long 0x0, 0x0, 0x0, 0x0, 0x0, 0x0, 0x0, 0x0
    .long 0x0, 0x0, 0x0, 0x0, 0x0, 0x0, 0x0, 0x0
    .long 0x7b6000, 0x1f100, 0xffff8000, 0x400d380, 0x9005000, 0x1000, 0x600c540, 0xf460
    .long 0xa008380, 0x8380, 0xefed820, 0x8380, 0x1200c540, 0xfffed820, 0x14008380, 0x8380
    .long 0x16fed820, 0x8380, 0x18ffbe40, 0xfffed820, 0x1a00a460, 0x62a0, 0x1c008380, 0x8380
    .long 0x1d000000, 0xfffed820, 0x0, 0x0, 0x0, 0x0, 0x0, 0xff000000
    .long 0x0, 0x0, 0x0, 0x0, 0x0, 0x0, 0x0, 0x0
    .long 0x0, 0x0, 0x0, 0x0, 0x0, 0x0, 0x0, 0x0
    .long 0x0, 0x0, 0x0, 0x0, 0x0, 0x0, 0x0, 0x0
    .long 0x0, 0x0, 0x0, 0x0, 0x0, 0x0, 0x0, 0x0
    .long 0x756000, 0x88500e, 0x776000, 0x488500c, 0x7b6000, 0x888500c, 0x776000, 0xc88500e
    .long 0x876000, 0x1088500c, 0x796000, 0x1488500e, 0x816000, 0x1888500c, 0x27b6004, 0x288500e
    .long 0x2856040, 0x688500c, 0x27d6200, 0xe88500e, 0x27f6001, 0x1688500e, 0x2816010, 0x488500e
    .long 0x28366ff, 0x88500e, 0x48566ff, 0xa88500e, 0x68766ff, 0x1288500e, 0x0, 0x0
    .long 0x0, 0x0, 0x0, 0x0, 0x0, 0x0, 0x0, 0x0
    .long 0x0, 0x0, 0x0, 0x0, 0x0, 0x0, 0x0, 0x0
    .long 0x0, 0x0, 0x0, 0x0, 0x0, 0x0, 0x0, 0x0
    .long 0x0, 0x0, 0x0, 0x0, 0x0, 0x0, 0x0, 0x0
    .long 0x756000, 0x288500c, 0x796000, 0x688500c, 0x756000, 0xa88500d, 0x7d6000, 0xe88500c
    .long 0x776000, 0x1288500d, 0x7f6000, 0x1688500c, 0x796000, 0x1a88500d, 0x2836008, 0x488500c
    .long 0x27b6080, 0x888500d, 0x27d6400, 0x1088500d, 0x27f6002, 0x1888500d, 0x2816020, 0x688500d
    .long 0x48366ff, 0xc88500d, 0x68566ff, 0x1488500d, 0x88766ff, 0x288500d, 0x0, 0x0
    .long 0x0, 0x0, 0x0, 0x0, 0x0, 0x0, 0x0, 0x0
    .long 0x0, 0x0, 0x0, 0x0, 0x0, 0x0, 0x0, 0x0
    .long 0x0, 0x0, 0x0, 0x0, 0x0, 0x0, 0x0, 0x0
    .long 0x0, 0x0, 0x0, 0x0, 0x0, 0x0, 0x0, 0x0
    .long 0x7d6000, 0x1f100, 0xffff8000, 0x7013620, 0x9005000, 0x1000, 0x600c540, 0xf460
    .long 0xa008380, 0x8380, 0xefed820, 0x8380, 0x1200c540, 0xfffed820, 0x14008380, 0x8380
    .long 0x16fed820, 0x8380, 0x18ffbe40, 0xfffed820, 0x1a00a460, 0x62a0, 0x1c008380, 0x8380
    .long 0x1d000000, 0xfffed820, 0x0, 0x0, 0x0, 0x0, 0x0, 0xff000000
    .long 0x0, 0x0, 0x0, 0x0, 0x0, 0x0, 0x0, 0x0
    .long 0x0, 0x0, 0x0, 0x0, 0x0, 0x0, 0x0, 0x0
    .long 0x0, 0x0, 0x0, 0x0, 0x0, 0x0, 0x0, 0x0
    .long 0x0, 0x0, 0x0, 0x0, 0x0, 0x0, 0x0, 0x0
    .long 0x876000, 0xe100, 0xffff8000, 0x8015700, 0x9005000, 0x1100, 0x600c540, 0xf460
    .long 0xa008380, 0x8380, 0xefed820, 0x8380, 0x1200c540, 0xfffed820, 0x14008380, 0x8380
    .long 0x16fed820, 0x8380, 0x18ffbe40, 0xfffed820, 0x1a00a460, 0x62a0, 0x1c008380, 0x8380
    .long 0x1d000000, 0xfffed820, 0x0, 0x0, 0x0, 0x0, 0x0, 0xff000000
    .long 0x0, 0x0, 0x0, 0x0, 0x0, 0x0, 0x0, 0x0
    .long 0x0, 0x0, 0x0, 0x0, 0x0, 0x0, 0x0, 0x0
    .long 0x0, 0x0, 0x0, 0x0, 0x0, 0x0, 0x0, 0x0
    .long 0x0, 0x0, 0x0, 0x0, 0x0, 0x0, 0x0, 0x0
    .long 0x7f6000, 0x1f100, 0xffff8000, 0xb01b9a0, 0x9005000, 0x1c00, 0x600c540, 0xf460
    .long 0xa008380, 0x8380, 0xefed820, 0x8380, 0x1200c540, 0xfffed820, 0x14008380, 0x8380
    .long 0x16fed820, 0x8380, 0x18ffbe40, 0xfffed820, 0x1a00a460, 0x62a0, 0x1c008380, 0x8380
    .long 0x1d000000, 0xfffed820, 0x0, 0x0, 0x0, 0x0, 0x0, 0xff000000
    .long 0x0, 0x0, 0x0, 0x0, 0x0, 0x0, 0x0, 0x0
    .long 0x0, 0x0, 0x0, 0x0, 0x0, 0x0, 0x0, 0x0
    .long 0x0, 0x0, 0x0, 0x0, 0x0, 0x0, 0x0, 0x0
    .long 0x0, 0x0, 0x0, 0x0, 0x0, 0x0, 0x0, 0x0
    .long 0x816000, 0x1f100, 0xffff8000, 0xc01da80, 0x9005000, 0x1c00, 0x600c540, 0xf460
    .long 0xa008380, 0x8380, 0xefed820, 0x8380, 0x1200c540, 0xfffed820, 0x14008380, 0x8380
    .long 0x16fed820, 0x8380, 0x18ffbe40, 0xfffed820, 0x1a00a460, 0x62a0, 0x1c008380, 0x8380
    .long 0x1d000000, 0xfffed820, 0x0, 0x0, 0x0, 0x0, 0x0, 0xff000000
    .long 0x0, 0x0, 0x0, 0x0, 0x0, 0x0, 0x0, 0x0
    .long 0x0, 0x0, 0x0, 0x0, 0x0, 0x0, 0x0, 0x0
    .long 0x0, 0x0, 0x0, 0x0, 0x0, 0x0, 0x0, 0x0
    .long 0x0, 0x0, 0x0, 0x0, 0x0, 0x0, 0x0, 0x0
    .long 0x756000, 0x1f100, 0xffff8000, 0x10070e0, 0x9005000, 0x1c00, 0x600c540, 0xf460
    .long 0xa008380, 0x8380, 0xefed820, 0x8380, 0x1200c540, 0xfffed820, 0x14008380, 0x8380
    .long 0x16fed820, 0x8380, 0x18ffbe40, 0xfffed820, 0x1a00a460, 0x62a0, 0x1c008380, 0x8380
    .long 0x1d000000, 0xfffed820, 0x0, 0x0, 0x0, 0x0, 0x0, 0xff000000
    .long 0x0, 0x0, 0x0, 0x0, 0x0, 0x0, 0x0, 0x0
    .long 0x0, 0x0, 0x0, 0x0, 0x0, 0x0, 0x0, 0x0
    .long 0x0, 0x0, 0x0, 0x0, 0x0, 0x0, 0x0, 0x0
    .long 0x0, 0x0, 0x0, 0x0, 0x0, 0x0, 0x0, 0x0
    .long 0x776000, 0x1f100, 0xffff8000, 0x20091c0, 0x9005000, 0x1c00, 0x600c540, 0xf460
    .long 0xa008380, 0x8380, 0xefed820, 0x8380, 0x1200c540, 0xfffed820, 0x14008380, 0x8380
    .long 0x16fed820, 0x8380, 0x18ffbe40, 0xfffed820, 0x1a00a460, 0x62a0, 0x1c008380, 0x8380
    .long 0x1d000000, 0xfffed820, 0x0, 0x0, 0x0, 0x0, 0x0, 0xff000000
    .long 0x0, 0x0, 0x0, 0x0, 0x0, 0x0, 0x0, 0x0
    .long 0x0, 0x0, 0x0, 0x0, 0x0, 0x0, 0x0, 0x0
    .long 0x0, 0x0, 0x0, 0x0, 0x0, 0x0, 0x0, 0x0
    .long 0x0, 0x0, 0x0, 0x0, 0x0, 0x0, 0x0, 0x0
    .long 0x836000, 0x1f100, 0xffff8000, 0xf0091c0, 0x9005000, 0x1000, 0x600c540, 0xf460
    .long 0xa008380, 0x8380, 0xefed820, 0x8380, 0x1200c540, 0xfffed820, 0x14008380, 0x8380
    .long 0x16fed820, 0x8380, 0x18ffbe40, 0xfffed820, 0x1a00a460, 0x62a0, 0x1c008380, 0x8380
    .long 0x1d000000, 0xfffed820, 0x0, 0x0, 0x0, 0x0, 0x0, 0xff000000
    .long 0x0, 0x0, 0x0, 0x0, 0x0, 0x0, 0x0, 0x0
    .long 0x0, 0x0, 0x0, 0x0, 0x0, 0x0, 0x0, 0x0
    .long 0x0, 0x0, 0x0, 0x0, 0x0, 0x0, 0x0, 0x0
    .long 0x0, 0x0, 0x0, 0x0, 0x0, 0x0, 0x0, 0x0
    .long 0x856000, 0x1f100, 0xffff8000, 0x1000b2a0, 0x9005000, 0x1000, 0x600c540, 0xf460
    .long 0xa008380, 0x8380, 0xefed820, 0x8380, 0x1200c540, 0xfffed820, 0x14008380, 0x8380
    .long 0x16fed820, 0x8380, 0x18ffbe40, 0xfffed820, 0x1a00a460, 0x62a0, 0x1c008380, 0x8380
    .long 0x1d000000, 0xfffed820, 0x0, 0x0, 0x0, 0x0, 0x0, 0xff000000
    .long 0x0, 0x0, 0x0, 0x0, 0x0, 0x0, 0x0, 0x0
    .long 0x0, 0x0, 0x0, 0x0, 0x0, 0x0, 0x0, 0x0
    .long 0x0, 0x0, 0x0, 0x0, 0x0, 0x0, 0x0, 0x0
    .long 0x0, 0x0, 0x0, 0x0, 0x0, 0x0, 0x0, 0x0
    .long 0x796000, 0x1f100, 0xffff8000, 0x300b2a0, 0x9005000, 0x1000, 0x600c540, 0xf460
    .long 0xa008380, 0x8380, 0xefed820, 0x8380, 0x1200c540, 0xfffed820, 0x14008380, 0x8380
    .long 0x16fed820, 0x8380, 0x18ffbe40, 0xfffed820, 0x1a00a460, 0x62a0, 0x1c008380, 0x8380
    .long 0x1d000000, 0xfffed820, 0x0, 0x0, 0x0, 0x0, 0x0, 0xff000000
    .long 0x0, 0x0, 0x0, 0x0, 0x0, 0x0, 0x0, 0x0
    .long 0x0, 0x0, 0x0, 0x0, 0x0, 0x0, 0x0, 0x0
    .long 0x0, 0x0, 0x0, 0x0, 0x0, 0x0, 0x0, 0x0
    .long 0x0, 0x0, 0x0, 0x0, 0x0, 0x0, 0x0, 0x0
    .long 0x7b6000, 0x1f100, 0xffff8000, 0x400d380, 0x9005000, 0x1000, 0x600c540, 0xf460
    .long 0xa008380, 0x8380, 0xefed820, 0x8380, 0x1200c540, 0xfffed820, 0x14008380, 0x8380
    .long 0x16fed820, 0x8380, 0x18ffbe40, 0xfffed820, 0x1a00a460, 0x62a0, 0x1c008380, 0x8380
    .long 0x1d000000, 0xfffed820, 0x0, 0x0, 0x0, 0x0, 0x0, 0xff000000
    .long 0x0, 0x0, 0x0, 0x0, 0x0, 0x0, 0x0, 0x0
    .long 0x0, 0x0, 0x0, 0x0, 0x0, 0x0, 0x0, 0x0
    .long 0x0, 0x0, 0x0, 0x0, 0x0, 0x0, 0x0, 0x0
    .long 0x0, 0x0, 0x0, 0x0, 0x0, 0x0, 0x0, 0x0
    .long 0xee3000, 0x104900a, 0xf03000, 0x5049008, 0xf43000, 0x9049008, 0xf03000, 0xd04900a
    .long 0xf23000, 0x1104900a, 0xf83000, 0x15049008, 0x2fc3001, 0x3049008, 0x2f43004, 0x704900e
    .long 0x2f63010, 0x1304900e, 0x2f83040, 0x1704900e, 0x2fa30ff, 0x104900e, 0x4fc30ff, 0xb04900e
    .long 0x6fe30ff, 0xf04900e, 0x90030ff, 0x504900e, 0xb0230ff, 0x904900e, 0xd0430ff, 0x1504900e
    .long 0x0, 0x0, 0x0, 0x0, 0x0, 0x0, 0x0, 0x0
    .long 0x0, 0x0, 0x0, 0x0, 0x0, 0x0, 0x0, 0x0
    .long 0x0, 0x0, 0x0, 0x0, 0x0, 0x0, 0x0, 0x0
    .long 0x0, 0x0, 0x0, 0x0, 0x0, 0x0, 0x0, 0x0
    .long 0xee3000, 0x3049008, 0xf23000, 0x7049008, 0xee3000, 0xb049009, 0xf03000, 0xf049009
    .long 0xf63000, 0x13049008, 0xfa3000, 0x17049008, 0x2f23002, 0x5049009, 0x2f43008, 0x904900d
    .long 0x2f63020, 0x1504900d, 0x2f83080, 0x304900d, 0x4fa30ff, 0xd04900d, 0x6fc30ff, 0x1104900d
    .long 0x8fe30ff, 0x704900d, 0xb0030ff, 0x1304900d, 0xd0230ff, 0x1704900d, 0xf0430ff, 0x104900d
    .long 0x0, 0x0, 0x0, 0x0, 0x0, 0x0, 0x0, 0x0
    .long 0x0, 0x0, 0x0, 0x0, 0x0, 0x0, 0x0, 0x0
    .long 0x0, 0x0, 0x0, 0x0, 0x0, 0x0, 0x0, 0x0
    .long 0x0, 0x0, 0x0, 0x0, 0x0, 0x0, 0x0, 0x0
    .long 0x0, 0x0, 0x0, 0x0, 0x0, 0xff000000, 0x0, 0x0
    .long 0x0, 0x0, 0x0, 0x0, 0x0, 0x0, 0x0, 0x0
    .long 0x0, 0x0, 0x0, 0x0, 0x0, 0x0, 0x0, 0x0
    .long 0x0, 0x0, 0x0, 0x0, 0x0, 0x0, 0x0, 0x0
    .long 0x0, 0x0, 0x0, 0x0, 0x0, 0x0, 0x0, 0x0
    .long 0x0, 0x0, 0x0, 0x0, 0x0, 0x0, 0x0, 0x0
    .long 0x0, 0x0, 0x0, 0x0, 0x0, 0x0, 0x0, 0x0
    .long 0x0, 0x0, 0x0, 0x0, 0x0, 0x0, 0x0, 0x0
    .long 0x0, 0x0, 0x0, 0x0, 0x0, 0xff000000, 0x0, 0x0
    .long 0x0, 0x0, 0x0, 0x0, 0x0, 0x0, 0x0, 0x0
    .long 0x0, 0x0, 0x0, 0x0, 0x0, 0x0, 0x0, 0x0
    .long 0x0, 0x0, 0x0, 0x0, 0x0, 0x0, 0x0, 0x0
    .long 0x0, 0x0, 0x0, 0x0, 0x0, 0x0, 0x0, 0x0
    .long 0x0, 0x0, 0x0, 0x0, 0x0, 0x0, 0x0, 0x0
    .long 0x0, 0x0, 0x0, 0x0, 0x0, 0x0, 0x0, 0x0
    .long 0x0, 0x0, 0x0, 0x0, 0x0, 0x0, 0x0, 0x0
    .long 0xee3000, 0x1f100, 0xffffffc0, 0x10070e0, 0xb005000, 0x1c00, 0x600c540, 0xf460
    .long 0x80041c0, 0x41c0, 0xeff5ba0, 0xffff5ba0, 0x1000c540, 0x41c0, 0x120041c0, 0xc540
    .long 0x14fe9660, 0xfffed820, 0x1600a460, 0xa460, 0x180041c0, 0x41c0, 0x1aff5ba0, 0xffff5ba0
    .long 0x1c0041c0, 0xc540, 0x1e00c540, 0x41c0, 0x1f000000, 0xfffe9660, 0x0, 0x0
    .long 0x0, 0x0, 0x0, 0xff000000, 0x0, 0x0, 0x0, 0x0
    .long 0x0, 0x0, 0x0, 0x0, 0x0, 0x0, 0x0, 0x0
    .long 0x0, 0x0, 0x0, 0x0, 0x0, 0x0, 0x0, 0x0
    .long 0x0, 0x0, 0x0, 0x0, 0x0, 0x0, 0x0, 0x0
    .long 0xf03000, 0x1f100, 0xffffffc0, 0x20091c0, 0xb005000, 0x1c00, 0x600c540, 0xf460
    .long 0x80041c0, 0x41c0, 0xeff5ba0, 0xffff5ba0, 0x1000c540, 0x41c0, 0x120041c0, 0xc540
    .long 0x14fe9660, 0xfffed820, 0x1600a460, 0xa460, 0x180041c0, 0x41c0, 0x1aff5ba0, 0xffff5ba0
    .long 0x1c0041c0, 0xc540, 0x1e00c540, 0x41c0, 0x1f000000, 0xfffe9660, 0x0, 0x0
    .long 0x0, 0x0, 0x0, 0xff000000, 0x0, 0x0, 0x0, 0x0
    .long 0x0, 0x0, 0x0, 0x0, 0x0, 0x0, 0x0, 0x0
    .long 0x0, 0x0, 0x0, 0x0, 0x0, 0x0, 0x0, 0x0
    .long 0x0, 0x0, 0x0, 0x0, 0x0, 0x0, 0x0, 0x0
    .long 0xf23000, 0x1f100, 0xffffffc0, 0x300b2a0, 0xb005000, 0x1c00, 0x600c540, 0xf460
    .long 0x80041c0, 0x41c0, 0xeff5ba0, 0xffff5ba0, 0x1000c540, 0x41c0, 0x120041c0, 0xc540
    .long 0x14fe9660, 0xfffed820, 0x1600a460, 0xa460, 0x180041c0, 0x41c0, 0x1aff5ba0, 0xffff5ba0
    .long 0x1c0041c0, 0xc540, 0x1e00c540, 0x41c0, 0x1f000000, 0xfffe9660, 0x0, 0x0
    .long 0x0, 0x0, 0x0, 0xff000000, 0x0, 0x0, 0x0, 0x0
    .long 0x0, 0x0, 0x0, 0x0, 0x0, 0x0, 0x0, 0x0
    .long 0x0, 0x0, 0x0, 0x0, 0x0, 0x0, 0x0, 0x0
    .long 0x0, 0x0, 0x0, 0x0, 0x0, 0x0, 0x0, 0x0
    .long 0xf43000, 0x1f100, 0xffffffc0, 0x400d380, 0xb005000, 0x1c00, 0x600c540, 0xf460
    .long 0x80041c0, 0x41c0, 0xeff5ba0, 0xffff5ba0, 0x1000c540, 0x41c0, 0x120041c0, 0xc540
    .long 0x14fe9660, 0xfffed820, 0x1600a460, 0xa460, 0x180041c0, 0x41c0, 0x1aff5ba0, 0xffff5ba0
    .long 0x1c0041c0, 0xc540, 0x1e00c540, 0x41c0, 0x1f000000, 0xfffe9660, 0x0, 0x0
    .long 0x0, 0x0, 0x0, 0xff000000, 0x0, 0x0, 0x0, 0x0
    .long 0x0, 0x0, 0x0, 0x0, 0x0, 0x0, 0x0, 0x0
    .long 0x0, 0x0, 0x0, 0x0, 0x0, 0x0, 0x0, 0x0
    .long 0x0, 0x0, 0x0, 0x0, 0x0, 0x0, 0x0, 0x0
    .long 0xf63000, 0x1f100, 0xffffffc0, 0x90177e0, 0xb005000, 0x1000, 0x600c540, 0xf460
    .long 0x80041c0, 0x41c0, 0xeff5ba0, 0xffff5ba0, 0x1000c540, 0x41c0, 0x120041c0, 0xc540
    .long 0x14fe9660, 0xfffed820, 0x1600a460, 0xa460, 0x180041c0, 0x41c0, 0x1aff5ba0, 0xffff5ba0
    .long 0x1c0041c0, 0xc540, 0x1e00c540, 0x41c0, 0x1f000000, 0xfffe9660, 0x0, 0x0
    .long 0x0, 0x0, 0x0, 0xff000000, 0x0, 0x0, 0x0, 0x0
    .long 0x0, 0x0, 0x0, 0x0, 0x0, 0x0, 0x0, 0x0
    .long 0x0, 0x0, 0x0, 0x0, 0x0, 0x0, 0x0, 0x0
    .long 0x0, 0x0, 0x0, 0x0, 0x0, 0x0, 0x0, 0x0
    .long 0xf83000, 0x1f100, 0xffffffc0, 0xa0198c0, 0xb005000, 0x1000, 0x600c540, 0xf460
    .long 0x80041c0, 0x41c0, 0xeff5ba0, 0xffff5ba0, 0x1000c540, 0x41c0, 0x120041c0, 0xc540
    .long 0x14fe9660, 0xfffed820, 0x1600a460, 0xa460, 0x180041c0, 0x41c0, 0x1aff5ba0, 0xffff5ba0
    .long 0x1c0041c0, 0xc540, 0x1e00c540, 0x41c0, 0x1f000000, 0xfffe9660, 0x0, 0x0
    .long 0x0, 0x0, 0x0, 0xff000000, 0x0, 0x0, 0x0, 0x0
    .long 0x0, 0x0, 0x0, 0x0, 0x0, 0x0, 0x0, 0x0
    .long 0x0, 0x0, 0x0, 0x0, 0x0, 0x0, 0x0, 0x0
    .long 0x0, 0x0, 0x0, 0x0, 0x0, 0x0, 0x0, 0x0
    .long 0xfa3000, 0x1f100, 0xffffffc0, 0xb01b9a0, 0xb005000, 0x1000, 0x600c540, 0xf460
    .long 0x80041c0, 0x41c0, 0xeff5ba0, 0xffff5ba0, 0x1000c540, 0x41c0, 0x120041c0, 0xc540
    .long 0x14fe9660, 0xfffed820, 0x1600a460, 0xa460, 0x180041c0, 0x41c0, 0x1aff5ba0, 0xffff5ba0
    .long 0x1c0041c0, 0xc540, 0x1e00c540, 0x41c0, 0x1f000000, 0xfffe9660, 0x0, 0x0
    .long 0x0, 0x0, 0x0, 0xff000000, 0x0, 0x0, 0x0, 0x0
    .long 0x0, 0x0, 0x0, 0x0, 0x0, 0x0, 0x0, 0x0
    .long 0x0, 0x0, 0x0, 0x0, 0x0, 0x0, 0x0, 0x0
    .long 0x0, 0x0, 0x0, 0x0, 0x0, 0x0, 0x0, 0x0
    .long 0xfc3000, 0x1f100, 0xffffffc0, 0xc0070e0, 0xb005000, 0x1000, 0x600c540, 0xf460
    .long 0x80041c0, 0x41c0, 0xeff5ba0, 0xffff5ba0, 0x1000c540, 0x41c0, 0x120041c0, 0xc540
    .long 0x14fe9660, 0xfffed820, 0x1600a460, 0xa460, 0x180041c0, 0x41c0, 0x1aff5ba0, 0xffff5ba0
    .long 0x1c0041c0, 0xc540, 0x1e00c540, 0x41c0, 0x1f000000, 0xfffe9660, 0x0, 0x0
    .long 0x0, 0x0, 0x0, 0xff000000, 0x0, 0x0, 0x0, 0x0
    .long 0x0, 0x0, 0x0, 0x0, 0x0, 0x0, 0x0, 0x0
    .long 0x0, 0x0, 0x0, 0x0, 0x0, 0x0, 0x0, 0x0
    .long 0x0, 0x0, 0x0, 0x0, 0x0, 0x0, 0x0, 0x0
    .long 0xee3000, 0x104900a, 0xf03000, 0x5049008, 0xf43000, 0x9049008, 0xf03000, 0xd04900a
    .long 0xf83000, 0x11049008, 0xfc3000, 0x15049008, 0x2f23001, 0x304900a, 0x2f43004, 0x704900e
    .long 0x2f63010, 0xf04900e, 0x2f83040, 0x1304900e, 0x2fa3080, 0x1504900e, 0x4fc30ff, 0xb04900e
    .long 0x6fe30ff, 0x1704900e, 0x90030ff, 0x704900e, 0xb0230ff, 0xf04900e, 0xd0430ff, 0x1104900e
    .long 0x0, 0x0, 0x0, 0x0, 0x0, 0x0, 0x0, 0x0
    .long 0x0, 0x0, 0x0, 0x0, 0x0, 0x0, 0x0, 0x0
    .long 0x0, 0x0, 0x0, 0x0, 0x0, 0x0, 0x0, 0x0
    .long 0x0, 0x0, 0x0, 0x0, 0x0, 0x0, 0x0, 0x0
    .long 0xee3000, 0x3049008, 0xf23000, 0x7049008, 0xee3000, 0xb049009, 0xf63000, 0xf049008
    .long 0xfa3000, 0x13049008, 0xf03000, 0x17049009, 0x2f23002, 0x5049009, 0x2f43008, 0x904900d
    .long 0x2f63020, 0x1104900d, 0x2f830ff, 0x104900d, 0x4fa30ff, 0xd04900d, 0x6fc30ff, 0x304900d
    .long 0x8fe30ff, 0x504900d, 0xb0030ff, 0x904900d, 0xd0230ff, 0x1304900d, 0xf0430ff, 0x104900d
    .long 0x0, 0x0, 0x0, 0x0, 0x0, 0x0, 0x0, 0x0
    .long 0x0, 0x0, 0x0, 0x0, 0x0, 0x0, 0x0, 0x0
    .long 0x0, 0x0, 0x0, 0x0, 0x0, 0x0, 0x0, 0x0
    .long 0x0, 0x0, 0x0, 0x0, 0x0, 0x0, 0x0, 0x0
    .long 0x0, 0x0, 0x0, 0x0, 0x0, 0xff000000, 0x0, 0x0
    .long 0x0, 0x0, 0x0, 0x0, 0x0, 0x0, 0x0, 0x0
    .long 0x0, 0x0, 0x0, 0x0, 0x0, 0x0, 0x0, 0x0
    .long 0x0, 0x0, 0x0, 0x0, 0x0, 0x0, 0x0, 0x0
    .long 0x0, 0x0, 0x0, 0x0, 0x0, 0x0, 0x0, 0x0
    .long 0x0, 0x0, 0x0, 0x0, 0x0, 0x0, 0x0, 0x0
    .long 0x0, 0x0, 0x0, 0x0, 0x0, 0x0, 0x0, 0x0
    .long 0x0, 0x0, 0x0, 0x0, 0x0, 0x0, 0x0, 0x0
    .long 0x0, 0x0, 0x0, 0x0, 0x0, 0xff000000, 0x0, 0x0
    .long 0x0, 0x0, 0x0, 0x0, 0x0, 0x0, 0x0, 0x0
    .long 0x0, 0x0, 0x0, 0x0, 0x0, 0x0, 0x0, 0x0
    .long 0x0, 0x0, 0x0, 0x0, 0x0, 0x0, 0x0, 0x0
    .long 0x0, 0x0, 0x0, 0x0, 0x0, 0x0, 0x0, 0x0
    .long 0x0, 0x0, 0x0, 0x0, 0x0, 0x0, 0x0, 0x0
    .long 0x0, 0x0, 0x0, 0x0, 0x0, 0x0, 0x0, 0x0
    .long 0x0, 0x0, 0x0, 0x0, 0x0, 0x0, 0x0, 0x0
    .long 0xee3000, 0x1f100, 0xffffffc0, 0x10070e0, 0xb005000, 0x1c00, 0x600c540, 0xf460
    .long 0xcff5ba0, 0xc540, 0xe0041c0, 0xfffed820, 0x10008380, 0x41c0, 0x120041c0, 0x8380
    .long 0x140020e0, 0xfffef900, 0x16ff5ba0, 0xc540, 0x1800c540, 0xffff5ba0, 0x1afef900, 0x20e0
    .long 0x1c008380, 0x41c0, 0x1e0020e0, 0xa460, 0x1f000000, 0xfffed820, 0x0, 0x0
    .long 0x0, 0x0, 0x0, 0xff000000, 0x0, 0x0, 0x0, 0x0
    .long 0x0, 0x0, 0x0, 0x0, 0x0, 0x0, 0x0, 0x0
    .long 0x0, 0x0, 0x0, 0x0, 0x0, 0x0, 0x0, 0x0
    .long 0x0, 0x0, 0x0, 0x0, 0x0, 0x0, 0x0, 0x0
    .long 0xf03000, 0x1f100, 0xffffffc0, 0x20091c0, 0xb005000, 0x1c00, 0x600c540, 0xf460
    .long 0xcff5ba0, 0xc540, 0xe0041c0, 0xfffed820, 0x10008380, 0x41c0, 0x120041c0, 0x8380
    .long 0x140020e0, 0xfffef900, 0x16ff5ba0, 0xc540, 0x1800c540, 0xffff5ba0, 0x1afef900, 0x20e0
    .long 0x1c008380, 0x41c0, 0x1e0020e0, 0xa460, 0x1f000000, 0xfffed820, 0x0, 0x0
    .long 0x0, 0x0, 0x0, 0xff000000, 0x0, 0x0, 0x0, 0x0
    .long 0x0, 0x0, 0x0, 0x0, 0x0, 0x0, 0x0, 0x0
    .long 0x0, 0x0, 0x0, 0x0, 0x0, 0x0, 0x0, 0x0
    .long 0x0, 0x0, 0x0, 0x0, 0x0, 0x0, 0x0, 0x0
    .long 0xf23000, 0x1f100, 0xffffffc0, 0x300b2a0, 0xb005000, 0x1c00, 0x600c540, 0xf460
    .long 0xcff5ba0, 0xc540, 0xe0041c0, 0xfffed820, 0x10008380, 0x41c0, 0x120041c0, 0x8380
    .long 0x140020e0, 0xfffef900, 0x16ff5ba0, 0xc540, 0x1800c540, 0xffff5ba0, 0x1afef900, 0x20e0
    .long 0x1c008380, 0x41c0, 0x1e0020e0, 0xa460, 0x1f000000, 0xfffed820, 0x0, 0x0
    .long 0x0, 0x0, 0x0, 0xff000000, 0x0, 0x0, 0x0, 0x0
    .long 0x0, 0x0, 0x0, 0x0, 0x0, 0x0, 0x0, 0x0
    .long 0x0, 0x0, 0x0, 0x0, 0x0, 0x0, 0x0, 0x0
    .long 0x0, 0x0, 0x0, 0x0, 0x0, 0x0, 0x0, 0x0
    .long 0xf43000, 0x1f100, 0xffffffc0, 0x400d380, 0xb005000, 0x1c00, 0x600c540, 0xf460
    .long 0xcff5ba0, 0xc540, 0xe0041c0, 0xfffed820, 0x10008380, 0x41c0, 0x120041c0, 0x8380
    .long 0x140020e0, 0xfffef900, 0x16ff5ba0, 0xc540, 0x1800c540, 0xffff5ba0, 0x1afef900, 0x20e0
    .long 0x1c008380, 0x41c0, 0x1e0020e0, 0xa460, 0x1f000000, 0xfffed820, 0x0, 0x0
    .long 0x0, 0x0, 0x0, 0xff000000, 0x0, 0x0, 0x0, 0x0
    .long 0x0, 0x0, 0x0, 0x0, 0x0, 0x0, 0x0, 0x0
    .long 0x0, 0x0, 0x0, 0x0, 0x0, 0x0, 0x0, 0x0
    .long 0x0, 0x0, 0x0, 0x0, 0x0, 0x0, 0x0, 0x0
    .long 0xf63000, 0x1f100, 0xffffffc0, 0x7013620, 0xb005000, 0x1000, 0x600c540, 0xf460
    .long 0xcff5ba0, 0xc540, 0xe0041c0, 0xfffed820, 0x10008380, 0x41c0, 0x120041c0, 0x8380
    .long 0x140020e0, 0xfffef900, 0x16ff5ba0, 0xc540, 0x1800c540, 0xffff5ba0, 0x1afef900, 0x20e0
    .long 0x1c008380, 0x41c0, 0x1e0020e0, 0xa460, 0x1f000000, 0xfffed820, 0x0, 0x0
    .long 0x0, 0x0, 0x0, 0xff000000, 0x0, 0x0, 0x0, 0x0
    .long 0x0, 0x0, 0x0, 0x0, 0x0, 0x0, 0x0, 0x0
    .long 0x0, 0x0, 0x0, 0x0, 0x0, 0x0, 0x0, 0x0
    .long 0x0, 0x0, 0x0, 0x0, 0x0, 0x0, 0x0, 0x0
    .long 0xf83000, 0x1f100, 0xffffffc0, 0x8015700, 0xb005000, 0x1000, 0x600c540, 0xf460
    .long 0xcff5ba0, 0xc540, 0xe0041c0, 0xfffed820, 0x10008380, 0x41c0, 0x120041c0, 0x8380
    .long 0x140020e0, 0xfffef900, 0x16ff5ba0, 0xc540, 0x1800c540, 0xffff5ba0, 0x1afef900, 0x20e0
    .long 0x1c008380, 0x41c0, 0x1e0020e0, 0xa460, 0x1f000000, 0xfffed820, 0x0, 0x0
    .long 0x0, 0x0, 0x0, 0xff000000, 0x0, 0x0, 0x0, 0x0
    .long 0x0, 0x0, 0x0, 0x0, 0x0, 0x0, 0x0, 0x0
    .long 0x0, 0x0, 0x0, 0x0, 0x0, 0x0, 0x0, 0x0
    .long 0x0, 0x0, 0x0, 0x0, 0x0, 0x0, 0x0, 0x0
    .long 0xfa3000, 0x1f100, 0xffffffc0, 0x90177e0, 0xb005000, 0x1000, 0x600c540, 0xf460
    .long 0xcff5ba0, 0xc540, 0xe0041c0, 0xfffed820, 0x10008380, 0x41c0, 0x120041c0, 0x8380
    .long 0x140020e0, 0xfffef900, 0x16ff5ba0, 0xc540, 0x1800c540, 0xffff5ba0, 0x1afef900, 0x20e0
    .long 0x1c008380, 0x41c0, 0x1e0020e0, 0xa460, 0x1f000000, 0xfffed820, 0x0, 0x0
    .long 0x0, 0x0, 0x0, 0xff000000, 0x0, 0x0, 0x0, 0x0
    .long 0x0, 0x0, 0x0, 0x0, 0x0, 0x0, 0x0, 0x0
    .long 0x0, 0x0, 0x0, 0x0, 0x0, 0x0, 0x0, 0x0
    .long 0x0, 0x0, 0x0, 0x0, 0x0, 0x0, 0x0, 0x0
    .long 0xfc3000, 0x1f100, 0xffffffc0, 0xa0198c0, 0xb005000, 0x1000, 0x600c540, 0xf460
    .long 0xcff5ba0, 0xc540, 0xe0041c0, 0xfffed820, 0x10008380, 0x41c0, 0x120041c0, 0x8380
    .long 0x140020e0, 0xfffef900, 0x16ff5ba0, 0xc540, 0x1800c540, 0xffff5ba0, 0x1afef900, 0x20e0
    .long 0x1c008380, 0x41c0, 0x1e0020e0, 0xa460, 0x1f000000, 0xfffed820, 0x0, 0x0
    .long 0x0, 0x0, 0x0, 0xff000000, 0x0, 0x0, 0x0, 0x0
    .long 0x0, 0x0, 0x0, 0x0, 0x0, 0x0, 0x0, 0x0
    .long 0x0, 0x0, 0x0, 0x0, 0x0, 0x0, 0x0, 0x0
    .long 0x0, 0x0, 0x0, 0x0, 0x0, 0x0, 0x0, 0x0
    .long 0x92f100, 0xa5600e, 0x94f100, 0x4a5600c, 0x98f100, 0x8a5600c, 0x94f100, 0xca5600e
    .long 0xa4f100, 0x10a5600c, 0x96f100, 0x14a5600e, 0x9ef100, 0x18a5600c, 0x298f104, 0x2a5600e
    .long 0x2a2f140, 0x6a5600c, 0x29af300, 0xea5600e, 0x29cf101, 0x16a5600e, 0x29ef110, 0x4a5600e
    .long 0x2a0f7ff, 0xa5600e, 0x4a2f7ff, 0xaa5600e, 0x6a4f7ff, 0x12a5600e, 0x0, 0x0
    .long 0x0, 0x0, 0x0, 0x0, 0x0, 0x0, 0x0, 0x0
    .long 0x0, 0x0, 0x0, 0x0, 0x0, 0x0, 0x0, 0x0
    .long 0x0, 0x0, 0x0, 0x0, 0x0, 0x0, 0x0, 0x0
    .long 0x0, 0x0, 0x0, 0x0, 0x0, 0x0, 0x0, 0x0
    .long 0x92f100, 0x2a5600c, 0x96f100, 0x6a5600c, 0x92f100, 0xaa5600d, 0x9af100, 0xea5600c
    .long 0x94f100, 0x12a5600d, 0x9cf100, 0x16a5600c, 0x96f100, 0x1aa5600d, 0x2a0f108, 0x4a5600c
    .long 0x298f180, 0x8a5600d, 0x29af500, 0x10a5600d, 0x29cf102, 0x18a5600d, 0x29ef120, 0x6a5600d
    .long 0x4a0f7ff, 0xca5600d, 0x6a2f7ff, 0x14a5600d, 0x8a4f7ff, 0x2a5600d, 0x0, 0x0
    .long 0x0, 0x0, 0x0, 0x0, 0x0, 0x0, 0x0, 0x0
    .long 0x0, 0x0, 0x0, 0x0, 0x0, 0x0, 0x0, 0x0
    .long 0x0, 0x0, 0x0, 0x0, 0x0, 0x0, 0x0, 0x0
    .long 0x0, 0x0, 0x0, 0x0, 0x0, 0x0, 0x0, 0x0
    .long 0x9af100, 0x1f100, 0xffffff80, 0x7013620, 0x9005000, 0x1000, 0x600c540, 0xf460
    .long 0xa008380, 0x8380, 0xefed820, 0x8380, 0x1200c540, 0xfffed820, 0x14008380, 0x8380
    .long 0x16fed820, 0x8380, 0x18ffbe40, 0xfffed820, 0x1a00a460, 0x62a0, 0x1c008380, 0x8380
    .long 0x1d000000, 0xfffed820, 0x0, 0x0, 0x0, 0x0, 0x0, 0xff000000
    .long 0x0, 0x0, 0x0, 0x0, 0x0, 0x0, 0x0, 0x0
    .long 0x0, 0x0, 0x0, 0x0, 0x0, 0x0, 0x0, 0x0
    .long 0x0, 0x0, 0x0, 0x0, 0x0, 0x0, 0x0, 0x0
    .long 0x0, 0x0, 0x0, 0x0, 0x0, 0x0, 0x0, 0x0
    .long 0xa4f100, 0x6100, 0xffffff80, 0x8015700, 0x9005000, 0x1100, 0x600c540, 0xf460
    .long 0xa008380, 0x8380, 0xefed820, 0x8380, 0x1200c540, 0xfffed820, 0x14008380, 0x8380
    .long 0x16fed820, 0x8380, 0x18ffbe40, 0xfffed820, 0x1a00a460, 0x62a0, 0x1c008380, 0x8380
    .long 0x1d000000, 0xfffed820, 0x0, 0x0, 0x0, 0x0, 0x0, 0xff000000
    .long 0x0, 0x0, 0x0, 0x0, 0x0, 0x0, 0x0, 0x0
    .long 0x0, 0x0, 0x0, 0x0, 0x0, 0x0, 0x0, 0x0
    .long 0x0, 0x0, 0x0, 0x0, 0x0, 0x0, 0x0, 0x0
    .long 0x0, 0x0, 0x0, 0x0, 0x0, 0x0, 0x0, 0x0
    .long 0x9cf100, 0x1f100, 0xffffff80, 0xb01b9a0, 0x9005000, 0x1c00, 0x600c540, 0xf460
    .long 0xa008380, 0x8380, 0xefed820, 0x8380, 0x1200c540, 0xfffed820, 0x14008380, 0x8380
    .long 0x16fed820, 0x8380, 0x18ffbe40, 0xfffed820, 0x1a00a460, 0x62a0, 0x1c008380, 0x8380
    .long 0x1d000000, 0xfffed820, 0x0, 0x0, 0x0, 0x0, 0x0, 0xff000000
    .long 0x0, 0x0, 0x0, 0x0, 0x0, 0x0, 0x0, 0x0
    .long 0x0, 0x0, 0x0, 0x0, 0x0, 0x0, 0x0, 0x0
    .long 0x0, 0x0, 0x0, 0x0, 0x0, 0x0, 0x0, 0x0
    .long 0x0, 0x0, 0x0, 0x0, 0x0, 0x0, 0x0, 0x0
    .long 0x9ef100, 0x1f100, 0xffffff80, 0xc01da80, 0x9005000, 0x1c00, 0x600c540, 0xf460
    .long 0xa008380, 0x8380, 0xefed820, 0x8380, 0x1200c540, 0xfffed820, 0x14008380, 0x8380
    .long 0x16fed820, 0x8380, 0x18ffbe40, 0xfffed820, 0x1a00a460, 0x62a0, 0x1c008380, 0x8380
    .long 0x1d000000, 0xfffed820, 0x0, 0x0, 0x0, 0x0, 0x0, 0xff000000
    .long 0x0, 0x0, 0x0, 0x0, 0x0, 0x0, 0x0, 0x0
    .long 0x0, 0x0, 0x0, 0x0, 0x0, 0x0, 0x0, 0x0
    .long 0x0, 0x0, 0x0, 0x0, 0x0, 0x0, 0x0, 0x0
    .long 0x0, 0x0, 0x0, 0x0, 0x0, 0x0, 0x0, 0x0
    .long 0x92f100, 0x1f100, 0xffffff80, 0x10070e0, 0x9005000, 0x1c00, 0x600c540, 0xf460
    .long 0xa008380, 0x8380, 0xefed820, 0x8380, 0x1200c540, 0xfffed820, 0x14008380, 0x8380
    .long 0x16fed820, 0x8380, 0x18ffbe40, 0xfffed820, 0x1a00a460, 0x62a0, 0x1c008380, 0x8380
    .long 0x1d000000, 0xfffed820, 0x0, 0x0, 0x0, 0x0, 0x0, 0xff000000
    .long 0x0, 0x0, 0x0, 0x0, 0x0, 0x0, 0x0, 0x0
    .long 0x0, 0x0, 0x0, 0x0, 0x0, 0x0, 0x0, 0x0
    .long 0x0, 0x0, 0x0, 0x0, 0x0, 0x0, 0x0, 0x0
    .long 0x0, 0x0, 0x0, 0x0, 0x0, 0x0, 0x0, 0x0
    .long 0x94f100, 0x1f100, 0xffffff80, 0x20091c0, 0x9005000, 0x1c00, 0x600c540, 0xf460
    .long 0xa008380, 0x8380, 0xefed820, 0x8380, 0x1200c540, 0xfffed820, 0x14008380, 0x8380
    .long 0x16fed820, 0x8380, 0x18ffbe40, 0xfffed820, 0x1a00a460, 0x62a0, 0x1c008380, 0x8380
    .long 0x1d000000, 0xfffed820, 0x0, 0x0, 0x0, 0x0, 0x0, 0xff000000
    .long 0x0, 0x0, 0x0, 0x0, 0x0, 0x0, 0x0, 0x0
    .long 0x0, 0x0, 0x0, 0x0, 0x0, 0x0, 0x0, 0x0
    .long 0x0, 0x0, 0x0, 0x0, 0x0, 0x0, 0x0, 0x0
    .long 0x0, 0x0, 0x0, 0x0, 0x0, 0x0, 0x0, 0x0
    .long 0xa0f100, 0x1f100, 0xffffff80, 0xf0091c0, 0x9005000, 0x1000, 0x600c540, 0xf460
    .long 0xa008380, 0x8380, 0xefed820, 0x8380, 0x1200c540, 0xfffed820, 0x14008380, 0x8380
    .long 0x16fed820, 0x8380, 0x18ffbe40, 0xfffed820, 0x1a00a460, 0x62a0, 0x1c008380, 0x8380
    .long 0x1d000000, 0xfffed820, 0x0, 0x0, 0x0, 0x0, 0x0, 0xff000000
    .long 0x0, 0x0, 0x0, 0x0, 0x0, 0x0, 0x0, 0x0
    .long 0x0, 0x0, 0x0, 0x0, 0x0, 0x0, 0x0, 0x0
    .long 0x0, 0x0, 0x0, 0x0, 0x0, 0x0, 0x0, 0x0
    .long 0x0, 0x0, 0x0, 0x0, 0x0, 0x0, 0x0, 0x0
    .long 0xa2f100, 0x1f100, 0xffffff80, 0x1000b2a0, 0x9005000, 0x1000, 0x600c540, 0xf460
    .long 0xa008380, 0x8380, 0xefed820, 0x8380, 0x1200c540, 0xfffed820, 0x14008380, 0x8380
    .long 0x16fed820, 0x8380, 0x18ffbe40, 0xfffed820, 0x1a00a460, 0x62a0, 0x1c008380, 0x8380
    .long 0x1d000000, 0xfffed820, 0x0, 0x0, 0x0, 0x0, 0x0, 0xff000000
    .long 0x0, 0x0, 0x0, 0x0, 0x0, 0x0, 0x0, 0x0
    .long 0x0, 0x0, 0x0, 0x0, 0x0, 0x0, 0x0, 0x0
    .long 0x0, 0x0, 0x0, 0x0, 0x0, 0x0, 0x0, 0x0
    .long 0x0, 0x0, 0x0, 0x0, 0x0, 0x0, 0x0, 0x0
    .long 0x96f100, 0x1f100, 0xffffff80, 0x300b2a0, 0x9005000, 0x1000, 0x600c540, 0xf460
    .long 0xa008380, 0x8380, 0xefed820, 0x8380, 0x1200c540, 0xfffed820, 0x14008380, 0x8380
    .long 0x16fed820, 0x8380, 0x18ffbe40, 0xfffed820, 0x1a00a460, 0x62a0, 0x1c008380, 0x8380
    .long 0x1d000000, 0xfffed820, 0x0, 0x0, 0x0, 0x0, 0x0, 0xff000000
    .long 0x0, 0x0, 0x0, 0x0, 0x0, 0x0, 0x0, 0x0
    .long 0x0, 0x0, 0x0, 0x0, 0x0, 0x0, 0x0, 0x0
    .long 0x0, 0x0, 0x0, 0x0, 0x0, 0x0, 0x0, 0x0
    .long 0x0, 0x0, 0x0, 0x0, 0x0, 0x0, 0x0, 0x0
    .long 0x98f100, 0x1f100, 0xffffff80, 0x400d380, 0x9005000, 0x1000, 0x600c540, 0xf460
    .long 0xa008380, 0x8380, 0xefed820, 0x8380, 0x1200c540, 0xfffed820, 0x14008380, 0x8380
    .long 0x16fed820, 0x8380, 0x18ffbe40, 0xfffed820, 0x1a00a460, 0x62a0, 0x1c008380, 0x8380
    .long 0x1d000000, 0xfffed820, 0x0, 0x0, 0x0, 0x0, 0x0, 0xff000000
    .long 0x0, 0x0, 0x0, 0x0, 0x0, 0x0, 0x0, 0x0
    .long 0x0, 0x0, 0x0, 0x0, 0x0, 0x0, 0x0, 0x0
    .long 0x0, 0x0, 0x0, 0x0, 0x0, 0x0, 0x0, 0x0
    .long 0x0, 0x0, 0x0, 0x0, 0x0, 0x0, 0x0, 0x0
    .long 0x92f100, 0xa5600e, 0x94f100, 0x4a5600c, 0x98f100, 0x8a5600c, 0x94f100, 0xca5600e
    .long 0xa4f100, 0x10a5600c, 0x96f100, 0x14a5600e, 0x9ef100, 0x18a5600c, 0x298f104, 0x2a5600e
    .long 0x2a2f140, 0x6a5600c, 0x29af300, 0xea5600e, 0x29cf101, 0x16a5600e, 0x29ef110, 0x4a5600e
    .long 0x2a0f7ff, 0xa5600e, 0x4a2f7ff, 0xaa5600e, 0x6a4f7ff, 0x12a5600e, 0x0, 0x0
    .long 0x0, 0x0, 0x0, 0x0, 0x0, 0x0, 0x0, 0x0
    .long 0x0, 0x0, 0x0, 0x0, 0x0, 0x0, 0x0, 0x0
    .long 0x0, 0x0, 0x0, 0x0, 0x0, 0x0, 0x0, 0x0
    .long 0x0, 0x0, 0x0, 0x0, 0x0, 0x0, 0x0, 0x0
    .long 0x92f100, 0x2a5600c, 0x96f100, 0x6a5600c, 0x92f100, 0xaa5600d, 0x9af100, 0xea5600c
    .long 0x94f100, 0x12a5600d, 0x9cf100, 0x16a5600c, 0x96f100, 0x1aa5600d, 0x2a0f108, 0x4a5600c
    .long 0x298f180, 0x8a5600d, 0x29af500, 0x10a5600d, 0x29cf102, 0x18a5600d, 0x29ef120, 0x6a5600d
    .long 0x4a0f7ff, 0xca5600d, 0x6a2f7ff, 0x14a5600d, 0x8a4f7ff, 0x2a5600d, 0x0, 0x0
    .long 0x0, 0x0, 0x0, 0x0, 0x0, 0x0, 0x0, 0x0
    .long 0x0, 0x0, 0x0, 0x0, 0x0, 0x0, 0x0, 0x0
    .long 0x0, 0x0, 0x0, 0x0, 0x0, 0x0, 0x0, 0x0
    .long 0x0, 0x0, 0x0, 0x0, 0x0, 0x0, 0x0, 0x0
    .long 0x9af100, 0x1f100, 0xffffff80, 0x7013620, 0x9005000, 0x1000, 0x600c540, 0xf460
    .long 0xa008380, 0x8380, 0xefed820, 0x8380, 0x1200c540, 0xfffed820, 0x14008380, 0x8380
    .long 0x16fed820, 0x8380, 0x18ffbe40, 0xfffed820, 0x1a00a460, 0x62a0, 0x1c008380, 0x8380
    .long 0x1d000000, 0xfffed820, 0x0, 0x0, 0x0, 0x0, 0x0, 0xff000000
    .long 0x0, 0x0, 0x0, 0x0, 0x0, 0x0, 0x0, 0x0
    .long 0x0, 0x0, 0x0, 0x0, 0x0, 0x0, 0x0, 0x0
    .long 0x0, 0x0, 0x0, 0x0, 0x0, 0x0, 0x0, 0x0
    .long 0x0, 0x0, 0x0, 0x0, 0x0, 0x0, 0x0, 0x0
    .long 0xa4f100, 0x6100, 0xffffff80, 0x8015700, 0x9005000, 0x1100, 0x600c540, 0xf460
    .long 0xa008380, 0x8380, 0xefed820, 0x8380, 0x1200c540, 0xfffed820, 0x14008380, 0x8380
    .long 0x16fed820, 0x8380, 0x18ffbe40, 0xfffed820, 0x1a00a460, 0x62a0, 0x1c008380, 0x8380
    .long 0x1d000000, 0xfffed820, 0x0, 0x0, 0x0, 0x0, 0x0, 0xff000000
    .long 0x0, 0x0, 0x0, 0x0, 0x0, 0x0, 0x0, 0x0
    .long 0x0, 0x0, 0x0, 0x0, 0x0, 0x0, 0x0, 0x0
    .long 0x0, 0x0, 0x0, 0x0, 0x0, 0x0, 0x0, 0x0
    .long 0x0, 0x0, 0x0, 0x0, 0x0, 0x0, 0x0, 0x0
    .long 0x9cf100, 0x1f100, 0xffffff80, 0xb01b9a0, 0x9005000, 0x1c00, 0x600c540, 0xf460
    .long 0xa008380, 0x8380, 0xefed820, 0x8380, 0x1200c540, 0xfffed820, 0x14008380, 0x8380
    .long 0x16fed820, 0x8380, 0x18ffbe40, 0xfffed820, 0x1a00a460, 0x62a0, 0x1c008380, 0x8380
    .long 0x1d000000, 0xfffed820, 0x0, 0x0, 0x0, 0x0, 0x0, 0xff000000
    .long 0x0, 0x0, 0x0, 0x0, 0x0, 0x0, 0x0, 0x0
    .long 0x0, 0x0, 0x0, 0x0, 0x0, 0x0, 0x0, 0x0
    .long 0x0, 0x0, 0x0, 0x0, 0x0, 0x0, 0x0, 0x0
    .long 0x0, 0x0, 0x0, 0x0, 0x0, 0x0, 0x0, 0x0
    .long 0x9ef100, 0x1f100, 0xffffff80, 0xc01da80, 0x9005000, 0x1c00, 0x600c540, 0xf460
    .long 0xa008380, 0x8380, 0xefed820, 0x8380, 0x1200c540, 0xfffed820, 0x14008380, 0x8380
    .long 0x16fed820, 0x8380, 0x18ffbe40, 0xfffed820, 0x1a00a460, 0x62a0, 0x1c008380, 0x8380
    .long 0x1d000000, 0xfffed820, 0x0, 0x0, 0x0, 0x0, 0x0, 0xff000000
    .long 0x0, 0x0, 0x0, 0x0, 0x0, 0x0, 0x0, 0x0
    .long 0x0, 0x0, 0x0, 0x0, 0x0, 0x0, 0x0, 0x0
    .long 0x0, 0x0, 0x0, 0x0, 0x0, 0x0, 0x0, 0x0
    .long 0x0, 0x0, 0x0, 0x0, 0x0, 0x0, 0x0, 0x0
    .long 0x92f100, 0x1f100, 0xffffff80, 0x10070e0, 0x9005000, 0x1c00, 0x600c540, 0xf460
    .long 0xa008380, 0x8380, 0xefed820, 0x8380, 0x1200c540, 0xfffed820, 0x14008380, 0x8380
    .long 0x16fed820, 0x8380, 0x18ffbe40, 0xfffed820, 0x1a00a460, 0x62a0, 0x1c008380, 0x8380
    .long 0x1d000000, 0xfffed820, 0x0, 0x0, 0x0, 0x0, 0x0, 0xff000000
    .long 0x0, 0x0, 0x0, 0x0, 0x0, 0x0, 0x0, 0x0
    .long 0x0, 0x0, 0x0, 0x0, 0x0, 0x0, 0x0, 0x0
    .long 0x0, 0x0, 0x0, 0x0, 0x0, 0x0, 0x0, 0x0
    .long 0x0, 0x0, 0x0, 0x0, 0x0, 0x0, 0x0, 0x0
    .long 0x94f100, 0x1f100, 0xffffff80, 0x20091c0, 0x9005000, 0x1c00, 0x600c540, 0xf460
    .long 0xa008380, 0x8380, 0xefed820, 0x8380, 0x1200c540, 0xfffed820, 0x14008380, 0x8380
    .long 0x16fed820, 0x8380, 0x18ffbe40, 0xfffed820, 0x1a00a460, 0x62a0, 0x1c008380, 0x8380
    .long 0x1d000000, 0xfffed820, 0x0, 0x0, 0x0, 0x0, 0x0, 0xff000000
    .long 0x0, 0x0, 0x0, 0x0, 0x0, 0x0, 0x0, 0x0
    .long 0x0, 0x0, 0x0, 0x0, 0x0, 0x0, 0x0, 0x0
    .long 0x0, 0x0, 0x0, 0x0, 0x0, 0x0, 0x0, 0x0
    .long 0x0, 0x0, 0x0, 0x0, 0x0, 0x0, 0x0, 0x0
    .long 0xa0f100, 0x1f100, 0xffffff80, 0xf0091c0, 0x9005000, 0x1000, 0x600c540, 0xf460
    .long 0xa008380, 0x8380, 0xefed820, 0x8380, 0x1200c540, 0xfffed820, 0x14008380, 0x8380
    .long 0x16fed820, 0x8380, 0x18ffbe40, 0xfffed820, 0x1a00a460, 0x62a0, 0x1c008380, 0x8380
    .long 0x1d000000, 0xfffed820, 0x0, 0x0, 0x0, 0x0, 0x0, 0xff000000
    .long 0x0, 0x0, 0x0, 0x0, 0x0, 0x0, 0x0, 0x0
    .long 0x0, 0x0, 0x0, 0x0, 0x0, 0x0, 0x0, 0x0
    .long 0x0, 0x0, 0x0, 0x0, 0x0, 0x0, 0x0, 0x0
    .long 0x0, 0x0, 0x0, 0x0, 0x0, 0x0, 0x0, 0x0
    .long 0xa2f100, 0x1f100, 0xffffff80, 0x1000b2a0, 0x9005000, 0x1000, 0x600c540, 0xf460
    .long 0xa008380, 0x8380, 0xefed820, 0x8380, 0x1200c540, 0xfffed820, 0x14008380, 0x8380
    .long 0x16fed820, 0x8380, 0x18ffbe40, 0xfffed820, 0x1a00a460, 0x62a0, 0x1c008380, 0x8380
    .long 0x1d000000, 0xfffed820, 0x0, 0x0, 0x0, 0x0, 0x0, 0xff000000
    .long 0x0, 0x0, 0x0, 0x0, 0x0, 0x0, 0x0, 0x0
    .long 0x0, 0x0, 0x0, 0x0, 0x0, 0x0, 0x0, 0x0
    .long 0x0, 0x0, 0x0, 0x0, 0x0, 0x0, 0x0, 0x0
    .long 0x0, 0x0, 0x0, 0x0, 0x0, 0x0, 0x0, 0x0
    .long 0x96f100, 0x1f100, 0xffffff80, 0x300b2a0, 0x9005000, 0x1000, 0x600c540, 0xf460
    .long 0xa008380, 0x8380, 0xefed820, 0x8380, 0x1200c540, 0xfffed820, 0x14008380, 0x8380
    .long 0x16fed820, 0x8380, 0x18ffbe40, 0xfffed820, 0x1a00a460, 0x62a0, 0x1c008380, 0x8380
    .long 0x1d000000, 0xfffed820, 0x0, 0x0, 0x0, 0x0, 0x0, 0xff000000
    .long 0x0, 0x0, 0x0, 0x0, 0x0, 0x0, 0x0, 0x0
    .long 0x0, 0x0, 0x0, 0x0, 0x0, 0x0, 0x0, 0x0
    .long 0x0, 0x0, 0x0, 0x0, 0x0, 0x0, 0x0, 0x0
    .long 0x0, 0x0, 0x0, 0x0, 0x0, 0x0, 0x0, 0x0
    .long 0x98f100, 0x1f100, 0xffffff80, 0x400d380, 0x9005000, 0x1000, 0x600c540, 0xf460
    .long 0xa008380, 0x8380, 0xefed820, 0x8380, 0x1200c540, 0xfffed820, 0x14008380, 0x8380
    .long 0x16fed820, 0x8380, 0x18ffbe40, 0xfffed820, 0x1a00a460, 0x62a0, 0x1c008380, 0x8380
    .long 0x1d000000, 0xfffed820, 0x0, 0x0, 0x0, 0x0, 0x0, 0xff000000
    .long 0x0, 0x0, 0x0, 0x0, 0x0, 0x0, 0x0, 0x0
    .long 0x0, 0x0, 0x0, 0x0, 0x0, 0x0, 0x0, 0x0
    .long 0x0, 0x0, 0x0, 0x0, 0x0, 0x0, 0x0, 0x0
    .long 0x0, 0x0, 0x0, 0x0, 0x0, 0x0, 0x0, 0x0
    .long 0x100, 0x14100e, 0x20100, 0x414100c, 0x60100, 0x814100c, 0x20100, 0xc14100e
    .long 0x40100, 0x1014100e, 0xa0100, 0x1414100c, 0x20e0101, 0x214100c, 0x2060104, 0x614100e
    .long 0x2080110, 0x1214100e, 0x20a0140, 0x1614100e, 0x20c0180, 0x214100e, 0x40e01ff, 0xa14100e
    .long 0x61001ff, 0x1014100e, 0x81201ff, 0x614100e, 0xa1401ff, 0x814100e, 0x0, 0x0
    .long 0x0, 0x0, 0x0, 0x0, 0x0, 0x0, 0x0, 0x0
    .long 0x0, 0x0, 0x0, 0x0, 0x0, 0x0, 0x0, 0x0
    .long 0x0, 0x0, 0x0, 0x0, 0x0, 0x0, 0x0, 0x0
    .long 0x0, 0x0, 0x0, 0x0, 0x0, 0x0, 0x0, 0x0
    .long 0x100, 0x214100c, 0x40100, 0x614100c, 0x100, 0xa14100d, 0x20100, 0xe14100d
    .long 0x80100, 0x1214100c, 0xc0100, 0x1614100c, 0x2040102, 0x414100d, 0x2060108, 0x814100d
    .long 0x2080120, 0x1414100d, 0x20a01ff, 0x14100d, 0x40c01ff, 0xc14100d, 0x60e01ff, 0xe14100d
    .long 0x81001ff, 0x414100d, 0xa1201ff, 0x1214100d, 0xc1401ff, 0x1414100d, 0x0, 0x0
    .long 0x0, 0x0, 0x0, 0x0, 0x0, 0x0, 0x0, 0x0
    .long 0x0, 0x0, 0x0, 0x0, 0x0, 0x0, 0x0, 0x0
    .long 0x0, 0x0, 0x0, 0x0, 0x0, 0x0, 0x0, 0x0
    .long 0x0, 0x0, 0x0, 0x0, 0x0, 0x0, 0x0, 0x0
    .long 0x0, 0x0, 0x0, 0x0, 0x0, 0xff000000, 0x0, 0x0
    .long 0x0, 0x0, 0x0, 0x0, 0x0, 0x0, 0x0, 0x0
    .long 0x0, 0x0, 0x0, 0x0, 0x0, 0x0, 0x0, 0x0
    .long 0x0, 0x0, 0x0, 0x0, 0x0, 0x0, 0x0, 0x0
    .long 0x0, 0x0, 0x0, 0x0, 0x0, 0x0, 0x0, 0x0
    .long 0x0, 0x0, 0x0, 0x0, 0x0, 0x0, 0x0, 0x0
    .long 0x0, 0x0, 0x0, 0x0, 0x0, 0x0, 0x0, 0x0
    .long 0x0, 0x0, 0x0, 0x0, 0x0, 0x0, 0x0, 0x0
    .long 0x0, 0x0, 0x0, 0x0, 0x0, 0xff000000, 0x0, 0x0
    .long 0x0, 0x0, 0x0, 0x0, 0x0, 0x0, 0x0, 0x0
    .long 0x0, 0x0, 0x0, 0x0, 0x0, 0x0, 0x0, 0x0
    .long 0x0, 0x0, 0x0, 0x0, 0x0, 0x0, 0x0, 0x0
    .long 0x0, 0x0, 0x0, 0x0, 0x0, 0x0, 0x0, 0x0
    .long 0x0, 0x0, 0x0, 0x0, 0x0, 0x0, 0x0, 0x0
    .long 0x0, 0x0, 0x0, 0x0, 0x0, 0x0, 0x0, 0x0
    .long 0x0, 0x0, 0x0, 0x0, 0x0, 0x0, 0x0, 0x0
    .long 0x100, 0x1f100, 0xfffffffe, 0x10070e0, 0xa005000, 0x1c00, 0x600c540, 0xf460
    .long 0x80041c0, 0x41c0, 0xeff5ba0, 0xffff5ba0, 0x1000c540, 0x41c0, 0x120041c0, 0xc540
    .long 0x14feb740, 0xfffeb740, 0x16008380, 0xc540, 0x180062a0, 0x20e0, 0x1aff5ba0, 0xffff5ba0
    .long 0x1c0020e0, 0xe620, 0x1d000000, 0x20e0, 0x0, 0x0, 0x0, 0x0
    .long 0x0, 0xff000000, 0x0, 0x0, 0x0, 0x0, 0x0, 0x0
    .long 0x0, 0x0, 0x0, 0x0, 0x0, 0x0, 0x0, 0x0
    .long 0x0, 0x0, 0x0, 0x0, 0x0, 0x0, 0x0, 0x0
    .long 0x0, 0x0, 0x0, 0x0, 0x0, 0x0, 0x0, 0x0
    .long 0x20100, 0x1f100, 0xfffffffe, 0x20091c0, 0xa005000, 0x1c00, 0x600c540, 0xf460
    .long 0x80041c0, 0x41c0, 0xeff5ba0, 0xffff5ba0, 0x1000c540, 0x41c0, 0x120041c0, 0xc540
    .long 0x14feb740, 0xfffeb740, 0x16008380, 0xc540, 0x180062a0, 0x20e0, 0x1aff5ba0, 0xffff5ba0
    .long 0x1c0020e0, 0xe620, 0x1d000000, 0x20e0, 0x0, 0x0, 0x0, 0x0
    .long 0x0, 0xff000000, 0x0, 0x0, 0x0, 0x0, 0x0, 0x0
    .long 0x0, 0x0, 0x0, 0x0, 0x0, 0x0, 0x0, 0x0
    .long 0x0, 0x0, 0x0, 0x0, 0x0, 0x0, 0x0, 0x0
    .long 0x0, 0x0, 0x0, 0x0, 0x0, 0x0, 0x0, 0x0
    .long 0x40100, 0x1f100, 0xfffffffe, 0x300b2a0, 0xa005000, 0x1c00, 0x600c540, 0xf460
    .long 0x80041c0, 0x41c0, 0xeff5ba0, 0xffff5ba0, 0x1000c540, 0x41c0, 0x120041c0, 0xc540
    .long 0x14feb740, 0xfffeb740, 0x16008380, 0xc540, 0x180062a0, 0x20e0, 0x1aff5ba0, 0xffff5ba0
    .long 0x1c0020e0, 0xe620, 0x1d000000, 0x20e0, 0x0, 0x0, 0x0, 0x0
    .long 0x0, 0xff000000, 0x0, 0x0, 0x0, 0x0, 0x0, 0x0
    .long 0x0, 0x0, 0x0, 0x0, 0x0, 0x0, 0x0, 0x0
    .long 0x0, 0x0, 0x0, 0x0, 0x0, 0x0, 0x0, 0x0
    .long 0x0, 0x0, 0x0, 0x0, 0x0, 0x0, 0x0, 0x0
    .long 0x60100, 0x1f100, 0xfffffffe, 0x400d380, 0xa005000, 0x1c00, 0x600c540, 0xf460
    .long 0x80041c0, 0x41c0, 0xeff5ba0, 0xffff5ba0, 0x1000c540, 0x41c0, 0x120041c0, 0xc540
    .long 0x14feb740, 0xfffeb740, 0x16008380, 0xc540, 0x180062a0, 0x20e0, 0x1aff5ba0, 0xffff5ba0
    .long 0x1c0020e0, 0xe620, 0x1d000000, 0x20e0, 0x0, 0x0, 0x0, 0x0
    .long 0x0, 0xff000000, 0x0, 0x0, 0x0, 0x0, 0x0, 0x0
    .long 0x0, 0x0, 0x0, 0x0, 0x0, 0x0, 0x0, 0x0
    .long 0x0, 0x0, 0x0, 0x0, 0x0, 0x0, 0x0, 0x0
    .long 0x0, 0x0, 0x0, 0x0, 0x0, 0x0, 0x0, 0x0
    .long 0x80100, 0x1f100, 0xfffffffe, 0x90177e0, 0xa005000, 0x1000, 0x600c540, 0xf460
    .long 0x80041c0, 0x41c0, 0xeff5ba0, 0xffff5ba0, 0x1000c540, 0x41c0, 0x120041c0, 0xc540
    .long 0x14feb740, 0xfffeb740, 0x16008380, 0xc540, 0x180062a0, 0x20e0, 0x1aff5ba0, 0xffff5ba0
    .long 0x1c0020e0, 0xe620, 0x1d000000, 0x20e0, 0x0, 0x0, 0x0, 0x0
    .long 0x0, 0xff000000, 0x0, 0x0, 0x0, 0x0, 0x0, 0x0
    .long 0x0, 0x0, 0x0, 0x0, 0x0, 0x0, 0x0, 0x0
    .long 0x0, 0x0, 0x0, 0x0, 0x0, 0x0, 0x0, 0x0
    .long 0x0, 0x0, 0x0, 0x0, 0x0, 0x0, 0x0, 0x0
    .long 0xa0100, 0x1f100, 0xfffffffe, 0xa0198c0, 0xa005000, 0x1000, 0x600c540, 0xf460
    .long 0x80041c0, 0x41c0, 0xeff5ba0, 0xffff5ba0, 0x1000c540, 0x41c0, 0x120041c0, 0xc540
    .long 0x14feb740, 0xfffeb740, 0x16008380, 0xc540, 0x180062a0, 0x20e0, 0x1aff5ba0, 0xffff5ba0
    .long 0x1c0020e0, 0xe620, 0x1d000000, 0x20e0, 0x0, 0x0, 0x0, 0x0
    .long 0x0, 0xff000000, 0x0, 0x0, 0x0, 0x0, 0x0, 0x0
    .long 0x0, 0x0, 0x0, 0x0, 0x0, 0x0, 0x0, 0x0
    .long 0x0, 0x0, 0x0, 0x0, 0x0, 0x0, 0x0, 0x0
    .long 0x0, 0x0, 0x0, 0x0, 0x0, 0x0, 0x0, 0x0
    .long 0xc0100, 0x1f100, 0xfffffffe, 0xb01b9a0, 0xa005000, 0x1000, 0x600c540, 0xf460
    .long 0x80041c0, 0x41c0, 0xeff5ba0, 0xffff5ba0, 0x1000c540, 0x41c0, 0x120041c0, 0xc540
    .long 0x14feb740, 0xfffeb740, 0x16008380, 0xc540, 0x180062a0, 0x20e0, 0x1aff5ba0, 0xffff5ba0
    .long 0x1c0020e0, 0xe620, 0x1d000000, 0x20e0, 0x0, 0x0, 0x0, 0x0
    .long 0x0, 0xff000000, 0x0, 0x0, 0x0, 0x0, 0x0, 0x0
    .long 0x0, 0x0, 0x0, 0x0, 0x0, 0x0, 0x0, 0x0
    .long 0x0, 0x0, 0x0, 0x0, 0x0, 0x0, 0x0, 0x0
    .long 0x0, 0x0, 0x0, 0x0, 0x0, 0x0, 0x0, 0x0
    .long 0xe0100, 0x1f100, 0xfffffffe, 0xc0070e0, 0xa005000, 0x1000, 0x600c540, 0xf460
    .long 0x80041c0, 0x41c0, 0xeff5ba0, 0xffff5ba0, 0x1000c540, 0x41c0, 0x120041c0, 0xc540
    .long 0x14feb740, 0xfffeb740, 0x16008380, 0xc540, 0x180062a0, 0x20e0, 0x1aff5ba0, 0xffff5ba0
    .long 0x1c0020e0, 0xe620, 0x1d000000, 0x20e0, 0x0, 0x0, 0x0, 0x0
    .long 0x0, 0xff000000, 0x0, 0x0, 0x0, 0x0, 0x0, 0x0
    .long 0x0, 0x0, 0x0, 0x0, 0x0, 0x0, 0x0, 0x0
    .long 0x0, 0x0, 0x0, 0x0, 0x0, 0x0, 0x0, 0x0
    .long 0x0, 0x0, 0x0, 0x0, 0x0, 0x0, 0x0, 0x0
    .long 0x100, 0x14100e, 0x20100, 0x414100c, 0x60100, 0x814100c, 0x20100, 0xc14100e
    .long 0x40100, 0x1014100e, 0x60100, 0x1414100e, 0xa0100, 0x1814100c, 0x20e0101, 0x214100c
    .long 0x2080104, 0x614100e, 0x20a0110, 0x1614100e, 0x20c0140, 0x1a14100e, 0x20e01ff, 0x14100e
    .long 0x41001ff, 0xa14100e, 0x61201ff, 0x1014100e, 0x81401ff, 0x1414100e, 0x0, 0x0
    .long 0x0, 0x0, 0x0, 0x0, 0x0, 0x0, 0x0, 0x0
    .long 0x0, 0x0, 0x0, 0x0, 0x0, 0x0, 0x0, 0x0
    .long 0x0, 0x0, 0x0, 0x0, 0x0, 0x0, 0x0, 0x0
    .long 0x0, 0x0, 0x0, 0x0, 0x0, 0x0, 0x0, 0x0
    .long 0x100, 0x214100c, 0x40100, 0x614100c, 0x100, 0xa14100d, 0x20100, 0xe14100d
    .long 0x40100, 0x1214100d, 0x80100, 0x1614100c, 0xc0100, 0x1a14100c, 0x2060102, 0x414100d
    .long 0x2080108, 0x814100d, 0x20a0120, 0x1814100d, 0x20c0180, 0x214100d, 0x40e01ff, 0xc14100d
    .long 0x61001ff, 0xe14100d, 0x81201ff, 0x1214100d, 0xa1401ff, 0x414100d, 0x0, 0x0
    .long 0x0, 0x0, 0x0, 0x0, 0x0, 0x0, 0x0, 0x0
    .long 0x0, 0x0, 0x0, 0x0, 0x0, 0x0, 0x0, 0x0
    .long 0x0, 0x0, 0x0, 0x0, 0x0, 0x0, 0x0, 0x0
    .long 0x0, 0x0, 0x0, 0x0, 0x0, 0x0, 0x0, 0x0
    .long 0x0, 0x0, 0x0, 0x0, 0x0, 0xff000000, 0x0, 0x0
    .long 0x0, 0x0, 0x0, 0x0, 0x0, 0x0, 0x0, 0x0
    .long 0x0, 0x0, 0x0, 0x0, 0x0, 0x0, 0x0, 0x0
    .long 0x0, 0x0, 0x0, 0x0, 0x0, 0x0, 0x0, 0x0
    .long 0x0, 0x0, 0x0, 0x0, 0x0, 0x0, 0x0, 0x0
    .long 0x0, 0x0, 0x0, 0x0, 0x0, 0x0, 0x0, 0x0
    .long 0x0, 0x0, 0x0, 0x0, 0x0, 0x0, 0x0, 0x0
    .long 0x0, 0x0, 0x0, 0x0, 0x0, 0x0, 0x0, 0x0
    .long 0x0, 0x0, 0x0, 0x0, 0x0, 0xff000000, 0x0, 0x0
    .long 0x0, 0x0, 0x0, 0x0, 0x0, 0x0, 0x0, 0x0
    .long 0x0, 0x0, 0x0, 0x0, 0x0, 0x0, 0x0, 0x0
    .long 0x0, 0x0, 0x0, 0x0, 0x0, 0x0, 0x0, 0x0
    .long 0x0, 0x0, 0x0, 0x0, 0x0, 0x0, 0x0, 0x0
    .long 0x0, 0x0, 0x0, 0x0, 0x0, 0x0, 0x0, 0x0
    .long 0x0, 0x0, 0x0, 0x0, 0x0, 0x0, 0x0, 0x0
    .long 0x0, 0x0, 0x0, 0x0, 0x0, 0x0, 0x0, 0x0
    .long 0x100, 0x1f100, 0xfffffffe, 0x10070e0, 0xa005000, 0x1c00, 0x600c540, 0xf460
    .long 0x80041c0, 0x41c0, 0xa0041c0, 0x41c0, 0x10ff19e0, 0xffff19e0, 0x12010700, 0x41c0
    .long 0x140041c0, 0x10700, 0x16fe54a0, 0xfffe9660, 0x1800a460, 0xa460, 0x1a0062a0, 0x20e0
    .long 0x1c0041c0, 0x41c0, 0x1d000000, 0xffff19e0, 0x0, 0x0, 0x0, 0x0
    .long 0x0, 0xff000000, 0x0, 0x0, 0x0, 0x0, 0x0, 0x0
    .long 0x0, 0x0, 0x0, 0x0, 0x0, 0x0, 0x0, 0x0
    .long 0x0, 0x0, 0x0, 0x0, 0x0, 0x0, 0x0, 0x0
    .long 0x0, 0x0, 0x0, 0x0, 0x0, 0x0, 0x0, 0x0
    .long 0x20100, 0x1f100, 0xfffffffe, 0x20091c0, 0xa005000, 0x1c00, 0x600c540, 0xf460
    .long 0x80041c0, 0x41c0, 0xa0041c0, 0x41c0, 0x10ff19e0, 0xffff19e0, 0x12010700, 0x41c0
    .long 0x140041c0, 0x10700, 0x16fe54a0, 0xfffe9660, 0x1800a460, 0xa460, 0x1a0062a0, 0x20e0
    .long 0x1c0041c0, 0x41c0, 0x1d000000, 0xffff19e0, 0x0, 0x0, 0x0, 0x0
    .long 0x0, 0xff000000, 0x0, 0x0, 0x0, 0x0, 0x0, 0x0
    .long 0x0, 0x0, 0x0, 0x0, 0x0, 0x0, 0x0, 0x0
    .long 0x0, 0x0, 0x0, 0x0, 0x0, 0x0, 0x0, 0x0
    .long 0x0, 0x0, 0x0, 0x0, 0x0, 0x0, 0x0, 0x0
    .long 0x40100, 0x1f100, 0xfffffffe, 0x300b2a0, 0xa005000, 0x1c00, 0x600c540, 0xf460
    .long 0x80041c0, 0x41c0, 0xa0041c0, 0x41c0, 0x10ff19e0, 0xffff19e0, 0x12010700, 0x41c0
    .long 0x140041c0, 0x10700, 0x16fe54a0, 0xfffe9660, 0x1800a460, 0xa460, 0x1a0062a0, 0x20e0
    .long 0x1c0041c0, 0x41c0, 0x1d000000, 0xffff19e0, 0x0, 0x0, 0x0, 0x0
    .long 0x0, 0xff000000, 0x0, 0x0, 0x0, 0x0, 0x0, 0x0
    .long 0x0, 0x0, 0x0, 0x0, 0x0, 0x0, 0x0, 0x0
    .long 0x0, 0x0, 0x0, 0x0, 0x0, 0x0, 0x0, 0x0
    .long 0x0, 0x0, 0x0, 0x0, 0x0, 0x0, 0x0, 0x0
    .long 0x60100, 0x1f100, 0xfffffffe, 0x400d380, 0xa005000, 0x1c00, 0x600c540, 0xf460
    .long 0x80041c0, 0x41c0, 0xa0041c0, 0x41c0, 0x10ff19e0, 0xffff19e0, 0x12010700, 0x41c0
    .long 0x140041c0, 0x10700, 0x16fe54a0, 0xfffe9660, 0x1800a460, 0xa460, 0x1a0062a0, 0x20e0
    .long 0x1c0041c0, 0x41c0, 0x1d000000, 0xffff19e0, 0x0, 0x0, 0x0, 0x0
    .long 0x0, 0xff000000, 0x0, 0x0, 0x0, 0x0, 0x0, 0x0
    .long 0x0, 0x0, 0x0, 0x0, 0x0, 0x0, 0x0, 0x0
    .long 0x0, 0x0, 0x0, 0x0, 0x0, 0x0, 0x0, 0x0
    .long 0x0, 0x0, 0x0, 0x0, 0x0, 0x0, 0x0, 0x0
    .long 0x80100, 0x1f100, 0xfffffffe, 0xb01b9a0, 0xa005000, 0x1000, 0x600c540, 0xf460
    .long 0x80041c0, 0x41c0, 0xa0041c0, 0x41c0, 0x10ff19e0, 0xffff19e0, 0x12010700, 0x41c0
    .long 0x140041c0, 0x10700, 0x16fe54a0, 0xfffe9660, 0x1800a460, 0xa460, 0x1a0062a0, 0x20e0
    .long 0x1c0041c0, 0x41c0, 0x1d000000, 0xffff19e0, 0x0, 0x0, 0x0, 0x0
    .long 0x0, 0xff000000, 0x0, 0x0, 0x0, 0x0, 0x0, 0x0
    .long 0x0, 0x0, 0x0, 0x0, 0x0, 0x0, 0x0, 0x0
    .long 0x0, 0x0, 0x0, 0x0, 0x0, 0x0, 0x0, 0x0
    .long 0x0, 0x0, 0x0, 0x0, 0x0, 0x0, 0x0, 0x0
    .long 0xa0100, 0x1f100, 0xfffffffe, 0xc01da80, 0xa005000, 0x1000, 0x600c540, 0xf460
    .long 0x80041c0, 0x41c0, 0xa0041c0, 0x41c0, 0x10ff19e0, 0xffff19e0, 0x12010700, 0x41c0
    .long 0x140041c0, 0x10700, 0x16fe54a0, 0xfffe9660, 0x1800a460, 0xa460, 0x1a0062a0, 0x20e0
    .long 0x1c0041c0, 0x41c0, 0x1d000000, 0xffff19e0, 0x0, 0x0, 0x0, 0x0
    .long 0x0, 0xff000000, 0x0, 0x0, 0x0, 0x0, 0x0, 0x0
    .long 0x0, 0x0, 0x0, 0x0, 0x0, 0x0, 0x0, 0x0
    .long 0x0, 0x0, 0x0, 0x0, 0x0, 0x0, 0x0, 0x0
    .long 0x0, 0x0, 0x0, 0x0, 0x0, 0x0, 0x0, 0x0
    .long 0xc0100, 0x1f100, 0xfffffffe, 0xd01fb60, 0xa005000, 0x1000, 0x600c540, 0xf460
    .long 0x80041c0, 0x41c0, 0xa0041c0, 0x41c0, 0x10ff19e0, 0xffff19e0, 0x12010700, 0x41c0
    .long 0x140041c0, 0x10700, 0x16fe54a0, 0xfffe9660, 0x1800a460, 0xa460, 0x1a0062a0, 0x20e0
    .long 0x1c0041c0, 0x41c0, 0x1d000000, 0xffff19e0, 0x0, 0x0, 0x0, 0x0
    .long 0x0, 0xff000000, 0x0, 0x0, 0x0, 0x0, 0x0, 0x0
    .long 0x0, 0x0, 0x0, 0x0, 0x0, 0x0, 0x0, 0x0
    .long 0x0, 0x0, 0x0, 0x0, 0x0, 0x0, 0x0, 0x0
    .long 0x0, 0x0, 0x0, 0x0, 0x0, 0x0, 0x0, 0x0
    .long 0xe0100, 0x1f100, 0xfffffffe, 0xe0070e0, 0xa005000, 0x1000, 0x600c540, 0xf460
    .long 0x80041c0, 0x41c0, 0xa0041c0, 0x41c0, 0x10ff19e0, 0xffff19e0, 0x12010700, 0x41c0
    .long 0x140041c0, 0x10700, 0x16fe54a0, 0xfffe9660, 0x1800a460, 0xa460, 0x1a0062a0, 0x20e0
    .long 0x1c0041c0, 0x41c0, 0x1d000000, 0xffff19e0, 0x0, 0x0, 0x0, 0x0
    .long 0x0, 0xff000000, 0x0, 0x0, 0x0, 0x0, 0x0, 0x0
    .long 0x0, 0x0, 0x0, 0x0, 0x0, 0x0, 0x0, 0x0
    .long 0x0, 0x0, 0x0, 0x0, 0x0, 0x0, 0x0, 0x0
    .long 0x0, 0x0, 0x0, 0x0, 0x0, 0x0, 0x0, 0x0
    .long 0x92f000, 0xa5600e, 0x94f000, 0x4a5600c, 0x98f000, 0x8a5600c, 0x94f000, 0xca5600e
    .long 0xa4f000, 0x10a5600c, 0x96f000, 0x14a5600e, 0x9ef000, 0x18a5600c, 0x298f004, 0x2a5600e
    .long 0x2a2f040, 0x6a5600c, 0x29af200, 0xea5600e, 0x29cf001, 0x16a5600e, 0x29ef010, 0x4a5600e
    .long 0x2a0f6ff, 0xa5600e, 0x4a2f6ff, 0xaa5600e, 0x6a4f6ff, 0x12a5600e, 0x0, 0x0
    .long 0x0, 0x0, 0x0, 0x0, 0x0, 0x0, 0x0, 0x0
    .long 0x0, 0x0, 0x0, 0x0, 0x0, 0x0, 0x0, 0x0
    .long 0x0, 0x0, 0x0, 0x0, 0x0, 0x0, 0x0, 0x0
    .long 0x0, 0x0, 0x0, 0x0, 0x0, 0x0, 0x0, 0x0
    .long 0x92f000, 0x2a5600c, 0x96f000, 0x6a5600c, 0x92f000, 0xaa5600d, 0x9af000, 0xea5600c
    .long 0x94f000, 0x12a5600d, 0x9cf000, 0x16a5600c, 0x96f000, 0x1aa5600d, 0x2a0f008, 0x4a5600c
    .long 0x298f080, 0x8a5600d, 0x29af400, 0x10a5600d, 0x29cf002, 0x18a5600d, 0x29ef020, 0x6a5600d
    .long 0x4a0f6ff, 0xca5600d, 0x6a2f6ff, 0x14a5600d, 0x8a4f6ff, 0x2a5600d, 0x0, 0x0
    .long 0x0, 0x0, 0x0, 0x0, 0x0, 0x0, 0x0, 0x0
    .long 0x0, 0x0, 0x0, 0x0, 0x0, 0x0, 0x0, 0x0
    .long 0x0, 0x0, 0x0, 0x0, 0x0, 0x0, 0x0, 0x0
    .long 0x0, 0x0, 0x0, 0x0, 0x0, 0x0, 0x0, 0x0
    .long 0x9af000, 0x1f100, 0xffffff80, 0x7013620, 0x9005000, 0x1000, 0x600c540, 0xf460
    .long 0xa008380, 0x8380, 0xefed820, 0x8380, 0x1200c540, 0xfffed820, 0x14008380, 0x8380
    .long 0x16fed820, 0x8380, 0x18ffbe40, 0xfffed820, 0x1a00a460, 0x62a0, 0x1c008380, 0x8380
    .long 0x1d000000, 0xfffed820, 0x0, 0x0, 0x0, 0x0, 0x0, 0xff000000
    .long 0x0, 0x0, 0x0, 0x0, 0x0, 0x0, 0x0, 0x0
    .long 0x0, 0x0, 0x0, 0x0, 0x0, 0x0, 0x0, 0x0
    .long 0x0, 0x0, 0x0, 0x0, 0x0, 0x0, 0x0, 0x0
    .long 0x0, 0x0, 0x0, 0x0, 0x0, 0x0, 0x0, 0x0
    .long 0xa4f000, 0x6100, 0xffffff80, 0x8015700, 0x9005000, 0x1100, 0x600c540, 0xf460
    .long 0xa008380, 0x8380, 0xefed820, 0x8380, 0x1200c540, 0xfffed820, 0x14008380, 0x8380
    .long 0x16fed820, 0x8380, 0x18ffbe40, 0xfffed820, 0x1a00a460, 0x62a0, 0x1c008380, 0x8380
    .long 0x1d000000, 0xfffed820, 0x0, 0x0, 0x0, 0x0, 0x0, 0xff000000
    .long 0x0, 0x0, 0x0, 0x0, 0x0, 0x0, 0x0, 0x0
    .long 0x0, 0x0, 0x0, 0x0, 0x0, 0x0, 0x0, 0x0
    .long 0x0, 0x0, 0x0, 0x0, 0x0, 0x0, 0x0, 0x0
    .long 0x0, 0x0, 0x0, 0x0, 0x0, 0x0, 0x0, 0x0
    .long 0x9cf000, 0x1f100, 0xffffff80, 0xb01b9a0, 0x9005000, 0x1c00, 0x600c540, 0xf460
    .long 0xa008380, 0x8380, 0xefed820, 0x8380, 0x1200c540, 0xfffed820, 0x14008380, 0x8380
    .long 0x16fed820, 0x8380, 0x18ffbe40, 0xfffed820, 0x1a00a460, 0x62a0, 0x1c008380, 0x8380
    .long 0x1d000000, 0xfffed820, 0x0, 0x0, 0x0, 0x0, 0x0, 0xff000000
    .long 0x0, 0x0, 0x0, 0x0, 0x0, 0x0, 0x0, 0x0
    .long 0x0, 0x0, 0x0, 0x0, 0x0, 0x0, 0x0, 0x0
    .long 0x0, 0x0, 0x0, 0x0, 0x0, 0x0, 0x0, 0x0
    .long 0x0, 0x0, 0x0, 0x0, 0x0, 0x0, 0x0, 0x0
    .long 0x9ef000, 0x1f100, 0xffffff80, 0xc01da80, 0x9005000, 0x1c00, 0x600c540, 0xf460
    .long 0xa008380, 0x8380, 0xefed820, 0x8380, 0x1200c540, 0xfffed820, 0x14008380, 0x8380
    .long 0x16fed820, 0x8380, 0x18ffbe40, 0xfffed820, 0x1a00a460, 0x62a0, 0x1c008380, 0x8380
    .long 0x1d000000, 0xfffed820, 0x0, 0x0, 0x0, 0x0, 0x0, 0xff000000
    .long 0x0, 0x0, 0x0, 0x0, 0x0, 0x0, 0x0, 0x0
    .long 0x0, 0x0, 0x0, 0x0, 0x0, 0x0, 0x0, 0x0
    .long 0x0, 0x0, 0x0, 0x0, 0x0, 0x0, 0x0, 0x0
    .long 0x0, 0x0, 0x0, 0x0, 0x0, 0x0, 0x0, 0x0
    .long 0x92f000, 0x1f100, 0xffffff80, 0x10070e0, 0x9005000, 0x1c00, 0x600c540, 0xf460
    .long 0xa008380, 0x8380, 0xefed820, 0x8380, 0x1200c540, 0xfffed820, 0x14008380, 0x8380
    .long 0x16fed820, 0x8380, 0x18ffbe40, 0xfffed820, 0x1a00a460, 0x62a0, 0x1c008380, 0x8380
    .long 0x1d000000, 0xfffed820, 0x0, 0x0, 0x0, 0x0, 0x0, 0xff000000
    .long 0x0, 0x0, 0x0, 0x0, 0x0, 0x0, 0x0, 0x0
    .long 0x0, 0x0, 0x0, 0x0, 0x0, 0x0, 0x0, 0x0
    .long 0x0, 0x0, 0x0, 0x0, 0x0, 0x0, 0x0, 0x0
    .long 0x0, 0x0, 0x0, 0x0, 0x0, 0x0, 0x0, 0x0
    .long 0x94f000, 0x1f100, 0xffffff80, 0x20091c0, 0x9005000, 0x1c00, 0x600c540, 0xf460
    .long 0xa008380, 0x8380, 0xefed820, 0x8380, 0x1200c540, 0xfffed820, 0x14008380, 0x8380
    .long 0x16fed820, 0x8380, 0x18ffbe40, 0xfffed820, 0x1a00a460, 0x62a0, 0x1c008380, 0x8380
    .long 0x1d000000, 0xfffed820, 0x0, 0x0, 0x0, 0x0, 0x0, 0xff000000
    .long 0x0, 0x0, 0x0, 0x0, 0x0, 0x0, 0x0, 0x0
    .long 0x0, 0x0, 0x0, 0x0, 0x0, 0x0, 0x0, 0x0
    .long 0x0, 0x0, 0x0, 0x0, 0x0, 0x0, 0x0, 0x0
    .long 0x0, 0x0, 0x0, 0x0, 0x0, 0x0, 0x0, 0x0
    .long 0xa0f000, 0x1f100, 0xffffff80, 0xf0091c0, 0x9005000, 0x1000, 0x600c540, 0xf460
    .long 0xa008380, 0x8380, 0xefed820, 0x8380, 0x1200c540, 0xfffed820, 0x14008380, 0x8380
    .long 0x16fed820, 0x8380, 0x18ffbe40, 0xfffed820, 0x1a00a460, 0x62a0, 0x1c008380, 0x8380
    .long 0x1d000000, 0xfffed820, 0x0, 0x0, 0x0, 0x0, 0x0, 0xff000000
    .long 0x0, 0x0, 0x0, 0x0, 0x0, 0x0, 0x0, 0x0
    .long 0x0, 0x0, 0x0, 0x0, 0x0, 0x0, 0x0, 0x0
    .long 0x0, 0x0, 0x0, 0x0, 0x0, 0x0, 0x0, 0x0
    .long 0x0, 0x0, 0x0, 0x0, 0x0, 0x0, 0x0, 0x0
    .long 0xa2f000, 0x1f100, 0xffffff80, 0x1000b2a0, 0x9005000, 0x1000, 0x600c540, 0xf460
    .long 0xa008380, 0x8380, 0xefed820, 0x8380, 0x1200c540, 0xfffed820, 0x14008380, 0x8380
    .long 0x16fed820, 0x8380, 0x18ffbe40, 0xfffed820, 0x1a00a460, 0x62a0, 0x1c008380, 0x8380
    .long 0x1d000000, 0xfffed820, 0x0, 0x0, 0x0, 0x0, 0x0, 0xff000000
    .long 0x0, 0x0, 0x0, 0x0, 0x0, 0x0, 0x0, 0x0
    .long 0x0, 0x0, 0x0, 0x0, 0x0, 0x0, 0x0, 0x0
    .long 0x0, 0x0, 0x0, 0x0, 0x0, 0x0, 0x0, 0x0
    .long 0x0, 0x0, 0x0, 0x0, 0x0, 0x0, 0x0, 0x0
    .long 0x96f000, 0x1f100, 0xffffff80, 0x300b2a0, 0x9005000, 0x1000, 0x600c540, 0xf460
    .long 0xa008380, 0x8380, 0xefed820, 0x8380, 0x1200c540, 0xfffed820, 0x14008380, 0x8380
    .long 0x16fed820, 0x8380, 0x18ffbe40, 0xfffed820, 0x1a00a460, 0x62a0, 0x1c008380, 0x8380
    .long 0x1d000000, 0xfffed820, 0x0, 0x0, 0x0, 0x0, 0x0, 0xff000000
    .long 0x0, 0x0, 0x0, 0x0, 0x0, 0x0, 0x0, 0x0
    .long 0x0, 0x0, 0x0, 0x0, 0x0, 0x0, 0x0, 0x0
    .long 0x0, 0x0, 0x0, 0x0, 0x0, 0x0, 0x0, 0x0
    .long 0x0, 0x0, 0x0, 0x0, 0x0, 0x0, 0x0, 0x0
    .long 0x98f000, 0x1f100, 0xffffff80, 0x400d380, 0x9005000, 0x1000, 0x600c540, 0xf460
    .long 0xa008380, 0x8380, 0xefed820, 0x8380, 0x1200c540, 0xfffed820, 0x14008380, 0x8380
    .long 0x16fed820, 0x8380, 0x18ffbe40, 0xfffed820, 0x1a00a460, 0x62a0, 0x1c008380, 0x8380
    .long 0x1d000000, 0xfffed820, 0x0, 0x0, 0x0, 0x0, 0x0, 0xff000000
    .long 0x0, 0x0, 0x0, 0x0, 0x0, 0x0, 0x0, 0x0
    .long 0x0, 0x0, 0x0, 0x0, 0x0, 0x0, 0x0, 0x0
    .long 0x0, 0x0, 0x0, 0x0, 0x0, 0x0, 0x0, 0x0
    .long 0x0, 0x0, 0x0, 0x0, 0x0, 0x0, 0x0, 0x0
    .long 0x92f000, 0xa5600e, 0x94f000, 0x4a5600c, 0x98f000, 0x8a5600c, 0x94f000, 0xca5600e
    .long 0xa4f000, 0x10a5600c, 0x96f000, 0x14a5600e, 0x9ef000, 0x18a5600c, 0x298f004, 0x2a5600e
    .long 0x2a2f040, 0x6a5600c, 0x29af200, 0xea5600e, 0x29cf001, 0x16a5600e, 0x29ef010, 0x4a5600e
    .long 0x2a0f6ff, 0xa5600e, 0x4a2f6ff, 0xaa5600e, 0x6a4f6ff, 0x12a5600e, 0x0, 0x0
    .long 0x0, 0x0, 0x0, 0x0, 0x0, 0x0, 0x0, 0x0
    .long 0x0, 0x0, 0x0, 0x0, 0x0, 0x0, 0x0, 0x0
    .long 0x0, 0x0, 0x0, 0x0, 0x0, 0x0, 0x0, 0x0
    .long 0x0, 0x0, 0x0, 0x0, 0x0, 0x0, 0x0, 0x0
    .long 0x92f000, 0x2a5600c, 0x96f000, 0x6a5600c, 0x92f000, 0xaa5600d, 0x9af000, 0xea5600c
    .long 0x94f000, 0x12a5600d, 0x9cf000, 0x16a5600c, 0x96f000, 0x1aa5600d, 0x2a0f008, 0x4a5600c
    .long 0x298f080, 0x8a5600d, 0x29af400, 0x10a5600d, 0x29cf002, 0x18a5600d, 0x29ef020, 0x6a5600d
    .long 0x4a0f6ff, 0xca5600d, 0x6a2f6ff, 0x14a5600d, 0x8a4f6ff, 0x2a5600d, 0x0, 0x0
    .long 0x0, 0x0, 0x0, 0x0, 0x0, 0x0, 0x0, 0x0
    .long 0x0, 0x0, 0x0, 0x0, 0x0, 0x0, 0x0, 0x0
    .long 0x0, 0x0, 0x0, 0x0, 0x0, 0x0, 0x0, 0x0
    .long 0x0, 0x0, 0x0, 0x0, 0x0, 0x0, 0x0, 0x0
    .long 0x9af000, 0x1f100, 0xffffff80, 0x7013620, 0x9005000, 0x1000, 0x600c540, 0xf460
    .long 0xa008380, 0x8380, 0xefed820, 0x8380, 0x1200c540, 0xfffed820, 0x14008380, 0x8380
    .long 0x16fed820, 0x8380, 0x18ffbe40, 0xfffed820, 0x1a00a460, 0x62a0, 0x1c008380, 0x8380
    .long 0x1d000000, 0xfffed820, 0x0, 0x0, 0x0, 0x0, 0x0, 0xff000000
    .long 0x0, 0x0, 0x0, 0x0, 0x0, 0x0, 0x0, 0x0
    .long 0x0, 0x0, 0x0, 0x0, 0x0, 0x0, 0x0, 0x0
    .long 0x0, 0x0, 0x0, 0x0, 0x0, 0x0, 0x0, 0x0
    .long 0x0, 0x0, 0x0, 0x0, 0x0, 0x0, 0x0, 0x0
    .long 0xa4f000, 0x6100, 0xffffff80, 0x8015700, 0x9005000, 0x1100, 0x600c540, 0xf460
    .long 0xa008380, 0x8380, 0xefed820, 0x8380, 0x1200c540, 0xfffed820, 0x14008380, 0x8380
    .long 0x16fed820, 0x8380, 0x18ffbe40, 0xfffed820, 0x1a00a460, 0x62a0, 0x1c008380, 0x8380
    .long 0x1d000000, 0xfffed820, 0x0, 0x0, 0x0, 0x0, 0x0, 0xff000000
    .long 0x0, 0x0, 0x0, 0x0, 0x0, 0x0, 0x0, 0x0
    .long 0x0, 0x0, 0x0, 0x0, 0x0, 0x0, 0x0, 0x0
    .long 0x0, 0x0, 0x0, 0x0, 0x0, 0x0, 0x0, 0x0
    .long 0x0, 0x0, 0x0, 0x0, 0x0, 0x0, 0x0, 0x0
    .long 0x9cf000, 0x1f100, 0xffffff80, 0xb01b9a0, 0x9005000, 0x1c00, 0x600c540, 0xf460
    .long 0xa008380, 0x8380, 0xefed820, 0x8380, 0x1200c540, 0xfffed820, 0x14008380, 0x8380
    .long 0x16fed820, 0x8380, 0x18ffbe40, 0xfffed820, 0x1a00a460, 0x62a0, 0x1c008380, 0x8380
    .long 0x1d000000, 0xfffed820, 0x0, 0x0, 0x0, 0x0, 0x0, 0xff000000
    .long 0x0, 0x0, 0x0, 0x0, 0x0, 0x0, 0x0, 0x0
    .long 0x0, 0x0, 0x0, 0x0, 0x0, 0x0, 0x0, 0x0
    .long 0x0, 0x0, 0x0, 0x0, 0x0, 0x0, 0x0, 0x0
    .long 0x0, 0x0, 0x0, 0x0, 0x0, 0x0, 0x0, 0x0
    .long 0x9ef000, 0x1f100, 0xffffff80, 0xc01da80, 0x9005000, 0x1c00, 0x600c540, 0xf460
    .long 0xa008380, 0x8380, 0xefed820, 0x8380, 0x1200c540, 0xfffed820, 0x14008380, 0x8380
    .long 0x16fed820, 0x8380, 0x18ffbe40, 0xfffed820, 0x1a00a460, 0x62a0, 0x1c008380, 0x8380
    .long 0x1d000000, 0xfffed820, 0x0, 0x0, 0x0, 0x0, 0x0, 0xff000000
    .long 0x0, 0x0, 0x0, 0x0, 0x0, 0x0, 0x0, 0x0
    .long 0x0, 0x0, 0x0, 0x0, 0x0, 0x0, 0x0, 0x0
    .long 0x0, 0x0, 0x0, 0x0, 0x0, 0x0, 0x0, 0x0
    .long 0x0, 0x0, 0x0, 0x0, 0x0, 0x0, 0x0, 0x0
    .long 0x92f000, 0x1f100, 0xffffff80, 0x10070e0, 0x9005000, 0x1c00, 0x600c540, 0xf460
    .long 0xa008380, 0x8380, 0xefed820, 0x8380, 0x1200c540, 0xfffed820, 0x14008380, 0x8380
    .long 0x16fed820, 0x8380, 0x18ffbe40, 0xfffed820, 0x1a00a460, 0x62a0, 0x1c008380, 0x8380
    .long 0x1d000000, 0xfffed820, 0x0, 0x0, 0x0, 0x0, 0x0, 0xff000000
    .long 0x0, 0x0, 0x0, 0x0, 0x0, 0x0, 0x0, 0x0
    .long 0x0, 0x0, 0x0, 0x0, 0x0, 0x0, 0x0, 0x0
    .long 0x0, 0x0, 0x0, 0x0, 0x0, 0x0, 0x0, 0x0
    .long 0x0, 0x0, 0x0, 0x0, 0x0, 0x0, 0x0, 0x0
    .long 0x94f000, 0x1f100, 0xffffff80, 0x20091c0, 0x9005000, 0x1c00, 0x600c540, 0xf460
    .long 0xa008380, 0x8380, 0xefed820, 0x8380, 0x1200c540, 0xfffed820, 0x14008380, 0x8380
    .long 0x16fed820, 0x8380, 0x18ffbe40, 0xfffed820, 0x1a00a460, 0x62a0, 0x1c008380, 0x8380
    .long 0x1d000000, 0xfffed820, 0x0, 0x0, 0x0, 0x0, 0x0, 0xff000000
    .long 0x0, 0x0, 0x0, 0x0, 0x0, 0x0, 0x0, 0x0
    .long 0x0, 0x0, 0x0, 0x0, 0x0, 0x0, 0x0, 0x0
    .long 0x0, 0x0, 0x0, 0x0, 0x0, 0x0, 0x0, 0x0
    .long 0x0, 0x0, 0x0, 0x0, 0x0, 0x0, 0x0, 0x0
    .long 0xa0f000, 0x1f100, 0xffffff80, 0xf0091c0, 0x9005000, 0x1000, 0x600c540, 0xf460
    .long 0xa008380, 0x8380, 0xefed820, 0x8380, 0x1200c540, 0xfffed820, 0x14008380, 0x8380
    .long 0x16fed820, 0x8380, 0x18ffbe40, 0xfffed820, 0x1a00a460, 0x62a0, 0x1c008380, 0x8380
    .long 0x1d000000, 0xfffed820, 0x0, 0x0, 0x0, 0x0, 0x0, 0xff000000
    .long 0x0, 0x0, 0x0, 0x0, 0x0, 0x0, 0x0, 0x0
    .long 0x0, 0x0, 0x0, 0x0, 0x0, 0x0, 0x0, 0x0
    .long 0x0, 0x0, 0x0, 0x0, 0x0, 0x0, 0x0, 0x0
    .long 0x0, 0x0, 0x0, 0x0, 0x0, 0x0, 0x0, 0x0
    .long 0xa2f000, 0x1f100, 0xffffff80, 0x1000b2a0, 0x9005000, 0x1000, 0x600c540, 0xf460
    .long 0xa008380, 0x8380, 0xefed820, 0x8380, 0x1200c540, 0xfffed820, 0x14008380, 0x8380
    .long 0x16fed820, 0x8380, 0x18ffbe40, 0xfffed820, 0x1a00a460, 0x62a0, 0x1c008380, 0x8380
    .long 0x1d000000, 0xfffed820, 0x0, 0x0, 0x0, 0x0, 0x0, 0xff000000
    .long 0x0, 0x0, 0x0, 0x0, 0x0, 0x0, 0x0, 0x0
    .long 0x0, 0x0, 0x0, 0x0, 0x0, 0x0, 0x0, 0x0
    .long 0x0, 0x0, 0x0, 0x0, 0x0, 0x0, 0x0, 0x0
    .long 0x0, 0x0, 0x0, 0x0, 0x0, 0x0, 0x0, 0x0
    .long 0x96f000, 0x1f100, 0xffffff80, 0x300b2a0, 0x9005000, 0x1000, 0x600c540, 0xf460
    .long 0xa008380, 0x8380, 0xefed820, 0x8380, 0x1200c540, 0xfffed820, 0x14008380, 0x8380
    .long 0x16fed820, 0x8380, 0x18ffbe40, 0xfffed820, 0x1a00a460, 0x62a0, 0x1c008380, 0x8380
    .long 0x1d000000, 0xfffed820, 0x0, 0x0, 0x0, 0x0, 0x0, 0xff000000
    .long 0x0, 0x0, 0x0, 0x0, 0x0, 0x0, 0x0, 0x0
    .long 0x0, 0x0, 0x0, 0x0, 0x0, 0x0, 0x0, 0x0
    .long 0x0, 0x0, 0x0, 0x0, 0x0, 0x0, 0x0, 0x0
    .long 0x0, 0x0, 0x0, 0x0, 0x0, 0x0, 0x0, 0x0
    .long 0x98f000, 0x1f100, 0xffffff80, 0x400d380, 0x9005000, 0x1000, 0x600c540, 0xf460
    .long 0xa008380, 0x8380, 0xefed820, 0x8380, 0x1200c540, 0xfffed820, 0x14008380, 0x8380
    .long 0x16fed820, 0x8380, 0x18ffbe40, 0xfffed820, 0x1a00a460, 0x62a0, 0x1c008380, 0x8380
    .long 0x1d000000, 0xfffed820, 0x0, 0x0, 0x0, 0x0, 0x0, 0xff000000
    .long 0x0, 0x0, 0x0, 0x0, 0x0, 0x0, 0x0, 0x0
    .long 0x0, 0x0, 0x0, 0x0, 0x0, 0x0, 0x0, 0x0
    .long 0x0, 0x0, 0x0, 0x0, 0x0, 0x0, 0x0, 0x0
    .long 0x0, 0x0, 0x0, 0x0, 0x0, 0x0, 0x0, 0x0
    .long 0x0, 0x14100a, 0x20000, 0x4141008, 0x60000, 0x8141008, 0x20000, 0xc14100a
    .long 0x40000, 0x1014100a, 0xa0000, 0x14141008, 0x20e0001, 0x2141008, 0x2060004, 0x614100a
    .long 0x2080010, 0x1214100a, 0x20a0040, 0x1614100a, 0x20c0080, 0x214100a, 0x40e00ff, 0xa14100a
    .long 0x61000ff, 0x1014100a, 0x81200ff, 0x614100a, 0xa1400ff, 0x1214100a, 0x0, 0x0
    .long 0x0, 0x0, 0x0, 0x0, 0x0, 0x0, 0x0, 0x0
    .long 0x0, 0x0, 0x0, 0x0, 0x0, 0x0, 0x0, 0x0
    .long 0x0, 0x0, 0x0, 0x0, 0x0, 0x0, 0x0, 0x0
    .long 0x0, 0x0, 0x0, 0x0, 0x0, 0x0, 0x0, 0x0
    .long 0x0, 0x2141008, 0x40000, 0x6141008, 0x0, 0xa141009, 0x20000, 0xe141009
    .long 0x80000, 0x12141008, 0xc0000, 0x16141008, 0x2040002, 0x4141009, 0x2060008, 0x8141009
    .long 0x2080020, 0x14141009, 0x20a00ff, 0x141009, 0x40c00ff, 0xc141009, 0x60e00ff, 0xe141009
    .long 0x81000ff, 0x4141009, 0xa1200ff, 0x8141009, 0xc1400ff, 0x14141009, 0x0, 0x0
    .long 0x0, 0x0, 0x0, 0x0, 0x0, 0x0, 0x0, 0x0
    .long 0x0, 0x0, 0x0, 0x0, 0x0, 0x0, 0x0, 0x0
    .long 0x0, 0x0, 0x0, 0x0, 0x0, 0x0, 0x0, 0x0
    .long 0x0, 0x0, 0x0, 0x0, 0x0, 0x0, 0x0, 0x0
    .long 0x0, 0x0, 0x0, 0x0, 0x0, 0xff000000, 0x0, 0x0
    .long 0x0, 0x0, 0x0, 0x0, 0x0, 0x0, 0x0, 0x0
    .long 0x0, 0x0, 0x0, 0x0, 0x0, 0x0, 0x0, 0x0
    .long 0x0, 0x0, 0x0, 0x0, 0x0, 0x0, 0x0, 0x0
    .long 0x0, 0x0, 0x0, 0x0, 0x0, 0x0, 0x0, 0x0
    .long 0x0, 0x0, 0x0, 0x0, 0x0, 0x0, 0x0, 0x0
    .long 0x0, 0x0, 0x0, 0x0, 0x0, 0x0, 0x0, 0x0
    .long 0x0, 0x0, 0x0, 0x0, 0x0, 0x0, 0x0, 0x0
    .long 0x0, 0x0, 0x0, 0x0, 0x0, 0xff000000, 0x0, 0x0
    .long 0x0, 0x0, 0x0, 0x0, 0x0, 0x0, 0x0, 0x0
    .long 0x0, 0x0, 0x0, 0x0, 0x0, 0x0, 0x0, 0x0
    .long 0x0, 0x0, 0x0, 0x0, 0x0, 0x0, 0x0, 0x0
    .long 0x0, 0x0, 0x0, 0x0, 0x0, 0x0, 0x0, 0x0
    .long 0x0, 0x0, 0x0, 0x0, 0x0, 0x0, 0x0, 0x0
    .long 0x0, 0x0, 0x0, 0x0, 0x0, 0x0, 0x0, 0x0
    .long 0x0, 0x0, 0x0, 0x0, 0x0, 0x0, 0x0, 0x0
    .long 0x0, 0x1f100, 0xfffffffe, 0x10070e0, 0xa005000, 0x1c00, 0x600c540, 0xf460
    .long 0x80041c0, 0x41c0, 0xeff5ba0, 0xffff5ba0, 0x1000c540, 0x41c0, 0x120041c0, 0xc540
    .long 0x14feb740, 0xfffeb740, 0x16008380, 0xc540, 0x180062a0, 0x20e0, 0x1aff5ba0, 0xffff5ba0
    .long 0x1c00c540, 0x41c0, 0x1d000000, 0xc540, 0x0, 0x0, 0x0, 0x0
    .long 0x0, 0xff000000, 0x0, 0x0, 0x0, 0x0, 0x0, 0x0
    .long 0x0, 0x0, 0x0, 0x0, 0x0, 0x0, 0x0, 0x0
    .long 0x0, 0x0, 0x0, 0x0, 0x0, 0x0, 0x0, 0x0
    .long 0x0, 0x0, 0x0, 0x0, 0x0, 0x0, 0x0, 0x0
    .long 0x20000, 0x1f100, 0xfffffffe, 0x20091c0, 0xa005000, 0x1c00, 0x600c540, 0xf460
    .long 0x80041c0, 0x41c0, 0xeff5ba0, 0xffff5ba0, 0x1000c540, 0x41c0, 0x120041c0, 0xc540
    .long 0x14feb740, 0xfffeb740, 0x16008380, 0xc540, 0x180062a0, 0x20e0, 0x1aff5ba0, 0xffff5ba0
    .long 0x1c00c540, 0x41c0, 0x1d000000, 0xc540, 0x0, 0x0, 0x0, 0x0
    .long 0x0, 0xff000000, 0x0, 0x0, 0x0, 0x0, 0x0, 0x0
    .long 0x0, 0x0, 0x0, 0x0, 0x0, 0x0, 0x0, 0x0
    .long 0x0, 0x0, 0x0, 0x0, 0x0, 0x0, 0x0, 0x0
    .long 0x0, 0x0, 0x0, 0x0, 0x0, 0x0, 0x0, 0x0
    .long 0x40000, 0x1f100, 0xfffffffe, 0x300b2a0, 0xa005000, 0x1c00, 0x600c540, 0xf460
    .long 0x80041c0, 0x41c0, 0xeff5ba0, 0xffff5ba0, 0x1000c540, 0x41c0, 0x120041c0, 0xc540
    .long 0x14feb740, 0xfffeb740, 0x16008380, 0xc540, 0x180062a0, 0x20e0, 0x1aff5ba0, 0xffff5ba0
    .long 0x1c00c540, 0x41c0, 0x1d000000, 0xc540, 0x0, 0x0, 0x0, 0x0
    .long 0x0, 0xff000000, 0x0, 0x0, 0x0, 0x0, 0x0, 0x0
    .long 0x0, 0x0, 0x0, 0x0, 0x0, 0x0, 0x0, 0x0
    .long 0x0, 0x0, 0x0, 0x0, 0x0, 0x0, 0x0, 0x0
    .long 0x0, 0x0, 0x0, 0x0, 0x0, 0x0, 0x0, 0x0
    .long 0x60000, 0x1f100, 0xfffffffe, 0x400d380, 0xa005000, 0x1c00, 0x600c540, 0xf460
    .long 0x80041c0, 0x41c0, 0xeff5ba0, 0xffff5ba0, 0x1000c540, 0x41c0, 0x120041c0, 0xc540
    .long 0x14feb740, 0xfffeb740, 0x16008380, 0xc540, 0x180062a0, 0x20e0, 0x1aff5ba0, 0xffff5ba0
    .long 0x1c00c540, 0x41c0, 0x1d000000, 0xc540, 0x0, 0x0, 0x0, 0x0
    .long 0x0, 0xff000000, 0x0, 0x0, 0x0, 0x0, 0x0, 0x0
    .long 0x0, 0x0, 0x0, 0x0, 0x0, 0x0, 0x0, 0x0
    .long 0x0, 0x0, 0x0, 0x0, 0x0, 0x0, 0x0, 0x0
    .long 0x0, 0x0, 0x0, 0x0, 0x0, 0x0, 0x0, 0x0
    .long 0x80000, 0x1f100, 0xfffffffe, 0x90177e0, 0xa005000, 0x1000, 0x600c540, 0xf460
    .long 0x80041c0, 0x41c0, 0xeff5ba0, 0xffff5ba0, 0x1000c540, 0x41c0, 0x120041c0, 0xc540
    .long 0x14feb740, 0xfffeb740, 0x16008380, 0xc540, 0x180062a0, 0x20e0, 0x1aff5ba0, 0xffff5ba0
    .long 0x1c00c540, 0x41c0, 0x1d000000, 0xc540, 0x0, 0x0, 0x0, 0x0
    .long 0x0, 0xff000000, 0x0, 0x0, 0x0, 0x0, 0x0, 0x0
    .long 0x0, 0x0, 0x0, 0x0, 0x0, 0x0, 0x0, 0x0
    .long 0x0, 0x0, 0x0, 0x0, 0x0, 0x0, 0x0, 0x0
    .long 0x0, 0x0, 0x0, 0x0, 0x0, 0x0, 0x0, 0x0
    .long 0xa0000, 0x1f100, 0xfffffffe, 0xa0198c0, 0xa005000, 0x1000, 0x600c540, 0xf460
    .long 0x80041c0, 0x41c0, 0xeff5ba0, 0xffff5ba0, 0x1000c540, 0x41c0, 0x120041c0, 0xc540
    .long 0x14feb740, 0xfffeb740, 0x16008380, 0xc540, 0x180062a0, 0x20e0, 0x1aff5ba0, 0xffff5ba0
    .long 0x1c00c540, 0x41c0, 0x1d000000, 0xc540, 0x0, 0x0, 0x0, 0x0
    .long 0x0, 0xff000000, 0x0, 0x0, 0x0, 0x0, 0x0, 0x0
    .long 0x0, 0x0, 0x0, 0x0, 0x0, 0x0, 0x0, 0x0
    .long 0x0, 0x0, 0x0, 0x0, 0x0, 0x0, 0x0, 0x0
    .long 0x0, 0x0, 0x0, 0x0, 0x0, 0x0, 0x0, 0x0
    .long 0xc0000, 0x1f100, 0xfffffffe, 0xb01b9a0, 0xa005000, 0x1000, 0x600c540, 0xf460
    .long 0x80041c0, 0x41c0, 0xeff5ba0, 0xffff5ba0, 0x1000c540, 0x41c0, 0x120041c0, 0xc540
    .long 0x14feb740, 0xfffeb740, 0x16008380, 0xc540, 0x180062a0, 0x20e0, 0x1aff5ba0, 0xffff5ba0
    .long 0x1c00c540, 0x41c0, 0x1d000000, 0xc540, 0x0, 0x0, 0x0, 0x0
    .long 0x0, 0xff000000, 0x0, 0x0, 0x0, 0x0, 0x0, 0x0
    .long 0x0, 0x0, 0x0, 0x0, 0x0, 0x0, 0x0, 0x0
    .long 0x0, 0x0, 0x0, 0x0, 0x0, 0x0, 0x0, 0x0
    .long 0x0, 0x0, 0x0, 0x0, 0x0, 0x0, 0x0, 0x0
    .long 0xe0000, 0x1f100, 0xfffffffe, 0xc0070e0, 0xa005000, 0x1000, 0x600c540, 0xf460
    .long 0x80041c0, 0x41c0, 0xeff5ba0, 0xffff5ba0, 0x1000c540, 0x41c0, 0x120041c0, 0xc540
    .long 0x14feb740, 0xfffeb740, 0x16008380, 0xc540, 0x180062a0, 0x20e0, 0x1aff5ba0, 0xffff5ba0
    .long 0x1c00c540, 0x41c0, 0x1d000000, 0xc540, 0x0, 0x0, 0x0, 0x0
    .long 0x0, 0xff000000, 0x0, 0x0, 0x0, 0x0, 0x0, 0x0
    .long 0x0, 0x0, 0x0, 0x0, 0x0, 0x0, 0x0, 0x0
    .long 0x0, 0x0, 0x0, 0x0, 0x0, 0x0, 0x0, 0x0
    .long 0x0, 0x0, 0x0, 0x0, 0x0, 0x0, 0x0, 0x0
    .long 0x0, 0x14100a, 0x20000, 0x4141008, 0x60000, 0x8141008, 0x20000, 0xc14100a
    .long 0x40000, 0x1014100a, 0xa0000, 0x14141008, 0x20e0001, 0x2141008, 0x2060004, 0x614100a
    .long 0x2080010, 0x1214100a, 0x20a0040, 0x1614100a, 0x20c0080, 0x214100a, 0x40e00ff, 0xa14100a
    .long 0x61000ff, 0x1014100a, 0x81200ff, 0x414100a, 0xa1400ff, 0x1214100a, 0x0, 0x0
    .long 0x0, 0x0, 0x0, 0x0, 0x0, 0x0, 0x0, 0x0
    .long 0x0, 0x0, 0x0, 0x0, 0x0, 0x0, 0x0, 0x0
    .long 0x0, 0x0, 0x0, 0x0, 0x0, 0x0, 0x0, 0x0
    .long 0x0, 0x0, 0x0, 0x0, 0x0, 0x0, 0x0, 0x0
    .long 0x0, 0x2141008, 0x40000, 0x6141008, 0x0, 0xa141009, 0x20000, 0xe141009
    .long 0x80000, 0x12141008, 0xc0000, 0x16141008, 0x2040002, 0x4141009, 0x2060008, 0x8141009
    .long 0x2080020, 0x14141009, 0x20a00ff, 0x141009, 0x40c00ff, 0xc141009, 0x60e00ff, 0xe141009
    .long 0x81000ff, 0x6141009, 0xa1200ff, 0x8141009, 0xc1400ff, 0x14141009, 0x0, 0x0
    .long 0x0, 0x0, 0x0, 0x0, 0x0, 0x0, 0x0, 0x0
    .long 0x0, 0x0, 0x0, 0x0, 0x0, 0x0, 0x0, 0x0
    .long 0x0, 0x0, 0x0, 0x0, 0x0, 0x0, 0x0, 0x0
    .long 0x0, 0x0, 0x0, 0x0, 0x0, 0x0, 0x0, 0x0
    .long 0x0, 0x0, 0x0, 0x0, 0x0, 0xff000000, 0x0, 0x0
    .long 0x0, 0x0, 0x0, 0x0, 0x0, 0x0, 0x0, 0x0
    .long 0x0, 0x0, 0x0, 0x0, 0x0, 0x0, 0x0, 0x0
    .long 0x0, 0x0, 0x0, 0x0, 0x0, 0x0, 0x0, 0x0
    .long 0x0, 0x0, 0x0, 0x0, 0x0, 0x0, 0x0, 0x0
    .long 0x0, 0x0, 0x0, 0x0, 0x0, 0x0, 0x0, 0x0
    .long 0x0, 0x0, 0x0, 0x0, 0x0, 0x0, 0x0, 0x0
    .long 0x0, 0x0, 0x0, 0x0, 0x0, 0x0, 0x0, 0x0
    .long 0x0, 0x0, 0x0, 0x0, 0x0, 0xff000000, 0x0, 0x0
    .long 0x0, 0x0, 0x0, 0x0, 0x0, 0x0, 0x0, 0x0
    .long 0x0, 0x0, 0x0, 0x0, 0x0, 0x0, 0x0, 0x0
    .long 0x0, 0x0, 0x0, 0x0, 0x0, 0x0, 0x0, 0x0
    .long 0x0, 0x0, 0x0, 0x0, 0x0, 0x0, 0x0, 0x0
    .long 0x0, 0x0, 0x0, 0x0, 0x0, 0x0, 0x0, 0x0
    .long 0x0, 0x0, 0x0, 0x0, 0x0, 0x0, 0x0, 0x0
    .long 0x0, 0x0, 0x0, 0x0, 0x0, 0x0, 0x0, 0x0
    .long 0x0, 0x1f100, 0xfffffffe, 0x10070e0, 0xa005000, 0x1c00, 0x600c540, 0xf460
    .long 0x80041c0, 0x41c0, 0xeff5ba0, 0xffff5ba0, 0x1000c540, 0x41c0, 0x120041c0, 0xc540
    .long 0x14feb740, 0xfffeb740, 0x16008380, 0xc540, 0x180062a0, 0x20e0, 0x1aff3ac0, 0xffff7c80
    .long 0x1c00e620, 0x20e0, 0x1d000000, 0xc540, 0x0, 0x0, 0x0, 0x0
    .long 0x0, 0xff000000, 0x0, 0x0, 0x0, 0x0, 0x0, 0x0
    .long 0x0, 0x0, 0x0, 0x0, 0x0, 0x0, 0x0, 0x0
    .long 0x0, 0x0, 0x0, 0x0, 0x0, 0x0, 0x0, 0x0
    .long 0x0, 0x0, 0x0, 0x0, 0x0, 0x0, 0x0, 0x0
    .long 0x20000, 0x1f100, 0xfffffffe, 0x20091c0, 0xa005000, 0x1c00, 0x600c540, 0xf460
    .long 0x80041c0, 0x41c0, 0xeff5ba0, 0xffff5ba0, 0x1000c540, 0x41c0, 0x120041c0, 0xc540
    .long 0x14feb740, 0xfffeb740, 0x16008380, 0xc540, 0x180062a0, 0x20e0, 0x1aff3ac0, 0xffff7c80
    .long 0x1c00e620, 0x20e0, 0x1d000000, 0xc540, 0x0, 0x0, 0x0, 0x0
    .long 0x0, 0xff000000, 0x0, 0x0, 0x0, 0x0, 0x0, 0x0
    .long 0x0, 0x0, 0x0, 0x0, 0x0, 0x0, 0x0, 0x0
    .long 0x0, 0x0, 0x0, 0x0, 0x0, 0x0, 0x0, 0x0
    .long 0x0, 0x0, 0x0, 0x0, 0x0, 0x0, 0x0, 0x0
    .long 0x40000, 0x1f100, 0xfffffffe, 0x300b2a0, 0xa005000, 0x1c00, 0x600c540, 0xf460
    .long 0x80041c0, 0x41c0, 0xeff5ba0, 0xffff5ba0, 0x1000c540, 0x41c0, 0x120041c0, 0xc540
    .long 0x14feb740, 0xfffeb740, 0x16008380, 0xc540, 0x180062a0, 0x20e0, 0x1aff3ac0, 0xffff7c80
    .long 0x1c00e620, 0x20e0, 0x1d000000, 0xc540, 0x0, 0x0, 0x0, 0x0
    .long 0x0, 0xff000000, 0x0, 0x0, 0x0, 0x0, 0x0, 0x0
    .long 0x0, 0x0, 0x0, 0x0, 0x0, 0x0, 0x0, 0x0
    .long 0x0, 0x0, 0x0, 0x0, 0x0, 0x0, 0x0, 0x0
    .long 0x0, 0x0, 0x0, 0x0, 0x0, 0x0, 0x0, 0x0
    .long 0x60000, 0x1f100, 0xfffffffe, 0x400d380, 0xa005000, 0x1c00, 0x600c540, 0xf460
    .long 0x80041c0, 0x41c0, 0xeff5ba0, 0xffff5ba0, 0x1000c540, 0x41c0, 0x120041c0, 0xc540
    .long 0x14feb740, 0xfffeb740, 0x16008380, 0xc540, 0x180062a0, 0x20e0, 0x1aff3ac0, 0xffff7c80
    .long 0x1c00e620, 0x20e0, 0x1d000000, 0xc540, 0x0, 0x0, 0x0, 0x0
    .long 0x0, 0xff000000, 0x0, 0x0, 0x0, 0x0, 0x0, 0x0
    .long 0x0, 0x0, 0x0, 0x0, 0x0, 0x0, 0x0, 0x0
    .long 0x0, 0x0, 0x0, 0x0, 0x0, 0x0, 0x0, 0x0
    .long 0x0, 0x0, 0x0, 0x0, 0x0, 0x0, 0x0, 0x0
    .long 0x80000, 0x1f100, 0xfffffffe, 0x90177e0, 0xa005000, 0x1000, 0x600c540, 0xf460
    .long 0x80041c0, 0x41c0, 0xeff5ba0, 0xffff5ba0, 0x1000c540, 0x41c0, 0x120041c0, 0xc540
    .long 0x14feb740, 0xfffeb740, 0x16008380, 0xc540, 0x180062a0, 0x20e0, 0x1aff3ac0, 0xffff7c80
    .long 0x1c00e620, 0x20e0, 0x1d000000, 0xc540, 0x0, 0x0, 0x0, 0x0
    .long 0x0, 0xff000000, 0x0, 0x0, 0x0, 0x0, 0x0, 0x0
    .long 0x0, 0x0, 0x0, 0x0, 0x0, 0x0, 0x0, 0x0
    .long 0x0, 0x0, 0x0, 0x0, 0x0, 0x0, 0x0, 0x0
    .long 0x0, 0x0, 0x0, 0x0, 0x0, 0x0, 0x0, 0x0
    .long 0xa0000, 0x1f100, 0xfffffffe, 0xa0198c0, 0xa005000, 0x1000, 0x600c540, 0xf460
    .long 0x80041c0, 0x41c0, 0xeff5ba0, 0xffff5ba0, 0x1000c540, 0x41c0, 0x120041c0, 0xc540
    .long 0x14feb740, 0xfffeb740, 0x16008380, 0xc540, 0x180062a0, 0x20e0, 0x1aff3ac0, 0xffff7c80
    .long 0x1c00e620, 0x20e0, 0x1d000000, 0xc540, 0x0, 0x0, 0x0, 0x0
    .long 0x0, 0xff000000, 0x0, 0x0, 0x0, 0x0, 0x0, 0x0
    .long 0x0, 0x0, 0x0, 0x0, 0x0, 0x0, 0x0, 0x0
    .long 0x0, 0x0, 0x0, 0x0, 0x0, 0x0, 0x0, 0x0
    .long 0x0, 0x0, 0x0, 0x0, 0x0, 0x0, 0x0, 0x0
    .long 0xc0000, 0x1f100, 0xfffffffe, 0xb01b9a0, 0xa005000, 0x1000, 0x600c540, 0xf460
    .long 0x80041c0, 0x41c0, 0xeff5ba0, 0xffff5ba0, 0x1000c540, 0x41c0, 0x120041c0, 0xc540
    .long 0x14feb740, 0xfffeb740, 0x16008380, 0xc540, 0x180062a0, 0x20e0, 0x1aff3ac0, 0xffff7c80
    .long 0x1c00e620, 0x20e0, 0x1d000000, 0xc540, 0x0, 0x0, 0x0, 0x0
    .long 0x0, 0xff000000, 0x0, 0x0, 0x0, 0x0, 0x0, 0x0
    .long 0x0, 0x0, 0x0, 0x0, 0x0, 0x0, 0x0, 0x0
    .long 0x0, 0x0, 0x0, 0x0, 0x0, 0x0, 0x0, 0x0
    .long 0x0, 0x0, 0x0, 0x0, 0x0, 0x0, 0x0, 0x0
    .long 0xe0000, 0x1f100, 0xfffffffe, 0xc0070e0, 0xa005000, 0x1000, 0x600c540, 0xf460
    .long 0x80041c0, 0x41c0, 0xeff5ba0, 0xffff5ba0, 0x1000c540, 0x41c0, 0x120041c0, 0xc540
    .long 0x14feb740, 0xfffeb740, 0x16008380, 0xc540, 0x180062a0, 0x20e0, 0x1aff3ac0, 0xffff7c80
    .long 0x1c00e620, 0x20e0, 0x1d000000, 0xc540, 0x0, 0x0, 0x0, 0x0
    .long 0x0, 0xff000000, 0x0, 0x0, 0x0, 0x0, 0x0, 0x0
    .long 0x0, 0x0, 0x0, 0x0, 0x0, 0x0, 0x0, 0x0
    .long 0x0, 0x0, 0x0, 0x0, 0x0, 0x0, 0x0, 0x0
    .long 0x0, 0x0, 0x0, 0x0, 0x0, 0x0, 0x0, 0x0
    .long 0x141100, 0x22b00a, 0x161100, 0x422b008, 0x1a1100, 0x822b008, 0x161100, 0xc22b00a
    .long 0x181100, 0x1022b00a, 0x1e1100, 0x1422b008, 0x141100, 0x1822b008, 0x1a1100, 0x1c22b00e
    .long 0x21c1101, 0x222b00e, 0x21e1104, 0x622b00e, 0x2201110, 0x1222b00e, 0x2221140, 0x1622b00e
    .long 0x2a56180, 0x18afa00c, 0x4a761ff, 0xcafa00c, 0x6a761ff, 0xeafa00e, 0x8a761ff, 0x1aafa00d
    .long 0x42a96500, 0xcafa00d, 0xaab61ff, 0x2afa00d, 0xcad61ff, 0x4afa00d, 0x42af6701, 0xaafa00d
    .long 0x0, 0x0, 0x0, 0x0, 0x0, 0x0, 0x0, 0x0
    .long 0x0, 0x0, 0x0, 0x0, 0x0, 0x0, 0x0, 0x0
    .long 0x0, 0x0, 0x0, 0x0, 0x0, 0x0, 0x0, 0x0
    .long 0x221100, 0x222b008, 0x181100, 0x622b008, 0x141100, 0xa22b009, 0x161100, 0xe22b009
    .long 0x1c1100, 0x1222b008, 0x201100, 0x1622b008, 0x181100, 0x1a22b009, 0x1a1100, 0x1e22b00d
    .long 0x21c1102, 0x422b00d, 0x21e1108, 0x822b00d, 0x2201120, 0x1422b00d, 0x22211ff, 0x22b00d
    .long 0x4a561ff, 0xaafa00e, 0x6a561ff, 0x10afa00d, 0x8a961ff, 0x1cafa00c, 0x42a96300, 0x18afa00e
    .long 0xaab61ff, 0x1eafa00e, 0xcad61ff, 0x6afa00e, 0x42af6101, 0x1cafa00e, 0x0, 0x0
    .long 0x0, 0x0, 0x0, 0x0, 0x0, 0x0, 0x0, 0x0
    .long 0x0, 0x0, 0x0, 0x0, 0x0, 0x0, 0x0, 0x0
    .long 0x0, 0x0, 0x0, 0x0, 0x0, 0x0, 0x0, 0x0
    .long 0xa56100, 0x1f100, 0xfffffff0, 0x1901da80, 0x500f460, 0x20001000, 0x1c0041c0, 0x15700
    .long 0x1f00a460, 0xa460, 0x210062a0, 0xffff19e0, 0x23fe7580, 0xffff5ba0, 0x250169a0, 0x20e0
    .long 0x26000000, 0x62a0, 0x0, 0x0, 0x0, 0x0, 0x0, 0xff000000
    .long 0x0, 0x0, 0x0, 0x0, 0x0, 0x0, 0x0, 0x0
    .long 0x0, 0x0, 0x0, 0x0, 0x0, 0x0, 0x0, 0x0
    .long 0x0, 0x0, 0x0, 0x0, 0x0, 0x0, 0x0, 0x0
    .long 0x0, 0x0, 0x0, 0x0, 0x0, 0x0, 0x0, 0x0
    .long 0x0, 0x0, 0x0, 0x0, 0x0, 0x0, 0x0, 0x0
    .long 0xa76100, 0x1f100, 0xfffffff0, 0x1a011540, 0x500f460, 0x20001000, 0x1c0041c0, 0x15700
    .long 0x1f00a460, 0xa460, 0x210062a0, 0xffff19e0, 0x23fe7580, 0xffff5ba0, 0x250169a0, 0x20e0
    .long 0x26000000, 0x62a0, 0x0, 0x0, 0x0, 0x0, 0x0, 0xff000000
    .long 0x0, 0x0, 0x0, 0x0, 0x0, 0x0, 0x0, 0x0
    .long 0x0, 0x0, 0x0, 0x0, 0x0, 0x0, 0x0, 0x0
    .long 0x0, 0x0, 0x0, 0x0, 0x0, 0x0, 0x0, 0x0
    .long 0x0, 0x0, 0x0, 0x0, 0x0, 0x0, 0x0, 0x0
    .long 0x0, 0x0, 0x0, 0x0, 0x0, 0x0, 0x0, 0x0
    .long 0x221100, 0x9100, 0xfffffc00, 0x10070e0, 0x7005000, 0x1d00, 0x600c540, 0xf460
    .long 0x80041c0, 0x41c0, 0xe00c540, 0xc540, 0x10fe54a0, 0x41c0, 0x120041c0, 0xfffe54a0
    .long 0x1400c540, 0x41c0, 0x160041c0, 0xc540, 0x17000000, 0xfffeb740, 0xa96100, 0x1f100
    .long 0xfffffff0, 0x1d0062a0, 0x5ff3ac0, 0x20001c00, 0x1c0041c0, 0x10700, 0x1f00a460, 0xa460
    .long 0x210062a0, 0xffff19e0, 0x23fe7580, 0xffff5ba0, 0x250169a0, 0x20e0, 0x26000000, 0x62a0
    .long 0x0, 0x0, 0x0, 0x0, 0x0, 0xff000000, 0x0, 0x0
    .long 0x0, 0x0, 0x0, 0x0, 0x0, 0x0, 0x0, 0x0
    .long 0x0, 0x0, 0x0, 0x0, 0x0, 0x0, 0x0, 0x0
    .long 0x161100, 0x1f100, 0xfffffc00, 0x20091c0, 0x7005000, 0x1c00, 0x600c540, 0xf460
    .long 0x80041c0, 0x41c0, 0xe00c540, 0xc540, 0x10fe54a0, 0x41c0, 0x120041c0, 0xfffe54a0
    .long 0x1400c540, 0x41c0, 0x160041c0, 0xc540, 0x17000000, 0xfffeb740, 0x0, 0x0
    .long 0x0, 0x0, 0x0, 0xff000000, 0x0, 0x0, 0x0, 0x0
    .long 0x0, 0x0, 0x0, 0x0, 0x0, 0x0, 0x0, 0x0
    .long 0x0, 0x0, 0x0, 0x0, 0x0, 0x0, 0x0, 0x0
    .long 0x0, 0x0, 0x0, 0x0, 0x0, 0x0, 0x0, 0x0
    .long 0x0, 0x0, 0x0, 0x0, 0x0, 0x0, 0x0, 0x0
    .long 0x181100, 0x1f100, 0xfffffc00, 0x300b2a0, 0x7005000, 0x1c00, 0x600c540, 0xf460
    .long 0x80041c0, 0x41c0, 0xe00c540, 0xc540, 0x10fe54a0, 0x41c0, 0x120041c0, 0xfffe54a0
    .long 0x1400c540, 0x41c0, 0x160041c0, 0xc540, 0x17000000, 0xfffeb740, 0x0, 0x0
    .long 0x0, 0x0, 0x0, 0xff000000, 0x0, 0x0, 0x0, 0x0
    .long 0x0, 0x0, 0x0, 0x0, 0x0, 0x0, 0x0, 0x0
    .long 0x0, 0x0, 0x0, 0x0, 0x0, 0x0, 0x0, 0x0
    .long 0x0, 0x0, 0x0, 0x0, 0x0, 0x0, 0x0, 0x0
    .long 0x0, 0x0, 0x0, 0x0, 0x0, 0x0, 0x0, 0x0
    .long 0x1a1100, 0x1f100, 0xfffffc00, 0x400d380, 0x7005000, 0x1c00, 0x600c540, 0xf460
    .long 0x80041c0, 0x41c0, 0xe00c540, 0xc540, 0x10fe54a0, 0x41c0, 0x120041c0, 0xfffe54a0
    .long 0x1400c540, 0x41c0, 0x160041c0, 0xc540, 0x17000000, 0xfffeb740, 0x0, 0x0
    .long 0x0, 0x0, 0x0, 0xff000000, 0x0, 0x0, 0x0, 0x0
    .long 0x0, 0x0, 0x0, 0x0, 0x0, 0x0, 0x0, 0x0
    .long 0x0, 0x0, 0x0, 0x0, 0x0, 0x0, 0x0, 0x0
    .long 0x0, 0x0, 0x0, 0x0, 0x0, 0x0, 0x0, 0x0
    .long 0x0, 0x0, 0x0, 0x0, 0x0, 0x0, 0x0, 0x0
    .long 0x1c1100, 0x1f100, 0xfffffc00, 0x90177e0, 0x7005000, 0x1000, 0x600c540, 0xf460
    .long 0x80041c0, 0x41c0, 0xe00c540, 0xc540, 0x10fe54a0, 0x41c0, 0x120041c0, 0xfffe54a0
    .long 0x1400c540, 0x41c0, 0x160041c0, 0xc540, 0x17000000, 0xfffeb740, 0x0, 0x0
    .long 0x0, 0x0, 0x0, 0xff000000, 0x0, 0x0, 0x0, 0x0
    .long 0x0, 0x0, 0x0, 0x0, 0x0, 0x0, 0x0, 0x0
    .long 0x0, 0x0, 0x0, 0x0, 0x0, 0x0, 0x0, 0x0
    .long 0x0, 0x0, 0x0, 0x0, 0x0, 0x0, 0x0, 0x0
    .long 0x0, 0x0, 0x0, 0x0, 0x0, 0x0, 0x0, 0x0
    .long 0x1e1100, 0x1f100, 0xfffffc00, 0xa0198c0, 0x7005000, 0x1000, 0x600c540, 0xf460
    .long 0x80041c0, 0x41c0, 0xe00c540, 0xc540, 0x10fe54a0, 0x41c0, 0x120041c0, 0xfffe54a0
    .long 0x1400c540, 0x41c0, 0x160041c0, 0xc540, 0x17000000, 0xfffeb740, 0x0, 0x0
    .long 0x0, 0x0, 0x0, 0xff000000, 0x0, 0x0, 0x0, 0x0
    .long 0x0, 0x0, 0x0, 0x0, 0x0, 0x0, 0x0, 0x0
    .long 0x0, 0x0, 0x0, 0x0, 0x0, 0x0, 0x0, 0x0
    .long 0x0, 0x0, 0x0, 0x0, 0x0, 0x0, 0x0, 0x0
    .long 0x0, 0x0, 0x0, 0x0, 0x0, 0x0, 0x0, 0x0
    .long 0x201100, 0x1f100, 0xfffffc00, 0xb01b9a0, 0x7005000, 0x1000, 0x600c540, 0xf460
    .long 0x80041c0, 0x41c0, 0xe00c540, 0xc540, 0x10fe54a0, 0x41c0, 0x120041c0, 0xfffe54a0
    .long 0x1400c540, 0x41c0, 0x160041c0, 0xc540, 0x17000000, 0xfffeb740, 0x0, 0x0
    .long 0x0, 0x0, 0x0, 0xff000000, 0x0, 0x0, 0x0, 0x0
    .long 0x0, 0x0, 0x0, 0x0, 0x0, 0x0, 0x0, 0x0
    .long 0x0, 0x0, 0x0, 0x0, 0x0, 0x0, 0x0, 0x0
    .long 0x0, 0x0, 0x0, 0x0, 0x0, 0x0, 0x0, 0x0
    .long 0x0, 0x0, 0x0, 0x0, 0x0, 0x0, 0x0, 0x0
    .long 0x141100, 0x1f100, 0xfffffc00, 0xc01da80, 0x7005000, 0x1000, 0x600c540, 0xf460
    .long 0x80041c0, 0x41c0, 0xe00c540, 0xc540, 0x10fe54a0, 0x41c0, 0x120041c0, 0xfffe54a0
    .long 0x1400c540, 0x41c0, 0x160041c0, 0xc540, 0x17000000, 0xfffeb740, 0x0, 0x0
    .long 0x0, 0x0, 0x0, 0xff000000, 0x0, 0x0, 0x0, 0x0
    .long 0x0, 0x0, 0x0, 0x0, 0x0, 0x0, 0x0, 0x0
    .long 0x0, 0x0, 0x0, 0x0, 0x0, 0x0, 0x0, 0x0
    .long 0x0, 0x0, 0x0, 0x0, 0x0, 0x0, 0x0, 0x0
    .long 0x0, 0x0, 0x0, 0x0, 0x0, 0x0, 0x0, 0x0
    .long 0x141100, 0x22b00a, 0x161100, 0x422b008, 0x1a1100, 0x822b008, 0x161100, 0xc22b00a
    .long 0x181100, 0x1022b00a, 0x1e1100, 0x1422b008, 0x141100, 0x1822b008, 0x1a1100, 0x1c22b00e
    .long 0x21c1101, 0x222b00e, 0x21e1104, 0x622b00e, 0x2201110, 0x1222b00e, 0x2221140, 0x1622b00e
    .long 0x2a56180, 0x18afa00c, 0x4a761ff, 0xaafa00c, 0x6a761ff, 0xeafa00e, 0x8a761ff, 0x1aafa00d
    .long 0x42a96500, 0xaafa00d, 0xaab61ff, 0x2afa00d, 0xcad61ff, 0x4afa00d, 0xeaf61ff, 0x8afa00d
    .long 0x0, 0x0, 0x0, 0x0, 0x0, 0x0, 0x0, 0x0
    .long 0x0, 0x0, 0x0, 0x0, 0x0, 0x0, 0x0, 0x0
    .long 0x0, 0x0, 0x0, 0x0, 0x0, 0x0, 0x0, 0x0
    .long 0x221100, 0x222b008, 0x181100, 0x622b008, 0x141100, 0xa22b009, 0x161100, 0xe22b009
    .long 0x1c1100, 0x1222b008, 0x201100, 0x1622b008, 0x181100, 0x1a22b009, 0x1a1100, 0x1e22b00d
    .long 0x21c1102, 0x422b00d, 0x21e1108, 0x822b00d, 0x2201120, 0x1422b00d, 0x22211ff, 0x22b00d
    .long 0x4a561ff, 0xcafa00e, 0x6a561ff, 0x10afa00d, 0x8a961ff, 0x1cafa00c, 0x42a96300, 0x18afa00e
    .long 0xaab61ff, 0x1eafa00e, 0xcad61ff, 0x6afa00e, 0xeaf61ff, 0x12afa00e, 0x0, 0x0
    .long 0x0, 0x0, 0x0, 0x0, 0x0, 0x0, 0x0, 0x0
    .long 0x0, 0x0, 0x0, 0x0, 0x0, 0x0, 0x0, 0x0
    .long 0x0, 0x0, 0x0, 0x0, 0x0, 0x0, 0x0, 0x0
    .long 0xa56100, 0x1f100, 0xfffffff0, 0x1901da80, 0x5011540, 0x20001000, 0x1c0020e0, 0x15700
    .long 0x1f00a460, 0xa460, 0x210062a0, 0xfffef900, 0x23fe7580, 0xffff7c80, 0x2500c540, 0x20e0
    .long 0x26000000, 0x41c0, 0x0, 0x0, 0x0, 0x0, 0x0, 0xff000000
    .long 0x0, 0x0, 0x0, 0x0, 0x0, 0x0, 0x0, 0x0
    .long 0x0, 0x0, 0x0, 0x0, 0x0, 0x0, 0x0, 0x0
    .long 0x0, 0x0, 0x0, 0x0, 0x0, 0x0, 0x0, 0x0
    .long 0x0, 0x0, 0x0, 0x0, 0x0, 0x0, 0x0, 0x0
    .long 0x0, 0x0, 0x0, 0x0, 0x0, 0x0, 0x0, 0x0
    .long 0xa76100, 0x1f100, 0xfffffff0, 0x1a00f460, 0x5011540, 0x20001000, 0x1c0020e0, 0x15700
    .long 0x1f00a460, 0xa460, 0x210062a0, 0xfffef900, 0x23fe7580, 0xffff7c80, 0x2500c540, 0x20e0
    .long 0x26000000, 0x41c0, 0x0, 0x0, 0x0, 0x0, 0x0, 0xff000000
    .long 0x0, 0x0, 0x0, 0x0, 0x0, 0x0, 0x0, 0x0
    .long 0x0, 0x0, 0x0, 0x0, 0x0, 0x0, 0x0, 0x0
    .long 0x0, 0x0, 0x0, 0x0, 0x0, 0x0, 0x0, 0x0
    .long 0x0, 0x0, 0x0, 0x0, 0x0, 0x0, 0x0, 0x0
    .long 0x0, 0x0, 0x0, 0x0, 0x0, 0x0, 0x0, 0x0
    .long 0x221100, 0x9100, 0xfffffc00, 0x10070e0, 0x7005000, 0x1d00, 0x600c540, 0xf460
    .long 0x80041c0, 0x41c0, 0xe00c540, 0xc540, 0x10fe54a0, 0x41c0, 0x120041c0, 0xfffe54a0
    .long 0x1400c540, 0x41c0, 0x160041c0, 0xc540, 0x17000000, 0xfffeb740, 0xa96100, 0x1f100
    .long 0xfffffff0, 0x1d0062a0, 0x5ff5ba0, 0x20001c00, 0x1c0020e0, 0x10700, 0x1f00a460, 0xa460
    .long 0x210062a0, 0xfffef900, 0x23fe7580, 0xffff7c80, 0x2500c540, 0x20e0, 0x26000000, 0x41c0
    .long 0x0, 0x0, 0x0, 0x0, 0x0, 0xff000000, 0x0, 0x0
    .long 0x0, 0x0, 0x0, 0x0, 0x0, 0x0, 0x0, 0x0
    .long 0x0, 0x0, 0x0, 0x0, 0x0, 0x0, 0x0, 0x0
    .long 0x161100, 0x1f100, 0xfffffc00, 0x20091c0, 0x7005000, 0x1c00, 0x600c540, 0xf460
    .long 0x80041c0, 0x41c0, 0xe00c540, 0xc540, 0x10fe54a0, 0x41c0, 0x120041c0, 0xfffe54a0
    .long 0x1400c540, 0x41c0, 0x160041c0, 0xc540, 0x17000000, 0xfffeb740, 0x0, 0x0
    .long 0x0, 0x0, 0x0, 0xff000000, 0x0, 0x0, 0x0, 0x0
    .long 0x0, 0x0, 0x0, 0x0, 0x0, 0x0, 0x0, 0x0
    .long 0x0, 0x0, 0x0, 0x0, 0x0, 0x0, 0x0, 0x0
    .long 0x0, 0x0, 0x0, 0x0, 0x0, 0x0, 0x0, 0x0
    .long 0x0, 0x0, 0x0, 0x0, 0x0, 0x0, 0x0, 0x0
    .long 0x181100, 0x1f100, 0xfffffc00, 0x300b2a0, 0x7005000, 0x1c00, 0x600c540, 0xf460
    .long 0x80041c0, 0x41c0, 0xe00c540, 0xc540, 0x10fe54a0, 0x41c0, 0x120041c0, 0xfffe54a0
    .long 0x1400c540, 0x41c0, 0x160041c0, 0xc540, 0x17000000, 0xfffeb740, 0x0, 0x0
    .long 0x0, 0x0, 0x0, 0xff000000, 0x0, 0x0, 0x0, 0x0
    .long 0x0, 0x0, 0x0, 0x0, 0x0, 0x0, 0x0, 0x0
    .long 0x0, 0x0, 0x0, 0x0, 0x0, 0x0, 0x0, 0x0
    .long 0x0, 0x0, 0x0, 0x0, 0x0, 0x0, 0x0, 0x0
    .long 0x0, 0x0, 0x0, 0x0, 0x0, 0x0, 0x0, 0x0
    .long 0x1a1100, 0x1f100, 0xfffffc00, 0x400d380, 0x7005000, 0x1c00, 0x600c540, 0xf460
    .long 0x80041c0, 0x41c0, 0xe00c540, 0xc540, 0x10fe54a0, 0x41c0, 0x120041c0, 0xfffe54a0
    .long 0x1400c540, 0x41c0, 0x160041c0, 0xc540, 0x17000000, 0xfffeb740, 0x0, 0x0
    .long 0x0, 0x0, 0x0, 0xff000000, 0x0, 0x0, 0x0, 0x0
    .long 0x0, 0x0, 0x0, 0x0, 0x0, 0x0, 0x0, 0x0
    .long 0x0, 0x0, 0x0, 0x0, 0x0, 0x0, 0x0, 0x0
    .long 0x0, 0x0, 0x0, 0x0, 0x0, 0x0, 0x0, 0x0
    .long 0x0, 0x0, 0x0, 0x0, 0x0, 0x0, 0x0, 0x0
    .long 0x1c1100, 0x1f100, 0xfffffc00, 0x90177e0, 0x7005000, 0x1000, 0x600c540, 0xf460
    .long 0x80041c0, 0x41c0, 0xe00c540, 0xc540, 0x10fe54a0, 0x41c0, 0x120041c0, 0xfffe54a0
    .long 0x1400c540, 0x41c0, 0x160041c0, 0xc540, 0x17000000, 0xfffeb740, 0x0, 0x0
    .long 0x0, 0x0, 0x0, 0xff000000, 0x0, 0x0, 0x0, 0x0
    .long 0x0, 0x0, 0x0, 0x0, 0x0, 0x0, 0x0, 0x0
    .long 0x0, 0x0, 0x0, 0x0, 0x0, 0x0, 0x0, 0x0
    .long 0x0, 0x0, 0x0, 0x0, 0x0, 0x0, 0x0, 0x0
    .long 0x0, 0x0, 0x0, 0x0, 0x0, 0x0, 0x0, 0x0
    .long 0x1e1100, 0x1f100, 0xfffffc00, 0xa0198c0, 0x7005000, 0x1000, 0x600c540, 0xf460
    .long 0x80041c0, 0x41c0, 0xe00c540, 0xc540, 0x10fe54a0, 0x41c0, 0x120041c0, 0xfffe54a0
    .long 0x1400c540, 0x41c0, 0x160041c0, 0xc540, 0x17000000, 0xfffeb740, 0x0, 0x0
    .long 0x0, 0x0, 0x0, 0xff000000, 0x0, 0x0, 0x0, 0x0
    .long 0x0, 0x0, 0x0, 0x0, 0x0, 0x0, 0x0, 0x0
    .long 0x0, 0x0, 0x0, 0x0, 0x0, 0x0, 0x0, 0x0
    .long 0x0, 0x0, 0x0, 0x0, 0x0, 0x0, 0x0, 0x0
    .long 0x0, 0x0, 0x0, 0x0, 0x0, 0x0, 0x0, 0x0
    .long 0x201100, 0x1f100, 0xfffffc00, 0xb01b9a0, 0x7005000, 0x1000, 0x600c540, 0xf460
    .long 0x80041c0, 0x41c0, 0xe00c540, 0xc540, 0x10fe54a0, 0x41c0, 0x120041c0, 0xfffe54a0
    .long 0x1400c540, 0x41c0, 0x160041c0, 0xc540, 0x17000000, 0xfffeb740, 0x0, 0x0
    .long 0x0, 0x0, 0x0, 0xff000000, 0x0, 0x0, 0x0, 0x0
    .long 0x0, 0x0, 0x0, 0x0, 0x0, 0x0, 0x0, 0x0
    .long 0x0, 0x0, 0x0, 0x0, 0x0, 0x0, 0x0, 0x0
    .long 0x0, 0x0, 0x0, 0x0, 0x0, 0x0, 0x0, 0x0
    .long 0x0, 0x0, 0x0, 0x0, 0x0, 0x0, 0x0, 0x0
    .long 0x141100, 0x1f100, 0xfffffc00, 0xc01da80, 0x7005000, 0x1000, 0x600c540, 0xf460
    .long 0x80041c0, 0x41c0, 0xe00c540, 0xc540, 0x10fe54a0, 0x41c0, 0x120041c0, 0xfffe54a0
    .long 0x1400c540, 0x41c0, 0x160041c0, 0xc540, 0x17000000, 0xfffeb740, 0x0, 0x0
    .long 0x0, 0x0, 0x0, 0xff000000, 0x0, 0x0, 0x0, 0x0
    .long 0x0, 0x0, 0x0, 0x0, 0x0, 0x0, 0x0, 0x0
    .long 0x0, 0x0, 0x0, 0x0, 0x0, 0x0, 0x0, 0x0
    .long 0x0, 0x0, 0x0, 0x0, 0x0, 0x0, 0x0, 0x0
    .long 0x0, 0x0, 0x0, 0x0, 0x0, 0x0, 0x0, 0x0
    .long 0x22b100, 0x36e00e, 0x24b100, 0x436e00c, 0x28b100, 0x836e00c, 0x24b100, 0xc36e00e
    .long 0x26b100, 0x1036e00e, 0x2cb100, 0x1436e00c, 0x230b101, 0x236e00c, 0x228b104, 0x636e00e
    .long 0x22ab110, 0x1236e00e, 0x22cb140, 0x1636e00e, 0x22eb180, 0x236e00e, 0x430b1ff, 0xa36e00e
    .long 0x632b1ff, 0x1036e00e, 0x834b1ff, 0x636e00e, 0xa36b1ff, 0x836e00e, 0x0, 0x0
    .long 0x0, 0x0, 0x0, 0x0, 0x0, 0x0, 0x0, 0x0
    .long 0x0, 0x0, 0x0, 0x0, 0x0, 0x0, 0x0, 0x0
    .long 0x0, 0x0, 0x0, 0x0, 0x0, 0x0, 0x0, 0x0
    .long 0x0, 0x0, 0x0, 0x0, 0x0, 0x0, 0x0, 0x0
    .long 0x22b100, 0x236e00c, 0x26b100, 0x636e00c, 0x22b100, 0xa36e00d, 0x24b100, 0xe36e00d
    .long 0x2ab100, 0x1236e00c, 0x2eb100, 0x1636e00c, 0x226b102, 0x436e00d, 0x228b108, 0x836e00d
    .long 0x22ab120, 0x1436e00d, 0x22cb1ff, 0x36e00d, 0x42eb1ff, 0xc36e00d, 0x630b1ff, 0xe36e00d
    .long 0x832b1ff, 0x436e00d, 0xa34b1ff, 0x1236e00d, 0xc36b1ff, 0x1436e00d, 0x0, 0x0
    .long 0x0, 0x0, 0x0, 0x0, 0x0, 0x0, 0x0, 0x0
    .long 0x0, 0x0, 0x0, 0x0, 0x0, 0x0, 0x0, 0x0
    .long 0x0, 0x0, 0x0, 0x0, 0x0, 0x0, 0x0, 0x0
    .long 0x0, 0x0, 0x0, 0x0, 0x0, 0x0, 0x0, 0x0
    .long 0x0, 0x0, 0x0, 0x0, 0x0, 0xff000000, 0x0, 0x0
    .long 0x0, 0x0, 0x0, 0x0, 0x0, 0x0, 0x0, 0x0
    .long 0x0, 0x0, 0x0, 0x0, 0x0, 0x0, 0x0, 0x0
    .long 0x0, 0x0, 0x0, 0x0, 0x0, 0x0, 0x0, 0x0
    .long 0x0, 0x0, 0x0, 0x0, 0x0, 0x0, 0x0, 0x0
    .long 0x0, 0x0, 0x0, 0x0, 0x0, 0x0, 0x0, 0x0
    .long 0x0, 0x0, 0x0, 0x0, 0x0, 0x0, 0x0, 0x0
    .long 0x0, 0x0, 0x0, 0x0, 0x0, 0x0, 0x0, 0x0
    .long 0x0, 0x0, 0x0, 0x0, 0x0, 0xff000000, 0x0, 0x0
    .long 0x0, 0x0, 0x0, 0x0, 0x0, 0x0, 0x0, 0x0
    .long 0x0, 0x0, 0x0, 0x0, 0x0, 0x0, 0x0, 0x0
    .long 0x0, 0x0, 0x0, 0x0, 0x0, 0x0, 0x0, 0x0
    .long 0x0, 0x0, 0x0, 0x0, 0x0, 0x0, 0x0, 0x0
    .long 0x0, 0x0, 0x0, 0x0, 0x0, 0x0, 0x0, 0x0
    .long 0x0, 0x0, 0x0, 0x0, 0x0, 0x0, 0x0, 0x0
    .long 0x0, 0x0, 0x0, 0x0, 0x0, 0x0, 0x0, 0x0
    .long 0x22b100, 0x1f100, 0xfffffff8, 0x10070e0, 0xa005000, 0x1c00, 0x600c540, 0xf460
    .long 0x80041c0, 0x41c0, 0xeff5ba0, 0xffff5ba0, 0x1000c540, 0x41c0, 0x120041c0, 0xc540
    .long 0x14feb740, 0xfffeb740, 0x16008380, 0xc540, 0x180062a0, 0x20e0, 0x1aff5ba0, 0xffff5ba0
    .long 0x1c0020e0, 0xe620, 0x1d000000, 0x20e0, 0x0, 0x0, 0x0, 0x0
    .long 0x0, 0xff000000, 0x0, 0x0, 0x0, 0x0, 0x0, 0x0
    .long 0x0, 0x0, 0x0, 0x0, 0x0, 0x0, 0x0, 0x0
    .long 0x0, 0x0, 0x0, 0x0, 0x0, 0x0, 0x0, 0x0
    .long 0x0, 0x0, 0x0, 0x0, 0x0, 0x0, 0x0, 0x0
    .long 0x24b100, 0x1f100, 0xfffffff8, 0x20091c0, 0xa005000, 0x1c00, 0x600c540, 0xf460
    .long 0x80041c0, 0x41c0, 0xeff5ba0, 0xffff5ba0, 0x1000c540, 0x41c0, 0x120041c0, 0xc540
    .long 0x14feb740, 0xfffeb740, 0x16008380, 0xc540, 0x180062a0, 0x20e0, 0x1aff5ba0, 0xffff5ba0
    .long 0x1c0020e0, 0xe620, 0x1d000000, 0x20e0, 0x0, 0x0, 0x0, 0x0
    .long 0x0, 0xff000000, 0x0, 0x0, 0x0, 0x0, 0x0, 0x0
    .long 0x0, 0x0, 0x0, 0x0, 0x0, 0x0, 0x0, 0x0
    .long 0x0, 0x0, 0x0, 0x0, 0x0, 0x0, 0x0, 0x0
    .long 0x0, 0x0, 0x0, 0x0, 0x0, 0x0, 0x0, 0x0
    .long 0x26b100, 0x1f100, 0xfffffff8, 0x300b2a0, 0xa005000, 0x1c00, 0x600c540, 0xf460
    .long 0x80041c0, 0x41c0, 0xeff5ba0, 0xffff5ba0, 0x1000c540, 0x41c0, 0x120041c0, 0xc540
    .long 0x14feb740, 0xfffeb740, 0x16008380, 0xc540, 0x180062a0, 0x20e0, 0x1aff5ba0, 0xffff5ba0
    .long 0x1c0020e0, 0xe620, 0x1d000000, 0x20e0, 0x0, 0x0, 0x0, 0x0
    .long 0x0, 0xff000000, 0x0, 0x0, 0x0, 0x0, 0x0, 0x0
    .long 0x0, 0x0, 0x0, 0x0, 0x0, 0x0, 0x0, 0x0
    .long 0x0, 0x0, 0x0, 0x0, 0x0, 0x0, 0x0, 0x0
    .long 0x0, 0x0, 0x0, 0x0, 0x0, 0x0, 0x0, 0x0
    .long 0x28b100, 0x1f100, 0xfffffff8, 0x400d380, 0xa005000, 0x1c00, 0x600c540, 0xf460
    .long 0x80041c0, 0x41c0, 0xeff5ba0, 0xffff5ba0, 0x1000c540, 0x41c0, 0x120041c0, 0xc540
    .long 0x14feb740, 0xfffeb740, 0x16008380, 0xc540, 0x180062a0, 0x20e0, 0x1aff5ba0, 0xffff5ba0
    .long 0x1c0020e0, 0xe620, 0x1d000000, 0x20e0, 0x0, 0x0, 0x0, 0x0
    .long 0x0, 0xff000000, 0x0, 0x0, 0x0, 0x0, 0x0, 0x0
    .long 0x0, 0x0, 0x0, 0x0, 0x0, 0x0, 0x0, 0x0
    .long 0x0, 0x0, 0x0, 0x0, 0x0, 0x0, 0x0, 0x0
    .long 0x0, 0x0, 0x0, 0x0, 0x0, 0x0, 0x0, 0x0
    .long 0x2ab100, 0x1f100, 0xfffffff8, 0x90177e0, 0xa005000, 0x1000, 0x600c540, 0xf460
    .long 0x80041c0, 0x41c0, 0xeff5ba0, 0xffff5ba0, 0x1000c540, 0x41c0, 0x120041c0, 0xc540
    .long 0x14feb740, 0xfffeb740, 0x16008380, 0xc540, 0x180062a0, 0x20e0, 0x1aff5ba0, 0xffff5ba0
    .long 0x1c0020e0, 0xe620, 0x1d000000, 0x20e0, 0x0, 0x0, 0x0, 0x0
    .long 0x0, 0xff000000, 0x0, 0x0, 0x0, 0x0, 0x0, 0x0
    .long 0x0, 0x0, 0x0, 0x0, 0x0, 0x0, 0x0, 0x0
    .long 0x0, 0x0, 0x0, 0x0, 0x0, 0x0, 0x0, 0x0
    .long 0x0, 0x0, 0x0, 0x0, 0x0, 0x0, 0x0, 0x0
    .long 0x2cb100, 0x1f100, 0xfffffff8, 0xa0198c0, 0xa005000, 0x1000, 0x600c540, 0xf460
    .long 0x80041c0, 0x41c0, 0xeff5ba0, 0xffff5ba0, 0x1000c540, 0x41c0, 0x120041c0, 0xc540
    .long 0x14feb740, 0xfffeb740, 0x16008380, 0xc540, 0x180062a0, 0x20e0, 0x1aff5ba0, 0xffff5ba0
    .long 0x1c0020e0, 0xe620, 0x1d000000, 0x20e0, 0x0, 0x0, 0x0, 0x0
    .long 0x0, 0xff000000, 0x0, 0x0, 0x0, 0x0, 0x0, 0x0
    .long 0x0, 0x0, 0x0, 0x0, 0x0, 0x0, 0x0, 0x0
    .long 0x0, 0x0, 0x0, 0x0, 0x0, 0x0, 0x0, 0x0
    .long 0x0, 0x0, 0x0, 0x0, 0x0, 0x0, 0x0, 0x0
    .long 0x2eb100, 0x1f100, 0xfffffff8, 0xb01b9a0, 0xa005000, 0x1000, 0x600c540, 0xf460
    .long 0x80041c0, 0x41c0, 0xeff5ba0, 0xffff5ba0, 0x1000c540, 0x41c0, 0x120041c0, 0xc540
    .long 0x14feb740, 0xfffeb740, 0x16008380, 0xc540, 0x180062a0, 0x20e0, 0x1aff5ba0, 0xffff5ba0
    .long 0x1c0020e0, 0xe620, 0x1d000000, 0x20e0, 0x0, 0x0, 0x0, 0x0
    .long 0x0, 0xff000000, 0x0, 0x0, 0x0, 0x0, 0x0, 0x0
    .long 0x0, 0x0, 0x0, 0x0, 0x0, 0x0, 0x0, 0x0
    .long 0x0, 0x0, 0x0, 0x0, 0x0, 0x0, 0x0, 0x0
    .long 0x0, 0x0, 0x0, 0x0, 0x0, 0x0, 0x0, 0x0
    .long 0x30b100, 0x1f100, 0xfffffff8, 0xc0070e0, 0xa005000, 0x1000, 0x600c540, 0xf460
    .long 0x80041c0, 0x41c0, 0xeff5ba0, 0xffff5ba0, 0x1000c540, 0x41c0, 0x120041c0, 0xc540
    .long 0x14feb740, 0xfffeb740, 0x16008380, 0xc540, 0x180062a0, 0x20e0, 0x1aff5ba0, 0xffff5ba0
    .long 0x1c0020e0, 0xe620, 0x1d000000, 0x20e0, 0x0, 0x0, 0x0, 0x0
    .long 0x0, 0xff000000, 0x0, 0x0, 0x0, 0x0, 0x0, 0x0
    .long 0x0, 0x0, 0x0, 0x0, 0x0, 0x0, 0x0, 0x0
    .long 0x0, 0x0, 0x0, 0x0, 0x0, 0x0, 0x0, 0x0
    .long 0x0, 0x0, 0x0, 0x0, 0x0, 0x0, 0x0, 0x0
    .long 0x22b100, 0x36e00e, 0x24b100, 0x436e00c, 0x28b100, 0x836e00c, 0x24b100, 0xc36e00e
    .long 0x26b100, 0x1036e00e, 0x28b100, 0x1436e00e, 0x2cb100, 0x1836e00c, 0x230b101, 0x236e00c
    .long 0x22ab104, 0x636e00e, 0x22cb110, 0x1636e00e, 0x22eb140, 0x1a36e00e, 0x230b1ff, 0x36e00e
    .long 0x432b1ff, 0xa36e00e, 0x634b1ff, 0x1036e00e, 0x836b1ff, 0x1436e00e, 0x0, 0x0
    .long 0x0, 0x0, 0x0, 0x0, 0x0, 0x0, 0x0, 0x0
    .long 0x0, 0x0, 0x0, 0x0, 0x0, 0x0, 0x0, 0x0
    .long 0x0, 0x0, 0x0, 0x0, 0x0, 0x0, 0x0, 0x0
    .long 0x0, 0x0, 0x0, 0x0, 0x0, 0x0, 0x0, 0x0
    .long 0x22b100, 0x236e00c, 0x26b100, 0x636e00c, 0x22b100, 0xa36e00d, 0x24b100, 0xe36e00d
    .long 0x26b100, 0x1236e00d, 0x2ab100, 0x1636e00c, 0x2eb100, 0x1a36e00c, 0x228b102, 0x436e00d
    .long 0x22ab108, 0x836e00d, 0x22cb120, 0x1836e00d, 0x22eb180, 0x236e00d, 0x430b1ff, 0xc36e00d
    .long 0x632b1ff, 0xe36e00d, 0x834b1ff, 0x1236e00d, 0xa36b1ff, 0x436e00d, 0x0, 0x0
    .long 0x0, 0x0, 0x0, 0x0, 0x0, 0x0, 0x0, 0x0
    .long 0x0, 0x0, 0x0, 0x0, 0x0, 0x0, 0x0, 0x0
    .long 0x0, 0x0, 0x0, 0x0, 0x0, 0x0, 0x0, 0x0
    .long 0x0, 0x0, 0x0, 0x0, 0x0, 0x0, 0x0, 0x0
    .long 0x0, 0x0, 0x0, 0x0, 0x0, 0xff000000, 0x0, 0x0
    .long 0x0, 0x0, 0x0, 0x0, 0x0, 0x0, 0x0, 0x0
    .long 0x0, 0x0, 0x0, 0x0, 0x0, 0x0, 0x0, 0x0
    .long 0x0, 0x0, 0x0, 0x0, 0x0, 0x0, 0x0, 0x0
    .long 0x0, 0x0, 0x0, 0x0, 0x0, 0x0, 0x0, 0x0
    .long 0x0, 0x0, 0x0, 0x0, 0x0, 0x0, 0x0, 0x0
    .long 0x0, 0x0, 0x0, 0x0, 0x0, 0x0, 0x0, 0x0
    .long 0x0, 0x0, 0x0, 0x0, 0x0, 0x0, 0x0, 0x0
    .long 0x0, 0x0, 0x0, 0x0, 0x0, 0xff000000, 0x0, 0x0
    .long 0x0, 0x0, 0x0, 0x0, 0x0, 0x0, 0x0, 0x0
    .long 0x0, 0x0, 0x0, 0x0, 0x0, 0x0, 0x0, 0x0
    .long 0x0, 0x0, 0x0, 0x0, 0x0, 0x0, 0x0, 0x0
    .long 0x0, 0x0, 0x0, 0x0, 0x0, 0x0, 0x0, 0x0
    .long 0x0, 0x0, 0x0, 0x0, 0x0, 0x0, 0x0, 0x0
    .long 0x0, 0x0, 0x0, 0x0, 0x0, 0x0, 0x0, 0x0
    .long 0x0, 0x0, 0x0, 0x0, 0x0, 0x0, 0x0, 0x0
    .long 0x22b100, 0x1f100, 0xfffffff8, 0x10070e0, 0xa005000, 0x1c00, 0x600c540, 0xf460
    .long 0x80041c0, 0x41c0, 0xa0041c0, 0x41c0, 0x10ff19e0, 0xffff19e0, 0x12010700, 0x41c0
    .long 0x140041c0, 0x10700, 0x16fe54a0, 0xfffe9660, 0x1800a460, 0xa460, 0x1a0062a0, 0x20e0
    .long 0x1c0041c0, 0x41c0, 0x1d000000, 0xffff19e0, 0x0, 0x0, 0x0, 0x0
    .long 0x0, 0xff000000, 0x0, 0x0, 0x0, 0x0, 0x0, 0x0
    .long 0x0, 0x0, 0x0, 0x0, 0x0, 0x0, 0x0, 0x0
    .long 0x0, 0x0, 0x0, 0x0, 0x0, 0x0, 0x0, 0x0
    .long 0x0, 0x0, 0x0, 0x0, 0x0, 0x0, 0x0, 0x0
    .long 0x24b100, 0x1f100, 0xfffffff8, 0x20091c0, 0xa005000, 0x1c00, 0x600c540, 0xf460
    .long 0x80041c0, 0x41c0, 0xa0041c0, 0x41c0, 0x10ff19e0, 0xffff19e0, 0x12010700, 0x41c0
    .long 0x140041c0, 0x10700, 0x16fe54a0, 0xfffe9660, 0x1800a460, 0xa460, 0x1a0062a0, 0x20e0
    .long 0x1c0041c0, 0x41c0, 0x1d000000, 0xffff19e0, 0x0, 0x0, 0x0, 0x0
    .long 0x0, 0xff000000, 0x0, 0x0, 0x0, 0x0, 0x0, 0x0
    .long 0x0, 0x0, 0x0, 0x0, 0x0, 0x0, 0x0, 0x0
    .long 0x0, 0x0, 0x0, 0x0, 0x0, 0x0, 0x0, 0x0
    .long 0x0, 0x0, 0x0, 0x0, 0x0, 0x0, 0x0, 0x0
    .long 0x26b100, 0x1f100, 0xfffffff8, 0x300b2a0, 0xa005000, 0x1c00, 0x600c540, 0xf460
    .long 0x80041c0, 0x41c0, 0xa0041c0, 0x41c0, 0x10ff19e0, 0xffff19e0, 0x12010700, 0x41c0
    .long 0x140041c0, 0x10700, 0x16fe54a0, 0xfffe9660, 0x1800a460, 0xa460, 0x1a0062a0, 0x20e0
    .long 0x1c0041c0, 0x41c0, 0x1d000000, 0xffff19e0, 0x0, 0x0, 0x0, 0x0
    .long 0x0, 0xff000000, 0x0, 0x0, 0x0, 0x0, 0x0, 0x0
    .long 0x0, 0x0, 0x0, 0x0, 0x0, 0x0, 0x0, 0x0
    .long 0x0, 0x0, 0x0, 0x0, 0x0, 0x0, 0x0, 0x0
    .long 0x0, 0x0, 0x0, 0x0, 0x0, 0x0, 0x0, 0x0
    .long 0x28b100, 0x1f100, 0xfffffff8, 0x400d380, 0xa005000, 0x1c00, 0x600c540, 0xf460
    .long 0x80041c0, 0x41c0, 0xa0041c0, 0x41c0, 0x10ff19e0, 0xffff19e0, 0x12010700, 0x41c0
    .long 0x140041c0, 0x10700, 0x16fe54a0, 0xfffe9660, 0x1800a460, 0xa460, 0x1a0062a0, 0x20e0
    .long 0x1c0041c0, 0x41c0, 0x1d000000, 0xffff19e0, 0x0, 0x0, 0x0, 0x0
    .long 0x0, 0xff000000, 0x0, 0x0, 0x0, 0x0, 0x0, 0x0
    .long 0x0, 0x0, 0x0, 0x0, 0x0, 0x0, 0x0, 0x0
    .long 0x0, 0x0, 0x0, 0x0, 0x0, 0x0, 0x0, 0x0
    .long 0x0, 0x0, 0x0, 0x0, 0x0, 0x0, 0x0, 0x0
    .long 0x2ab100, 0x1f100, 0xfffffff8, 0xb01b9a0, 0xa005000, 0x1000, 0x600c540, 0xf460
    .long 0x80041c0, 0x41c0, 0xa0041c0, 0x41c0, 0x10ff19e0, 0xffff19e0, 0x12010700, 0x41c0
    .long 0x140041c0, 0x10700, 0x16fe54a0, 0xfffe9660, 0x1800a460, 0xa460, 0x1a0062a0, 0x20e0
    .long 0x1c0041c0, 0x41c0, 0x1d000000, 0xffff19e0, 0x0, 0x0, 0x0, 0x0
    .long 0x0, 0xff000000, 0x0, 0x0, 0x0, 0x0, 0x0, 0x0
    .long 0x0, 0x0, 0x0, 0x0, 0x0, 0x0, 0x0, 0x0
    .long 0x0, 0x0, 0x0, 0x0, 0x0, 0x0, 0x0, 0x0
    .long 0x0, 0x0, 0x0, 0x0, 0x0, 0x0, 0x0, 0x0
    .long 0x2cb100, 0x1f100, 0xfffffff8, 0xc01da80, 0xa005000, 0x1000, 0x600c540, 0xf460
    .long 0x80041c0, 0x41c0, 0xa0041c0, 0x41c0, 0x10ff19e0, 0xffff19e0, 0x12010700, 0x41c0
    .long 0x140041c0, 0x10700, 0x16fe54a0, 0xfffe9660, 0x1800a460, 0xa460, 0x1a0062a0, 0x20e0
    .long 0x1c0041c0, 0x41c0, 0x1d000000, 0xffff19e0, 0x0, 0x0, 0x0, 0x0
    .long 0x0, 0xff000000, 0x0, 0x0, 0x0, 0x0, 0x0, 0x0
    .long 0x0, 0x0, 0x0, 0x0, 0x0, 0x0, 0x0, 0x0
    .long 0x0, 0x0, 0x0, 0x0, 0x0, 0x0, 0x0, 0x0
    .long 0x0, 0x0, 0x0, 0x0, 0x0, 0x0, 0x0, 0x0
    .long 0x2eb100, 0x1f100, 0xfffffff8, 0xd01fb60, 0xa005000, 0x1000, 0x600c540, 0xf460
    .long 0x80041c0, 0x41c0, 0xa0041c0, 0x41c0, 0x10ff19e0, 0xffff19e0, 0x12010700, 0x41c0
    .long 0x140041c0, 0x10700, 0x16fe54a0, 0xfffe9660, 0x1800a460, 0xa460, 0x1a0062a0, 0x20e0
    .long 0x1c0041c0, 0x41c0, 0x1d000000, 0xffff19e0, 0x0, 0x0, 0x0, 0x0
    .long 0x0, 0xff000000, 0x0, 0x0, 0x0, 0x0, 0x0, 0x0
    .long 0x0, 0x0, 0x0, 0x0, 0x0, 0x0, 0x0, 0x0
    .long 0x0, 0x0, 0x0, 0x0, 0x0, 0x0, 0x0, 0x0
    .long 0x0, 0x0, 0x0, 0x0, 0x0, 0x0, 0x0, 0x0
    .long 0x30b100, 0x1f100, 0xfffffff8, 0xe0070e0, 0xa005000, 0x1000, 0x600c540, 0xf460
    .long 0x80041c0, 0x41c0, 0xa0041c0, 0x41c0, 0x10ff19e0, 0xffff19e0, 0x12010700, 0x41c0
    .long 0x140041c0, 0x10700, 0x16fe54a0, 0xfffe9660, 0x1800a460, 0xa460, 0x1a0062a0, 0x20e0
    .long 0x1c0041c0, 0x41c0, 0x1d000000, 0xffff19e0, 0x0, 0x0, 0x0, 0x0
    .long 0x0, 0xff000000, 0x0, 0x0, 0x0, 0x0, 0x0, 0x0
    .long 0x0, 0x0, 0x0, 0x0, 0x0, 0x0, 0x0, 0x0
    .long 0x0, 0x0, 0x0, 0x0, 0x0, 0x0, 0x0, 0x0
    .long 0x0, 0x0, 0x0, 0x0, 0x0, 0x0, 0x0, 0x0
    .long 0x141000, 0x22b00a, 0x161000, 0x422b008, 0x1a1000, 0x822b008, 0x161000, 0xc22b00a
    .long 0x181000, 0x1022b00a, 0x1e1000, 0x1422b008, 0x141000, 0x1822b008, 0x1a1000, 0x1c22b00a
    .long 0x21c1001, 0x222b00a, 0x21e1004, 0x622b00a, 0x2201010, 0x1222b00a, 0x2221040, 0x1622b00a
    .long 0x2a56080, 0x18afa008, 0x4a760ff, 0xcafa008, 0x6a760ff, 0x10afa00a, 0x8a760ff, 0x1cafa009
    .long 0xaa960ff, 0x1eafa009, 0x42ab6400, 0xcafa009, 0xcad60ff, 0x6afa009, 0xeaf60ff, 0x12afa009
    .long 0x0, 0x0, 0x0, 0x0, 0x0, 0x0, 0x0, 0x0
    .long 0x0, 0x0, 0x0, 0x0, 0x0, 0x0, 0x0, 0x0
    .long 0x0, 0x0, 0x0, 0x0, 0x0, 0x0, 0x0, 0x0
    .long 0x221000, 0x222b008, 0x181000, 0x622b008, 0x141000, 0xa22b009, 0x161000, 0xe22b009
    .long 0x1c1000, 0x1222b008, 0x201000, 0x1622b008, 0x181000, 0x1a22b009, 0x1a1000, 0x1e22b009
    .long 0x21c1002, 0x422b009, 0x21e1008, 0x822b009, 0x2201020, 0x1422b009, 0x22210ff, 0x22b009
    .long 0x4a560ff, 0xaafa00a, 0x6a560ff, 0xeafa009, 0x8a960ff, 0x1aafa008, 0xaa960ff, 0x2afa00a
    .long 0x42ab6200, 0x18afa00a, 0xcad60ff, 0x4afa00a, 0xeaf60ff, 0x8afa00a, 0x0, 0x0
    .long 0x0, 0x0, 0x0, 0x0, 0x0, 0x0, 0x0, 0x0
    .long 0x0, 0x0, 0x0, 0x0, 0x0, 0x0, 0x0, 0x0
    .long 0x0, 0x0, 0x0, 0x0, 0x0, 0x0, 0x0, 0x0
    .long 0xa56000, 0x1f100, 0xfffffff0, 0x1901da80, 0x500f460, 0x20001000, 0x1c0062a0, 0x13620
    .long 0x1fff19e0, 0xe620, 0x210169a0, 0x20e0, 0x23feb740, 0xfffed820, 0x250041c0, 0xffff9d60
    .long 0x26000000, 0xc540, 0x0, 0x0, 0x0, 0x0, 0x0, 0xff000000
    .long 0x0, 0x0, 0x0, 0x0, 0x0, 0x0, 0x0, 0x0
    .long 0x0, 0x0, 0x0, 0x0, 0x0, 0x0, 0x0, 0x0
    .long 0x0, 0x0, 0x0, 0x0, 0x0, 0x0, 0x0, 0x0
    .long 0x0, 0x0, 0x0, 0x0, 0x0, 0x0, 0x0, 0x0
    .long 0x0, 0x0, 0x0, 0x0, 0x0, 0x0, 0x0, 0x0
    .long 0xa76000, 0x1f100, 0xfffffff0, 0x1a011540, 0x500f460, 0x20001000, 0x1c0062a0, 0x13620
    .long 0x1fff19e0, 0xe620, 0x210169a0, 0x20e0, 0x23feb740, 0xfffed820, 0x250041c0, 0xffff9d60
    .long 0x26000000, 0xc540, 0x0, 0x0, 0x0, 0x0, 0x0, 0xff000000
    .long 0x0, 0x0, 0x0, 0x0, 0x0, 0x0, 0x0, 0x0
    .long 0x0, 0x0, 0x0, 0x0, 0x0, 0x0, 0x0, 0x0
    .long 0x0, 0x0, 0x0, 0x0, 0x0, 0x0, 0x0, 0x0
    .long 0x0, 0x0, 0x0, 0x0, 0x0, 0x0, 0x0, 0x0
    .long 0x0, 0x0, 0x0, 0x0, 0x0, 0x0, 0x0, 0x0
    .long 0x221000, 0x9100, 0xfffffc00, 0x10070e0, 0x7005000, 0x1d00, 0x600c540, 0xf460
    .long 0x80041c0, 0x41c0, 0xe00c540, 0xc540, 0x10fe54a0, 0x41c0, 0x120041c0, 0xfffe54a0
    .long 0x1400c540, 0x41c0, 0x160041c0, 0xc540, 0x17000000, 0xfffeb740, 0xa96000, 0x1f100
    .long 0xfffffff0, 0x1d0041c0, 0x5ff3ac0, 0x20001c00, 0x1c0062a0, 0xe620, 0x1fff19e0, 0xe620
    .long 0x210169a0, 0x20e0, 0x23feb740, 0xfffed820, 0x250041c0, 0xffff9d60, 0x26000000, 0xc540
    .long 0x0, 0x0, 0x0, 0x0, 0x0, 0xff000000, 0x0, 0x0
    .long 0x0, 0x0, 0x0, 0x0, 0x0, 0x0, 0x0, 0x0
    .long 0x0, 0x0, 0x0, 0x0, 0x0, 0x0, 0x0, 0x0
    .long 0x161000, 0x1f100, 0xfffffc00, 0x20091c0, 0x7005000, 0x1c00, 0x600c540, 0xf460
    .long 0x80041c0, 0x41c0, 0xe00c540, 0xc540, 0x10fe54a0, 0x41c0, 0x120041c0, 0xfffe54a0
    .long 0x1400c540, 0x41c0, 0x160041c0, 0xc540, 0x17000000, 0xfffeb740, 0x0, 0x0
    .long 0x0, 0x0, 0x0, 0xff000000, 0x0, 0x0, 0x0, 0x0
    .long 0x0, 0x0, 0x0, 0x0, 0x0, 0x0, 0x0, 0x0
    .long 0x0, 0x0, 0x0, 0x0, 0x0, 0x0, 0x0, 0x0
    .long 0x0, 0x0, 0x0, 0x0, 0x0, 0x0, 0x0, 0x0
    .long 0x0, 0x0, 0x0, 0x0, 0x0, 0x0, 0x0, 0x0
    .long 0x181000, 0x1f100, 0xfffffc00, 0x300b2a0, 0x7005000, 0x1c00, 0x600c540, 0xf460
    .long 0x80041c0, 0x41c0, 0xe00c540, 0xc540, 0x10fe54a0, 0x41c0, 0x120041c0, 0xfffe54a0
    .long 0x1400c540, 0x41c0, 0x160041c0, 0xc540, 0x17000000, 0xfffeb740, 0x0, 0x0
    .long 0x0, 0x0, 0x0, 0xff000000, 0x0, 0x0, 0x0, 0x0
    .long 0x0, 0x0, 0x0, 0x0, 0x0, 0x0, 0x0, 0x0
    .long 0x0, 0x0, 0x0, 0x0, 0x0, 0x0, 0x0, 0x0
    .long 0x0, 0x0, 0x0, 0x0, 0x0, 0x0, 0x0, 0x0
    .long 0x0, 0x0, 0x0, 0x0, 0x0, 0x0, 0x0, 0x0
    .long 0x1a1000, 0x1f100, 0xfffffc00, 0x400d380, 0x7005000, 0x1c00, 0x600c540, 0xf460
    .long 0x80041c0, 0x41c0, 0xe00c540, 0xc540, 0x10fe54a0, 0x41c0, 0x120041c0, 0xfffe54a0
    .long 0x1400c540, 0x41c0, 0x160041c0, 0xc540, 0x17000000, 0xfffeb740, 0x0, 0x0
    .long 0x0, 0x0, 0x0, 0xff000000, 0x0, 0x0, 0x0, 0x0
    .long 0x0, 0x0, 0x0, 0x0, 0x0, 0x0, 0x0, 0x0
    .long 0x0, 0x0, 0x0, 0x0, 0x0, 0x0, 0x0, 0x0
    .long 0x0, 0x0, 0x0, 0x0, 0x0, 0x0, 0x0, 0x0
    .long 0x0, 0x0, 0x0, 0x0, 0x0, 0x0, 0x0, 0x0
    .long 0x1c1000, 0x1f100, 0xfffffc00, 0x90177e0, 0x7005000, 0x1000, 0x600c540, 0xf460
    .long 0x80041c0, 0x41c0, 0xe00c540, 0xc540, 0x10fe54a0, 0x41c0, 0x120041c0, 0xfffe54a0
    .long 0x1400c540, 0x41c0, 0x160041c0, 0xc540, 0x17000000, 0xfffeb740, 0x0, 0x0
    .long 0x0, 0x0, 0x0, 0xff000000, 0x0, 0x0, 0x0, 0x0
    .long 0x0, 0x0, 0x0, 0x0, 0x0, 0x0, 0x0, 0x0
    .long 0x0, 0x0, 0x0, 0x0, 0x0, 0x0, 0x0, 0x0
    .long 0x0, 0x0, 0x0, 0x0, 0x0, 0x0, 0x0, 0x0
    .long 0x0, 0x0, 0x0, 0x0, 0x0, 0x0, 0x0, 0x0
    .long 0x1e1000, 0x1f100, 0xfffffc00, 0xa0198c0, 0x7005000, 0x1000, 0x600c540, 0xf460
    .long 0x80041c0, 0x41c0, 0xe00c540, 0xc540, 0x10fe54a0, 0x41c0, 0x120041c0, 0xfffe54a0
    .long 0x1400c540, 0x41c0, 0x160041c0, 0xc540, 0x17000000, 0xfffeb740, 0x0, 0x0
    .long 0x0, 0x0, 0x0, 0xff000000, 0x0, 0x0, 0x0, 0x0
    .long 0x0, 0x0, 0x0, 0x0, 0x0, 0x0, 0x0, 0x0
    .long 0x0, 0x0, 0x0, 0x0, 0x0, 0x0, 0x0, 0x0
    .long 0x0, 0x0, 0x0, 0x0, 0x0, 0x0, 0x0, 0x0
    .long 0x0, 0x0, 0x0, 0x0, 0x0, 0x0, 0x0, 0x0
    .long 0x201000, 0x1f100, 0xfffffc00, 0xb01b9a0, 0x7005000, 0x1000, 0x600c540, 0xf460
    .long 0x80041c0, 0x41c0, 0xe00c540, 0xc540, 0x10fe54a0, 0x41c0, 0x120041c0, 0xfffe54a0
    .long 0x1400c540, 0x41c0, 0x160041c0, 0xc540, 0x17000000, 0xfffeb740, 0x0, 0x0
    .long 0x0, 0x0, 0x0, 0xff000000, 0x0, 0x0, 0x0, 0x0
    .long 0x0, 0x0, 0x0, 0x0, 0x0, 0x0, 0x0, 0x0
    .long 0x0, 0x0, 0x0, 0x0, 0x0, 0x0, 0x0, 0x0
    .long 0x0, 0x0, 0x0, 0x0, 0x0, 0x0, 0x0, 0x0
    .long 0x0, 0x0, 0x0, 0x0, 0x0, 0x0, 0x0, 0x0
    .long 0x141000, 0x1f100, 0xfffffc00, 0xc01da80, 0x7005000, 0x1000, 0x600c540, 0xf460
    .long 0x80041c0, 0x41c0, 0xe00c540, 0xc540, 0x10fe54a0, 0x41c0, 0x120041c0, 0xfffe54a0
    .long 0x1400c540, 0x41c0, 0x160041c0, 0xc540, 0x17000000, 0xfffeb740, 0x0, 0x0
    .long 0x0, 0x0, 0x0, 0xff000000, 0x0, 0x0, 0x0, 0x0
    .long 0x0, 0x0, 0x0, 0x0, 0x0, 0x0, 0x0, 0x0
    .long 0x0, 0x0, 0x0, 0x0, 0x0, 0x0, 0x0, 0x0
    .long 0x0, 0x0, 0x0, 0x0, 0x0, 0x0, 0x0, 0x0
    .long 0x0, 0x0, 0x0, 0x0, 0x0, 0x0, 0x0, 0x0
    .long 0x141000, 0x22b00a, 0x161000, 0x422b008, 0x1a1000, 0x822b008, 0x161000, 0xc22b00a
    .long 0x181000, 0x1022b00a, 0x1e1000, 0x1422b008, 0x141000, 0x1822b008, 0x1a1000, 0x1c22b00a
    .long 0x21c1001, 0x222b00a, 0x21e1004, 0x622b00a, 0x2201010, 0x1222b00a, 0x2221040, 0x1622b00a
    .long 0x2a56080, 0x18afa008, 0x4a760ff, 0xcafa008, 0x6a760ff, 0x10afa00a, 0x8a760ff, 0x1cafa009
    .long 0xaa960ff, 0x1eafa009, 0x42ab6400, 0xcafa009, 0xcad60ff, 0x6afa009, 0xeaf60ff, 0x12afa009
    .long 0x0, 0x0, 0x0, 0x0, 0x0, 0x0, 0x0, 0x0
    .long 0x0, 0x0, 0x0, 0x0, 0x0, 0x0, 0x0, 0x0
    .long 0x0, 0x0, 0x0, 0x0, 0x0, 0x0, 0x0, 0x0
    .long 0x221000, 0x222b008, 0x181000, 0x622b008, 0x141000, 0xa22b009, 0x161000, 0xe22b009
    .long 0x1c1000, 0x1222b008, 0x201000, 0x1622b008, 0x181000, 0x1a22b009, 0x1a1000, 0x1e22b009
    .long 0x21c1002, 0x422b009, 0x21e1008, 0x822b009, 0x2201020, 0x1422b009, 0x22210ff, 0x22b009
    .long 0x4a560ff, 0xaafa00a, 0x6a560ff, 0xeafa009, 0x8a960ff, 0x1aafa008, 0xaa960ff, 0x2afa00a
    .long 0x42ab6200, 0x18afa00a, 0xcad60ff, 0x4afa00a, 0xeaf60ff, 0x8afa00a, 0x0, 0x0
    .long 0x0, 0x0, 0x0, 0x0, 0x0, 0x0, 0x0, 0x0
    .long 0x0, 0x0, 0x0, 0x0, 0x0, 0x0, 0x0, 0x0
    .long 0x0, 0x0, 0x0, 0x0, 0x0, 0x0, 0x0, 0x0
    .long 0xa56000, 0x1f100, 0xfffffff0, 0x1901da80, 0x500f460, 0x20001000, 0x1c0062a0, 0x13620
    .long 0x1fff19e0, 0xe620, 0x210169a0, 0x20e0, 0x23feb740, 0xfffed820, 0x250041c0, 0xffff9d60
    .long 0x26000000, 0xc540, 0x0, 0x0, 0x0, 0x0, 0x0, 0xff000000
    .long 0x0, 0x0, 0x0, 0x0, 0x0, 0x0, 0x0, 0x0
    .long 0x0, 0x0, 0x0, 0x0, 0x0, 0x0, 0x0, 0x0
    .long 0x0, 0x0, 0x0, 0x0, 0x0, 0x0, 0x0, 0x0
    .long 0x0, 0x0, 0x0, 0x0, 0x0, 0x0, 0x0, 0x0
    .long 0x0, 0x0, 0x0, 0x0, 0x0, 0x0, 0x0, 0x0
    .long 0xa76000, 0x1f100, 0xfffffff0, 0x1a011540, 0x500f460, 0x20001000, 0x1c0062a0, 0x13620
    .long 0x1fff19e0, 0xe620, 0x210169a0, 0x20e0, 0x23feb740, 0xfffed820, 0x250041c0, 0xffff9d60
    .long 0x26000000, 0xc540, 0x0, 0x0, 0x0, 0x0, 0x0, 0xff000000
    .long 0x0, 0x0, 0x0, 0x0, 0x0, 0x0, 0x0, 0x0
    .long 0x0, 0x0, 0x0, 0x0, 0x0, 0x0, 0x0, 0x0
    .long 0x0, 0x0, 0x0, 0x0, 0x0, 0x0, 0x0, 0x0
    .long 0x0, 0x0, 0x0, 0x0, 0x0, 0x0, 0x0, 0x0
    .long 0x0, 0x0, 0x0, 0x0, 0x0, 0x0, 0x0, 0x0
    .long 0x221000, 0x9100, 0xfffffc00, 0x10070e0, 0x7005000, 0x1d00, 0x600c540, 0xf460
    .long 0x80041c0, 0x41c0, 0xe00c540, 0xc540, 0x10fe54a0, 0x41c0, 0x120041c0, 0xfffe54a0
    .long 0x1400c540, 0x41c0, 0x160041c0, 0xc540, 0x17000000, 0xfffeb740, 0xa96000, 0x1f100
    .long 0xfffffff0, 0x1d0041c0, 0x5ff3ac0, 0x20001c00, 0x1c0062a0, 0xe620, 0x1fff19e0, 0xe620
    .long 0x210169a0, 0x20e0, 0x23feb740, 0xfffed820, 0x250041c0, 0xffff9d60, 0x26000000, 0xc540
    .long 0x0, 0x0, 0x0, 0x0, 0x0, 0xff000000, 0x0, 0x0
    .long 0x0, 0x0, 0x0, 0x0, 0x0, 0x0, 0x0, 0x0
    .long 0x0, 0x0, 0x0, 0x0, 0x0, 0x0, 0x0, 0x0
    .long 0x161000, 0x1f100, 0xfffffc00, 0x20091c0, 0x7005000, 0x1c00, 0x600c540, 0xf460
    .long 0x80041c0, 0x41c0, 0xe00c540, 0xc540, 0x10fe54a0, 0x41c0, 0x120041c0, 0xfffe54a0
    .long 0x1400c540, 0x41c0, 0x160041c0, 0xc540, 0x17000000, 0xfffeb740, 0x0, 0x0
    .long 0x0, 0x0, 0x0, 0xff000000, 0x0, 0x0, 0x0, 0x0
    .long 0x0, 0x0, 0x0, 0x0, 0x0, 0x0, 0x0, 0x0
    .long 0x0, 0x0, 0x0, 0x0, 0x0, 0x0, 0x0, 0x0
    .long 0x0, 0x0, 0x0, 0x0, 0x0, 0x0, 0x0, 0x0
    .long 0x0, 0x0, 0x0, 0x0, 0x0, 0x0, 0x0, 0x0
    .long 0x181000, 0x1f100, 0xfffffc00, 0x300b2a0, 0x7005000, 0x1c00, 0x600c540, 0xf460
    .long 0x80041c0, 0x41c0, 0xe00c540, 0xc540, 0x10fe54a0, 0x41c0, 0x120041c0, 0xfffe54a0
    .long 0x1400c540, 0x41c0, 0x160041c0, 0xc540, 0x17000000, 0xfffeb740, 0x0, 0x0
    .long 0x0, 0x0, 0x0, 0xff000000, 0x0, 0x0, 0x0, 0x0
    .long 0x0, 0x0, 0x0, 0x0, 0x0, 0x0, 0x0, 0x0
    .long 0x0, 0x0, 0x0, 0x0, 0x0, 0x0, 0x0, 0x0
    .long 0x0, 0x0, 0x0, 0x0, 0x0, 0x0, 0x0, 0x0
    .long 0x0, 0x0, 0x0, 0x0, 0x0, 0x0, 0x0, 0x0
    .long 0x1a1000, 0x1f100, 0xfffffc00, 0x400d380, 0x7005000, 0x1c00, 0x600c540, 0xf460
    .long 0x80041c0, 0x41c0, 0xe00c540, 0xc540, 0x10fe54a0, 0x41c0, 0x120041c0, 0xfffe54a0
    .long 0x1400c540, 0x41c0, 0x160041c0, 0xc540, 0x17000000, 0xfffeb740, 0x0, 0x0
    .long 0x0, 0x0, 0x0, 0xff000000, 0x0, 0x0, 0x0, 0x0
    .long 0x0, 0x0, 0x0, 0x0, 0x0, 0x0, 0x0, 0x0
    .long 0x0, 0x0, 0x0, 0x0, 0x0, 0x0, 0x0, 0x0
    .long 0x0, 0x0, 0x0, 0x0, 0x0, 0x0, 0x0, 0x0
    .long 0x0, 0x0, 0x0, 0x0, 0x0, 0x0, 0x0, 0x0
    .long 0x1c1000, 0x1f100, 0xfffffc00, 0x90177e0, 0x7005000, 0x1000, 0x600c540, 0xf460
    .long 0x80041c0, 0x41c0, 0xe00c540, 0xc540, 0x10fe54a0, 0x41c0, 0x120041c0, 0xfffe54a0
    .long 0x1400c540, 0x41c0, 0x160041c0, 0xc540, 0x17000000, 0xfffeb740, 0x0, 0x0
    .long 0x0, 0x0, 0x0, 0xff000000, 0x0, 0x0, 0x0, 0x0
    .long 0x0, 0x0, 0x0, 0x0, 0x0, 0x0, 0x0, 0x0
    .long 0x0, 0x0, 0x0, 0x0, 0x0, 0x0, 0x0, 0x0
    .long 0x0, 0x0, 0x0, 0x0, 0x0, 0x0, 0x0, 0x0
    .long 0x0, 0x0, 0x0, 0x0, 0x0, 0x0, 0x0, 0x0
    .long 0x1e1000, 0x1f100, 0xfffffc00, 0xa0198c0, 0x7005000, 0x1000, 0x600c540, 0xf460
    .long 0x80041c0, 0x41c0, 0xe00c540, 0xc540, 0x10fe54a0, 0x41c0, 0x120041c0, 0xfffe54a0
    .long 0x1400c540, 0x41c0, 0x160041c0, 0xc540, 0x17000000, 0xfffeb740, 0x0, 0x0
    .long 0x0, 0x0, 0x0, 0xff000000, 0x0, 0x0, 0x0, 0x0
    .long 0x0, 0x0, 0x0, 0x0, 0x0, 0x0, 0x0, 0x0
    .long 0x0, 0x0, 0x0, 0x0, 0x0, 0x0, 0x0, 0x0
    .long 0x0, 0x0, 0x0, 0x0, 0x0, 0x0, 0x0, 0x0
    .long 0x0, 0x0, 0x0, 0x0, 0x0, 0x0, 0x0, 0x0
    .long 0x201000, 0x1f100, 0xfffffc00, 0xb01b9a0, 0x7005000, 0x1000, 0x600c540, 0xf460
    .long 0x80041c0, 0x41c0, 0xe00c540, 0xc540, 0x10fe54a0, 0x41c0, 0x120041c0, 0xfffe54a0
    .long 0x1400c540, 0x41c0, 0x160041c0, 0xc540, 0x17000000, 0xfffeb740, 0x0, 0x0
    .long 0x0, 0x0, 0x0, 0xff000000, 0x0, 0x0, 0x0, 0x0
    .long 0x0, 0x0, 0x0, 0x0, 0x0, 0x0, 0x0, 0x0
    .long 0x0, 0x0, 0x0, 0x0, 0x0, 0x0, 0x0, 0x0
    .long 0x0, 0x0, 0x0, 0x0, 0x0, 0x0, 0x0, 0x0
    .long 0x0, 0x0, 0x0, 0x0, 0x0, 0x0, 0x0, 0x0
    .long 0x141000, 0x1f100, 0xfffffc00, 0xc01da80, 0x7005000, 0x1000, 0x600c540, 0xf460
    .long 0x80041c0, 0x41c0, 0xe00c540, 0xc540, 0x10fe54a0, 0x41c0, 0x120041c0, 0xfffe54a0
    .long 0x1400c540, 0x41c0, 0x160041c0, 0xc540, 0x17000000, 0xfffeb740, 0x0, 0x0
    .long 0x0, 0x0, 0x0, 0xff000000, 0x0, 0x0, 0x0, 0x0
    .long 0x0, 0x0, 0x0, 0x0, 0x0, 0x0, 0x0, 0x0
    .long 0x0, 0x0, 0x0, 0x0, 0x0, 0x0, 0x0, 0x0
    .long 0x0, 0x0, 0x0, 0x0, 0x0, 0x0, 0x0, 0x0
    .long 0x0, 0x0, 0x0, 0x0, 0x0, 0x0, 0x0, 0x0
    .long 0x22b000, 0x36e00a, 0x24b000, 0x436e008, 0x28b000, 0x836e008, 0x24b000, 0xc36e00a
    .long 0x26b000, 0x1036e00a, 0x2cb000, 0x1436e008, 0x230b001, 0x236e008, 0x228b004, 0x636e00a
    .long 0x22ab010, 0x1236e00a, 0x22cb040, 0x1636e00a, 0x22eb080, 0x236e00a, 0x430b0ff, 0xa36e00a
    .long 0x632b0ff, 0x1036e00a, 0x834b0ff, 0x436e00a, 0xa36b0ff, 0x836e00a, 0x0, 0x0
    .long 0x0, 0x0, 0x0, 0x0, 0x0, 0x0, 0x0, 0x0
    .long 0x0, 0x0, 0x0, 0x0, 0x0, 0x0, 0x0, 0x0
    .long 0x0, 0x0, 0x0, 0x0, 0x0, 0x0, 0x0, 0x0
    .long 0x0, 0x0, 0x0, 0x0, 0x0, 0x0, 0x0, 0x0
    .long 0x22b000, 0x236e008, 0x26b000, 0x636e008, 0x22b000, 0xa36e009, 0x24b000, 0xe36e009
    .long 0x2ab000, 0x1236e008, 0x2eb000, 0x1636e008, 0x226b002, 0x436e009, 0x228b008, 0x836e009
    .long 0x22ab020, 0x1436e009, 0x22cb0ff, 0x36e009, 0x42eb0ff, 0xc36e009, 0x630b0ff, 0xe36e009
    .long 0x832b0ff, 0x636e009, 0xa34b0ff, 0x1236e009, 0xc36b0ff, 0x1436e009, 0x0, 0x0
    .long 0x0, 0x0, 0x0, 0x0, 0x0, 0x0, 0x0, 0x0
    .long 0x0, 0x0, 0x0, 0x0, 0x0, 0x0, 0x0, 0x0
    .long 0x0, 0x0, 0x0, 0x0, 0x0, 0x0, 0x0, 0x0
    .long 0x0, 0x0, 0x0, 0x0, 0x0, 0x0, 0x0, 0x0
    .long 0x0, 0x0, 0x0, 0x0, 0x0, 0xff000000, 0x0, 0x0
    .long 0x0, 0x0, 0x0, 0x0, 0x0, 0x0, 0x0, 0x0
    .long 0x0, 0x0, 0x0, 0x0, 0x0, 0x0, 0x0, 0x0
    .long 0x0, 0x0, 0x0, 0x0, 0x0, 0x0, 0x0, 0x0
    .long 0x0, 0x0, 0x0, 0x0, 0x0, 0x0, 0x0, 0x0
    .long 0x0, 0x0, 0x0, 0x0, 0x0, 0x0, 0x0, 0x0
    .long 0x0, 0x0, 0x0, 0x0, 0x0, 0x0, 0x0, 0x0
    .long 0x0, 0x0, 0x0, 0x0, 0x0, 0x0, 0x0, 0x0
    .long 0x0, 0x0, 0x0, 0x0, 0x0, 0xff000000, 0x0, 0x0
    .long 0x0, 0x0, 0x0, 0x0, 0x0, 0x0, 0x0, 0x0
    .long 0x0, 0x0, 0x0, 0x0, 0x0, 0x0, 0x0, 0x0
    .long 0x0, 0x0, 0x0, 0x0, 0x0, 0x0, 0x0, 0x0
    .long 0x0, 0x0, 0x0, 0x0, 0x0, 0x0, 0x0, 0x0
    .long 0x0, 0x0, 0x0, 0x0, 0x0, 0x0, 0x0, 0x0
    .long 0x0, 0x0, 0x0, 0x0, 0x0, 0x0, 0x0, 0x0
    .long 0x0, 0x0, 0x0, 0x0, 0x0, 0x0, 0x0, 0x0
    .long 0x22b000, 0x1f100, 0xfffffff8, 0x10070e0, 0xa005000, 0x1c00, 0x600c540, 0xf460
    .long 0x80041c0, 0x41c0, 0xeff5ba0, 0xffff5ba0, 0x1000c540, 0x41c0, 0x120041c0, 0xc540
    .long 0x14feb740, 0xfffeb740, 0x16008380, 0xc540, 0x180062a0, 0x20e0, 0x1aff3ac0, 0xffff7c80
    .long 0x1c0041c0, 0xc540, 0x1d000000, 0x20e0, 0x0, 0x0, 0x0, 0x0
    .long 0x0, 0xff000000, 0x0, 0x0, 0x0, 0x0, 0x0, 0x0
    .long 0x0, 0x0, 0x0, 0x0, 0x0, 0x0, 0x0, 0x0
    .long 0x0, 0x0, 0x0, 0x0, 0x0, 0x0, 0x0, 0x0
    .long 0x0, 0x0, 0x0, 0x0, 0x0, 0x0, 0x0, 0x0
    .long 0x24b000, 0x1f100, 0xfffffff8, 0x20091c0, 0xa005000, 0x1c00, 0x600c540, 0xf460
    .long 0x80041c0, 0x41c0, 0xeff5ba0, 0xffff5ba0, 0x1000c540, 0x41c0, 0x120041c0, 0xc540
    .long 0x14feb740, 0xfffeb740, 0x16008380, 0xc540, 0x180062a0, 0x20e0, 0x1aff3ac0, 0xffff7c80
    .long 0x1c0041c0, 0xc540, 0x1d000000, 0x20e0, 0x0, 0x0, 0x0, 0x0
    .long 0x0, 0xff000000, 0x0, 0x0, 0x0, 0x0, 0x0, 0x0
    .long 0x0, 0x0, 0x0, 0x0, 0x0, 0x0, 0x0, 0x0
    .long 0x0, 0x0, 0x0, 0x0, 0x0, 0x0, 0x0, 0x0
    .long 0x0, 0x0, 0x0, 0x0, 0x0, 0x0, 0x0, 0x0
    .long 0x26b000, 0x1f100, 0xfffffff8, 0x300b2a0, 0xa005000, 0x1c00, 0x600c540, 0xf460
    .long 0x80041c0, 0x41c0, 0xeff5ba0, 0xffff5ba0, 0x1000c540, 0x41c0, 0x120041c0, 0xc540
    .long 0x14feb740, 0xfffeb740, 0x16008380, 0xc540, 0x180062a0, 0x20e0, 0x1aff3ac0, 0xffff7c80
    .long 0x1c0041c0, 0xc540, 0x1d000000, 0x20e0, 0x0, 0x0, 0x0, 0x0
    .long 0x0, 0xff000000, 0x0, 0x0, 0x0, 0x0, 0x0, 0x0
    .long 0x0, 0x0, 0x0, 0x0, 0x0, 0x0, 0x0, 0x0
    .long 0x0, 0x0, 0x0, 0x0, 0x0, 0x0, 0x0, 0x0
    .long 0x0, 0x0, 0x0, 0x0, 0x0, 0x0, 0x0, 0x0
    .long 0x28b000, 0x1f100, 0xfffffff8, 0x400d380, 0xa005000, 0x1c00, 0x600c540, 0xf460
    .long 0x80041c0, 0x41c0, 0xeff5ba0, 0xffff5ba0, 0x1000c540, 0x41c0, 0x120041c0, 0xc540
    .long 0x14feb740, 0xfffeb740, 0x16008380, 0xc540, 0x180062a0, 0x20e0, 0x1aff3ac0, 0xffff7c80
    .long 0x1c0041c0, 0xc540, 0x1d000000, 0x20e0, 0x0, 0x0, 0x0, 0x0
    .long 0x0, 0xff000000, 0x0, 0x0, 0x0, 0x0, 0x0, 0x0
    .long 0x0, 0x0, 0x0, 0x0, 0x0, 0x0, 0x0, 0x0
    .long 0x0, 0x0, 0x0, 0x0, 0x0, 0x0, 0x0, 0x0
    .long 0x0, 0x0, 0x0, 0x0, 0x0, 0x0, 0x0, 0x0
    .long 0x2ab000, 0x1f100, 0xfffffff8, 0x90177e0, 0xa005000, 0x1000, 0x600c540, 0xf460
    .long 0x80041c0, 0x41c0, 0xeff5ba0, 0xffff5ba0, 0x1000c540, 0x41c0, 0x120041c0, 0xc540
    .long 0x14feb740, 0xfffeb740, 0x16008380, 0xc540, 0x180062a0, 0x20e0, 0x1aff3ac0, 0xffff7c80
    .long 0x1c0041c0, 0xc540, 0x1d000000, 0x20e0, 0x0, 0x0, 0x0, 0x0
    .long 0x0, 0xff000000, 0x0, 0x0, 0x0, 0x0, 0x0, 0x0
    .long 0x0, 0x0, 0x0, 0x0, 0x0, 0x0, 0x0, 0x0
    .long 0x0, 0x0, 0x0, 0x0, 0x0, 0x0, 0x0, 0x0
    .long 0x0, 0x0, 0x0, 0x0, 0x0, 0x0, 0x0, 0x0
    .long 0x2cb000, 0x1f100, 0xfffffff8, 0xa0198c0, 0xa005000, 0x1000, 0x600c540, 0xf460
    .long 0x80041c0, 0x41c0, 0xeff5ba0, 0xffff5ba0, 0x1000c540, 0x41c0, 0x120041c0, 0xc540
    .long 0x14feb740, 0xfffeb740, 0x16008380, 0xc540, 0x180062a0, 0x20e0, 0x1aff3ac0, 0xffff7c80
    .long 0x1c0041c0, 0xc540, 0x1d000000, 0x20e0, 0x0, 0x0, 0x0, 0x0
    .long 0x0, 0xff000000, 0x0, 0x0, 0x0, 0x0, 0x0, 0x0
    .long 0x0, 0x0, 0x0, 0x0, 0x0, 0x0, 0x0, 0x0
    .long 0x0, 0x0, 0x0, 0x0, 0x0, 0x0, 0x0, 0x0
    .long 0x0, 0x0, 0x0, 0x0, 0x0, 0x0, 0x0, 0x0
    .long 0x2eb000, 0x1f100, 0xfffffff8, 0xb01b9a0, 0xa005000, 0x1000, 0x600c540, 0xf460
    .long 0x80041c0, 0x41c0, 0xeff5ba0, 0xffff5ba0, 0x1000c540, 0x41c0, 0x120041c0, 0xc540
    .long 0x14feb740, 0xfffeb740, 0x16008380, 0xc540, 0x180062a0, 0x20e0, 0x1aff3ac0, 0xffff7c80
    .long 0x1c0041c0, 0xc540, 0x1d000000, 0x20e0, 0x0, 0x0, 0x0, 0x0
    .long 0x0, 0xff000000, 0x0, 0x0, 0x0, 0x0, 0x0, 0x0
    .long 0x0, 0x0, 0x0, 0x0, 0x0, 0x0, 0x0, 0x0
    .long 0x0, 0x0, 0x0, 0x0, 0x0, 0x0, 0x0, 0x0
    .long 0x0, 0x0, 0x0, 0x0, 0x0, 0x0, 0x0, 0x0
    .long 0x30b000, 0x1f100, 0xfffffff8, 0xc0070e0, 0xa005000, 0x1000, 0x600c540, 0xf460
    .long 0x80041c0, 0x41c0, 0xeff5ba0, 0xffff5ba0, 0x1000c540, 0x41c0, 0x120041c0, 0xc540
    .long 0x14feb740, 0xfffeb740, 0x16008380, 0xc540, 0x180062a0, 0x20e0, 0x1aff3ac0, 0xffff7c80
    .long 0x1c0041c0, 0xc540, 0x1d000000, 0x20e0, 0x0, 0x0, 0x0, 0x0
    .long 0x0, 0xff000000, 0x0, 0x0, 0x0, 0x0, 0x0, 0x0
    .long 0x0, 0x0, 0x0, 0x0, 0x0, 0x0, 0x0, 0x0
    .long 0x0, 0x0, 0x0, 0x0, 0x0, 0x0, 0x0, 0x0
    .long 0x0, 0x0, 0x0, 0x0, 0x0, 0x0, 0x0, 0x0
    .long 0x22b000, 0x36e00a, 0x24b000, 0x436e008, 0x28b000, 0x836e008, 0x24b000, 0xc36e00a
    .long 0x26b000, 0x1036e00a, 0x2cb000, 0x1436e008, 0x230b001, 0x236e008, 0x228b004, 0x636e00a
    .long 0x22ab010, 0x1236e00a, 0x22cb040, 0x1636e00a, 0x22eb080, 0x236e00a, 0x430b0ff, 0xa36e00a
    .long 0x632b0ff, 0x1036e00a, 0x834b0ff, 0x636e00a, 0xa36b0ff, 0x1236e00a, 0x0, 0x0
    .long 0x0, 0x0, 0x0, 0x0, 0x0, 0x0, 0x0, 0x0
    .long 0x0, 0x0, 0x0, 0x0, 0x0, 0x0, 0x0, 0x0
    .long 0x0, 0x0, 0x0, 0x0, 0x0, 0x0, 0x0, 0x0
    .long 0x0, 0x0, 0x0, 0x0, 0x0, 0x0, 0x0, 0x0
    .long 0x22b000, 0x236e008, 0x26b000, 0x636e008, 0x22b000, 0xa36e009, 0x24b000, 0xe36e009
    .long 0x2ab000, 0x1236e008, 0x2eb000, 0x1636e008, 0x226b002, 0x436e009, 0x228b008, 0x836e009
    .long 0x22ab020, 0x1436e009, 0x22cb0ff, 0x36e009, 0x42eb0ff, 0xc36e009, 0x630b0ff, 0xe36e009
    .long 0x832b0ff, 0x436e009, 0xa34b0ff, 0x836e009, 0xc36b0ff, 0x1436e009, 0x0, 0x0
    .long 0x0, 0x0, 0x0, 0x0, 0x0, 0x0, 0x0, 0x0
    .long 0x0, 0x0, 0x0, 0x0, 0x0, 0x0, 0x0, 0x0
    .long 0x0, 0x0, 0x0, 0x0, 0x0, 0x0, 0x0, 0x0
    .long 0x0, 0x0, 0x0, 0x0, 0x0, 0x0, 0x0, 0x0
    .long 0x0, 0x0, 0x0, 0x0, 0x0, 0xff000000, 0x0, 0x0
    .long 0x0, 0x0, 0x0, 0x0, 0x0, 0x0, 0x0, 0x0
    .long 0x0, 0x0, 0x0, 0x0, 0x0, 0x0, 0x0, 0x0
    .long 0x0, 0x0, 0x0, 0x0, 0x0, 0x0, 0x0, 0x0
    .long 0x0, 0x0, 0x0, 0x0, 0x0, 0x0, 0x0, 0x0
    .long 0x0, 0x0, 0x0, 0x0, 0x0, 0x0, 0x0, 0x0
    .long 0x0, 0x0, 0x0, 0x0, 0x0, 0x0, 0x0, 0x0
    .long 0x0, 0x0, 0x0, 0x0, 0x0, 0x0, 0x0, 0x0
    .long 0x0, 0x0, 0x0, 0x0, 0x0, 0xff000000, 0x0, 0x0
    .long 0x0, 0x0, 0x0, 0x0, 0x0, 0x0, 0x0, 0x0
    .long 0x0, 0x0, 0x0, 0x0, 0x0, 0x0, 0x0, 0x0
    .long 0x0, 0x0, 0x0, 0x0, 0x0, 0x0, 0x0, 0x0
    .long 0x0, 0x0, 0x0, 0x0, 0x0, 0x0, 0x0, 0x0
    .long 0x0, 0x0, 0x0, 0x0, 0x0, 0x0, 0x0, 0x0
    .long 0x0, 0x0, 0x0, 0x0, 0x0, 0x0, 0x0, 0x0
    .long 0x0, 0x0, 0x0, 0x0, 0x0, 0x0, 0x0, 0x0
    .long 0x22b000, 0x1f100, 0xfffffff8, 0x10070e0, 0xa005000, 0x1c00, 0x600c540, 0xf460
    .long 0x80041c0, 0x41c0, 0xeff5ba0, 0xffff5ba0, 0x1000c540, 0x41c0, 0x120041c0, 0xc540
    .long 0x14feb740, 0xfffeb740, 0x16008380, 0xc540, 0x180062a0, 0x20e0, 0x1aff5ba0, 0xffff5ba0
    .long 0x1c00c540, 0x41c0, 0x1d000000, 0xc540, 0x0, 0x0, 0x0, 0x0
    .long 0x0, 0xff000000, 0x0, 0x0, 0x0, 0x0, 0x0, 0x0
    .long 0x0, 0x0, 0x0, 0x0, 0x0, 0x0, 0x0, 0x0
    .long 0x0, 0x0, 0x0, 0x0, 0x0, 0x0, 0x0, 0x0
    .long 0x0, 0x0, 0x0, 0x0, 0x0, 0x0, 0x0, 0x0
    .long 0x24b000, 0x1f100, 0xfffffff8, 0x20091c0, 0xa005000, 0x1c00, 0x600c540, 0xf460
    .long 0x80041c0, 0x41c0, 0xeff5ba0, 0xffff5ba0, 0x1000c540, 0x41c0, 0x120041c0, 0xc540
    .long 0x14feb740, 0xfffeb740, 0x16008380, 0xc540, 0x180062a0, 0x20e0, 0x1aff5ba0, 0xffff5ba0
    .long 0x1c00c540, 0x41c0, 0x1d000000, 0xc540, 0x0, 0x0, 0x0, 0x0
    .long 0x0, 0xff000000, 0x0, 0x0, 0x0, 0x0, 0x0, 0x0
    .long 0x0, 0x0, 0x0, 0x0, 0x0, 0x0, 0x0, 0x0
    .long 0x0, 0x0, 0x0, 0x0, 0x0, 0x0, 0x0, 0x0
    .long 0x0, 0x0, 0x0, 0x0, 0x0, 0x0, 0x0, 0x0
    .long 0x26b000, 0x1f100, 0xfffffff8, 0x300b2a0, 0xa005000, 0x1c00, 0x600c540, 0xf460
    .long 0x80041c0, 0x41c0, 0xeff5ba0, 0xffff5ba0, 0x1000c540, 0x41c0, 0x120041c0, 0xc540
    .long 0x14feb740, 0xfffeb740, 0x16008380, 0xc540, 0x180062a0, 0x20e0, 0x1aff5ba0, 0xffff5ba0
    .long 0x1c00c540, 0x41c0, 0x1d000000, 0xc540, 0x0, 0x0, 0x0, 0x0
    .long 0x0, 0xff000000, 0x0, 0x0, 0x0, 0x0, 0x0, 0x0
    .long 0x0, 0x0, 0x0, 0x0, 0x0, 0x0, 0x0, 0x0
    .long 0x0, 0x0, 0x0, 0x0, 0x0, 0x0, 0x0, 0x0
    .long 0x0, 0x0, 0x0, 0x0, 0x0, 0x0, 0x0, 0x0
    .long 0x28b000, 0x1f100, 0xfffffff8, 0x400d380, 0xa005000, 0x1c00, 0x600c540, 0xf460
    .long 0x80041c0, 0x41c0, 0xeff5ba0, 0xffff5ba0, 0x1000c540, 0x41c0, 0x120041c0, 0xc540
    .long 0x14feb740, 0xfffeb740, 0x16008380, 0xc540, 0x180062a0, 0x20e0, 0x1aff5ba0, 0xffff5ba0
    .long 0x1c00c540, 0x41c0, 0x1d000000, 0xc540, 0x0, 0x0, 0x0, 0x0
    .long 0x0, 0xff000000, 0x0, 0x0, 0x0, 0x0, 0x0, 0x0
    .long 0x0, 0x0, 0x0, 0x0, 0x0, 0x0, 0x0, 0x0
    .long 0x0, 0x0, 0x0, 0x0, 0x0, 0x0, 0x0, 0x0
    .long 0x0, 0x0, 0x0, 0x0, 0x0, 0x0, 0x0, 0x0
    .long 0x2ab000, 0x1f100, 0xfffffff8, 0x90177e0, 0xa005000, 0x1000, 0x600c540, 0xf460
    .long 0x80041c0, 0x41c0, 0xeff5ba0, 0xffff5ba0, 0x1000c540, 0x41c0, 0x120041c0, 0xc540
    .long 0x14feb740, 0xfffeb740, 0x16008380, 0xc540, 0x180062a0, 0x20e0, 0x1aff5ba0, 0xffff5ba0
    .long 0x1c00c540, 0x41c0, 0x1d000000, 0xc540, 0x0, 0x0, 0x0, 0x0
    .long 0x0, 0xff000000, 0x0, 0x0, 0x0, 0x0, 0x0, 0x0
    .long 0x0, 0x0, 0x0, 0x0, 0x0, 0x0, 0x0, 0x0
    .long 0x0, 0x0, 0x0, 0x0, 0x0, 0x0, 0x0, 0x0
    .long 0x0, 0x0, 0x0, 0x0, 0x0, 0x0, 0x0, 0x0
    .long 0x2cb000, 0x1f100, 0xfffffff8, 0xa0198c0, 0xa005000, 0x1000, 0x600c540, 0xf460
    .long 0x80041c0, 0x41c0, 0xeff5ba0, 0xffff5ba0, 0x1000c540, 0x41c0, 0x120041c0, 0xc540
    .long 0x14feb740, 0xfffeb740, 0x16008380, 0xc540, 0x180062a0, 0x20e0, 0x1aff5ba0, 0xffff5ba0
    .long 0x1c00c540, 0x41c0, 0x1d000000, 0xc540, 0x0, 0x0, 0x0, 0x0
    .long 0x0, 0xff000000, 0x0, 0x0, 0x0, 0x0, 0x0, 0x0
    .long 0x0, 0x0, 0x0, 0x0, 0x0, 0x0, 0x0, 0x0
    .long 0x0, 0x0, 0x0, 0x0, 0x0, 0x0, 0x0, 0x0
    .long 0x0, 0x0, 0x0, 0x0, 0x0, 0x0, 0x0, 0x0
    .long 0x2eb000, 0x1f100, 0xfffffff8, 0xb01b9a0, 0xa005000, 0x1000, 0x600c540, 0xf460
    .long 0x80041c0, 0x41c0, 0xeff5ba0, 0xffff5ba0, 0x1000c540, 0x41c0, 0x120041c0, 0xc540
    .long 0x14feb740, 0xfffeb740, 0x16008380, 0xc540, 0x180062a0, 0x20e0, 0x1aff5ba0, 0xffff5ba0
    .long 0x1c00c540, 0x41c0, 0x1d000000, 0xc540, 0x0, 0x0, 0x0, 0x0
    .long 0x0, 0xff000000, 0x0, 0x0, 0x0, 0x0, 0x0, 0x0
    .long 0x0, 0x0, 0x0, 0x0, 0x0, 0x0, 0x0, 0x0
    .long 0x0, 0x0, 0x0, 0x0, 0x0, 0x0, 0x0, 0x0
    .long 0x0, 0x0, 0x0, 0x0, 0x0, 0x0, 0x0, 0x0
    .long 0x30b000, 0x1f100, 0xfffffff8, 0xc0070e0, 0xa005000, 0x1000, 0x600c540, 0xf460
    .long 0x80041c0, 0x41c0, 0xeff5ba0, 0xffff5ba0, 0x1000c540, 0x41c0, 0x120041c0, 0xc540
    .long 0x14feb740, 0xfffeb740, 0x16008380, 0xc540, 0x180062a0, 0x20e0, 0x1aff5ba0, 0xffff5ba0
    .long 0x1c00c540, 0x41c0, 0x1d000000, 0xc540, 0x0, 0x0, 0x0, 0x0
    .long 0x0, 0xff000000, 0x0, 0x0, 0x0, 0x0, 0x0, 0x0
    .long 0x0, 0x0, 0x0, 0x0, 0x0, 0x0, 0x0, 0x0
    .long 0x0, 0x0, 0x0, 0x0, 0x0, 0x0, 0x0, 0x0
    .long 0x0, 0x0, 0x0, 0x0, 0x0, 0x0, 0x0, 0x0
    .long 0x513100, 0x60f00a, 0x533100, 0x460f008, 0x573100, 0x860f008, 0x533100, 0xc60f00a
    .long 0x553100, 0x1060f00a, 0x5b3100, 0x1460f008, 0x513100, 0x1860f008, 0x573100, 0x1c60f00e
    .long 0x2593101, 0x260f00e, 0x25b3104, 0x660f00e, 0x25d3110, 0x1260f00e, 0x25f3140, 0x1660f00e
    .long 0x2ab6180, 0x18afa00c, 0x4ad61ff, 0xcafa00c, 0x6a761ff, 0x10afa00e, 0x8a761ff, 0x1cafa00d
    .long 0x42a96500, 0xcafa00d, 0xaab61ff, 0x1eafa00d, 0xcad61ff, 0x6afa00d, 0x42af6101, 0x1aafa00d
    .long 0x0, 0x0, 0x0, 0x0, 0x0, 0x0, 0x0, 0x0
    .long 0x0, 0x0, 0x0, 0x0, 0x0, 0x0, 0x0, 0x0
    .long 0x0, 0x0, 0x0, 0x0, 0x0, 0x0, 0x0, 0x0
    .long 0x5f3100, 0x260f008, 0x553100, 0x660f008, 0x513100, 0xa60f009, 0x533100, 0xe60f009
    .long 0x593100, 0x1260f008, 0x5d3100, 0x1660f008, 0x553100, 0x1a60f009, 0x573100, 0x1e60f00d
    .long 0x2593102, 0x460f00d, 0x25b3108, 0x860f00d, 0x25d3120, 0x1460f00d, 0x25f31ff, 0x60f00d
    .long 0x4a561ff, 0xaafa00e, 0x6a561ff, 0xeafa00d, 0x8af61ff, 0x1aafa00c, 0x42a96300, 0x18afa00e
    .long 0xaab61ff, 0x2afa00e, 0xcad61ff, 0x4afa00e, 0x42af6701, 0xaafa00e, 0x0, 0x0
    .long 0x0, 0x0, 0x0, 0x0, 0x0, 0x0, 0x0, 0x0
    .long 0x0, 0x0, 0x0, 0x0, 0x0, 0x0, 0x0, 0x0
    .long 0x0, 0x0, 0x0, 0x0, 0x0, 0x0, 0x0, 0x0
    .long 0xab6100, 0x1f100, 0xfffffff0, 0x1901da80, 0x500f460, 0x20001000, 0x1c0062a0, 0x13620
    .long 0x1f008380, 0xe620, 0x21fe9660, 0xfffef900, 0x230020e0, 0x127e0, 0x250062a0, 0xfffe7580
    .long 0x26000000, 0x148c0, 0x0, 0x0, 0x0, 0x0, 0x0, 0xff000000
    .long 0x0, 0x0, 0x0, 0x0, 0x0, 0x0, 0x0, 0x0
    .long 0x0, 0x0, 0x0, 0x0, 0x0, 0x0, 0x0, 0x0
    .long 0x0, 0x0, 0x0, 0x0, 0x0, 0x0, 0x0, 0x0
    .long 0x0, 0x0, 0x0, 0x0, 0x0, 0x0, 0x0, 0x0
    .long 0x0, 0x0, 0x0, 0x0, 0x0, 0x0, 0x0, 0x0
    .long 0xad6100, 0x1f100, 0xfffffff0, 0x1a011540, 0x500f460, 0x20001000, 0x1c0062a0, 0x13620
    .long 0x1f008380, 0xe620, 0x21fe9660, 0xfffef900, 0x230020e0, 0x127e0, 0x250062a0, 0xfffe7580
    .long 0x26000000, 0x148c0, 0x0, 0x0, 0x0, 0x0, 0x0, 0xff000000
    .long 0x0, 0x0, 0x0, 0x0, 0x0, 0x0, 0x0, 0x0
    .long 0x0, 0x0, 0x0, 0x0, 0x0, 0x0, 0x0, 0x0
    .long 0x0, 0x0, 0x0, 0x0, 0x0, 0x0, 0x0, 0x0
    .long 0x0, 0x0, 0x0, 0x0, 0x0, 0x0, 0x0, 0x0
    .long 0x0, 0x0, 0x0, 0x0, 0x0, 0x0, 0x0, 0x0
    .long 0x5f3100, 0x1b100, 0xf0000000, 0x10070e0, 0x7005000, 0xc00, 0x600c540, 0xf460
    .long 0x80041c0, 0x41c0, 0xe00c540, 0xc540, 0x10fe54a0, 0x41c0, 0x120041c0, 0xfffe54a0
    .long 0x1400c540, 0x41c0, 0x160041c0, 0xc540, 0x17000000, 0xfffeb740, 0xaf6100, 0x3100
    .long 0xfffffff0, 0x1d0041c0, 0x5ff3ac0, 0x20001d00, 0x1c0062a0, 0xe620, 0x1f008380, 0xe620
    .long 0x21fe9660, 0xfffef900, 0x230020e0, 0x127e0, 0x250062a0, 0xfffe7580, 0x26000000, 0x148c0
    .long 0x0, 0x0, 0x0, 0x0, 0x0, 0xff000000, 0x0, 0x0
    .long 0x0, 0x0, 0x0, 0x0, 0x0, 0x0, 0x0, 0x0
    .long 0x0, 0x0, 0x0, 0x0, 0x0, 0x0, 0x0, 0x0
    .long 0x533100, 0x1f100, 0xf0000000, 0x20091c0, 0x7005000, 0xc00, 0x600c540, 0xf460
    .long 0x80041c0, 0x41c0, 0xe00c540, 0xc540, 0x10fe54a0, 0x41c0, 0x120041c0, 0xfffe54a0
    .long 0x1400c540, 0x41c0, 0x160041c0, 0xc540, 0x17000000, 0xfffeb740, 0x0, 0x0
    .long 0x0, 0x0, 0x0, 0xff000000, 0x0, 0x0, 0x0, 0x0
    .long 0x0, 0x0, 0x0, 0x0, 0x0, 0x0, 0x0, 0x0
    .long 0x0, 0x0, 0x0, 0x0, 0x0, 0x0, 0x0, 0x0
    .long 0x0, 0x0, 0x0, 0x0, 0x0, 0x0, 0x0, 0x0
    .long 0x0, 0x0, 0x0, 0x0, 0x0, 0x0, 0x0, 0x0
    .long 0x553100, 0x1f100, 0xf0000000, 0x300b2a0, 0x7005000, 0xc00, 0x600c540, 0xf460
    .long 0x80041c0, 0x41c0, 0xe00c540, 0xc540, 0x10fe54a0, 0x41c0, 0x120041c0, 0xfffe54a0
    .long 0x1400c540, 0x41c0, 0x160041c0, 0xc540, 0x17000000, 0xfffeb740, 0x0, 0x0
    .long 0x0, 0x0, 0x0, 0xff000000, 0x0, 0x0, 0x0, 0x0
    .long 0x0, 0x0, 0x0, 0x0, 0x0, 0x0, 0x0, 0x0
    .long 0x0, 0x0, 0x0, 0x0, 0x0, 0x0, 0x0, 0x0
    .long 0x0, 0x0, 0x0, 0x0, 0x0, 0x0, 0x0, 0x0
    .long 0x0, 0x0, 0x0, 0x0, 0x0, 0x0, 0x0, 0x0
    .long 0x573100, 0x1f100, 0xf0000000, 0x400d380, 0x7005000, 0xc00, 0x600c540, 0xf460
    .long 0x80041c0, 0x41c0, 0xe00c540, 0xc540, 0x10fe54a0, 0x41c0, 0x120041c0, 0xfffe54a0
    .long 0x1400c540, 0x41c0, 0x160041c0, 0xc540, 0x17000000, 0xfffeb740, 0x0, 0x0
    .long 0x0, 0x0, 0x0, 0xff000000, 0x0, 0x0, 0x0, 0x0
    .long 0x0, 0x0, 0x0, 0x0, 0x0, 0x0, 0x0, 0x0
    .long 0x0, 0x0, 0x0, 0x0, 0x0, 0x0, 0x0, 0x0
    .long 0x0, 0x0, 0x0, 0x0, 0x0, 0x0, 0x0, 0x0
    .long 0x0, 0x0, 0x0, 0x0, 0x0, 0x0, 0x0, 0x0
    .long 0x593100, 0x1f100, 0xf0000000, 0x90177e0, 0x7005000, 0x0, 0x600c540, 0xf460
    .long 0x80041c0, 0x41c0, 0xe00c540, 0xc540, 0x10fe54a0, 0x41c0, 0x120041c0, 0xfffe54a0
    .long 0x1400c540, 0x41c0, 0x160041c0, 0xc540, 0x17000000, 0xfffeb740, 0x0, 0x0
    .long 0x0, 0x0, 0x0, 0xff000000, 0x0, 0x0, 0x0, 0x0
    .long 0x0, 0x0, 0x0, 0x0, 0x0, 0x0, 0x0, 0x0
    .long 0x0, 0x0, 0x0, 0x0, 0x0, 0x0, 0x0, 0x0
    .long 0x0, 0x0, 0x0, 0x0, 0x0, 0x0, 0x0, 0x0
    .long 0x0, 0x0, 0x0, 0x0, 0x0, 0x0, 0x0, 0x0
    .long 0x5b3100, 0x1f100, 0xf0000000, 0xa0198c0, 0x7005000, 0x0, 0x600c540, 0xf460
    .long 0x80041c0, 0x41c0, 0xe00c540, 0xc540, 0x10fe54a0, 0x41c0, 0x120041c0, 0xfffe54a0
    .long 0x1400c540, 0x41c0, 0x160041c0, 0xc540, 0x17000000, 0xfffeb740, 0x0, 0x0
    .long 0x0, 0x0, 0x0, 0xff000000, 0x0, 0x0, 0x0, 0x0
    .long 0x0, 0x0, 0x0, 0x0, 0x0, 0x0, 0x0, 0x0
    .long 0x0, 0x0, 0x0, 0x0, 0x0, 0x0, 0x0, 0x0
    .long 0x0, 0x0, 0x0, 0x0, 0x0, 0x0, 0x0, 0x0
    .long 0x0, 0x0, 0x0, 0x0, 0x0, 0x0, 0x0, 0x0
    .long 0x5d3100, 0x1f100, 0xf0000000, 0xb01b9a0, 0x7005000, 0x0, 0x600c540, 0xf460
    .long 0x80041c0, 0x41c0, 0xe00c540, 0xc540, 0x10fe54a0, 0x41c0, 0x120041c0, 0xfffe54a0
    .long 0x1400c540, 0x41c0, 0x160041c0, 0xc540, 0x17000000, 0xfffeb740, 0x0, 0x0
    .long 0x0, 0x0, 0x0, 0xff000000, 0x0, 0x0, 0x0, 0x0
    .long 0x0, 0x0, 0x0, 0x0, 0x0, 0x0, 0x0, 0x0
    .long 0x0, 0x0, 0x0, 0x0, 0x0, 0x0, 0x0, 0x0
    .long 0x0, 0x0, 0x0, 0x0, 0x0, 0x0, 0x0, 0x0
    .long 0x0, 0x0, 0x0, 0x0, 0x0, 0x0, 0x0, 0x0
    .long 0x513100, 0x1f100, 0xf0000000, 0xc01da80, 0x7005000, 0x0, 0x600c540, 0xf460
    .long 0x80041c0, 0x41c0, 0xe00c540, 0xc540, 0x10fe54a0, 0x41c0, 0x120041c0, 0xfffe54a0
    .long 0x1400c540, 0x41c0, 0x160041c0, 0xc540, 0x17000000, 0xfffeb740, 0x0, 0x0
    .long 0x0, 0x0, 0x0, 0xff000000, 0x0, 0x0, 0x0, 0x0
    .long 0x0, 0x0, 0x0, 0x0, 0x0, 0x0, 0x0, 0x0
    .long 0x0, 0x0, 0x0, 0x0, 0x0, 0x0, 0x0, 0x0
    .long 0x0, 0x0, 0x0, 0x0, 0x0, 0x0, 0x0, 0x0
    .long 0x0, 0x0, 0x0, 0x0, 0x0, 0x0, 0x0, 0x0
    .long 0x513100, 0x60f00a, 0x533100, 0x460f008, 0x573100, 0x860f008, 0x533100, 0xc60f00a
    .long 0x553100, 0x1060f00a, 0x5b3100, 0x1460f008, 0x513100, 0x1860f008, 0x573100, 0x1c60f00e
    .long 0x2593101, 0x260f00e, 0x25b3104, 0x660f00e, 0x25d3110, 0x1260f00e, 0x25f3140, 0x1660f00e
    .long 0x2ab6180, 0x18afa00c, 0x4ad61ff, 0xcafa00c, 0x6a761ff, 0x10afa00e, 0x8a761ff, 0x1cafa00d
    .long 0x42a96500, 0xcafa00d, 0xaab61ff, 0x1eafa00d, 0xcad61ff, 0x6afa00d, 0x42af6101, 0x1aafa00d
    .long 0x0, 0x0, 0x0, 0x0, 0x0, 0x0, 0x0, 0x0
    .long 0x0, 0x0, 0x0, 0x0, 0x0, 0x0, 0x0, 0x0
    .long 0x0, 0x0, 0x0, 0x0, 0x0, 0x0, 0x0, 0x0
    .long 0x5f3100, 0x260f008, 0x553100, 0x660f008, 0x513100, 0xa60f009, 0x533100, 0xe60f009
    .long 0x593100, 0x1260f008, 0x5d3100, 0x1660f008, 0x553100, 0x1a60f009, 0x573100, 0x1e60f00d
    .long 0x2593102, 0x460f00d, 0x25b3108, 0x860f00d, 0x25d3120, 0x1460f00d, 0x25f31ff, 0x60f00d
    .long 0x4a561ff, 0xaafa00e, 0x6a561ff, 0xeafa00d, 0x8af61ff, 0x1aafa00c, 0x42a96300, 0x18afa00e
    .long 0xaab61ff, 0x2afa00e, 0xcad61ff, 0x4afa00e, 0x42af6701, 0xaafa00e, 0x0, 0x0
    .long 0x0, 0x0, 0x0, 0x0, 0x0, 0x0, 0x0, 0x0
    .long 0x0, 0x0, 0x0, 0x0, 0x0, 0x0, 0x0, 0x0
    .long 0x0, 0x0, 0x0, 0x0, 0x0, 0x0, 0x0, 0x0
    .long 0xab6100, 0x1f100, 0xfffffff0, 0x1901da80, 0x500f460, 0x20001000, 0x1c0062a0, 0x13620
    .long 0x1f008380, 0xe620, 0x21fe9660, 0xfffef900, 0x230020e0, 0x127e0, 0x250062a0, 0xfffe7580
    .long 0x26000000, 0x148c0, 0x0, 0x0, 0x0, 0x0, 0x0, 0xff000000
    .long 0x0, 0x0, 0x0, 0x0, 0x0, 0x0, 0x0, 0x0
    .long 0x0, 0x0, 0x0, 0x0, 0x0, 0x0, 0x0, 0x0
    .long 0x0, 0x0, 0x0, 0x0, 0x0, 0x0, 0x0, 0x0
    .long 0x0, 0x0, 0x0, 0x0, 0x0, 0x0, 0x0, 0x0
    .long 0x0, 0x0, 0x0, 0x0, 0x0, 0x0, 0x0, 0x0
    .long 0xad6100, 0x1f100, 0xfffffff0, 0x1a011540, 0x500f460, 0x20001000, 0x1c0062a0, 0x13620
    .long 0x1f008380, 0xe620, 0x21fe9660, 0xfffef900, 0x230020e0, 0x127e0, 0x250062a0, 0xfffe7580
    .long 0x26000000, 0x148c0, 0x0, 0x0, 0x0, 0x0, 0x0, 0xff000000
    .long 0x0, 0x0, 0x0, 0x0, 0x0, 0x0, 0x0, 0x0
    .long 0x0, 0x0, 0x0, 0x0, 0x0, 0x0, 0x0, 0x0
    .long 0x0, 0x0, 0x0, 0x0, 0x0, 0x0, 0x0, 0x0
    .long 0x0, 0x0, 0x0, 0x0, 0x0, 0x0, 0x0, 0x0
    .long 0x0, 0x0, 0x0, 0x0, 0x0, 0x0, 0x0, 0x0
    .long 0x5f3100, 0x1b100, 0xf0000000, 0x10070e0, 0x7005000, 0xc00, 0x600c540, 0xf460
    .long 0x80041c0, 0x41c0, 0xe00c540, 0xc540, 0x10fe54a0, 0x41c0, 0x120041c0, 0xfffe54a0
    .long 0x1400c540, 0x41c0, 0x160041c0, 0xc540, 0x17000000, 0xfffeb740, 0xaf6100, 0x3100
    .long 0xfffffff0, 0x1d0041c0, 0x5ff3ac0, 0x20001d00, 0x1c0062a0, 0xe620, 0x1f008380, 0xe620
    .long 0x21fe9660, 0xfffef900, 0x230020e0, 0x127e0, 0x250062a0, 0xfffe7580, 0x26000000, 0x148c0
    .long 0x0, 0x0, 0x0, 0x0, 0x0, 0xff000000, 0x0, 0x0
    .long 0x0, 0x0, 0x0, 0x0, 0x0, 0x0, 0x0, 0x0
    .long 0x0, 0x0, 0x0, 0x0, 0x0, 0x0, 0x0, 0x0
    .long 0x533100, 0x1f100, 0xf0000000, 0x20091c0, 0x7005000, 0xc00, 0x600c540, 0xf460
    .long 0x80041c0, 0x41c0, 0xe00c540, 0xc540, 0x10fe54a0, 0x41c0, 0x120041c0, 0xfffe54a0
    .long 0x1400c540, 0x41c0, 0x160041c0, 0xc540, 0x17000000, 0xfffeb740, 0x0, 0x0
    .long 0x0, 0x0, 0x0, 0xff000000, 0x0, 0x0, 0x0, 0x0
    .long 0x0, 0x0, 0x0, 0x0, 0x0, 0x0, 0x0, 0x0
    .long 0x0, 0x0, 0x0, 0x0, 0x0, 0x0, 0x0, 0x0
    .long 0x0, 0x0, 0x0, 0x0, 0x0, 0x0, 0x0, 0x0
    .long 0x0, 0x0, 0x0, 0x0, 0x0, 0x0, 0x0, 0x0
    .long 0x553100, 0x1f100, 0xf0000000, 0x300b2a0, 0x7005000, 0xc00, 0x600c540, 0xf460
    .long 0x80041c0, 0x41c0, 0xe00c540, 0xc540, 0x10fe54a0, 0x41c0, 0x120041c0, 0xfffe54a0
    .long 0x1400c540, 0x41c0, 0x160041c0, 0xc540, 0x17000000, 0xfffeb740, 0x0, 0x0
    .long 0x0, 0x0, 0x0, 0xff000000, 0x0, 0x0, 0x0, 0x0
    .long 0x0, 0x0, 0x0, 0x0, 0x0, 0x0, 0x0, 0x0
    .long 0x0, 0x0, 0x0, 0x0, 0x0, 0x0, 0x0, 0x0
    .long 0x0, 0x0, 0x0, 0x0, 0x0, 0x0, 0x0, 0x0
    .long 0x0, 0x0, 0x0, 0x0, 0x0, 0x0, 0x0, 0x0
    .long 0x573100, 0x1f100, 0xf0000000, 0x400d380, 0x7005000, 0xc00, 0x600c540, 0xf460
    .long 0x80041c0, 0x41c0, 0xe00c540, 0xc540, 0x10fe54a0, 0x41c0, 0x120041c0, 0xfffe54a0
    .long 0x1400c540, 0x41c0, 0x160041c0, 0xc540, 0x17000000, 0xfffeb740, 0x0, 0x0
    .long 0x0, 0x0, 0x0, 0xff000000, 0x0, 0x0, 0x0, 0x0
    .long 0x0, 0x0, 0x0, 0x0, 0x0, 0x0, 0x0, 0x0
    .long 0x0, 0x0, 0x0, 0x0, 0x0, 0x0, 0x0, 0x0
    .long 0x0, 0x0, 0x0, 0x0, 0x0, 0x0, 0x0, 0x0
    .long 0x0, 0x0, 0x0, 0x0, 0x0, 0x0, 0x0, 0x0
    .long 0x593100, 0x1f100, 0xf0000000, 0x90177e0, 0x7005000, 0x0, 0x600c540, 0xf460
    .long 0x80041c0, 0x41c0, 0xe00c540, 0xc540, 0x10fe54a0, 0x41c0, 0x120041c0, 0xfffe54a0
    .long 0x1400c540, 0x41c0, 0x160041c0, 0xc540, 0x17000000, 0xfffeb740, 0x0, 0x0
    .long 0x0, 0x0, 0x0, 0xff000000, 0x0, 0x0, 0x0, 0x0
    .long 0x0, 0x0, 0x0, 0x0, 0x0, 0x0, 0x0, 0x0
    .long 0x0, 0x0, 0x0, 0x0, 0x0, 0x0, 0x0, 0x0
    .long 0x0, 0x0, 0x0, 0x0, 0x0, 0x0, 0x0, 0x0
    .long 0x0, 0x0, 0x0, 0x0, 0x0, 0x0, 0x0, 0x0
    .long 0x5b3100, 0x1f100, 0xf0000000, 0xa0198c0, 0x7005000, 0x0, 0x600c540, 0xf460
    .long 0x80041c0, 0x41c0, 0xe00c540, 0xc540, 0x10fe54a0, 0x41c0, 0x120041c0, 0xfffe54a0
    .long 0x1400c540, 0x41c0, 0x160041c0, 0xc540, 0x17000000, 0xfffeb740, 0x0, 0x0
    .long 0x0, 0x0, 0x0, 0xff000000, 0x0, 0x0, 0x0, 0x0
    .long 0x0, 0x0, 0x0, 0x0, 0x0, 0x0, 0x0, 0x0
    .long 0x0, 0x0, 0x0, 0x0, 0x0, 0x0, 0x0, 0x0
    .long 0x0, 0x0, 0x0, 0x0, 0x0, 0x0, 0x0, 0x0
    .long 0x0, 0x0, 0x0, 0x0, 0x0, 0x0, 0x0, 0x0
    .long 0x5d3100, 0x1f100, 0xf0000000, 0xb01b9a0, 0x7005000, 0x0, 0x600c540, 0xf460
    .long 0x80041c0, 0x41c0, 0xe00c540, 0xc540, 0x10fe54a0, 0x41c0, 0x120041c0, 0xfffe54a0
    .long 0x1400c540, 0x41c0, 0x160041c0, 0xc540, 0x17000000, 0xfffeb740, 0x0, 0x0
    .long 0x0, 0x0, 0x0, 0xff000000, 0x0, 0x0, 0x0, 0x0
    .long 0x0, 0x0, 0x0, 0x0, 0x0, 0x0, 0x0, 0x0
    .long 0x0, 0x0, 0x0, 0x0, 0x0, 0x0, 0x0, 0x0
    .long 0x0, 0x0, 0x0, 0x0, 0x0, 0x0, 0x0, 0x0
    .long 0x0, 0x0, 0x0, 0x0, 0x0, 0x0, 0x0, 0x0
    .long 0x513100, 0x1f100, 0xf0000000, 0xc01da80, 0x7005000, 0x0, 0x600c540, 0xf460
    .long 0x80041c0, 0x41c0, 0xe00c540, 0xc540, 0x10fe54a0, 0x41c0, 0x120041c0, 0xfffe54a0
    .long 0x1400c540, 0x41c0, 0x160041c0, 0xc540, 0x17000000, 0xfffeb740, 0x0, 0x0
    .long 0x0, 0x0, 0x0, 0xff000000, 0x0, 0x0, 0x0, 0x0
    .long 0x0, 0x0, 0x0, 0x0, 0x0, 0x0, 0x0, 0x0
    .long 0x0, 0x0, 0x0, 0x0, 0x0, 0x0, 0x0, 0x0
    .long 0x0, 0x0, 0x0, 0x0, 0x0, 0x0, 0x0, 0x0
    .long 0x0, 0x0, 0x0, 0x0, 0x0, 0x0, 0x0, 0x0
    .long 0xd8f100, 0xee300e, 0xdaf100, 0x4ee300c, 0xdef100, 0x8ee300c, 0xdaf100, 0xcee300e
    .long 0xdcf100, 0x10ee300e, 0xe2f100, 0x14ee300c, 0x2e6f101, 0x2ee300c, 0x2def104, 0x6ee300e
    .long 0x2e0f110, 0x12ee300e, 0x2e2f140, 0x16ee300e, 0x2e4f180, 0x2ee300e, 0x4e6f1ff, 0xcee300e
    .long 0x6e8f1ff, 0x10ee300e, 0x8eaf1ff, 0x6ee300e, 0xaecf1ff, 0x12ee300e, 0x0, 0x0
    .long 0x0, 0x0, 0x0, 0x0, 0x0, 0x0, 0x0, 0x0
    .long 0x0, 0x0, 0x0, 0x0, 0x0, 0x0, 0x0, 0x0
    .long 0x0, 0x0, 0x0, 0x0, 0x0, 0x0, 0x0, 0x0
    .long 0x0, 0x0, 0x0, 0x0, 0x0, 0x0, 0x0, 0x0
    .long 0xd8f100, 0x2ee300c, 0xdcf100, 0x6ee300c, 0xd8f100, 0xaee300d, 0xdaf100, 0xeee300d
    .long 0xe0f100, 0x12ee300c, 0xe4f100, 0x16ee300c, 0x2dcf102, 0x4ee300d, 0x2def108, 0x8ee300d
    .long 0x2e0f120, 0x14ee300d, 0x2e2f1ff, 0xee300d, 0x4e4f1ff, 0xaee300d, 0x6e6f1ff, 0xeee300d
    .long 0x8e8f1ff, 0x4ee300d, 0xaeaf1ff, 0x8ee300d, 0xcecf1ff, 0x14ee300d, 0x0, 0x0
    .long 0x0, 0x0, 0x0, 0x0, 0x0, 0x0, 0x0, 0x0
    .long 0x0, 0x0, 0x0, 0x0, 0x0, 0x0, 0x0, 0x0
    .long 0x0, 0x0, 0x0, 0x0, 0x0, 0x0, 0x0, 0x0
    .long 0x0, 0x0, 0x0, 0x0, 0x0, 0x0, 0x0, 0x0
    .long 0x0, 0x0, 0x0, 0x0, 0x0, 0xff000000, 0x0, 0x0
    .long 0x0, 0x0, 0x0, 0x0, 0x0, 0x0, 0x0, 0x0
    .long 0x0, 0x0, 0x0, 0x0, 0x0, 0x0, 0x0, 0x0
    .long 0x0, 0x0, 0x0, 0x0, 0x0, 0x0, 0x0, 0x0
    .long 0x0, 0x0, 0x0, 0x0, 0x0, 0x0, 0x0, 0x0
    .long 0x0, 0x0, 0x0, 0x0, 0x0, 0x0, 0x0, 0x0
    .long 0x0, 0x0, 0x0, 0x0, 0x0, 0x0, 0x0, 0x0
    .long 0x0, 0x0, 0x0, 0x0, 0x0, 0x0, 0x0, 0x0
    .long 0x0, 0x0, 0x0, 0x0, 0x0, 0xff000000, 0x0, 0x0
    .long 0x0, 0x0, 0x0, 0x0, 0x0, 0x0, 0x0, 0x0
    .long 0x0, 0x0, 0x0, 0x0, 0x0, 0x0, 0x0, 0x0
    .long 0x0, 0x0, 0x0, 0x0, 0x0, 0x0, 0x0, 0x0
    .long 0x0, 0x0, 0x0, 0x0, 0x0, 0x0, 0x0, 0x0
    .long 0x0, 0x0, 0x0, 0x0, 0x0, 0x0, 0x0, 0x0
    .long 0x0, 0x0, 0x0, 0x0, 0x0, 0x0, 0x0, 0x0
    .long 0x0, 0x0, 0x0, 0x0, 0x0, 0x0, 0x0, 0x0
    .long 0xd8f100, 0x1f100, 0xfff00000, 0x10070e0, 0xa005000, 0xc00, 0x600c540, 0xf460
    .long 0x80041c0, 0x41c0, 0xeff5ba0, 0xffff5ba0, 0x1000c540, 0x41c0, 0x120041c0, 0xc540
    .long 0x14feb740, 0xfffeb740, 0x1600a460, 0xa460, 0x180041c0, 0x41c0, 0x1aff5ba0, 0xffff5ba0
    .long 0x1c00c540, 0x41c0, 0x1d000000, 0xc540, 0x0, 0x0, 0x0, 0x0
    .long 0x0, 0xff000000, 0x0, 0x0, 0x0, 0x0, 0x0, 0x0
    .long 0x0, 0x0, 0x0, 0x0, 0x0, 0x0, 0x0, 0x0
    .long 0x0, 0x0, 0x0, 0x0, 0x0, 0x0, 0x0, 0x0
    .long 0x0, 0x0, 0x0, 0x0, 0x0, 0x0, 0x0, 0x0
    .long 0xdaf100, 0x1f100, 0xfff00000, 0x20091c0, 0xa005000, 0xc00, 0x600c540, 0xf460
    .long 0x80041c0, 0x41c0, 0xeff5ba0, 0xffff5ba0, 0x1000c540, 0x41c0, 0x120041c0, 0xc540
    .long 0x14feb740, 0xfffeb740, 0x1600a460, 0xa460, 0x180041c0, 0x41c0, 0x1aff5ba0, 0xffff5ba0
    .long 0x1c00c540, 0x41c0, 0x1d000000, 0xc540, 0x0, 0x0, 0x0, 0x0
    .long 0x0, 0xff000000, 0x0, 0x0, 0x0, 0x0, 0x0, 0x0
    .long 0x0, 0x0, 0x0, 0x0, 0x0, 0x0, 0x0, 0x0
    .long 0x0, 0x0, 0x0, 0x0, 0x0, 0x0, 0x0, 0x0
    .long 0x0, 0x0, 0x0, 0x0, 0x0, 0x0, 0x0, 0x0
    .long 0xdcf100, 0x1f100, 0xfff00000, 0x300b2a0, 0xa005000, 0xc00, 0x600c540, 0xf460
    .long 0x80041c0, 0x41c0, 0xeff5ba0, 0xffff5ba0, 0x1000c540, 0x41c0, 0x120041c0, 0xc540
    .long 0x14feb740, 0xfffeb740, 0x1600a460, 0xa460, 0x180041c0, 0x41c0, 0x1aff5ba0, 0xffff5ba0
    .long 0x1c00c540, 0x41c0, 0x1d000000, 0xc540, 0x0, 0x0, 0x0, 0x0
    .long 0x0, 0xff000000, 0x0, 0x0, 0x0, 0x0, 0x0, 0x0
    .long 0x0, 0x0, 0x0, 0x0, 0x0, 0x0, 0x0, 0x0
    .long 0x0, 0x0, 0x0, 0x0, 0x0, 0x0, 0x0, 0x0
    .long 0x0, 0x0, 0x0, 0x0, 0x0, 0x0, 0x0, 0x0
    .long 0xdef100, 0x1f100, 0xfff00000, 0x400d380, 0xa005000, 0xc00, 0x600c540, 0xf460
    .long 0x80041c0, 0x41c0, 0xeff5ba0, 0xffff5ba0, 0x1000c540, 0x41c0, 0x120041c0, 0xc540
    .long 0x14feb740, 0xfffeb740, 0x1600a460, 0xa460, 0x180041c0, 0x41c0, 0x1aff5ba0, 0xffff5ba0
    .long 0x1c00c540, 0x41c0, 0x1d000000, 0xc540, 0x0, 0x0, 0x0, 0x0
    .long 0x0, 0xff000000, 0x0, 0x0, 0x0, 0x0, 0x0, 0x0
    .long 0x0, 0x0, 0x0, 0x0, 0x0, 0x0, 0x0, 0x0
    .long 0x0, 0x0, 0x0, 0x0, 0x0, 0x0, 0x0, 0x0
    .long 0x0, 0x0, 0x0, 0x0, 0x0, 0x0, 0x0, 0x0
    .long 0xe0f100, 0x1f100, 0xfff00000, 0x90177e0, 0xa005000, 0x0, 0x600c540, 0xf460
    .long 0x80041c0, 0x41c0, 0xeff5ba0, 0xffff5ba0, 0x1000c540, 0x41c0, 0x120041c0, 0xc540
    .long 0x14feb740, 0xfffeb740, 0x1600a460, 0xa460, 0x180041c0, 0x41c0, 0x1aff5ba0, 0xffff5ba0
    .long 0x1c00c540, 0x41c0, 0x1d000000, 0xc540, 0x0, 0x0, 0x0, 0x0
    .long 0x0, 0xff000000, 0x0, 0x0, 0x0, 0x0, 0x0, 0x0
    .long 0x0, 0x0, 0x0, 0x0, 0x0, 0x0, 0x0, 0x0
    .long 0x0, 0x0, 0x0, 0x0, 0x0, 0x0, 0x0, 0x0
    .long 0x0, 0x0, 0x0, 0x0, 0x0, 0x0, 0x0, 0x0
    .long 0xe2f100, 0x1f100, 0xfff00000, 0xa0198c0, 0xa005000, 0x0, 0x600c540, 0xf460
    .long 0x80041c0, 0x41c0, 0xeff5ba0, 0xffff5ba0, 0x1000c540, 0x41c0, 0x120041c0, 0xc540
    .long 0x14feb740, 0xfffeb740, 0x1600a460, 0xa460, 0x180041c0, 0x41c0, 0x1aff5ba0, 0xffff5ba0
    .long 0x1c00c540, 0x41c0, 0x1d000000, 0xc540, 0x0, 0x0, 0x0, 0x0
    .long 0x0, 0xff000000, 0x0, 0x0, 0x0, 0x0, 0x0, 0x0
    .long 0x0, 0x0, 0x0, 0x0, 0x0, 0x0, 0x0, 0x0
    .long 0x0, 0x0, 0x0, 0x0, 0x0, 0x0, 0x0, 0x0
    .long 0x0, 0x0, 0x0, 0x0, 0x0, 0x0, 0x0, 0x0
    .long 0xe4f100, 0x1f100, 0xfff00000, 0xb01b9a0, 0xa005000, 0x0, 0x600c540, 0xf460
    .long 0x80041c0, 0x41c0, 0xeff5ba0, 0xffff5ba0, 0x1000c540, 0x41c0, 0x120041c0, 0xc540
    .long 0x14feb740, 0xfffeb740, 0x1600a460, 0xa460, 0x180041c0, 0x41c0, 0x1aff5ba0, 0xffff5ba0
    .long 0x1c00c540, 0x41c0, 0x1d000000, 0xc540, 0x0, 0x0, 0x0, 0x0
    .long 0x0, 0xff000000, 0x0, 0x0, 0x0, 0x0, 0x0, 0x0
    .long 0x0, 0x0, 0x0, 0x0, 0x0, 0x0, 0x0, 0x0
    .long 0x0, 0x0, 0x0, 0x0, 0x0, 0x0, 0x0, 0x0
    .long 0x0, 0x0, 0x0, 0x0, 0x0, 0x0, 0x0, 0x0
    .long 0xe6f100, 0x1f100, 0xfff00000, 0xc0070e0, 0xa005000, 0x0, 0x600c540, 0xf460
    .long 0x80041c0, 0x41c0, 0xeff5ba0, 0xffff5ba0, 0x1000c540, 0x41c0, 0x120041c0, 0xc540
    .long 0x14feb740, 0xfffeb740, 0x1600a460, 0xa460, 0x180041c0, 0x41c0, 0x1aff5ba0, 0xffff5ba0
    .long 0x1c00c540, 0x41c0, 0x1d000000, 0xc540, 0x0, 0x0, 0x0, 0x0
    .long 0x0, 0xff000000, 0x0, 0x0, 0x0, 0x0, 0x0, 0x0
    .long 0x0, 0x0, 0x0, 0x0, 0x0, 0x0, 0x0, 0x0
    .long 0x0, 0x0, 0x0, 0x0, 0x0, 0x0, 0x0, 0x0
    .long 0x0, 0x0, 0x0, 0x0, 0x0, 0x0, 0x0, 0x0
    .long 0xd8f100, 0xee300e, 0xdaf100, 0x4ee300c, 0xdef100, 0x8ee300c, 0xdaf100, 0xcee300e
    .long 0xdcf100, 0x10ee300e, 0xe2f100, 0x14ee300c, 0x2e6f101, 0x2ee300c, 0x2def104, 0x6ee300e
    .long 0x2e0f110, 0x12ee300e, 0x2e2f140, 0x16ee300e, 0x2e4f1ff, 0xee300e, 0x4e6f1ff, 0xaee300e
    .long 0x6e8f1ff, 0x10ee300e, 0x8eaf1ff, 0x6ee300e, 0xaecf1ff, 0x8ee300e, 0x0, 0x0
    .long 0x0, 0x0, 0x0, 0x0, 0x0, 0x0, 0x0, 0x0
    .long 0x0, 0x0, 0x0, 0x0, 0x0, 0x0, 0x0, 0x0
    .long 0x0, 0x0, 0x0, 0x0, 0x0, 0x0, 0x0, 0x0
    .long 0x0, 0x0, 0x0, 0x0, 0x0, 0x0, 0x0, 0x0
    .long 0xd8f100, 0x2ee300c, 0xdcf100, 0x6ee300c, 0xd8f100, 0xaee300d, 0xdaf100, 0xeee300d
    .long 0xe0f100, 0x12ee300c, 0xe4f100, 0x16ee300c, 0x2dcf102, 0x4ee300d, 0x2def108, 0x8ee300d
    .long 0x2e0f120, 0x14ee300d, 0x2e2f180, 0x2ee300d, 0x4e4f1ff, 0xcee300d, 0x6e6f1ff, 0xeee300d
    .long 0x8e8f1ff, 0x4ee300d, 0xaeaf1ff, 0x12ee300d, 0xcecf1ff, 0x14ee300d, 0x0, 0x0
    .long 0x0, 0x0, 0x0, 0x0, 0x0, 0x0, 0x0, 0x0
    .long 0x0, 0x0, 0x0, 0x0, 0x0, 0x0, 0x0, 0x0
    .long 0x0, 0x0, 0x0, 0x0, 0x0, 0x0, 0x0, 0x0
    .long 0x0, 0x0, 0x0, 0x0, 0x0, 0x0, 0x0, 0x0
    .long 0x0, 0x0, 0x0, 0x0, 0x0, 0xff000000, 0x0, 0x0
    .long 0x0, 0x0, 0x0, 0x0, 0x0, 0x0, 0x0, 0x0
    .long 0x0, 0x0, 0x0, 0x0, 0x0, 0x0, 0x0, 0x0
    .long 0x0, 0x0, 0x0, 0x0, 0x0, 0x0, 0x0, 0x0
    .long 0x0, 0x0, 0x0, 0x0, 0x0, 0x0, 0x0, 0x0
    .long 0x0, 0x0, 0x0, 0x0, 0x0, 0x0, 0x0, 0x0
    .long 0x0, 0x0, 0x0, 0x0, 0x0, 0x0, 0x0, 0x0
    .long 0x0, 0x0, 0x0, 0x0, 0x0, 0x0, 0x0, 0x0
    .long 0x0, 0x0, 0x0, 0x0, 0x0, 0xff000000, 0x0, 0x0
    .long 0x0, 0x0, 0x0, 0x0, 0x0, 0x0, 0x0, 0x0
    .long 0x0, 0x0, 0x0, 0x0, 0x0, 0x0, 0x0, 0x0
    .long 0x0, 0x0, 0x0, 0x0, 0x0, 0x0, 0x0, 0x0
    .long 0x0, 0x0, 0x0, 0x0, 0x0, 0x0, 0x0, 0x0
    .long 0x0, 0x0, 0x0, 0x0, 0x0, 0x0, 0x0, 0x0
    .long 0x0, 0x0, 0x0, 0x0, 0x0, 0x0, 0x0, 0x0
    .long 0x0, 0x0, 0x0, 0x0, 0x0, 0x0, 0x0, 0x0
    .long 0xd8f100, 0x1f100, 0xfff00000, 0x10070e0, 0xa005000, 0xc00, 0x600c540, 0xf460
    .long 0x80041c0, 0x41c0, 0xeff5ba0, 0xffff5ba0, 0x1000c540, 0x41c0, 0x120041c0, 0xc540
    .long 0x14fe9660, 0xfffed820, 0x1600a460, 0xa460, 0x180062a0, 0x20e0, 0x1aff5ba0, 0xffff5ba0
    .long 0x1c0020e0, 0xe620, 0x1d000000, 0x20e0, 0x0, 0x0, 0x0, 0x0
    .long 0x0, 0xff000000, 0x0, 0x0, 0x0, 0x0, 0x0, 0x0
    .long 0x0, 0x0, 0x0, 0x0, 0x0, 0x0, 0x0, 0x0
    .long 0x0, 0x0, 0x0, 0x0, 0x0, 0x0, 0x0, 0x0
    .long 0x0, 0x0, 0x0, 0x0, 0x0, 0x0, 0x0, 0x0
    .long 0xdaf100, 0x1f100, 0xfff00000, 0x20091c0, 0xa005000, 0xc00, 0x600c540, 0xf460
    .long 0x80041c0, 0x41c0, 0xeff5ba0, 0xffff5ba0, 0x1000c540, 0x41c0, 0x120041c0, 0xc540
    .long 0x14fe9660, 0xfffed820, 0x1600a460, 0xa460, 0x180062a0, 0x20e0, 0x1aff5ba0, 0xffff5ba0
    .long 0x1c0020e0, 0xe620, 0x1d000000, 0x20e0, 0x0, 0x0, 0x0, 0x0
    .long 0x0, 0xff000000, 0x0, 0x0, 0x0, 0x0, 0x0, 0x0
    .long 0x0, 0x0, 0x0, 0x0, 0x0, 0x0, 0x0, 0x0
    .long 0x0, 0x0, 0x0, 0x0, 0x0, 0x0, 0x0, 0x0
    .long 0x0, 0x0, 0x0, 0x0, 0x0, 0x0, 0x0, 0x0
    .long 0xdcf100, 0x1f100, 0xfff00000, 0x300b2a0, 0xa005000, 0xc00, 0x600c540, 0xf460
    .long 0x80041c0, 0x41c0, 0xeff5ba0, 0xffff5ba0, 0x1000c540, 0x41c0, 0x120041c0, 0xc540
    .long 0x14fe9660, 0xfffed820, 0x1600a460, 0xa460, 0x180062a0, 0x20e0, 0x1aff5ba0, 0xffff5ba0
    .long 0x1c0020e0, 0xe620, 0x1d000000, 0x20e0, 0x0, 0x0, 0x0, 0x0
    .long 0x0, 0xff000000, 0x0, 0x0, 0x0, 0x0, 0x0, 0x0
    .long 0x0, 0x0, 0x0, 0x0, 0x0, 0x0, 0x0, 0x0
    .long 0x0, 0x0, 0x0, 0x0, 0x0, 0x0, 0x0, 0x0
    .long 0x0, 0x0, 0x0, 0x0, 0x0, 0x0, 0x0, 0x0
    .long 0xdef100, 0x1f100, 0xfff00000, 0x400d380, 0xa005000, 0xc00, 0x600c540, 0xf460
    .long 0x80041c0, 0x41c0, 0xeff5ba0, 0xffff5ba0, 0x1000c540, 0x41c0, 0x120041c0, 0xc540
    .long 0x14fe9660, 0xfffed820, 0x1600a460, 0xa460, 0x180062a0, 0x20e0, 0x1aff5ba0, 0xffff5ba0
    .long 0x1c0020e0, 0xe620, 0x1d000000, 0x20e0, 0x0, 0x0, 0x0, 0x0
    .long 0x0, 0xff000000, 0x0, 0x0, 0x0, 0x0, 0x0, 0x0
    .long 0x0, 0x0, 0x0, 0x0, 0x0, 0x0, 0x0, 0x0
    .long 0x0, 0x0, 0x0, 0x0, 0x0, 0x0, 0x0, 0x0
    .long 0x0, 0x0, 0x0, 0x0, 0x0, 0x0, 0x0, 0x0
    .long 0xe0f100, 0x1f100, 0xfff00000, 0x90177e0, 0xa005000, 0x0, 0x600c540, 0xf460
    .long 0x80041c0, 0x41c0, 0xeff5ba0, 0xffff5ba0, 0x1000c540, 0x41c0, 0x120041c0, 0xc540
    .long 0x14fe9660, 0xfffed820, 0x1600a460, 0xa460, 0x180062a0, 0x20e0, 0x1aff5ba0, 0xffff5ba0
    .long 0x1c0020e0, 0xe620, 0x1d000000, 0x20e0, 0x0, 0x0, 0x0, 0x0
    .long 0x0, 0xff000000, 0x0, 0x0, 0x0, 0x0, 0x0, 0x0
    .long 0x0, 0x0, 0x0, 0x0, 0x0, 0x0, 0x0, 0x0
    .long 0x0, 0x0, 0x0, 0x0, 0x0, 0x0, 0x0, 0x0
    .long 0x0, 0x0, 0x0, 0x0, 0x0, 0x0, 0x0, 0x0
    .long 0xe2f100, 0x1f100, 0xfff00000, 0xa0198c0, 0xa005000, 0x0, 0x600c540, 0xf460
    .long 0x80041c0, 0x41c0, 0xeff5ba0, 0xffff5ba0, 0x1000c540, 0x41c0, 0x120041c0, 0xc540
    .long 0x14fe9660, 0xfffed820, 0x1600a460, 0xa460, 0x180062a0, 0x20e0, 0x1aff5ba0, 0xffff5ba0
    .long 0x1c0020e0, 0xe620, 0x1d000000, 0x20e0, 0x0, 0x0, 0x0, 0x0
    .long 0x0, 0xff000000, 0x0, 0x0, 0x0, 0x0, 0x0, 0x0
    .long 0x0, 0x0, 0x0, 0x0, 0x0, 0x0, 0x0, 0x0
    .long 0x0, 0x0, 0x0, 0x0, 0x0, 0x0, 0x0, 0x0
    .long 0x0, 0x0, 0x0, 0x0, 0x0, 0x0, 0x0, 0x0
    .long 0xe4f100, 0x1f100, 0xfff00000, 0xb01b9a0, 0xa005000, 0x0, 0x600c540, 0xf460
    .long 0x80041c0, 0x41c0, 0xeff5ba0, 0xffff5ba0, 0x1000c540, 0x41c0, 0x120041c0, 0xc540
    .long 0x14fe9660, 0xfffed820, 0x1600a460, 0xa460, 0x180062a0, 0x20e0, 0x1aff5ba0, 0xffff5ba0
    .long 0x1c0020e0, 0xe620, 0x1d000000, 0x20e0, 0x0, 0x0, 0x0, 0x0
    .long 0x0, 0xff000000, 0x0, 0x0, 0x0, 0x0, 0x0, 0x0
    .long 0x0, 0x0, 0x0, 0x0, 0x0, 0x0, 0x0, 0x0
    .long 0x0, 0x0, 0x0, 0x0, 0x0, 0x0, 0x0, 0x0
    .long 0x0, 0x0, 0x0, 0x0, 0x0, 0x0, 0x0, 0x0
    .long 0xe6f100, 0x1f100, 0xfff00000, 0xc0070e0, 0xa005000, 0x0, 0x600c540, 0xf460
    .long 0x80041c0, 0x41c0, 0xeff5ba0, 0xffff5ba0, 0x1000c540, 0x41c0, 0x120041c0, 0xc540
    .long 0x14fe9660, 0xfffed820, 0x1600a460, 0xa460, 0x180062a0, 0x20e0, 0x1aff5ba0, 0xffff5ba0
    .long 0x1c0020e0, 0xe620, 0x1d000000, 0x20e0, 0x0, 0x0, 0x0, 0x0
    .long 0x0, 0xff000000, 0x0, 0x0, 0x0, 0x0, 0x0, 0x0
    .long 0x0, 0x0, 0x0, 0x0, 0x0, 0x0, 0x0, 0x0
    .long 0x0, 0x0, 0x0, 0x0, 0x0, 0x0, 0x0, 0x0
    .long 0x0, 0x0, 0x0, 0x0, 0x0, 0x0, 0x0, 0x0
    .long 0x513000, 0x60f00a, 0x533000, 0x460f008, 0x573000, 0x860f008, 0x533000, 0xc60f00a
    .long 0x553000, 0x1060f00a, 0x5b3000, 0x1460f008, 0x513000, 0x1860f008, 0x573000, 0x1c60f00a
    .long 0x2593001, 0x260f00a, 0x25b3004, 0x660f00a, 0x25d3010, 0x1260f00a, 0x25f3040, 0x1660f00a
    .long 0x2ab6080, 0x18afa008, 0x4ad60ff, 0xcafa008, 0x6a760ff, 0x10afa00a, 0x8a760ff, 0x1cafa009
    .long 0xaa960ff, 0x1eafa009, 0x42ab6400, 0xcafa009, 0xcad60ff, 0x6afa009, 0xeaf60ff, 0x8afa009
    .long 0x0, 0x0, 0x0, 0x0, 0x0, 0x0, 0x0, 0x0
    .long 0x0, 0x0, 0x0, 0x0, 0x0, 0x0, 0x0, 0x0
    .long 0x0, 0x0, 0x0, 0x0, 0x0, 0x0, 0x0, 0x0
    .long 0x5f3000, 0x260f008, 0x553000, 0x660f008, 0x513000, 0xa60f009, 0x533000, 0xe60f009
    .long 0x593000, 0x1260f008, 0x5d3000, 0x1660f008, 0x553000, 0x1a60f009, 0x573000, 0x1e60f009
    .long 0x2593002, 0x460f009, 0x25b3008, 0x860f009, 0x25d3020, 0x1460f009, 0x25f30ff, 0x60f009
    .long 0x4a560ff, 0xaafa00a, 0x6a560ff, 0xeafa009, 0x8af60ff, 0x1aafa008, 0xaa960ff, 0x2afa00a
    .long 0x42ab6200, 0x18afa00a, 0xcad60ff, 0x4afa00a, 0xeaf60ff, 0x12afa00a, 0x0, 0x0
    .long 0x0, 0x0, 0x0, 0x0, 0x0, 0x0, 0x0, 0x0
    .long 0x0, 0x0, 0x0, 0x0, 0x0, 0x0, 0x0, 0x0
    .long 0x0, 0x0, 0x0, 0x0, 0x0, 0x0, 0x0, 0x0
    .long 0xab6000, 0x1f100, 0xfffffff0, 0x1901da80, 0x500f460, 0x20001000, 0x1c0062a0, 0x13620
    .long 0x1fff19e0, 0xe620, 0x210169a0, 0x20e0, 0x23feb740, 0xfffed820, 0x2500e620, 0xffff9d60
    .long 0x26000000, 0x20e0, 0x0, 0x0, 0x0, 0x0, 0x0, 0xff000000
    .long 0x0, 0x0, 0x0, 0x0, 0x0, 0x0, 0x0, 0x0
    .long 0x0, 0x0, 0x0, 0x0, 0x0, 0x0, 0x0, 0x0
    .long 0x0, 0x0, 0x0, 0x0, 0x0, 0x0, 0x0, 0x0
    .long 0x0, 0x0, 0x0, 0x0, 0x0, 0x0, 0x0, 0x0
    .long 0x0, 0x0, 0x0, 0x0, 0x0, 0x0, 0x0, 0x0
    .long 0xad6000, 0x1f100, 0xfffffff0, 0x1a011540, 0x500f460, 0x20001000, 0x1c0062a0, 0x13620
    .long 0x1fff19e0, 0xe620, 0x210169a0, 0x20e0, 0x23feb740, 0xfffed820, 0x2500e620, 0xffff9d60
    .long 0x26000000, 0x20e0, 0x0, 0x0, 0x0, 0x0, 0x0, 0xff000000
    .long 0x0, 0x0, 0x0, 0x0, 0x0, 0x0, 0x0, 0x0
    .long 0x0, 0x0, 0x0, 0x0, 0x0, 0x0, 0x0, 0x0
    .long 0x0, 0x0, 0x0, 0x0, 0x0, 0x0, 0x0, 0x0
    .long 0x0, 0x0, 0x0, 0x0, 0x0, 0x0, 0x0, 0x0
    .long 0x0, 0x0, 0x0, 0x0, 0x0, 0x0, 0x0, 0x0
    .long 0x5f3000, 0x1b100, 0xf0000000, 0x10070e0, 0x7005000, 0xc00, 0x600c540, 0xf460
    .long 0x80041c0, 0x41c0, 0xe00c540, 0xc540, 0x10fe54a0, 0x41c0, 0x120041c0, 0xfffe54a0
    .long 0x1400c540, 0x41c0, 0x160041c0, 0xc540, 0x17000000, 0xfffeb740, 0xaf6000, 0x3100
    .long 0xfffffff0, 0x1d0041c0, 0x5ff3ac0, 0x20001d00, 0x1c0062a0, 0xe620, 0x1fff19e0, 0xe620
    .long 0x210169a0, 0x20e0, 0x23feb740, 0xfffed820, 0x2500e620, 0xffff9d60, 0x26000000, 0x20e0
    .long 0x0, 0x0, 0x0, 0x0, 0x0, 0xff000000, 0x0, 0x0
    .long 0x0, 0x0, 0x0, 0x0, 0x0, 0x0, 0x0, 0x0
    .long 0x0, 0x0, 0x0, 0x0, 0x0, 0x0, 0x0, 0x0
    .long 0x533000, 0x1f100, 0xf0000000, 0x20091c0, 0x7005000, 0xc00, 0x600c540, 0xf460
    .long 0x80041c0, 0x41c0, 0xe00c540, 0xc540, 0x10fe54a0, 0x41c0, 0x120041c0, 0xfffe54a0
    .long 0x1400c540, 0x41c0, 0x160041c0, 0xc540, 0x17000000, 0xfffeb740, 0x0, 0x0
    .long 0x0, 0x0, 0x0, 0xff000000, 0x0, 0x0, 0x0, 0x0
    .long 0x0, 0x0, 0x0, 0x0, 0x0, 0x0, 0x0, 0x0
    .long 0x0, 0x0, 0x0, 0x0, 0x0, 0x0, 0x0, 0x0
    .long 0x0, 0x0, 0x0, 0x0, 0x0, 0x0, 0x0, 0x0
    .long 0x0, 0x0, 0x0, 0x0, 0x0, 0x0, 0x0, 0x0
    .long 0x553000, 0x1f100, 0xf0000000, 0x300b2a0, 0x7005000, 0xc00, 0x600c540, 0xf460
    .long 0x80041c0, 0x41c0, 0xe00c540, 0xc540, 0x10fe54a0, 0x41c0, 0x120041c0, 0xfffe54a0
    .long 0x1400c540, 0x41c0, 0x160041c0, 0xc540, 0x17000000, 0xfffeb740, 0x0, 0x0
    .long 0x0, 0x0, 0x0, 0xff000000, 0x0, 0x0, 0x0, 0x0
    .long 0x0, 0x0, 0x0, 0x0, 0x0, 0x0, 0x0, 0x0
    .long 0x0, 0x0, 0x0, 0x0, 0x0, 0x0, 0x0, 0x0
    .long 0x0, 0x0, 0x0, 0x0, 0x0, 0x0, 0x0, 0x0
    .long 0x0, 0x0, 0x0, 0x0, 0x0, 0x0, 0x0, 0x0
    .long 0x573000, 0x1f100, 0xf0000000, 0x400d380, 0x7005000, 0xc00, 0x600c540, 0xf460
    .long 0x80041c0, 0x41c0, 0xe00c540, 0xc540, 0x10fe54a0, 0x41c0, 0x120041c0, 0xfffe54a0
    .long 0x1400c540, 0x41c0, 0x160041c0, 0xc540, 0x17000000, 0xfffeb740, 0x0, 0x0
    .long 0x0, 0x0, 0x0, 0xff000000, 0x0, 0x0, 0x0, 0x0
    .long 0x0, 0x0, 0x0, 0x0, 0x0, 0x0, 0x0, 0x0
    .long 0x0, 0x0, 0x0, 0x0, 0x0, 0x0, 0x0, 0x0
    .long 0x0, 0x0, 0x0, 0x0, 0x0, 0x0, 0x0, 0x0
    .long 0x0, 0x0, 0x0, 0x0, 0x0, 0x0, 0x0, 0x0
    .long 0x593000, 0x1f100, 0xf0000000, 0x90177e0, 0x7005000, 0x0, 0x600c540, 0xf460
    .long 0x80041c0, 0x41c0, 0xe00c540, 0xc540, 0x10fe54a0, 0x41c0, 0x120041c0, 0xfffe54a0
    .long 0x1400c540, 0x41c0, 0x160041c0, 0xc540, 0x17000000, 0xfffeb740, 0x0, 0x0
    .long 0x0, 0x0, 0x0, 0xff000000, 0x0, 0x0, 0x0, 0x0
    .long 0x0, 0x0, 0x0, 0x0, 0x0, 0x0, 0x0, 0x0
    .long 0x0, 0x0, 0x0, 0x0, 0x0, 0x0, 0x0, 0x0
    .long 0x0, 0x0, 0x0, 0x0, 0x0, 0x0, 0x0, 0x0
    .long 0x0, 0x0, 0x0, 0x0, 0x0, 0x0, 0x0, 0x0
    .long 0x5b3000, 0x1f100, 0xf0000000, 0xa0198c0, 0x7005000, 0x0, 0x600c540, 0xf460
    .long 0x80041c0, 0x41c0, 0xe00c540, 0xc540, 0x10fe54a0, 0x41c0, 0x120041c0, 0xfffe54a0
    .long 0x1400c540, 0x41c0, 0x160041c0, 0xc540, 0x17000000, 0xfffeb740, 0x0, 0x0
    .long 0x0, 0x0, 0x0, 0xff000000, 0x0, 0x0, 0x0, 0x0
    .long 0x0, 0x0, 0x0, 0x0, 0x0, 0x0, 0x0, 0x0
    .long 0x0, 0x0, 0x0, 0x0, 0x0, 0x0, 0x0, 0x0
    .long 0x0, 0x0, 0x0, 0x0, 0x0, 0x0, 0x0, 0x0
    .long 0x0, 0x0, 0x0, 0x0, 0x0, 0x0, 0x0, 0x0
    .long 0x5d3000, 0x1f100, 0xf0000000, 0xb01b9a0, 0x7005000, 0x0, 0x600c540, 0xf460
    .long 0x80041c0, 0x41c0, 0xe00c540, 0xc540, 0x10fe54a0, 0x41c0, 0x120041c0, 0xfffe54a0
    .long 0x1400c540, 0x41c0, 0x160041c0, 0xc540, 0x17000000, 0xfffeb740, 0x0, 0x0
    .long 0x0, 0x0, 0x0, 0xff000000, 0x0, 0x0, 0x0, 0x0
    .long 0x0, 0x0, 0x0, 0x0, 0x0, 0x0, 0x0, 0x0
    .long 0x0, 0x0, 0x0, 0x0, 0x0, 0x0, 0x0, 0x0
    .long 0x0, 0x0, 0x0, 0x0, 0x0, 0x0, 0x0, 0x0
    .long 0x0, 0x0, 0x0, 0x0, 0x0, 0x0, 0x0, 0x0
    .long 0x513000, 0x1f100, 0xf0000000, 0xc01da80, 0x7005000, 0x0, 0x600c540, 0xf460
    .long 0x80041c0, 0x41c0, 0xe00c540, 0xc540, 0x10fe54a0, 0x41c0, 0x120041c0, 0xfffe54a0
    .long 0x1400c540, 0x41c0, 0x160041c0, 0xc540, 0x17000000, 0xfffeb740, 0x0, 0x0
    .long 0x0, 0x0, 0x0, 0xff000000, 0x0, 0x0, 0x0, 0x0
    .long 0x0, 0x0, 0x0, 0x0, 0x0, 0x0, 0x0, 0x0
    .long 0x0, 0x0, 0x0, 0x0, 0x0, 0x0, 0x0, 0x0
    .long 0x0, 0x0, 0x0, 0x0, 0x0, 0x0, 0x0, 0x0
    .long 0x0, 0x0, 0x0, 0x0, 0x0, 0x0, 0x0, 0x0
    .long 0x513000, 0x60f00a, 0x533000, 0x460f008, 0x573000, 0x860f008, 0x533000, 0xc60f00a
    .long 0x553000, 0x1060f00a, 0x5b3000, 0x1460f008, 0x513000, 0x1860f008, 0x573000, 0x1c60f00a
    .long 0x2593001, 0x260f00a, 0x25b3004, 0x660f00a, 0x25d3010, 0x1260f00a, 0x25f3040, 0x1660f00a
    .long 0x2ab6080, 0x18afa008, 0x4ad60ff, 0xcafa008, 0x6a760ff, 0x10afa00a, 0x8a760ff, 0x1cafa009
    .long 0xaa960ff, 0x1eafa009, 0x42ab6400, 0xcafa009, 0xcad60ff, 0x6afa009, 0xeaf60ff, 0x12afa009
    .long 0x0, 0x0, 0x0, 0x0, 0x0, 0x0, 0x0, 0x0
    .long 0x0, 0x0, 0x0, 0x0, 0x0, 0x0, 0x0, 0x0
    .long 0x0, 0x0, 0x0, 0x0, 0x0, 0x0, 0x0, 0x0
    .long 0x5f3000, 0x260f008, 0x553000, 0x660f008, 0x513000, 0xa60f009, 0x533000, 0xe60f009
    .long 0x593000, 0x1260f008, 0x5d3000, 0x1660f008, 0x553000, 0x1a60f009, 0x573000, 0x1e60f009
    .long 0x2593002, 0x460f009, 0x25b3008, 0x860f009, 0x25d3020, 0x1460f009, 0x25f30ff, 0x60f009
    .long 0x4a560ff, 0xaafa00a, 0x6a560ff, 0xeafa009, 0x8af60ff, 0x1aafa008, 0xaa960ff, 0x2afa00a
    .long 0x42ab6200, 0x18afa00a, 0xcad60ff, 0x4afa00a, 0xeaf60ff, 0x8afa00a, 0x0, 0x0
    .long 0x0, 0x0, 0x0, 0x0, 0x0, 0x0, 0x0, 0x0
    .long 0x0, 0x0, 0x0, 0x0, 0x0, 0x0, 0x0, 0x0
    .long 0x0, 0x0, 0x0, 0x0, 0x0, 0x0, 0x0, 0x0
    .long 0xab6000, 0x1f100, 0xfffffff0, 0x1901da80, 0x500f460, 0x20001000, 0x1c0062a0, 0x13620
    .long 0x1fff19e0, 0xe620, 0x210169a0, 0x20e0, 0x23feb740, 0xfffed820, 0x250041c0, 0xffff9d60
    .long 0x26000000, 0xc540, 0x0, 0x0, 0x0, 0x0, 0x0, 0xff000000
    .long 0x0, 0x0, 0x0, 0x0, 0x0, 0x0, 0x0, 0x0
    .long 0x0, 0x0, 0x0, 0x0, 0x0, 0x0, 0x0, 0x0
    .long 0x0, 0x0, 0x0, 0x0, 0x0, 0x0, 0x0, 0x0
    .long 0x0, 0x0, 0x0, 0x0, 0x0, 0x0, 0x0, 0x0
    .long 0x0, 0x0, 0x0, 0x0, 0x0, 0x0, 0x0, 0x0
    .long 0xad6000, 0x1f100, 0xfffffff0, 0x1a011540, 0x500f460, 0x20001000, 0x1c0062a0, 0x13620
    .long 0x1fff19e0, 0xe620, 0x210169a0, 0x20e0, 0x23feb740, 0xfffed820, 0x250041c0, 0xffff9d60
    .long 0x26000000, 0xc540, 0x0, 0x0, 0x0, 0x0, 0x0, 0xff000000
    .long 0x0, 0x0, 0x0, 0x0, 0x0, 0x0, 0x0, 0x0
    .long 0x0, 0x0, 0x0, 0x0, 0x0, 0x0, 0x0, 0x0
    .long 0x0, 0x0, 0x0, 0x0, 0x0, 0x0, 0x0, 0x0
    .long 0x0, 0x0, 0x0, 0x0, 0x0, 0x0, 0x0, 0x0
    .long 0x0, 0x0, 0x0, 0x0, 0x0, 0x0, 0x0, 0x0
    .long 0x5f3000, 0x1b100, 0xf0000000, 0x10070e0, 0x7005000, 0xc00, 0x600c540, 0xf460
    .long 0x80041c0, 0x41c0, 0xe00c540, 0xc540, 0x10fe54a0, 0x41c0, 0x120041c0, 0xfffe54a0
    .long 0x1400c540, 0x41c0, 0x160041c0, 0xc540, 0x17000000, 0xfffeb740, 0xaf6000, 0x3100
    .long 0xfffffff0, 0x1d0041c0, 0x5ff3ac0, 0x20001d00, 0x1c0062a0, 0xe620, 0x1fff19e0, 0xe620
    .long 0x210169a0, 0x20e0, 0x23feb740, 0xfffed820, 0x250041c0, 0xffff9d60, 0x26000000, 0xc540
    .long 0x0, 0x0, 0x0, 0x0, 0x0, 0xff000000, 0x0, 0x0
    .long 0x0, 0x0, 0x0, 0x0, 0x0, 0x0, 0x0, 0x0
    .long 0x0, 0x0, 0x0, 0x0, 0x0, 0x0, 0x0, 0x0
    .long 0x533000, 0x1f100, 0xf0000000, 0x20091c0, 0x7005000, 0xc00, 0x600c540, 0xf460
    .long 0x80041c0, 0x41c0, 0xe00c540, 0xc540, 0x10fe54a0, 0x41c0, 0x120041c0, 0xfffe54a0
    .long 0x1400c540, 0x41c0, 0x160041c0, 0xc540, 0x17000000, 0xfffeb740, 0x0, 0x0
    .long 0x0, 0x0, 0x0, 0xff000000, 0x0, 0x0, 0x0, 0x0
    .long 0x0, 0x0, 0x0, 0x0, 0x0, 0x0, 0x0, 0x0
    .long 0x0, 0x0, 0x0, 0x0, 0x0, 0x0, 0x0, 0x0
    .long 0x0, 0x0, 0x0, 0x0, 0x0, 0x0, 0x0, 0x0
    .long 0x0, 0x0, 0x0, 0x0, 0x0, 0x0, 0x0, 0x0
    .long 0x553000, 0x1f100, 0xf0000000, 0x300b2a0, 0x7005000, 0xc00, 0x600c540, 0xf460
    .long 0x80041c0, 0x41c0, 0xe00c540, 0xc540, 0x10fe54a0, 0x41c0, 0x120041c0, 0xfffe54a0
    .long 0x1400c540, 0x41c0, 0x160041c0, 0xc540, 0x17000000, 0xfffeb740, 0x0, 0x0
    .long 0x0, 0x0, 0x0, 0xff000000, 0x0, 0x0, 0x0, 0x0
    .long 0x0, 0x0, 0x0, 0x0, 0x0, 0x0, 0x0, 0x0
    .long 0x0, 0x0, 0x0, 0x0, 0x0, 0x0, 0x0, 0x0
    .long 0x0, 0x0, 0x0, 0x0, 0x0, 0x0, 0x0, 0x0
    .long 0x0, 0x0, 0x0, 0x0, 0x0, 0x0, 0x0, 0x0
    .long 0x573000, 0x1f100, 0xf0000000, 0x400d380, 0x7005000, 0xc00, 0x600c540, 0xf460
    .long 0x80041c0, 0x41c0, 0xe00c540, 0xc540, 0x10fe54a0, 0x41c0, 0x120041c0, 0xfffe54a0
    .long 0x1400c540, 0x41c0, 0x160041c0, 0xc540, 0x17000000, 0xfffeb740, 0x0, 0x0
    .long 0x0, 0x0, 0x0, 0xff000000, 0x0, 0x0, 0x0, 0x0
    .long 0x0, 0x0, 0x0, 0x0, 0x0, 0x0, 0x0, 0x0
    .long 0x0, 0x0, 0x0, 0x0, 0x0, 0x0, 0x0, 0x0
    .long 0x0, 0x0, 0x0, 0x0, 0x0, 0x0, 0x0, 0x0
    .long 0x0, 0x0, 0x0, 0x0, 0x0, 0x0, 0x0, 0x0
    .long 0x593000, 0x1f100, 0xf0000000, 0x90177e0, 0x7005000, 0x0, 0x600c540, 0xf460
    .long 0x80041c0, 0x41c0, 0xe00c540, 0xc540, 0x10fe54a0, 0x41c0, 0x120041c0, 0xfffe54a0
    .long 0x1400c540, 0x41c0, 0x160041c0, 0xc540, 0x17000000, 0xfffeb740, 0x0, 0x0
    .long 0x0, 0x0, 0x0, 0xff000000, 0x0, 0x0, 0x0, 0x0
    .long 0x0, 0x0, 0x0, 0x0, 0x0, 0x0, 0x0, 0x0
    .long 0x0, 0x0, 0x0, 0x0, 0x0, 0x0, 0x0, 0x0
    .long 0x0, 0x0, 0x0, 0x0, 0x0, 0x0, 0x0, 0x0
    .long 0x0, 0x0, 0x0, 0x0, 0x0, 0x0, 0x0, 0x0
    .long 0x5b3000, 0x1f100, 0xf0000000, 0xa0198c0, 0x7005000, 0x0, 0x600c540, 0xf460
    .long 0x80041c0, 0x41c0, 0xe00c540, 0xc540, 0x10fe54a0, 0x41c0, 0x120041c0, 0xfffe54a0
    .long 0x1400c540, 0x41c0, 0x160041c0, 0xc540, 0x17000000, 0xfffeb740, 0x0, 0x0
    .long 0x0, 0x0, 0x0, 0xff000000, 0x0, 0x0, 0x0, 0x0
    .long 0x0, 0x0, 0x0, 0x0, 0x0, 0x0, 0x0, 0x0
    .long 0x0, 0x0, 0x0, 0x0, 0x0, 0x0, 0x0, 0x0
    .long 0x0, 0x0, 0x0, 0x0, 0x0, 0x0, 0x0, 0x0
    .long 0x0, 0x0, 0x0, 0x0, 0x0, 0x0, 0x0, 0x0
    .long 0x5d3000, 0x1f100, 0xf0000000, 0xb01b9a0, 0x7005000, 0x0, 0x600c540, 0xf460
    .long 0x80041c0, 0x41c0, 0xe00c540, 0xc540, 0x10fe54a0, 0x41c0, 0x120041c0, 0xfffe54a0
    .long 0x1400c540, 0x41c0, 0x160041c0, 0xc540, 0x17000000, 0xfffeb740, 0x0, 0x0
    .long 0x0, 0x0, 0x0, 0xff000000, 0x0, 0x0, 0x0, 0x0
    .long 0x0, 0x0, 0x0, 0x0, 0x0, 0x0, 0x0, 0x0
    .long 0x0, 0x0, 0x0, 0x0, 0x0, 0x0, 0x0, 0x0
    .long 0x0, 0x0, 0x0, 0x0, 0x0, 0x0, 0x0, 0x0
    .long 0x0, 0x0, 0x0, 0x0, 0x0, 0x0, 0x0, 0x0
    .long 0x513000, 0x1f100, 0xf0000000, 0xc01da80, 0x7005000, 0x0, 0x600c540, 0xf460
    .long 0x80041c0, 0x41c0, 0xe00c540, 0xc540, 0x10fe54a0, 0x41c0, 0x120041c0, 0xfffe54a0
    .long 0x1400c540, 0x41c0, 0x160041c0, 0xc540, 0x17000000, 0xfffeb740, 0x0, 0x0
    .long 0x0, 0x0, 0x0, 0xff000000, 0x0, 0x0, 0x0, 0x0
    .long 0x0, 0x0, 0x0, 0x0, 0x0, 0x0, 0x0, 0x0
    .long 0x0, 0x0, 0x0, 0x0, 0x0, 0x0, 0x0, 0x0
    .long 0x0, 0x0, 0x0, 0x0, 0x0, 0x0, 0x0, 0x0
    .long 0x0, 0x0, 0x0, 0x0, 0x0, 0x0, 0x0, 0x0
    .long 0xd8f000, 0xee300a, 0xdaf000, 0x4ee3008, 0xdef000, 0x8ee3008, 0xdaf000, 0xcee300a
    .long 0xdcf000, 0x10ee300a, 0xe2f000, 0x14ee3008, 0x2e6f001, 0x2ee3008, 0x2def004, 0x6ee300a
    .long 0x2e0f010, 0x12ee300a, 0x2e2f040, 0x16ee300a, 0x2e4f080, 0x2ee300a, 0x4e6f0ff, 0xaee300a
    .long 0x6e8f0ff, 0x10ee300a, 0x8eaf0ff, 0x4ee300a, 0xaecf0ff, 0x8ee300a, 0x0, 0x0
    .long 0x0, 0x0, 0x0, 0x0, 0x0, 0x0, 0x0, 0x0
    .long 0x0, 0x0, 0x0, 0x0, 0x0, 0x0, 0x0, 0x0
    .long 0x0, 0x0, 0x0, 0x0, 0x0, 0x0, 0x0, 0x0
    .long 0x0, 0x0, 0x0, 0x0, 0x0, 0x0, 0x0, 0x0
    .long 0xd8f000, 0x2ee3008, 0xdcf000, 0x6ee3008, 0xd8f000, 0xaee3009, 0xdaf000, 0xeee3009
    .long 0xe0f000, 0x12ee3008, 0xe4f000, 0x16ee3008, 0x2dcf002, 0x4ee3009, 0x2def008, 0x8ee3009
    .long 0x2e0f020, 0x14ee3009, 0x2e2f0ff, 0xee3009, 0x4e4f0ff, 0xcee3009, 0x6e6f0ff, 0xeee3009
    .long 0x8e8f0ff, 0x6ee3009, 0xaeaf0ff, 0x12ee3009, 0xcecf0ff, 0x14ee3009, 0x0, 0x0
    .long 0x0, 0x0, 0x0, 0x0, 0x0, 0x0, 0x0, 0x0
    .long 0x0, 0x0, 0x0, 0x0, 0x0, 0x0, 0x0, 0x0
    .long 0x0, 0x0, 0x0, 0x0, 0x0, 0x0, 0x0, 0x0
    .long 0x0, 0x0, 0x0, 0x0, 0x0, 0x0, 0x0, 0x0
    .long 0x0, 0x0, 0x0, 0x0, 0x0, 0xff000000, 0x0, 0x0
    .long 0x0, 0x0, 0x0, 0x0, 0x0, 0x0, 0x0, 0x0
    .long 0x0, 0x0, 0x0, 0x0, 0x0, 0x0, 0x0, 0x0
    .long 0x0, 0x0, 0x0, 0x0, 0x0, 0x0, 0x0, 0x0
    .long 0x0, 0x0, 0x0, 0x0, 0x0, 0x0, 0x0, 0x0
    .long 0x0, 0x0, 0x0, 0x0, 0x0, 0x0, 0x0, 0x0
    .long 0x0, 0x0, 0x0, 0x0, 0x0, 0x0, 0x0, 0x0
    .long 0x0, 0x0, 0x0, 0x0, 0x0, 0x0, 0x0, 0x0
    .long 0x0, 0x0, 0x0, 0x0, 0x0, 0xff000000, 0x0, 0x0
    .long 0x0, 0x0, 0x0, 0x0, 0x0, 0x0, 0x0, 0x0
    .long 0x0, 0x0, 0x0, 0x0, 0x0, 0x0, 0x0, 0x0
    .long 0x0, 0x0, 0x0, 0x0, 0x0, 0x0, 0x0, 0x0
    .long 0x0, 0x0, 0x0, 0x0, 0x0, 0x0, 0x0, 0x0
    .long 0x0, 0x0, 0x0, 0x0, 0x0, 0x0, 0x0, 0x0
    .long 0x0, 0x0, 0x0, 0x0, 0x0, 0x0, 0x0, 0x0
    .long 0x0, 0x0, 0x0, 0x0, 0x0, 0x0, 0x0, 0x0
    .long 0xd8f000, 0x1f100, 0xfff00000, 0x10070e0, 0xa005000, 0xc00, 0x600c540, 0xf460
    .long 0x80041c0, 0x41c0, 0xeff5ba0, 0xffff5ba0, 0x1000c540, 0x41c0, 0x120041c0, 0xc540
    .long 0x14feb740, 0xfffeb740, 0x16008380, 0xc540, 0x180062a0, 0x20e0, 0x1aff3ac0, 0xffff7c80
    .long 0x1c0041c0, 0xc540, 0x1d000000, 0x20e0, 0x0, 0x0, 0x0, 0x0
    .long 0x0, 0xff000000, 0x0, 0x0, 0x0, 0x0, 0x0, 0x0
    .long 0x0, 0x0, 0x0, 0x0, 0x0, 0x0, 0x0, 0x0
    .long 0x0, 0x0, 0x0, 0x0, 0x0, 0x0, 0x0, 0x0
    .long 0x0, 0x0, 0x0, 0x0, 0x0, 0x0, 0x0, 0x0
    .long 0xdaf000, 0x1f100, 0xfff00000, 0x20091c0, 0xa005000, 0xc00, 0x600c540, 0xf460
    .long 0x80041c0, 0x41c0, 0xeff5ba0, 0xffff5ba0, 0x1000c540, 0x41c0, 0x120041c0, 0xc540
    .long 0x14feb740, 0xfffeb740, 0x16008380, 0xc540, 0x180062a0, 0x20e0, 0x1aff3ac0, 0xffff7c80
    .long 0x1c0041c0, 0xc540, 0x1d000000, 0x20e0, 0x0, 0x0, 0x0, 0x0
    .long 0x0, 0xff000000, 0x0, 0x0, 0x0, 0x0, 0x0, 0x0
    .long 0x0, 0x0, 0x0, 0x0, 0x0, 0x0, 0x0, 0x0
    .long 0x0, 0x0, 0x0, 0x0, 0x0, 0x0, 0x0, 0x0
    .long 0x0, 0x0, 0x0, 0x0, 0x0, 0x0, 0x0, 0x0
    .long 0xdcf000, 0x1f100, 0xfff00000, 0x300b2a0, 0xa005000, 0xc00, 0x600c540, 0xf460
    .long 0x80041c0, 0x41c0, 0xeff5ba0, 0xffff5ba0, 0x1000c540, 0x41c0, 0x120041c0, 0xc540
    .long 0x14feb740, 0xfffeb740, 0x16008380, 0xc540, 0x180062a0, 0x20e0, 0x1aff3ac0, 0xffff7c80
    .long 0x1c0041c0, 0xc540, 0x1d000000, 0x20e0, 0x0, 0x0, 0x0, 0x0
    .long 0x0, 0xff000000, 0x0, 0x0, 0x0, 0x0, 0x0, 0x0
    .long 0x0, 0x0, 0x0, 0x0, 0x0, 0x0, 0x0, 0x0
    .long 0x0, 0x0, 0x0, 0x0, 0x0, 0x0, 0x0, 0x0
    .long 0x0, 0x0, 0x0, 0x0, 0x0, 0x0, 0x0, 0x0
    .long 0xdef000, 0x1f100, 0xfff00000, 0x400d380, 0xa005000, 0xc00, 0x600c540, 0xf460
    .long 0x80041c0, 0x41c0, 0xeff5ba0, 0xffff5ba0, 0x1000c540, 0x41c0, 0x120041c0, 0xc540
    .long 0x14feb740, 0xfffeb740, 0x16008380, 0xc540, 0x180062a0, 0x20e0, 0x1aff3ac0, 0xffff7c80
    .long 0x1c0041c0, 0xc540, 0x1d000000, 0x20e0, 0x0, 0x0, 0x0, 0x0
    .long 0x0, 0xff000000, 0x0, 0x0, 0x0, 0x0, 0x0, 0x0
    .long 0x0, 0x0, 0x0, 0x0, 0x0, 0x0, 0x0, 0x0
    .long 0x0, 0x0, 0x0, 0x0, 0x0, 0x0, 0x0, 0x0
    .long 0x0, 0x0, 0x0, 0x0, 0x0, 0x0, 0x0, 0x0
    .long 0xe0f000, 0x1f100, 0xfff00000, 0x90177e0, 0xa005000, 0x0, 0x600c540, 0xf460
    .long 0x80041c0, 0x41c0, 0xeff5ba0, 0xffff5ba0, 0x1000c540, 0x41c0, 0x120041c0, 0xc540
    .long 0x14feb740, 0xfffeb740, 0x16008380, 0xc540, 0x180062a0, 0x20e0, 0x1aff3ac0, 0xffff7c80
    .long 0x1c0041c0, 0xc540, 0x1d000000, 0x20e0, 0x0, 0x0, 0x0, 0x0
    .long 0x0, 0xff000000, 0x0, 0x0, 0x0, 0x0, 0x0, 0x0
    .long 0x0, 0x0, 0x0, 0x0, 0x0, 0x0, 0x0, 0x0
    .long 0x0, 0x0, 0x0, 0x0, 0x0, 0x0, 0x0, 0x0
    .long 0x0, 0x0, 0x0, 0x0, 0x0, 0x0, 0x0, 0x0
    .long 0xe2f000, 0x1f100, 0xfff00000, 0xa0198c0, 0xa005000, 0x0, 0x600c540, 0xf460
    .long 0x80041c0, 0x41c0, 0xeff5ba0, 0xffff5ba0, 0x1000c540, 0x41c0, 0x120041c0, 0xc540
    .long 0x14feb740, 0xfffeb740, 0x16008380, 0xc540, 0x180062a0, 0x20e0, 0x1aff3ac0, 0xffff7c80
    .long 0x1c0041c0, 0xc540, 0x1d000000, 0x20e0, 0x0, 0x0, 0x0, 0x0
    .long 0x0, 0xff000000, 0x0, 0x0, 0x0, 0x0, 0x0, 0x0
    .long 0x0, 0x0, 0x0, 0x0, 0x0, 0x0, 0x0, 0x0
    .long 0x0, 0x0, 0x0, 0x0, 0x0, 0x0, 0x0, 0x0
    .long 0x0, 0x0, 0x0, 0x0, 0x0, 0x0, 0x0, 0x0
    .long 0xe4f000, 0x1f100, 0xfff00000, 0xb01b9a0, 0xa005000, 0x0, 0x600c540, 0xf460
    .long 0x80041c0, 0x41c0, 0xeff5ba0, 0xffff5ba0, 0x1000c540, 0x41c0, 0x120041c0, 0xc540
    .long 0x14feb740, 0xfffeb740, 0x16008380, 0xc540, 0x180062a0, 0x20e0, 0x1aff3ac0, 0xffff7c80
    .long 0x1c0041c0, 0xc540, 0x1d000000, 0x20e0, 0x0, 0x0, 0x0, 0x0
    .long 0x0, 0xff000000, 0x0, 0x0, 0x0, 0x0, 0x0, 0x0
    .long 0x0, 0x0, 0x0, 0x0, 0x0, 0x0, 0x0, 0x0
    .long 0x0, 0x0, 0x0, 0x0, 0x0, 0x0, 0x0, 0x0
    .long 0x0, 0x0, 0x0, 0x0, 0x0, 0x0, 0x0, 0x0
    .long 0xe6f000, 0x1f100, 0xfff00000, 0xc0070e0, 0xa005000, 0x0, 0x600c540, 0xf460
    .long 0x80041c0, 0x41c0, 0xeff5ba0, 0xffff5ba0, 0x1000c540, 0x41c0, 0x120041c0, 0xc540
    .long 0x14feb740, 0xfffeb740, 0x16008380, 0xc540, 0x180062a0, 0x20e0, 0x1aff3ac0, 0xffff7c80
    .long 0x1c0041c0, 0xc540, 0x1d000000, 0x20e0, 0x0, 0x0, 0x0, 0x0
    .long 0x0, 0xff000000, 0x0, 0x0, 0x0, 0x0, 0x0, 0x0
    .long 0x0, 0x0, 0x0, 0x0, 0x0, 0x0, 0x0, 0x0
    .long 0x0, 0x0, 0x0, 0x0, 0x0, 0x0, 0x0, 0x0
    .long 0x0, 0x0, 0x0, 0x0, 0x0, 0x0, 0x0, 0x0
    .long 0xd8f000, 0xee300a, 0xdaf000, 0x4ee3008, 0xdef000, 0x8ee3008, 0xdaf000, 0xcee300a
    .long 0xdcf000, 0x10ee300a, 0xe2f000, 0x14ee3008, 0x2e6f001, 0x2ee3008, 0x2def004, 0x6ee300a
    .long 0x2e0f010, 0x12ee300a, 0x2e2f040, 0x16ee300a, 0x2e4f080, 0x2ee300a, 0x4e6f0ff, 0xcee300a
    .long 0x6e8f0ff, 0x10ee300a, 0x8eaf0ff, 0x6ee300a, 0xaecf0ff, 0x12ee300a, 0x0, 0x0
    .long 0x0, 0x0, 0x0, 0x0, 0x0, 0x0, 0x0, 0x0
    .long 0x0, 0x0, 0x0, 0x0, 0x0, 0x0, 0x0, 0x0
    .long 0x0, 0x0, 0x0, 0x0, 0x0, 0x0, 0x0, 0x0
    .long 0x0, 0x0, 0x0, 0x0, 0x0, 0x0, 0x0, 0x0
    .long 0xd8f000, 0x2ee3008, 0xdcf000, 0x6ee3008, 0xd8f000, 0xaee3009, 0xdaf000, 0xeee3009
    .long 0xe0f000, 0x12ee3008, 0xe4f000, 0x16ee3008, 0x2dcf002, 0x4ee3009, 0x2def008, 0x8ee3009
    .long 0x2e0f020, 0x14ee3009, 0x2e2f0ff, 0xee3009, 0x4e4f0ff, 0xaee3009, 0x6e6f0ff, 0xeee3009
    .long 0x8e8f0ff, 0x4ee3009, 0xaeaf0ff, 0x8ee3009, 0xcecf0ff, 0x14ee3009, 0x0, 0x0
    .long 0x0, 0x0, 0x0, 0x0, 0x0, 0x0, 0x0, 0x0
    .long 0x0, 0x0, 0x0, 0x0, 0x0, 0x0, 0x0, 0x0
    .long 0x0, 0x0, 0x0, 0x0, 0x0, 0x0, 0x0, 0x0
    .long 0x0, 0x0, 0x0, 0x0, 0x0, 0x0, 0x0, 0x0
    .long 0x0, 0x0, 0x0, 0x0, 0x0, 0xff000000, 0x0, 0x0
    .long 0x0, 0x0, 0x0, 0x0, 0x0, 0x0, 0x0, 0x0
    .long 0x0, 0x0, 0x0, 0x0, 0x0, 0x0, 0x0, 0x0
    .long 0x0, 0x0, 0x0, 0x0, 0x0, 0x0, 0x0, 0x0
    .long 0x0, 0x0, 0x0, 0x0, 0x0, 0x0, 0x0, 0x0
    .long 0x0, 0x0, 0x0, 0x0, 0x0, 0x0, 0x0, 0x0
    .long 0x0, 0x0, 0x0, 0x0, 0x0, 0x0, 0x0, 0x0
    .long 0x0, 0x0, 0x0, 0x0, 0x0, 0x0, 0x0, 0x0
    .long 0x0, 0x0, 0x0, 0x0, 0x0, 0xff000000, 0x0, 0x0
    .long 0x0, 0x0, 0x0, 0x0, 0x0, 0x0, 0x0, 0x0
    .long 0x0, 0x0, 0x0, 0x0, 0x0, 0x0, 0x0, 0x0
    .long 0x0, 0x0, 0x0, 0x0, 0x0, 0x0, 0x0, 0x0
    .long 0x0, 0x0, 0x0, 0x0, 0x0, 0x0, 0x0, 0x0
    .long 0x0, 0x0, 0x0, 0x0, 0x0, 0x0, 0x0, 0x0
    .long 0x0, 0x0, 0x0, 0x0, 0x0, 0x0, 0x0, 0x0
    .long 0x0, 0x0, 0x0, 0x0, 0x0, 0x0, 0x0, 0x0
    .long 0xd8f000, 0x1f100, 0xfff00000, 0x10070e0, 0xa005000, 0xc00, 0x600c540, 0xf460
    .long 0x80041c0, 0x41c0, 0xeff5ba0, 0xffff5ba0, 0x1000c540, 0x41c0, 0x120041c0, 0xc540
    .long 0x14feb740, 0xfffeb740, 0x1600a460, 0xa460, 0x180041c0, 0x41c0, 0x1aff5ba0, 0xffff5ba0
    .long 0x1c00c540, 0x41c0, 0x1d000000, 0xc540, 0x0, 0x0, 0x0, 0x0
    .long 0x0, 0xff000000, 0x0, 0x0, 0x0, 0x0, 0x0, 0x0
    .long 0x0, 0x0, 0x0, 0x0, 0x0, 0x0, 0x0, 0x0
    .long 0x0, 0x0, 0x0, 0x0, 0x0, 0x0, 0x0, 0x0
    .long 0x0, 0x0, 0x0, 0x0, 0x0, 0x0, 0x0, 0x0
    .long 0xdaf000, 0x1f100, 0xfff00000, 0x20091c0, 0xa005000, 0xc00, 0x600c540, 0xf460
    .long 0x80041c0, 0x41c0, 0xeff5ba0, 0xffff5ba0, 0x1000c540, 0x41c0, 0x120041c0, 0xc540
    .long 0x14feb740, 0xfffeb740, 0x1600a460, 0xa460, 0x180041c0, 0x41c0, 0x1aff5ba0, 0xffff5ba0
    .long 0x1c00c540, 0x41c0, 0x1d000000, 0xc540, 0x0, 0x0, 0x0, 0x0
    .long 0x0, 0xff000000, 0x0, 0x0, 0x0, 0x0, 0x0, 0x0
    .long 0x0, 0x0, 0x0, 0x0, 0x0, 0x0, 0x0, 0x0
    .long 0x0, 0x0, 0x0, 0x0, 0x0, 0x0, 0x0, 0x0
    .long 0x0, 0x0, 0x0, 0x0, 0x0, 0x0, 0x0, 0x0
    .long 0xdcf000, 0x1f100, 0xfff00000, 0x300b2a0, 0xa005000, 0xc00, 0x600c540, 0xf460
    .long 0x80041c0, 0x41c0, 0xeff5ba0, 0xffff5ba0, 0x1000c540, 0x41c0, 0x120041c0, 0xc540
    .long 0x14feb740, 0xfffeb740, 0x1600a460, 0xa460, 0x180041c0, 0x41c0, 0x1aff5ba0, 0xffff5ba0
    .long 0x1c00c540, 0x41c0, 0x1d000000, 0xc540, 0x0, 0x0, 0x0, 0x0
    .long 0x0, 0xff000000, 0x0, 0x0, 0x0, 0x0, 0x0, 0x0
    .long 0x0, 0x0, 0x0, 0x0, 0x0, 0x0, 0x0, 0x0
    .long 0x0, 0x0, 0x0, 0x0, 0x0, 0x0, 0x0, 0x0
    .long 0x0, 0x0, 0x0, 0x0, 0x0, 0x0, 0x0, 0x0
    .long 0xdef000, 0x1f100, 0xfff00000, 0x400d380, 0xa005000, 0xc00, 0x600c540, 0xf460
    .long 0x80041c0, 0x41c0, 0xeff5ba0, 0xffff5ba0, 0x1000c540, 0x41c0, 0x120041c0, 0xc540
    .long 0x14feb740, 0xfffeb740, 0x1600a460, 0xa460, 0x180041c0, 0x41c0, 0x1aff5ba0, 0xffff5ba0
    .long 0x1c00c540, 0x41c0, 0x1d000000, 0xc540, 0x0, 0x0, 0x0, 0x0
    .long 0x0, 0xff000000, 0x0, 0x0, 0x0, 0x0, 0x0, 0x0
    .long 0x0, 0x0, 0x0, 0x0, 0x0, 0x0, 0x0, 0x0
    .long 0x0, 0x0, 0x0, 0x0, 0x0, 0x0, 0x0, 0x0
    .long 0x0, 0x0, 0x0, 0x0, 0x0, 0x0, 0x0, 0x0
    .long 0xe0f000, 0x1f100, 0xfff00000, 0x90177e0, 0xa005000, 0x0, 0x600c540, 0xf460
    .long 0x80041c0, 0x41c0, 0xeff5ba0, 0xffff5ba0, 0x1000c540, 0x41c0, 0x120041c0, 0xc540
    .long 0x14feb740, 0xfffeb740, 0x1600a460, 0xa460, 0x180041c0, 0x41c0, 0x1aff5ba0, 0xffff5ba0
    .long 0x1c00c540, 0x41c0, 0x1d000000, 0xc540, 0x0, 0x0, 0x0, 0x0
    .long 0x0, 0xff000000, 0x0, 0x0, 0x0, 0x0, 0x0, 0x0
    .long 0x0, 0x0, 0x0, 0x0, 0x0, 0x0, 0x0, 0x0
    .long 0x0, 0x0, 0x0, 0x0, 0x0, 0x0, 0x0, 0x0
    .long 0x0, 0x0, 0x0, 0x0, 0x0, 0x0, 0x0, 0x0
    .long 0xe2f000, 0x1f100, 0xfff00000, 0xa0198c0, 0xa005000, 0x0, 0x600c540, 0xf460
    .long 0x80041c0, 0x41c0, 0xeff5ba0, 0xffff5ba0, 0x1000c540, 0x41c0, 0x120041c0, 0xc540
    .long 0x14feb740, 0xfffeb740, 0x1600a460, 0xa460, 0x180041c0, 0x41c0, 0x1aff5ba0, 0xffff5ba0
    .long 0x1c00c540, 0x41c0, 0x1d000000, 0xc540, 0x0, 0x0, 0x0, 0x0
    .long 0x0, 0xff000000, 0x0, 0x0, 0x0, 0x0, 0x0, 0x0
    .long 0x0, 0x0, 0x0, 0x0, 0x0, 0x0, 0x0, 0x0
    .long 0x0, 0x0, 0x0, 0x0, 0x0, 0x0, 0x0, 0x0
    .long 0x0, 0x0, 0x0, 0x0, 0x0, 0x0, 0x0, 0x0
    .long 0xe4f000, 0x1f100, 0xfff00000, 0xb01b9a0, 0xa005000, 0x0, 0x600c540, 0xf460
    .long 0x80041c0, 0x41c0, 0xeff5ba0, 0xffff5ba0, 0x1000c540, 0x41c0, 0x120041c0, 0xc540
    .long 0x14feb740, 0xfffeb740, 0x1600a460, 0xa460, 0x180041c0, 0x41c0, 0x1aff5ba0, 0xffff5ba0
    .long 0x1c00c540, 0x41c0, 0x1d000000, 0xc540, 0x0, 0x0, 0x0, 0x0
    .long 0x0, 0xff000000, 0x0, 0x0, 0x0, 0x0, 0x0, 0x0
    .long 0x0, 0x0, 0x0, 0x0, 0x0, 0x0, 0x0, 0x0
    .long 0x0, 0x0, 0x0, 0x0, 0x0, 0x0, 0x0, 0x0
    .long 0x0, 0x0, 0x0, 0x0, 0x0, 0x0, 0x0, 0x0
    .long 0xe6f000, 0x1f100, 0xfff00000, 0xc0070e0, 0xa005000, 0x0, 0x600c540, 0xf460
    .long 0x80041c0, 0x41c0, 0xeff5ba0, 0xffff5ba0, 0x1000c540, 0x41c0, 0x120041c0, 0xc540
    .long 0x14feb740, 0xfffeb740, 0x1600a460, 0xa460, 0x180041c0, 0x41c0, 0x1aff5ba0, 0xffff5ba0
    .long 0x1c00c540, 0x41c0, 0x1d000000, 0xc540, 0x0, 0x0, 0x0, 0x0
    .long 0x0, 0xff000000, 0x0, 0x0, 0x0, 0x0, 0x0, 0x0
    .long 0x0, 0x0, 0x0, 0x0, 0x0, 0x0, 0x0, 0x0
    .long 0x0, 0x0, 0x0, 0x0, 0x0, 0x0, 0x0, 0x0
    .long 0x0, 0x0, 0x0, 0x0, 0x0, 0x0, 0x0, 0x0
.section .rodata,"a"
.p2align 6
.amdhsa_kernel standalone__varlen_attn_packed__ragged_kernel
  .amdhsa_next_free_vgpr 168
  .amdhsa_next_free_sgpr 102
  .amdhsa_accum_offset 168
  .amdhsa_group_segment_fixed_size 0
  .amdhsa_kernarg_size 56
  .amdhsa_user_sgpr_count 2
  .amdhsa_user_sgpr_kernarg_segment_ptr 1
  .amdhsa_system_sgpr_workgroup_id_x 1
.end_amdhsa_kernel
```
